```python
import torch

def _softmax(x, axis=-1):
    return torch.softmax(x, dim=axis)
def _gelu(x):
    return torch.nn.functional.gelu(x, approximate="tanh")
def _silu(x):
    return torch.nn.functional.silu(x)
def _sigmoid(x):
    return torch.sigmoid(x)
def _layernorm(x, axis=-1, eps=1e-5):
    m = x.mean(dim=axis, keepdim=True)
    v = x.var(dim=axis, keepdim=True, unbiased=False)
    return (x - m) / torch.sqrt(v + eps)
def _scatter_add(tgt, idx, src, axis=0):
    return tgt.clone().index_add_(axis, idx, src)
def _segment_sum(src, seg, n):
    out = torch.zeros((n,) + src.shape[1:], dtype=src.dtype)
    return out.index_add_(0, seg, src)
def _pad(x, pw):
    flat = tuple(v for pair in reversed(pw) for v in pair)
    return torch.nn.functional.pad(x, flat)

kernel_name = 'concat_heads__gqa_block_cached__gqa_block_cached__near_ridge'

def setup_inputs():

    _w = (lambda a: (lambda t: t.to(torch.bfloat16) if t.is_floating_point() else t)(torch.as_tensor(a)))
    def _A_setup():
        B, Sq, D = 8, 256, 640
        Hq, Hkv, Sk, Dh = 32, 32, 1024, 128
        assert Hq % Hkv == 0, (Hq, Hkv)
        return {
            "x": _w((lambda *s: torch.randn(*s, dtype=torch.bfloat16) * 0.8)(B, Sq, D)),
            "k_cache": _w((lambda *s: torch.randn(*s, dtype=torch.bfloat16) * 0.8)(B, Hkv, Sk, Dh)),
            "v_cache": _w((lambda *s: torch.randn(*s, dtype=torch.bfloat16) * 0.05)(B, Hkv, Sk, Dh)),
            "wq": _w((lambda *s: torch.randn(*s, dtype=torch.bfloat16) * 0.8)(D, Hq * Dh) * (D ** -0.5)),
            "wo": _w((lambda *s: torch.randn(*s, dtype=torch.bfloat16) * 0.05)(Hq * Dh, D) * ((Hq * Dh) ** -0.5)),
        }
    _A_in = _A_setup()

    def _B_setup():
        B, Sq, D = 8, 256, 640
        Hq, Hkv, Sk, Dh = 32, 32, 1024, 128
        assert Hq % Hkv == 0, (Hq, Hkv)
        return {
            "x": _w((lambda *s: torch.randn(*s, dtype=torch.bfloat16) * 0.8)(B, Sq, D)),
            "k_cache": _w((lambda *s: torch.randn(*s, dtype=torch.bfloat16) * 0.8)(B, Hkv, Sk, Dh)),
            "v_cache": _w((lambda *s: torch.randn(*s, dtype=torch.bfloat16) * 0.05)(B, Hkv, Sk, Dh)),
            "wq": _w((lambda *s: torch.randn(*s, dtype=torch.bfloat16) * 0.8)(D, Hq * Dh) * (D ** -0.5)),
            "wo": _w((lambda *s: torch.randn(*s, dtype=torch.bfloat16) * 0.05)(Hq * Dh, D) * ((Hq * Dh) ** -0.5)),
        }
    _B_in = _B_setup()

    return {
        "A_x": _A_in["x"],
        "A_k_cache": _A_in["k_cache"],
        "A_v_cache": _A_in["v_cache"],
        "A_wq": _A_in["wq"],
        "A_wo": _A_in["wo"],
        "B_x": _B_in["x"],
        "B_k_cache": _B_in["k_cache"],
        "B_v_cache": _B_in["v_cache"],
        "B_wq": _B_in["wq"],
        "B_wo": _B_in["wo"],
    }

def reference(A_x, A_k_cache, A_v_cache, A_wq, A_wo, B_x, B_k_cache, B_v_cache, B_wq, B_wo):
    def _A_ref(x, k_cache, v_cache, wq, wo):
        B, Sq, D = x.shape
        Hq, Dh = 32, 128
        Hkv = k_cache.shape[1]
        rep = Hq // Hkv
        q = (lambda x, *d: x.permute(*d))((x @ wq).reshape(B, Sq, Hq, Dh), 0, 2, 1, 3)
        k = (lambda x, n, axis: torch.repeat_interleave(x, n, dim=axis))(k_cache, rep, axis=1)
        v = (lambda x, n, axis: torch.repeat_interleave(x, n, dim=axis))(v_cache, rep, axis=1)
        scores = torch.einsum("bhqd,bhkd->bhqk", q, k) * (Dh ** -0.5)
        p = _softmax(scores, axis=-1)
        o = torch.einsum("bhqk,bhkd->bhqd", p, v)
        return (lambda x, *d: x.permute(*d))(o, 0, 2, 1, 3).reshape(B, Sq, Hq * Dh) @ wo

    def _B_ref(x, k_cache, v_cache, wq, wo):
        B, Sq, D = x.shape
        Hq, Dh = 32, 128
        Hkv = k_cache.shape[1]
        rep = Hq // Hkv
        q = (lambda x, *d: x.permute(*d))((x @ wq).reshape(B, Sq, Hq, Dh), 0, 2, 1, 3)
        k = (lambda x, n, axis: torch.repeat_interleave(x, n, dim=axis))(k_cache, rep, axis=1)
        v = (lambda x, n, axis: torch.repeat_interleave(x, n, dim=axis))(v_cache, rep, axis=1)
        scores = torch.einsum("bhqd,bhkd->bhqk", q, k) * (Dh ** -0.5)
        p = _softmax(scores, axis=-1)
        o = torch.einsum("bhqk,bhkd->bhqd", p, v)
        return (lambda x, *d: x.permute(*d))(o, 0, 2, 1, 3).reshape(B, Sq, Hq * Dh) @ wo

    a = _A_ref(A_x, A_k_cache, A_v_cache, A_wq, A_wo)
    b = _B_ref(B_x, B_k_cache, B_v_cache, B_wq, B_wo)
    return torch.concatenate([a, b], axis=-1)
```

```asm
; @launch kernel=attn_kernel grid=(256,1,1) block=(256,1,1) lds=163840
.amdgcn_target "amdgcn-amd-amdhsa--gfx950"
.text
.globl attn_kernel
.p2align 8
.type attn_kernel,@function
attn_kernel:
    s_cmp_ge_u32 s2, 256
    s_cbranch_scc1 K1_END
    s_load_dwordx16 s[64:79], s[0:1], 0
    s_load_dwordx4 s[80:83], s[0:1], 64
    s_load_dwordx2 s[94:95], s[0:1], 96
    s_load_dwordx2 s[92:93], s[0:1], 80
    v_lshrrev_b32 v212, 6, v0
    v_and_b32 v204, 63, v0
    v_readfirstlane_b32 s40, v212
    s_and_b32 s96, s2, 7
    s_lshr_b32 s97, s2, 3
    s_lshr_b32 s98, s96, 2
    s_and_b32 s96, s96, 3
    s_lshl_b32 s100, s96, 3
    s_and_b32 s101, s97, 3
    s_lshl_b32 s101, s101, 1
    s_add_u32 s100, s100, s101
    s_lshr_b32 s99, s97, 2
    v_mov_b32 v215, 1073741824
    s_and_b32 s101, s97, 3
    s_lshl_b32 s101, s101, 6
    v_add_u32 v212, s101, v204
    v_mul_u32_u24 v212, 1280, v212
    v_lshrrev_b32 v213, 2, v204
    s_lshl_b32 s101, s99, 3
    v_add_u32 v213, s101, v213
    v_lshlrev_b32 v213, 13, v213
    v_and_b32 v214, 3, v204
    v_lshl_add_u32 v213, v214, 7, v213
    v_cmp_gt_u32 vcc, 32, v204
    s_nop 1
    v_cndmask_b32 v213, v215, v213, vcc
    s_cmp_eq_u32 s40, 0
    s_cselect_b64 vcc, -1, 0
    v_cndmask_b32 v206, v213, v212, vcc
    s_cmp_gt_u32 s40, 1
    s_cselect_b64 vcc, -1, 0
    v_cndmask_b32 v206, v206, v215, vcc
    s_movk_i32 s50, 128
    s_cmp_eq_u32 s40, 0
    s_cselect_b32 s50, s50, 524288
    s_mul_i32 s51, s50, 1
    s_mul_i32 s53, s99, 327680
    s_lshl_b32 s54, s100, 8
    s_mov_b32 s6, 327680
    s_mov_b32 s7, 0x20000
    s_sub_u32 s10, 5242880, s54
    s_mov_b32 s11, 0x20000
    s_mov_b32 s27, 0x20000
    s_waitcnt lgkmcnt(0)
    s_cmp_eq_u32 s98, 0
    s_cselect_b32 s64, s64, s74
    s_cselect_b32 s65, s65, s75
    s_cselect_b32 s70, s70, s80
    s_cselect_b32 s71, s71, s81
    s_cselect_b32 s66, s66, s76
    s_cselect_b32 s67, s67, s77
    s_cselect_b32 s68, s68, s78
    s_cselect_b32 s69, s69, s79
    s_cselect_b32 s72, s72, s82
    s_cselect_b32 s73, s73, s83
    s_add_u32 s4, s64, s53
    s_addc_u32 s5, s65, 0
    s_add_u32 s8, s70, s54
    s_addc_u32 s9, s71, 0
    s_cmp_eq_u32 s40, 0
    s_cselect_b32 s24, s4, s8
    s_cselect_b32 s25, s5, s9
    s_cselect_b32 s26, s6, s10
    s_getpc_b64 s[56:57]
K1_PFBASE:
    v_and_b32 v212, 15, v204
    v_lshlrev_b32 v212, 7, v212
    s_lshl_b32 s58, s97, 11
    v_add_u32 v212, s58, v212
    v_min_u32 v212, K1_END-K1_PFBASE, v212
    global_load_dword v208, v212, s[56:57]
    s_mul_i32 s43, s40, 4104
    s_lshl_b32 s44, s40, 13
    v_lshrrev_b32 v212, 3, v204
    s_lshl_b32 s101, s40, 6
    v_add_u32 v212, s101, v212
    v_mul_u32_u24 v212, 1280, v212
    v_and_b32 v213, 7, v204
    v_lshrrev_b32 v214, 4, v204
    v_xor_b32 v213, v213, v214
    v_lshl_add_u32 v228, v213, 4, v212
    v_xor_b32 v213, 64, v228
    v_add_u32 v229, 9216, v213
    v_add_u32 v230, 18432, v228
    v_add_u32 v231, 27648, v213
    v_add_u32 v232, 40960, v228
    v_add_u32 v233, 50176, v213
    v_add_u32 v234, 59392, v228
    v_add_u32 v235, 68608, v213
    v_lshrrev_b32 v212, 5, v204
    v_and_b32 v213, 31, v204
    v_lshlrev_b32 v214, 2, v212
    v_xor_b32 v213, v213, v214
    v_lshlrev_b32 v213, 4, v213
    s_lshl_b32 s101, s40, 3
    v_add_u32 v212, s101, v212
    v_lshl_add_u32 v236, v212, 13, v213
    v_xor_b32 v213, 128, v236
    v_add_u32 v237, 15360, v213
    v_add_u32 v238, 30720, v236
    v_add_u32 v239, 46080, v213
    s_add_u32 m0, s44, 32640
    s_mov_b32 s53, 0
    buffer_load_dwordx4 v228, s[4:7], s53 offen offset:0 lds
    buffer_load_dwordx4 v229, s[4:7], s53 offen offset:1024 lds
    buffer_load_dwordx4 v230, s[4:7], s53 offen offset:2048 lds
    buffer_load_dwordx4 v231, s[4:7], s53 offen offset:3072 lds
    s_add_u32 m0, s44, 36736
    s_mov_b32 s53, 0
    buffer_load_dwordx4 v232, s[4:7], s53 offen offset:0 lds
    buffer_load_dwordx4 v233, s[4:7], s53 offen offset:1024 lds
    buffer_load_dwordx4 v234, s[4:7], s53 offen offset:2048 lds
    buffer_load_dwordx4 v235, s[4:7], s53 offen offset:3072 lds
    s_add_u32 m0, s43, 65408
    s_mov_b32 s54, 0
    buffer_load_dwordx4 v236, s[8:11], s54 offen offset:0 lds
    buffer_load_dwordx4 v237, s[8:11], s54 offen offset:1024 lds
    buffer_load_dwordx4 v238, s[8:11], s54 offen offset:2048 lds
    buffer_load_dwordx4 v239, s[8:11], s54 offen offset:3072 lds
    s_add_u32 m0, s43, 81824
    s_mov_b32 s54, 262144
    buffer_load_dwordx4 v236, s[8:11], s54 offen offset:0 lds
    buffer_load_dwordx4 v237, s[8:11], s54 offen offset:1024 lds
    buffer_load_dwordx4 v238, s[8:11], s54 offen offset:2048 lds
    buffer_load_dwordx4 v239, s[8:11], s54 offen offset:3072 lds
    buffer_load_dword v208, v206, s[24:27], s51 offen
    s_add_u32 s51, s51, s50
    buffer_load_dword v208, v206, s[24:27], s51 offen
    s_add_u32 s51, s51, s50
    s_lshl_b32 s101, s99, 5
    s_add_u32 s101, s101, s100
    s_lshl_b32 s101, s101, 18
    s_add_u32 s12, s66, s101
    s_addc_u32 s13, s67, 0
    s_mov_b32 s14, 524288
    s_mov_b32 s15, 0x20000
    s_add_u32 s16, s68, s101
    s_addc_u32 s17, s69, 0
    s_mov_b32 s18, 524288
    s_mov_b32 s19, 0x20000
    s_lshl_b32 s101, s98, 3
    s_add_u32 s101, s101, s99
    s_lshl_b32 s101, s101, 21
    s_add_u32 s20, s94, s101
    s_addc_u32 s21, s95, 0
    s_mov_b32 s22, 2097152
    s_mov_b32 s23, 0x20000
    s_lshr_b32 s49, s100, 4
    s_lshl_b32 s49, s49, 19
    s_and_b32 s101, s100, 15
    s_lshl_b32 s101, s101, 14
    s_add_u32 s49, s49, s101
    s_lshl_b32 s101, s96, 5
    s_add_u32 s101, s101, s97
    s_mul_i32 s55, s101, 40960
    s_add_u32 s32, s72, s55
    s_addc_u32 s33, s73, 0
    s_mov_b32 s34, 40960
    s_mov_b32 s35, 0x20000
    s_and_b32 s55, s101, 0x43
    s_bfe_u32 s56, s101, 0x10002
    s_lshl_b32 s56, s56, 5
    s_add_u32 s55, s55, s56
    s_bfe_u32 s56, s101, 0x30003
    s_lshl_b32 s56, s56, 2
    s_add_u32 s101, s55, s56
    s_mul_i32 s101, s101, 10240
    s_mul_i32 s55, s98, 5242880
    s_add_u32 s55, s55, 33554432
    s_add_u32 s55, s55, s101
    s_add_u32 s36, s94, s55
    s_addc_u32 s37, s95, 0
    s_sub_u32 s38, 5242880, s101
    s_mov_b32 s39, 0x20000
    s_lshl_b32 s101, s98, 9
    s_add_u32 s101, s101, 58720256
    v_lshlrev_b32 v209, 3, v204
    v_add_u32 v209, s101, v209
    global_load_dwordx2 v[254:255], v209, s[94:95] sc1
    s_lshl_b32 s101, s98, 3
    s_add_u32 s101, s101, s99
    s_lshl_b32 s101, s101, 2
    s_xor_b32 s55, s96, 2
    s_add_u32 s101, s101, s55
    s_lshl_b32 s101, s101, 2
    s_and_b32 s55, s97, 3
    s_add_u32 s101, s101, s55
    s_lshl_b32 s101, s101, 2
    s_add_u32 s101, s101, s40
    s_mul_i32 s101, s101, 10240
    s_add_u32 s101, s101, 46141440
    v_lshlrev_b32 v219, 4, v204
    v_add_u32 v219, s101, v219
    s_mul_i32 s41, s40, 2112
    s_add_u32 s42, s41, 67584
    s_mov_b32 s48, 0x3e0293ee
    s_mov_b32 s28, 0
    s_mov_b32 s29, 0
    s_mov_b32 s47, 0
    s_mov_b32 s30, 99
    s_mov_b32 s31, 99
    v_and_b32 v212, 15, v204
    v_lshlrev_b32 v212, 7, v212
    v_add_u32 v212, s44, v212
    v_lshrrev_b32 v213, 4, v204
    v_bfe_u32 v214, v204, 1, 3
    v_xor_b32 v213, v213, v214
    v_lshl_add_u32 v212, v213, 4, v212
    v_xor_b32 v213, 0, v212
    v_add_u32 v240, 32640, v213
    v_add_u32 v242, 131072, v213
    v_xor_b32 v213, 64, v212
    v_add_u32 v241, 32640, v213
    v_add_u32 v243, 131072, v213
    v_bfe_u32 v212, v204, 2, 2
    v_lshrrev_b32 v213, 4, v204
    v_mul_u32_u24 v213, 4104, v213
    v_lshl_add_u32 v213, v212, 9, v213
    v_and_b32 v214, 3, v204
    v_lshl_add_u32 v213, v214, 4, v213
    v_add_u32 v213, 65408, v213
    v_xor_b32 v214, 0, v212
    v_lshl_add_u32 v244, v214, 6, v213
    v_xor_b32 v214, 1, v212
    v_lshl_add_u32 v245, v214, 6, v213
    v_xor_b32 v214, 2, v212
    v_lshl_add_u32 v246, v214, 6, v213
    v_xor_b32 v214, 3, v212
    v_lshl_add_u32 v247, v214, 6, v213
    v_lshlrev_b32 v212, 4, v204
    s_lshl_b32 s55, s40, 10
    v_add_u32 v198, s55, v212
    v_add_u32 v199, 4096, v198
    v_add_u32 v200, 24576, v198
    v_add_u32 v201, 23520, v199
    v_add_u32 v202, 8192, v198
    v_add_u32 v203, 7136, v199
    s_lshr_b32 s55, s40, 1
    s_lshl_b32 s55, s55, 20
    s_and_b32 s56, s40, 1
    s_lshl_b32 s56, s56, 13
    s_add_u32 s55, s55, s56
    v_add_u32 v205, s55, v212
    s_lshr_b32 s55, s40, 1
    s_mul_i32 s55, s55, 1310720
    s_and_b32 s56, s40, 1
    s_mul_i32 s56, s56, 5120
    s_add_u32 s55, s55, s56
    v_add_u32 v218, s55, v212
    v_and_b32 v212, 3, v204
    v_bfe_u32 v213, v204, 2, 1
    v_lshl_add_u32 v212, v212, 1, v213
    v_mul_u32_u24 v212, 1056, v212
    v_bfe_u32 v213, v204, 3, 1
    v_lshl_add_u32 v212, v213, 8, v212
    v_lshrrev_b32 v213, 4, v204
    v_lshl_add_u32 v196, v213, 4, v212
    v_bfe_u32 v212, v204, 2, 2
    v_bfe_u32 v213, v204, 4, 1
    v_lshl_add_u32 v212, v212, 1, v213
    v_mul_u32_u24 v212, 1056, v212
    v_lshrrev_b32 v213, 5, v204
    v_lshl_add_u32 v212, v213, 8, v212
    v_and_b32 v213, 3, v204
    v_lshl_add_u32 v212, v213, 3, v212
    v_add_u32 v197, 67584, v212
    s_mul_i32 s55, s40, 10240
    v_add_u32 v212, 0, v204
    v_mul_u32_u24 v213, 1639, v212
    v_lshrrev_b32 v213, 16, v213
    v_mul_u32_u24 v214, 640, v213
    v_lshl_add_u32 v214, v212, 4, v214
    v_add_u32 v214, s55, v214
    v_subrev_u32 v128, 0, v214
    v_add_u32 v212, 64, v204
    v_mul_u32_u24 v213, 1639, v212
    v_lshrrev_b32 v213, 16, v213
    v_mul_u32_u24 v214, 640, v213
    v_lshl_add_u32 v214, v212, 4, v214
    v_add_u32 v214, s55, v214
    v_subrev_u32 v129, 1024, v214
    v_add_u32 v212, 128, v204
    v_mul_u32_u24 v213, 1639, v212
    v_lshrrev_b32 v213, 16, v213
    v_mul_u32_u24 v214, 640, v213
    v_lshl_add_u32 v214, v212, 4, v214
    v_add_u32 v214, s55, v214
    v_subrev_u32 v130, 2048, v214
    v_add_u32 v212, 192, v204
    v_mul_u32_u24 v213, 1639, v212
    v_lshrrev_b32 v213, 16, v213
    v_mul_u32_u24 v214, 640, v213
    v_lshl_add_u32 v214, v212, 4, v214
    v_add_u32 v214, s55, v214
    v_subrev_u32 v131, 3072, v214
    v_add_u32 v212, 256, v204
    v_mul_u32_u24 v213, 1639, v212
    v_lshrrev_b32 v213, 16, v213
    v_mul_u32_u24 v214, 640, v213
    v_lshl_add_u32 v214, v212, 4, v214
    v_add_u32 v214, s55, v214
    v_subrev_u32 v132, 0, v214
    v_lshrrev_b32 v212, 2, v204
    v_mul_u32_u24 v212, 640, v212
    v_and_b32 v213, 3, v204
    v_lshl_add_u32 v212, v213, 3, v212
    s_mul_i32 s55, s40, 160
    v_add_u32 v133, s55, v212
    v_mov_b32 v192, 0x3f803f80
    v_mov_b32 v193, 0x3f803f80
    v_mov_b32 v194, 0x3f803f80
    v_mov_b32 v195, 0x3f803f80
    v_mov_b32 v248, 0xff800000
    v_mov_b32 v249, 0xff800000
    v_mov_b32 v250, 0xff800000
    v_mov_b32 v251, 0xff800000
    s_lshl_b32 s55, s40, 2
    s_add_u32 s55, s55, 135168
    v_mov_b32 v207, s55
    s_waitcnt vmcnt(7)
    s_barrier
    ds_read_b128 a[128:131], v240 offset:0
    ds_read_b128 a[132:135], v240 offset:2048
    ds_read_b128 a[136:139], v240 offset:4096
    ds_read_b128 a[140:143], v240 offset:6144
    ds_read_b64_tr_b16 a[160:161], v244 offset:0
    ds_read_b64_tr_b16 a[162:163], v244 offset:2048
    ds_read_b64_tr_b16 a[164:165], v244 offset:8
    ds_read_b64_tr_b16 a[166:167], v244 offset:2056
    ds_read_b64_tr_b16 a[168:169], v245 offset:0
    ds_read_b64_tr_b16 a[170:171], v245 offset:2048
    ds_read_b64_tr_b16 a[172:173], v245 offset:8
    ds_read_b64_tr_b16 a[174:175], v245 offset:2056
    ds_read_b64_tr_b16 a[176:177], v246 offset:0
    ds_read_b64_tr_b16 a[178:179], v246 offset:2048
    ds_read_b64_tr_b16 a[180:181], v246 offset:8
    ds_read_b64_tr_b16 a[182:183], v246 offset:2056
    ds_read_b64_tr_b16 a[184:185], v247 offset:0
    ds_read_b64_tr_b16 a[186:187], v247 offset:2048
    ds_read_b64_tr_b16 a[188:189], v247 offset:8
    ds_read_b64_tr_b16 a[190:191], v247 offset:2056
    s_waitcnt lgkmcnt(12)
    v_mfma_f32_16x16x32_bf16 v[0:3], a[160:163], a[128:131], 0
    ds_read_b64_tr_b16 a[192:193], v244 offset:256
    v_mfma_f32_16x16x32_bf16 v[4:7], a[160:163], a[132:135], 0
    ds_read_b64_tr_b16 a[194:195], v244 offset:2304
    v_mfma_f32_16x16x32_bf16 v[8:11], a[160:163], a[136:139], 0
    s_add_u32 m0, s44, 131072
    v_mfma_f32_16x16x32_bf16 v[12:15], a[160:163], a[140:143], 0
    ds_read_b64_tr_b16 a[196:197], v244 offset:264
    v_mfma_f32_16x16x32_bf16 v[16:19], a[164:167], a[128:131], 0
    ds_read_b64_tr_b16 a[198:199], v244 offset:2312
    s_mov_b32 s53, 128
    v_mfma_f32_16x16x32_bf16 v[20:23], a[164:167], a[132:135], 0
    v_mfma_f32_16x16x32_bf16 v[24:27], a[164:167], a[136:139], 0
    ds_read_b64_tr_b16 a[200:201], v245 offset:256
    buffer_load_dwordx4 v228, s[4:7], s53 offen offset:0 lds
    v_mfma_f32_16x16x32_bf16 v[28:31], a[164:167], a[140:143], 0
    ds_read_b64_tr_b16 a[202:203], v245 offset:2304
    s_waitcnt lgkmcnt(14)
    v_mfma_f32_16x16x32_bf16 v[32:35], a[168:171], a[128:131], 0
    v_mfma_f32_16x16x32_bf16 v[36:39], a[168:171], a[132:135], 0
    ds_read_b64_tr_b16 a[204:205], v245 offset:264
    buffer_load_dwordx4 v229, s[4:7], s53 offen offset:1024 lds
    v_mfma_f32_16x16x32_bf16 v[40:43], a[168:171], a[136:139], 0
    ds_read_b64_tr_b16 a[206:207], v245 offset:2312
    v_mfma_f32_16x16x32_bf16 v[44:47], a[168:171], a[140:143], 0
    buffer_load_dwordx4 v230, s[4:7], s53 offen offset:2048 lds
    v_mfma_f32_16x16x32_bf16 v[48:51], a[172:175], a[128:131], 0
    ds_read_b64_tr_b16 a[208:209], v246 offset:256
    v_mfma_f32_16x16x32_bf16 v[52:55], a[172:175], a[132:135], 0
    ds_read_b64_tr_b16 a[210:211], v246 offset:2304
    buffer_load_dwordx4 v231, s[4:7], s53 offen offset:3072 lds
    v_mfma_f32_16x16x32_bf16 v[56:59], a[172:175], a[136:139], 0
    v_mfma_f32_16x16x32_bf16 v[60:63], a[172:175], a[140:143], 0
    ds_read_b64_tr_b16 a[212:213], v246 offset:264
    s_waitcnt lgkmcnt(15)
    v_mfma_f32_16x16x32_bf16 v[64:67], a[176:179], a[128:131], 0
    ds_read_b64_tr_b16 a[214:215], v246 offset:2312
    s_add_u32 m0, s44, 135168
    v_mfma_f32_16x16x32_bf16 v[68:71], a[176:179], a[132:135], 0
    v_mfma_f32_16x16x32_bf16 v[72:75], a[176:179], a[136:139], 0
    ds_read_b64_tr_b16 a[216:217], v247 offset:256
    s_mov_b32 s53, 128
    v_mfma_f32_16x16x32_bf16 v[76:79], a[176:179], a[140:143], 0
    ds_read_b64_tr_b16 a[218:219], v247 offset:2304
    v_mfma_f32_16x16x32_bf16 v[80:83], a[180:183], a[128:131], 0
    v_mfma_f32_16x16x32_bf16 v[84:87], a[180:183], a[132:135], 0
    ds_read_b64_tr_b16 a[220:221], v247 offset:264
    buffer_load_dwordx4 v232, s[4:7], s53 offen offset:0 lds
    v_mfma_f32_16x16x32_bf16 v[88:91], a[180:183], a[136:139], 0
    ds_read_b64_tr_b16 a[222:223], v247 offset:2312
    v_mfma_f32_16x16x32_bf16 v[92:95], a[180:183], a[140:143], 0
    buffer_load_dwordx4 v233, s[4:7], s53 offen offset:1024 lds
    s_waitcnt lgkmcnt(15)
    v_mfma_f32_16x16x32_bf16 v[96:99], a[184:187], a[128:131], 0
    v_mfma_f32_16x16x32_bf16 v[100:103], a[184:187], a[132:135], 0
    v_mfma_f32_16x16x32_bf16 v[104:107], a[184:187], a[136:139], 0
    buffer_load_dwordx4 v234, s[4:7], s53 offen offset:2048 lds
    v_mfma_f32_16x16x32_bf16 v[108:111], a[184:187], a[140:143], 0
    v_mfma_f32_16x16x32_bf16 v[112:115], a[188:191], a[128:131], 0
    buffer_load_dwordx4 v235, s[4:7], s53 offen offset:3072 lds
    v_mfma_f32_16x16x32_bf16 v[116:119], a[188:191], a[132:135], 0
    v_mfma_f32_16x16x32_bf16 v[120:123], a[188:191], a[136:139], 0
    v_mfma_f32_16x16x32_bf16 v[124:127], a[188:191], a[140:143], 0
    s_waitcnt vmcnt(11) lgkmcnt(0)
    s_barrier
    v_mfma_f32_16x16x32_bf16 a[0:3], a[192:195], a[128:131], 0
    ds_read_b128 a[144:147], v241 offset:0
    v_mfma_f32_16x16x32_bf16 a[4:7], a[192:195], a[132:135], 0
    ds_read_b128 a[148:151], v241 offset:2048
    v_mfma_f32_16x16x32_bf16 a[8:11], a[192:195], a[136:139], 0
    ds_read_b128 a[152:155], v241 offset:4096
    s_add_u32 m0, s43, 98240
    v_mfma_f32_16x16x32_bf16 a[12:15], a[192:195], a[140:143], 0
    v_mfma_f32_16x16x32_bf16 a[16:19], a[196:199], a[128:131], 0
    ds_read_b128 a[156:159], v241 offset:6144
    s_mov_b32 s54, 524288
    v_mfma_f32_16x16x32_bf16 a[20:23], a[196:199], a[132:135], 0
    ds_read_b64_tr_b16 a[160:161], v244 offset:16416
    v_mfma_f32_16x16x32_bf16 a[24:27], a[196:199], a[136:139], 0
    buffer_load_dwordx4 v236, s[8:11], s54 offen offset:0 lds
    v_mfma_f32_16x16x32_bf16 a[28:31], a[196:199], a[140:143], 0
    ds_read_b64_tr_b16 a[162:163], v244 offset:18464
    v_mfma_f32_16x16x32_bf16 a[32:35], a[200:203], a[128:131], 0
    ds_read_b64_tr_b16 a[164:165], v244 offset:16424
    v_mfma_f32_16x16x32_bf16 a[36:39], a[200:203], a[132:135], 0
    ds_read_b64_tr_b16 a[166:167], v244 offset:18472
    buffer_load_dwordx4 v237, s[8:11], s54 offen offset:1024 lds
    v_mfma_f32_16x16x32_bf16 a[40:43], a[200:203], a[136:139], 0
    v_mfma_f32_16x16x32_bf16 a[44:47], a[200:203], a[140:143], 0
    ds_read_b64_tr_b16 a[168:169], v245 offset:16416
    buffer_load_dwordx4 v238, s[8:11], s54 offen offset:2048 lds
    v_mfma_f32_16x16x32_bf16 a[48:51], a[204:207], a[128:131], 0
    ds_read_b64_tr_b16 a[170:171], v245 offset:18464
    v_mfma_f32_16x16x32_bf16 a[52:55], a[204:207], a[132:135], 0
    buffer_load_dwordx4 v239, s[8:11], s54 offen offset:3072 lds
    v_mfma_f32_16x16x32_bf16 a[56:59], a[204:207], a[136:139], 0
    ds_read_b64_tr_b16 a[172:173], v245 offset:16424
    v_mfma_f32_16x16x32_bf16 a[60:63], a[204:207], a[140:143], 0
    ds_read_b64_tr_b16 a[174:175], v245 offset:18472
    v_mfma_f32_16x16x32_bf16 a[64:67], a[208:211], a[128:131], 0
    ds_read_b64_tr_b16 a[176:177], v246 offset:16416
    v_mfma_f32_16x16x32_bf16 a[68:71], a[208:211], a[132:135], 0
    v_mfma_f32_16x16x32_bf16 a[72:75], a[208:211], a[136:139], 0
    ds_read_b64_tr_b16 a[178:179], v246 offset:18464
    v_mfma_f32_16x16x32_bf16 a[76:79], a[208:211], a[140:143], 0
    ds_read_b64_tr_b16 a[180:181], v246 offset:16424
    v_mfma_f32_16x16x32_bf16 a[80:83], a[212:215], a[128:131], 0
    v_mfma_f32_16x16x32_bf16 a[84:87], a[212:215], a[132:135], 0
    ds_read_b64_tr_b16 a[182:183], v246 offset:18472
    v_mfma_f32_16x16x32_bf16 a[88:91], a[212:215], a[136:139], 0
    ds_read_b64_tr_b16 a[184:185], v247 offset:16416
    v_mfma_f32_16x16x32_bf16 a[92:95], a[212:215], a[140:143], 0
    ds_read_b64_tr_b16 a[186:187], v247 offset:18464
    v_mfma_f32_16x16x32_bf16 a[96:99], a[216:219], a[128:131], 0
    v_mfma_f32_16x16x32_bf16 a[100:103], a[216:219], a[132:135], 0
    ds_read_b64_tr_b16 a[188:189], v247 offset:16424
    v_mfma_f32_16x16x32_bf16 a[104:107], a[216:219], a[136:139], 0
    ds_read_b64_tr_b16 a[190:191], v247 offset:18472
    v_mfma_f32_16x16x32_bf16 a[108:111], a[216:219], a[140:143], 0
    v_mfma_f32_16x16x32_bf16 a[112:115], a[220:223], a[128:131], 0
    v_mfma_f32_16x16x32_bf16 a[116:119], a[220:223], a[132:135], 0
    v_mfma_f32_16x16x32_bf16 a[120:123], a[220:223], a[136:139], 0
    v_mfma_f32_16x16x32_bf16 a[124:127], a[220:223], a[140:143], 0
    s_waitcnt lgkmcnt(12)
    v_mfma_f32_16x16x32_bf16 v[0:3], a[160:163], a[144:147], v[0:3]
    ds_read_b64_tr_b16 a[192:193], v244 offset:16672
    v_mfma_f32_16x16x32_bf16 v[4:7], a[160:163], a[148:151], v[4:7]
    ds_read_b64_tr_b16 a[194:195], v244 offset:18720
    v_mfma_f32_16x16x32_bf16 v[8:11], a[160:163], a[152:155], v[8:11]
    s_add_u32 m0, s43, 114656
    v_mfma_f32_16x16x32_bf16 v[12:15], a[160:163], a[156:159], v[12:15]
    ds_read_b64_tr_b16 a[196:197], v244 offset:16680
    v_mfma_f32_16x16x32_bf16 v[16:19], a[164:167], a[144:147], v[16:19]
    ds_read_b64_tr_b16 a[198:199], v244 offset:18728
    s_mov_b32 s54, 786432
    v_mfma_f32_16x16x32_bf16 v[20:23], a[164:167], a[148:151], v[20:23]
    v_mfma_f32_16x16x32_bf16 v[24:27], a[164:167], a[152:155], v[24:27]
    ds_read_b64_tr_b16 a[200:201], v245 offset:16672
    buffer_load_dwordx4 v236, s[8:11], s54 offen offset:0 lds
    v_mfma_f32_16x16x32_bf16 v[28:31], a[164:167], a[156:159], v[28:31]
    ds_read_b64_tr_b16 a[202:203], v245 offset:18720
    s_waitcnt lgkmcnt(14)
    v_mfma_f32_16x16x32_bf16 v[32:35], a[168:171], a[144:147], v[32:35]
    v_mfma_f32_16x16x32_bf16 v[36:39], a[168:171], a[148:151], v[36:39]
    ds_read_b64_tr_b16 a[204:205], v245 offset:16680
    buffer_load_dwordx4 v237, s[8:11], s54 offen offset:1024 lds
    v_mfma_f32_16x16x32_bf16 v[40:43], a[168:171], a[152:155], v[40:43]
    ds_read_b64_tr_b16 a[206:207], v245 offset:18728
    v_mfma_f32_16x16x32_bf16 v[44:47], a[168:171], a[156:159], v[44:47]
    buffer_load_dwordx4 v238, s[8:11], s54 offen offset:2048 lds
    v_mfma_f32_16x16x32_bf16 v[48:51], a[172:175], a[144:147], v[48:51]
    ds_read_b64_tr_b16 a[208:209], v246 offset:16672
    v_mfma_f32_16x16x32_bf16 v[52:55], a[172:175], a[148:151], v[52:55]
    ds_read_b64_tr_b16 a[210:211], v246 offset:18720
    buffer_load_dwordx4 v239, s[8:11], s54 offen offset:3072 lds
    v_mfma_f32_16x16x32_bf16 v[56:59], a[172:175], a[152:155], v[56:59]
    v_mfma_f32_16x16x32_bf16 v[60:63], a[172:175], a[156:159], v[60:63]
    ds_read_b64_tr_b16 a[212:213], v246 offset:16680
    s_waitcnt lgkmcnt(15)
    v_mfma_f32_16x16x32_bf16 v[64:67], a[176:179], a[144:147], v[64:67]
    ds_read_b64_tr_b16 a[214:215], v246 offset:18728
    buffer_load_dword v208, v206, s[24:27], s51 offen
    v_mfma_f32_16x16x32_bf16 v[68:71], a[176:179], a[148:151], v[68:71]
    v_mfma_f32_16x16x32_bf16 v[72:75], a[176:179], a[152:155], v[72:75]
    ds_read_b64_tr_b16 a[216:217], v247 offset:16672
    v_mfma_f32_16x16x32_bf16 v[76:79], a[176:179], a[156:159], v[76:79]
    ds_read_b64_tr_b16 a[218:219], v247 offset:18720
    v_mfma_f32_16x16x32_bf16 v[80:83], a[180:183], a[144:147], v[80:83]
    v_mfma_f32_16x16x32_bf16 v[84:87], a[180:183], a[148:151], v[84:87]
    ds_read_b64_tr_b16 a[220:221], v247 offset:16680
    v_mfma_f32_16x16x32_bf16 v[88:91], a[180:183], a[152:155], v[88:91]
    ds_read_b64_tr_b16 a[222:223], v247 offset:18728
    v_mfma_f32_16x16x32_bf16 v[92:95], a[180:183], a[156:159], v[92:95]
    s_add_u32 s51, s51, s50
    s_waitcnt lgkmcnt(15)
    v_mfma_f32_16x16x32_bf16 v[96:99], a[184:187], a[144:147], v[96:99]
    v_mfma_f32_16x16x32_bf16 v[100:103], a[184:187], a[148:151], v[100:103]
    v_mfma_f32_16x16x32_bf16 v[104:107], a[184:187], a[152:155], v[104:107]
    v_mfma_f32_16x16x32_bf16 v[108:111], a[184:187], a[156:159], v[108:111]
    v_mfma_f32_16x16x32_bf16 v[112:115], a[188:191], a[144:147], v[112:115]
    v_mfma_f32_16x16x32_bf16 v[116:119], a[188:191], a[148:151], v[116:119]
    v_mfma_f32_16x16x32_bf16 v[120:123], a[188:191], a[152:155], v[120:123]
    v_mfma_f32_16x16x32_bf16 v[124:127], a[188:191], a[156:159], v[124:127]
    s_waitcnt vmcnt(5) lgkmcnt(0)
    s_barrier
    v_mfma_f32_16x16x32_bf16 a[0:3], a[192:195], a[144:147], a[0:3]
    ds_read_b128 a[128:131], v242 offset:0
    v_mfma_f32_16x16x32_bf16 a[4:7], a[192:195], a[148:151], a[4:7]
    ds_read_b128 a[132:135], v242 offset:2048
    v_mfma_f32_16x16x32_bf16 a[8:11], a[192:195], a[152:155], a[8:11]
    ds_read_b128 a[136:139], v242 offset:4096
    v_mfma_f32_16x16x32_bf16 a[12:15], a[192:195], a[156:159], a[12:15]
    v_mfma_f32_16x16x32_bf16 a[16:19], a[196:199], a[144:147], a[16:19]
    ds_read_b128 a[140:143], v242 offset:6144
    v_mfma_f32_16x16x32_bf16 a[20:23], a[196:199], a[148:151], a[20:23]
    ds_read_b64_tr_b16 a[160:161], v244 offset:32832
    v_mfma_f32_16x16x32_bf16 a[24:27], a[196:199], a[152:155], a[24:27]
    v_mfma_f32_16x16x32_bf16 a[28:31], a[196:199], a[156:159], a[28:31]
    ds_read_b64_tr_b16 a[162:163], v244 offset:34880
    v_mfma_f32_16x16x32_bf16 a[32:35], a[200:203], a[144:147], a[32:35]
    ds_read_b64_tr_b16 a[164:165], v244 offset:32840
    v_mfma_f32_16x16x32_bf16 a[36:39], a[200:203], a[148:151], a[36:39]
    ds_read_b64_tr_b16 a[166:167], v244 offset:34888
    v_mfma_f32_16x16x32_bf16 a[40:43], a[200:203], a[152:155], a[40:43]
    v_mfma_f32_16x16x32_bf16 a[44:47], a[200:203], a[156:159], a[44:47]
    ds_read_b64_tr_b16 a[168:169], v245 offset:32832
    v_mfma_f32_16x16x32_bf16 a[48:51], a[204:207], a[144:147], a[48:51]
    ds_read_b64_tr_b16 a[170:171], v245 offset:34880
    v_mfma_f32_16x16x32_bf16 a[52:55], a[204:207], a[148:151], a[52:55]
    v_mfma_f32_16x16x32_bf16 a[56:59], a[204:207], a[152:155], a[56:59]
    ds_read_b64_tr_b16 a[172:173], v245 offset:32840
    v_mfma_f32_16x16x32_bf16 a[60:63], a[204:207], a[156:159], a[60:63]
    ds_read_b64_tr_b16 a[174:175], v245 offset:34888
    v_mfma_f32_16x16x32_bf16 a[64:67], a[208:211], a[144:147], a[64:67]
    ds_read_b64_tr_b16 a[176:177], v246 offset:32832
    s_add_u32 m0, s43, 65408
    v_mfma_f32_16x16x32_bf16 a[68:71], a[208:211], a[148:151], a[68:71]
    v_mfma_f32_16x16x32_bf16 a[72:75], a[208:211], a[152:155], a[72:75]
    ds_read_b64_tr_b16 a[178:179], v246 offset:34880
    s_mov_b32 s54, 1048576
    v_mfma_f32_16x16x32_bf16 a[76:79], a[208:211], a[156:159], a[76:79]
    ds_read_b64_tr_b16 a[180:181], v246 offset:32840
    v_mfma_f32_16x16x32_bf16 a[80:83], a[212:215], a[144:147], a[80:83]
    v_mfma_f32_16x16x32_bf16 a[84:87], a[212:215], a[148:151], a[84:87]
    ds_read_b64_tr_b16 a[182:183], v246 offset:34888
    buffer_load_dwordx4 v236, s[8:11], s54 offen offset:0 lds
    v_mfma_f32_16x16x32_bf16 a[88:91], a[212:215], a[152:155], a[88:91]
    ds_read_b64_tr_b16 a[184:185], v247 offset:32832
    v_mfma_f32_16x16x32_bf16 a[92:95], a[212:215], a[156:159], a[92:95]
    ds_read_b64_tr_b16 a[186:187], v247 offset:34880
    v_mfma_f32_16x16x32_bf16 a[96:99], a[216:219], a[144:147], a[96:99]
    buffer_load_dwordx4 v237, s[8:11], s54 offen offset:1024 lds
    v_mfma_f32_16x16x32_bf16 a[100:103], a[216:219], a[148:151], a[100:103]
    ds_read_b64_tr_b16 a[188:189], v247 offset:32840
    v_mfma_f32_16x16x32_bf16 a[104:107], a[216:219], a[152:155], a[104:107]
    ds_read_b64_tr_b16 a[190:191], v247 offset:34888
    buffer_load_dwordx4 v238, s[8:11], s54 offen offset:2048 lds
    v_mfma_f32_16x16x32_bf16 a[108:111], a[216:219], a[156:159], a[108:111]
    v_mfma_f32_16x16x32_bf16 a[112:115], a[220:223], a[144:147], a[112:115]
    v_mfma_f32_16x16x32_bf16 a[116:119], a[220:223], a[148:151], a[116:119]
    buffer_load_dwordx4 v239, s[8:11], s54 offen offset:3072 lds
    v_mfma_f32_16x16x32_bf16 a[120:123], a[220:223], a[152:155], a[120:123]
    v_mfma_f32_16x16x32_bf16 a[124:127], a[220:223], a[156:159], a[124:127]
    s_waitcnt lgkmcnt(12)
    v_mfma_f32_16x16x32_bf16 v[0:3], a[160:163], a[128:131], v[0:3]
    ds_read_b64_tr_b16 a[192:193], v244 offset:33088
    v_mfma_f32_16x16x32_bf16 v[4:7], a[160:163], a[132:135], v[4:7]
    ds_read_b64_tr_b16 a[194:195], v244 offset:35136
    v_mfma_f32_16x16x32_bf16 v[8:11], a[160:163], a[136:139], v[8:11]
    s_add_u32 m0, s44, 32640
    v_mfma_f32_16x16x32_bf16 v[12:15], a[160:163], a[140:143], v[12:15]
    ds_read_b64_tr_b16 a[196:197], v244 offset:33096
    v_mfma_f32_16x16x32_bf16 v[16:19], a[164:167], a[128:131], v[16:19]
    ds_read_b64_tr_b16 a[198:199], v244 offset:35144
    s_mov_b32 s53, 256
    v_mfma_f32_16x16x32_bf16 v[20:23], a[164:167], a[132:135], v[20:23]
    v_mfma_f32_16x16x32_bf16 v[24:27], a[164:167], a[136:139], v[24:27]
    ds_read_b64_tr_b16 a[200:201], v245 offset:33088
    buffer_load_dwordx4 v228, s[4:7], s53 offen offset:0 lds
    v_mfma_f32_16x16x32_bf16 v[28:31], a[164:167], a[140:143], v[28:31]
    ds_read_b64_tr_b16 a[202:203], v245 offset:35136
    s_waitcnt lgkmcnt(14)
    v_mfma_f32_16x16x32_bf16 v[32:35], a[168:171], a[128:131], v[32:35]
    v_mfma_f32_16x16x32_bf16 v[36:39], a[168:171], a[132:135], v[36:39]
    ds_read_b64_tr_b16 a[204:205], v245 offset:33096
    buffer_load_dwordx4 v229, s[4:7], s53 offen offset:1024 lds
    v_mfma_f32_16x16x32_bf16 v[40:43], a[168:171], a[136:139], v[40:43]
    ds_read_b64_tr_b16 a[206:207], v245 offset:35144
    v_mfma_f32_16x16x32_bf16 v[44:47], a[168:171], a[140:143], v[44:47]
    buffer_load_dwordx4 v230, s[4:7], s53 offen offset:2048 lds
    v_mfma_f32_16x16x32_bf16 v[48:51], a[172:175], a[128:131], v[48:51]
    ds_read_b64_tr_b16 a[208:209], v246 offset:33088
    v_mfma_f32_16x16x32_bf16 v[52:55], a[172:175], a[132:135], v[52:55]
    ds_read_b64_tr_b16 a[210:211], v246 offset:35136
    buffer_load_dwordx4 v231, s[4:7], s53 offen offset:3072 lds
    v_mfma_f32_16x16x32_bf16 v[56:59], a[172:175], a[136:139], v[56:59]
    v_mfma_f32_16x16x32_bf16 v[60:63], a[172:175], a[140:143], v[60:63]
    ds_read_b64_tr_b16 a[212:213], v246 offset:33096
    s_waitcnt lgkmcnt(15)
    v_mfma_f32_16x16x32_bf16 v[64:67], a[176:179], a[128:131], v[64:67]
    ds_read_b64_tr_b16 a[214:215], v246 offset:35144
    s_add_u32 m0, s44, 36736
    v_mfma_f32_16x16x32_bf16 v[68:71], a[176:179], a[132:135], v[68:71]
    v_mfma_f32_16x16x32_bf16 v[72:75], a[176:179], a[136:139], v[72:75]
    ds_read_b64_tr_b16 a[216:217], v247 offset:33088
    s_mov_b32 s53, 256
    v_mfma_f32_16x16x32_bf16 v[76:79], a[176:179], a[140:143], v[76:79]
    ds_read_b64_tr_b16 a[218:219], v247 offset:35136
    v_mfma_f32_16x16x32_bf16 v[80:83], a[180:183], a[128:131], v[80:83]
    v_mfma_f32_16x16x32_bf16 v[84:87], a[180:183], a[132:135], v[84:87]
    ds_read_b64_tr_b16 a[220:221], v247 offset:33096
    buffer_load_dwordx4 v232, s[4:7], s53 offen offset:0 lds
    v_mfma_f32_16x16x32_bf16 v[88:91], a[180:183], a[136:139], v[88:91]
    ds_read_b64_tr_b16 a[222:223], v247 offset:35144
    v_mfma_f32_16x16x32_bf16 v[92:95], a[180:183], a[140:143], v[92:95]
    buffer_load_dwordx4 v233, s[4:7], s53 offen offset:1024 lds
    s_waitcnt lgkmcnt(15)
    v_mfma_f32_16x16x32_bf16 v[96:99], a[184:187], a[128:131], v[96:99]
    v_mfma_f32_16x16x32_bf16 v[100:103], a[184:187], a[132:135], v[100:103]
    v_mfma_f32_16x16x32_bf16 v[104:107], a[184:187], a[136:139], v[104:107]
    buffer_load_dwordx4 v234, s[4:7], s53 offen offset:2048 lds
    v_mfma_f32_16x16x32_bf16 v[108:111], a[184:187], a[140:143], v[108:111]
    v_mfma_f32_16x16x32_bf16 v[112:115], a[188:191], a[128:131], v[112:115]
    buffer_load_dwordx4 v235, s[4:7], s53 offen offset:3072 lds
    v_mfma_f32_16x16x32_bf16 v[116:119], a[188:191], a[132:135], v[116:119]
    v_mfma_f32_16x16x32_bf16 v[120:123], a[188:191], a[136:139], v[120:123]
    v_mfma_f32_16x16x32_bf16 v[124:127], a[188:191], a[140:143], v[124:127]
    s_waitcnt vmcnt(13) lgkmcnt(0)
    s_barrier
    v_mfma_f32_16x16x32_bf16 a[0:3], a[192:195], a[128:131], a[0:3]
    ds_read_b128 a[144:147], v243 offset:0
    v_mfma_f32_16x16x32_bf16 a[4:7], a[192:195], a[132:135], a[4:7]
    ds_read_b128 a[148:151], v243 offset:2048
    v_mfma_f32_16x16x32_bf16 a[8:11], a[192:195], a[136:139], a[8:11]
    ds_read_b128 a[152:155], v243 offset:4096
    s_add_u32 m0, s43, 81824
    v_mfma_f32_16x16x32_bf16 a[12:15], a[192:195], a[140:143], a[12:15]
    v_mfma_f32_16x16x32_bf16 a[16:19], a[196:199], a[128:131], a[16:19]
    ds_read_b128 a[156:159], v243 offset:6144
    s_mov_b32 s54, 1310720
    v_mfma_f32_16x16x32_bf16 a[20:23], a[196:199], a[132:135], a[20:23]
    ds_read_b64_tr_b16 a[160:161], v244 offset:49248
    v_mfma_f32_16x16x32_bf16 a[24:27], a[196:199], a[136:139], a[24:27]
    buffer_load_dwordx4 v236, s[8:11], s54 offen offset:0 lds
    v_mfma_f32_16x16x32_bf16 a[28:31], a[196:199], a[140:143], a[28:31]
    ds_read_b64_tr_b16 a[162:163], v244 offset:51296
    v_mfma_f32_16x16x32_bf16 a[32:35], a[200:203], a[128:131], a[32:35]
    ds_read_b64_tr_b16 a[164:165], v244 offset:49256
    v_mfma_f32_16x16x32_bf16 a[36:39], a[200:203], a[132:135], a[36:39]
    ds_read_b64_tr_b16 a[166:167], v244 offset:51304
    buffer_load_dwordx4 v237, s[8:11], s54 offen offset:1024 lds
    v_mfma_f32_16x16x32_bf16 a[40:43], a[200:203], a[136:139], a[40:43]
    v_mfma_f32_16x16x32_bf16 a[44:47], a[200:203], a[140:143], a[44:47]
    ds_read_b64_tr_b16 a[168:169], v245 offset:49248
    buffer_load_dwordx4 v238, s[8:11], s54 offen offset:2048 lds
    v_mfma_f32_16x16x32_bf16 a[48:51], a[204:207], a[128:131], a[48:51]
    ds_read_b64_tr_b16 a[170:171], v245 offset:51296
    v_mfma_f32_16x16x32_bf16 a[52:55], a[204:207], a[132:135], a[52:55]
    buffer_load_dwordx4 v239, s[8:11], s54 offen offset:3072 lds
    v_mfma_f32_16x16x32_bf16 a[56:59], a[204:207], a[136:139], a[56:59]
    ds_read_b64_tr_b16 a[172:173], v245 offset:49256
    v_mfma_f32_16x16x32_bf16 a[60:63], a[204:207], a[140:143], a[60:63]
    ds_read_b64_tr_b16 a[174:175], v245 offset:51304
    v_mfma_f32_16x16x32_bf16 a[64:67], a[208:211], a[128:131], a[64:67]
    ds_read_b64_tr_b16 a[176:177], v246 offset:49248
    buffer_load_dword v208, v206, s[24:27], s51 offen
    v_mfma_f32_16x16x32_bf16 a[68:71], a[208:211], a[132:135], a[68:71]
    v_mfma_f32_16x16x32_bf16 a[72:75], a[208:211], a[136:139], a[72:75]
    ds_read_b64_tr_b16 a[178:179], v246 offset:51296
    v_mfma_f32_16x16x32_bf16 a[76:79], a[208:211], a[140:143], a[76:79]
    ds_read_b64_tr_b16 a[180:181], v246 offset:49256
    v_mfma_f32_16x16x32_bf16 a[80:83], a[212:215], a[128:131], a[80:83]
    v_mfma_f32_16x16x32_bf16 a[84:87], a[212:215], a[132:135], a[84:87]
    ds_read_b64_tr_b16 a[182:183], v246 offset:51304
    v_mfma_f32_16x16x32_bf16 a[88:91], a[212:215], a[136:139], a[88:91]
    ds_read_b64_tr_b16 a[184:185], v247 offset:49248
    v_mfma_f32_16x16x32_bf16 a[92:95], a[212:215], a[140:143], a[92:95]
    ds_read_b64_tr_b16 a[186:187], v247 offset:51296
    v_mfma_f32_16x16x32_bf16 a[96:99], a[216:219], a[128:131], a[96:99]
    s_add_u32 s51, s51, s50
    v_mfma_f32_16x16x32_bf16 a[100:103], a[216:219], a[132:135], a[100:103]
    ds_read_b64_tr_b16 a[188:189], v247 offset:49256
    v_mfma_f32_16x16x32_bf16 a[104:107], a[216:219], a[136:139], a[104:107]
    ds_read_b64_tr_b16 a[190:191], v247 offset:51304
    v_mfma_f32_16x16x32_bf16 a[108:111], a[216:219], a[140:143], a[108:111]
    v_mfma_f32_16x16x32_bf16 a[112:115], a[220:223], a[128:131], a[112:115]
    v_mfma_f32_16x16x32_bf16 a[116:119], a[220:223], a[132:135], a[116:119]
    v_mfma_f32_16x16x32_bf16 a[120:123], a[220:223], a[136:139], a[120:123]
    v_mfma_f32_16x16x32_bf16 a[124:127], a[220:223], a[140:143], a[124:127]
    s_waitcnt lgkmcnt(12)
    v_mfma_f32_16x16x32_bf16 v[0:3], a[160:163], a[144:147], v[0:3]
    ds_read_b64_tr_b16 a[192:193], v244 offset:49504
    v_mfma_f32_16x16x32_bf16 v[4:7], a[160:163], a[148:151], v[4:7]
    ds_read_b64_tr_b16 a[194:195], v244 offset:51552
    v_mfma_f32_16x16x32_bf16 v[8:11], a[160:163], a[152:155], v[8:11]
    v_mfma_f32_16x16x32_bf16 v[12:15], a[160:163], a[156:159], v[12:15]
    ds_read_b64_tr_b16 a[196:197], v244 offset:49512
    v_mfma_f32_16x16x32_bf16 v[16:19], a[164:167], a[144:147], v[16:19]
    ds_read_b64_tr_b16 a[198:199], v244 offset:51560
    v_mfma_f32_16x16x32_bf16 v[20:23], a[164:167], a[148:151], v[20:23]
    v_mfma_f32_16x16x32_bf16 v[24:27], a[164:167], a[152:155], v[24:27]
    ds_read_b64_tr_b16 a[200:201], v245 offset:49504
    v_mfma_f32_16x16x32_bf16 v[28:31], a[164:167], a[156:159], v[28:31]
    ds_read_b64_tr_b16 a[202:203], v245 offset:51552
    s_waitcnt lgkmcnt(14)
    v_mfma_f32_16x16x32_bf16 v[32:35], a[168:171], a[144:147], v[32:35]
    v_mfma_f32_16x16x32_bf16 v[36:39], a[168:171], a[148:151], v[36:39]
    ds_read_b64_tr_b16 a[204:205], v245 offset:49512
    v_mfma_f32_16x16x32_bf16 v[40:43], a[168:171], a[152:155], v[40:43]
    ds_read_b64_tr_b16 a[206:207], v245 offset:51560
    v_mfma_f32_16x16x32_bf16 v[44:47], a[168:171], a[156:159], v[44:47]
    v_mfma_f32_16x16x32_bf16 v[48:51], a[172:175], a[144:147], v[48:51]
    ds_read_b64_tr_b16 a[208:209], v246 offset:49504
    v_mfma_f32_16x16x32_bf16 v[52:55], a[172:175], a[148:151], v[52:55]
    ds_read_b64_tr_b16 a[210:211], v246 offset:51552
    v_mfma_f32_16x16x32_bf16 v[56:59], a[172:175], a[152:155], v[56:59]
    v_mfma_f32_16x16x32_bf16 v[60:63], a[172:175], a[156:159], v[60:63]
    ds_read_b64_tr_b16 a[212:213], v246 offset:49512
    s_waitcnt lgkmcnt(15)
    v_mfma_f32_16x16x32_bf16 v[64:67], a[176:179], a[144:147], v[64:67]
    ds_read_b64_tr_b16 a[214:215], v246 offset:51560
    s_add_u32 m0, s43, 98240
    v_mfma_f32_16x16x32_bf16 v[68:71], a[176:179], a[148:151], v[68:71]
    v_mfma_f32_16x16x32_bf16 v[72:75], a[176:179], a[152:155], v[72:75]
    ds_read_b64_tr_b16 a[216:217], v247 offset:49504
    s_mov_b32 s54, 1572864
    v_mfma_f32_16x16x32_bf16 v[76:79], a[176:179], a[156:159], v[76:79]
    ds_read_b64_tr_b16 a[218:219], v247 offset:51552
    v_mfma_f32_16x16x32_bf16 v[80:83], a[180:183], a[144:147], v[80:83]
    v_mfma_f32_16x16x32_bf16 v[84:87], a[180:183], a[148:151], v[84:87]
    ds_read_b64_tr_b16 a[220:221], v247 offset:49512
    buffer_load_dwordx4 v236, s[8:11], s54 offen offset:0 lds
    v_mfma_f32_16x16x32_bf16 v[88:91], a[180:183], a[152:155], v[88:91]
    ds_read_b64_tr_b16 a[222:223], v247 offset:51560
    v_mfma_f32_16x16x32_bf16 v[92:95], a[180:183], a[156:159], v[92:95]
    buffer_load_dwordx4 v237, s[8:11], s54 offen offset:1024 lds
    s_waitcnt lgkmcnt(15)
    v_mfma_f32_16x16x32_bf16 v[96:99], a[184:187], a[144:147], v[96:99]
    v_mfma_f32_16x16x32_bf16 v[100:103], a[184:187], a[148:151], v[100:103]
    v_mfma_f32_16x16x32_bf16 v[104:107], a[184:187], a[152:155], v[104:107]
    buffer_load_dwordx4 v238, s[8:11], s54 offen offset:2048 lds
    v_mfma_f32_16x16x32_bf16 v[108:111], a[184:187], a[156:159], v[108:111]
    v_mfma_f32_16x16x32_bf16 v[112:115], a[188:191], a[144:147], v[112:115]
    buffer_load_dwordx4 v239, s[8:11], s54 offen offset:3072 lds
    v_mfma_f32_16x16x32_bf16 v[116:119], a[188:191], a[148:151], v[116:119]
    v_mfma_f32_16x16x32_bf16 v[120:123], a[188:191], a[152:155], v[120:123]
    v_mfma_f32_16x16x32_bf16 v[124:127], a[188:191], a[156:159], v[124:127]
    s_waitcnt vmcnt(9) lgkmcnt(0)
    s_barrier
    v_mfma_f32_16x16x32_bf16 a[0:3], a[192:195], a[144:147], a[0:3]
    ds_read_b128 a[128:131], v240 offset:0
    v_mfma_f32_16x16x32_bf16 a[4:7], a[192:195], a[148:151], a[4:7]
    ds_read_b128 a[132:135], v240 offset:2048
    v_mfma_f32_16x16x32_bf16 a[8:11], a[192:195], a[152:155], a[8:11]
    ds_read_b128 a[136:139], v240 offset:4096
    s_add_u32 m0, s44, 131072
    v_mfma_f32_16x16x32_bf16 a[12:15], a[192:195], a[156:159], a[12:15]
    v_mfma_f32_16x16x32_bf16 a[16:19], a[196:199], a[144:147], a[16:19]
    ds_read_b128 a[140:143], v240 offset:6144
    s_mov_b32 s53, 384
    v_mfma_f32_16x16x32_bf16 a[20:23], a[196:199], a[148:151], a[20:23]
    ds_read_b64_tr_b16 a[160:161], v244 offset:0
    v_mfma_f32_16x16x32_bf16 a[24:27], a[196:199], a[152:155], a[24:27]
    buffer_load_dwordx4 v228, s[4:7], s53 offen offset:0 lds
    v_mfma_f32_16x16x32_bf16 a[28:31], a[196:199], a[156:159], a[28:31]
    ds_read_b64_tr_b16 a[162:163], v244 offset:2048
    v_mfma_f32_16x16x32_bf16 a[32:35], a[200:203], a[144:147], a[32:35]
    ds_read_b64_tr_b16 a[164:165], v244 offset:8
    v_mfma_f32_16x16x32_bf16 a[36:39], a[200:203], a[148:151], a[36:39]
    ds_read_b64_tr_b16 a[166:167], v244 offset:2056
    buffer_load_dwordx4 v229, s[4:7], s53 offen offset:1024 lds
    v_mfma_f32_16x16x32_bf16 a[40:43], a[200:203], a[152:155], a[40:43]
    v_mfma_f32_16x16x32_bf16 a[44:47], a[200:203], a[156:159], a[44:47]
    ds_read_b64_tr_b16 a[168:169], v245 offset:0
    buffer_load_dwordx4 v230, s[4:7], s53 offen offset:2048 lds
    v_mfma_f32_16x16x32_bf16 a[48:51], a[204:207], a[144:147], a[48:51]
    ds_read_b64_tr_b16 a[170:171], v245 offset:2048
    v_mfma_f32_16x16x32_bf16 a[52:55], a[204:207], a[148:151], a[52:55]
    buffer_load_dwordx4 v231, s[4:7], s53 offen offset:3072 lds
    v_mfma_f32_16x16x32_bf16 a[56:59], a[204:207], a[152:155], a[56:59]
    ds_read_b64_tr_b16 a[172:173], v245 offset:8
    v_mfma_f32_16x16x32_bf16 a[60:63], a[204:207], a[156:159], a[60:63]
    ds_read_b64_tr_b16 a[174:175], v245 offset:2056
    v_mfma_f32_16x16x32_bf16 a[64:67], a[208:211], a[144:147], a[64:67]
    ds_read_b64_tr_b16 a[176:177], v246 offset:0
    s_add_u32 m0, s44, 135168
    v_mfma_f32_16x16x32_bf16 a[68:71], a[208:211], a[148:151], a[68:71]
    v_mfma_f32_16x16x32_bf16 a[72:75], a[208:211], a[152:155], a[72:75]
    ds_read_b64_tr_b16 a[178:179], v246 offset:2048
    s_mov_b32 s53, 384
    v_mfma_f32_16x16x32_bf16 a[76:79], a[208:211], a[156:159], a[76:79]
    ds_read_b64_tr_b16 a[180:181], v246 offset:8
    v_mfma_f32_16x16x32_bf16 a[80:83], a[212:215], a[144:147], a[80:83]
    v_mfma_f32_16x16x32_bf16 a[84:87], a[212:215], a[148:151], a[84:87]
    ds_read_b64_tr_b16 a[182:183], v246 offset:2056
    buffer_load_dwordx4 v232, s[4:7], s53 offen offset:0 lds
    v_mfma_f32_16x16x32_bf16 a[88:91], a[212:215], a[152:155], a[88:91]
    ds_read_b64_tr_b16 a[184:185], v247 offset:0
    v_mfma_f32_16x16x32_bf16 a[92:95], a[212:215], a[156:159], a[92:95]
    ds_read_b64_tr_b16 a[186:187], v247 offset:2048
    v_mfma_f32_16x16x32_bf16 a[96:99], a[216:219], a[144:147], a[96:99]
    buffer_load_dwordx4 v233, s[4:7], s53 offen offset:1024 lds
    v_mfma_f32_16x16x32_bf16 a[100:103], a[216:219], a[148:151], a[100:103]
    ds_read_b64_tr_b16 a[188:189], v247 offset:8
    v_mfma_f32_16x16x32_bf16 a[104:107], a[216:219], a[152:155], a[104:107]
    ds_read_b64_tr_b16 a[190:191], v247 offset:2056
    buffer_load_dwordx4 v234, s[4:7], s53 offen offset:2048 lds
    v_mfma_f32_16x16x32_bf16 a[108:111], a[216:219], a[156:159], a[108:111]
    v_mfma_f32_16x16x32_bf16 a[112:115], a[220:223], a[144:147], a[112:115]
    v_mfma_f32_16x16x32_bf16 a[116:119], a[220:223], a[148:151], a[116:119]
    buffer_load_dwordx4 v235, s[4:7], s53 offen offset:3072 lds
    v_mfma_f32_16x16x32_bf16 a[120:123], a[220:223], a[152:155], a[120:123]
    v_mfma_f32_16x16x32_bf16 a[124:127], a[220:223], a[156:159], a[124:127]
    s_waitcnt lgkmcnt(12)
    v_mfma_f32_16x16x32_bf16 v[0:3], a[160:163], a[128:131], v[0:3]
    ds_read_b64_tr_b16 a[192:193], v244 offset:256
    v_mfma_f32_16x16x32_bf16 v[4:7], a[160:163], a[132:135], v[4:7]
    ds_read_b64_tr_b16 a[194:195], v244 offset:2304
    v_mfma_f32_16x16x32_bf16 v[8:11], a[160:163], a[136:139], v[8:11]
    s_add_u32 m0, s43, 114656
    v_mfma_f32_16x16x32_bf16 v[12:15], a[160:163], a[140:143], v[12:15]
    ds_read_b64_tr_b16 a[196:197], v244 offset:264
    v_mfma_f32_16x16x32_bf16 v[16:19], a[164:167], a[128:131], v[16:19]
    ds_read_b64_tr_b16 a[198:199], v244 offset:2312
    s_mov_b32 s54, 1835008
    v_mfma_f32_16x16x32_bf16 v[20:23], a[164:167], a[132:135], v[20:23]
    v_mfma_f32_16x16x32_bf16 v[24:27], a[164:167], a[136:139], v[24:27]
    ds_read_b64_tr_b16 a[200:201], v245 offset:256
    buffer_load_dwordx4 v236, s[8:11], s54 offen offset:0 lds
    v_mfma_f32_16x16x32_bf16 v[28:31], a[164:167], a[140:143], v[28:31]
    ds_read_b64_tr_b16 a[202:203], v245 offset:2304
    s_waitcnt lgkmcnt(14)
    v_mfma_f32_16x16x32_bf16 v[32:35], a[168:171], a[128:131], v[32:35]
    v_mfma_f32_16x16x32_bf16 v[36:39], a[168:171], a[132:135], v[36:39]
    ds_read_b64_tr_b16 a[204:205], v245 offset:264
    buffer_load_dwordx4 v237, s[8:11], s54 offen offset:1024 lds
    v_mfma_f32_16x16x32_bf16 v[40:43], a[168:171], a[136:139], v[40:43]
    ds_read_b64_tr_b16 a[206:207], v245 offset:2312
    v_mfma_f32_16x16x32_bf16 v[44:47], a[168:171], a[140:143], v[44:47]
    buffer_load_dwordx4 v238, s[8:11], s54 offen offset:2048 lds
    v_mfma_f32_16x16x32_bf16 v[48:51], a[172:175], a[128:131], v[48:51]
    ds_read_b64_tr_b16 a[208:209], v246 offset:256
    v_mfma_f32_16x16x32_bf16 v[52:55], a[172:175], a[132:135], v[52:55]
    ds_read_b64_tr_b16 a[210:211], v246 offset:2304
    buffer_load_dwordx4 v239, s[8:11], s54 offen offset:3072 lds
    v_mfma_f32_16x16x32_bf16 v[56:59], a[172:175], a[136:139], v[56:59]
    v_mfma_f32_16x16x32_bf16 v[60:63], a[172:175], a[140:143], v[60:63]
    ds_read_b64_tr_b16 a[212:213], v246 offset:264
    s_waitcnt lgkmcnt(15)
    v_mfma_f32_16x16x32_bf16 v[64:67], a[176:179], a[128:131], v[64:67]
    ds_read_b64_tr_b16 a[214:215], v246 offset:2312
    v_mfma_f32_16x16x32_bf16 v[68:71], a[176:179], a[132:135], v[68:71]
    v_mfma_f32_16x16x32_bf16 v[72:75], a[176:179], a[136:139], v[72:75]
    ds_read_b64_tr_b16 a[216:217], v247 offset:256
    buffer_load_dword v208, v206, s[24:27], s51 offen
    v_mfma_f32_16x16x32_bf16 v[76:79], a[176:179], a[140:143], v[76:79]
    ds_read_b64_tr_b16 a[218:219], v247 offset:2304
    s_add_u32 s51, s51, s50
    v_mfma_f32_16x16x32_bf16 v[80:83], a[180:183], a[128:131], v[80:83]
    v_mfma_f32_16x16x32_bf16 v[84:87], a[180:183], a[132:135], v[84:87]
    ds_read_b64_tr_b16 a[220:221], v247 offset:264
    s_mul_i32 s57, s40, 5120
    v_mfma_f32_16x16x32_bf16 v[88:91], a[180:183], a[136:139], v[88:91]
    ds_read_b64_tr_b16 a[222:223], v247 offset:2312
    v_mfma_f32_16x16x32_bf16 v[92:95], a[180:183], a[140:143], v[92:95]
    s_add_u32 m0, s57, 12160
    s_waitcnt lgkmcnt(15)
    v_mfma_f32_16x16x32_bf16 v[96:99], a[184:187], a[128:131], v[96:99]
    v_mfma_f32_16x16x32_bf16 v[100:103], a[184:187], a[132:135], v[100:103]
    s_mov_b32 s58, 0
    v_mfma_f32_16x16x32_bf16 v[104:107], a[184:187], a[136:139], v[104:107]
    v_mfma_f32_16x16x32_bf16 v[108:111], a[184:187], a[140:143], v[108:111]
    buffer_load_dwordx4 v128, s[32:35], s58 offen offset:0 lds
    v_mfma_f32_16x16x32_bf16 v[112:115], a[188:191], a[128:131], v[112:115]
    v_mfma_f32_16x16x32_bf16 v[116:119], a[188:191], a[132:135], v[116:119]
    buffer_load_dwordx4 v129, s[32:35], s58 offen offset:1024 lds
    v_mfma_f32_16x16x32_bf16 v[120:123], a[188:191], a[136:139], v[120:123]
    v_mfma_f32_16x16x32_bf16 v[124:127], a[188:191], a[140:143], v[124:127]
    s_waitcnt vmcnt(20) lgkmcnt(0)
    s_barrier
    v_mfma_f32_16x16x32_bf16 a[0:3], a[192:195], a[128:131], a[0:3]
    ds_read_b128 a[144:147], v241 offset:0
    v_mfma_f32_16x16x32_bf16 a[4:7], a[192:195], a[132:135], a[4:7]
    ds_read_b128 a[148:151], v241 offset:2048
    v_mfma_f32_16x16x32_bf16 a[8:11], a[192:195], a[136:139], a[8:11]
    ds_read_b128 a[152:155], v241 offset:4096
    v_mfma_f32_16x16x32_bf16 a[12:15], a[192:195], a[140:143], a[12:15]
    v_mfma_f32_16x16x32_bf16 a[16:19], a[196:199], a[128:131], a[16:19]
    ds_read_b128 a[156:159], v241 offset:6144
    v_mfma_f32_16x16x32_bf16 a[20:23], a[196:199], a[132:135], a[20:23]
    ds_read_b64_tr_b16 a[160:161], v244 offset:16416
    v_mfma_f32_16x16x32_bf16 a[24:27], a[196:199], a[136:139], a[24:27]
    v_mfma_f32_16x16x32_bf16 a[28:31], a[196:199], a[140:143], a[28:31]
    ds_read_b64_tr_b16 a[162:163], v244 offset:18464
    v_mfma_f32_16x16x32_bf16 a[32:35], a[200:203], a[128:131], a[32:35]
    ds_read_b64_tr_b16 a[164:165], v244 offset:16424
    v_mfma_f32_16x16x32_bf16 a[36:39], a[200:203], a[132:135], a[36:39]
    ds_read_b64_tr_b16 a[166:167], v244 offset:18472
    v_mfma_f32_16x16x32_bf16 a[40:43], a[200:203], a[136:139], a[40:43]
    v_mfma_f32_16x16x32_bf16 a[44:47], a[200:203], a[140:143], a[44:47]
    ds_read_b64_tr_b16 a[168:169], v245 offset:16416
    v_mfma_f32_16x16x32_bf16 a[48:51], a[204:207], a[128:131], a[48:51]
    ds_read_b64_tr_b16 a[170:171], v245 offset:18464
    v_mfma_f32_16x16x32_bf16 a[52:55], a[204:207], a[132:135], a[52:55]
    v_mfma_f32_16x16x32_bf16 a[56:59], a[204:207], a[136:139], a[56:59]
    ds_read_b64_tr_b16 a[172:173], v245 offset:16424
    v_mfma_f32_16x16x32_bf16 a[60:63], a[204:207], a[140:143], a[60:63]
    ds_read_b64_tr_b16 a[174:175], v245 offset:18472
    v_mfma_f32_16x16x32_bf16 a[64:67], a[208:211], a[128:131], a[64:67]
    ds_read_b64_tr_b16 a[176:177], v246 offset:16416
    v_mfma_f32_16x16x32_bf16 a[68:71], a[208:211], a[132:135], a[68:71]
    v_mfma_f32_16x16x32_bf16 a[72:75], a[208:211], a[136:139], a[72:75]
    ds_read_b64_tr_b16 a[178:179], v246 offset:18464
    v_mfma_f32_16x16x32_bf16 a[76:79], a[208:211], a[140:143], a[76:79]
    ds_read_b64_tr_b16 a[180:181], v246 offset:16424
    v_mfma_f32_16x16x32_bf16 a[80:83], a[212:215], a[128:131], a[80:83]
    v_mfma_f32_16x16x32_bf16 a[84:87], a[212:215], a[132:135], a[84:87]
    ds_read_b64_tr_b16 a[182:183], v246 offset:18472
    v_mfma_f32_16x16x32_bf16 a[88:91], a[212:215], a[136:139], a[88:91]
    ds_read_b64_tr_b16 a[184:185], v247 offset:16416
    v_mfma_f32_16x16x32_bf16 a[92:95], a[212:215], a[140:143], a[92:95]
    ds_read_b64_tr_b16 a[186:187], v247 offset:18464
    v_mfma_f32_16x16x32_bf16 a[96:99], a[216:219], a[128:131], a[96:99]
    v_mfma_f32_16x16x32_bf16 a[100:103], a[216:219], a[132:135], a[100:103]
    ds_read_b64_tr_b16 a[188:189], v247 offset:16424
    v_mfma_f32_16x16x32_bf16 a[104:107], a[216:219], a[136:139], a[104:107]
    ds_read_b64_tr_b16 a[190:191], v247 offset:18472
    v_mfma_f32_16x16x32_bf16 a[108:111], a[216:219], a[140:143], a[108:111]
    v_mfma_f32_16x16x32_bf16 a[112:115], a[220:223], a[128:131], a[112:115]
    v_mfma_f32_16x16x32_bf16 a[116:119], a[220:223], a[132:135], a[116:119]
    v_mfma_f32_16x16x32_bf16 a[120:123], a[220:223], a[136:139], a[120:123]
    v_mfma_f32_16x16x32_bf16 a[124:127], a[220:223], a[140:143], a[124:127]
    s_waitcnt lgkmcnt(12)
    v_mfma_f32_16x16x32_bf16 v[0:3], a[160:163], a[144:147], v[0:3]
    ds_read_b64_tr_b16 a[192:193], v244 offset:16672
    v_mfma_f32_16x16x32_bf16 v[4:7], a[160:163], a[148:151], v[4:7]
    ds_read_b64_tr_b16 a[194:195], v244 offset:18720
    v_mfma_f32_16x16x32_bf16 v[8:11], a[160:163], a[152:155], v[8:11]
    s_add_u32 m0, s43, 65408
    v_mfma_f32_16x16x32_bf16 v[12:15], a[160:163], a[156:159], v[12:15]
    ds_read_b64_tr_b16 a[196:197], v244 offset:16680
    v_mfma_f32_16x16x32_bf16 v[16:19], a[164:167], a[144:147], v[16:19]
    ds_read_b64_tr_b16 a[198:199], v244 offset:18728
    v_mfma_f32_16x16x32_bf16 v[20:23], a[164:167], a[148:151], v[20:23]
    s_mov_b32 s54, 2097152
    v_mfma_f32_16x16x32_bf16 v[24:27], a[164:167], a[152:155], v[24:27]
    ds_read_b64_tr_b16 a[200:201], v245 offset:16672
    v_mfma_f32_16x16x32_bf16 v[28:31], a[164:167], a[156:159], v[28:31]
    ds_read_b64_tr_b16 a[202:203], v245 offset:18720
    s_waitcnt lgkmcnt(14)
    v_mfma_f32_16x16x32_bf16 v[32:35], a[168:171], a[144:147], v[32:35]
    buffer_load_dwordx4 v236, s[8:11], s54 offen offset:0 lds
    v_mfma_f32_16x16x32_bf16 v[36:39], a[168:171], a[148:151], v[36:39]
    ds_read_b64_tr_b16 a[204:205], v245 offset:16680
    v_mfma_f32_16x16x32_bf16 v[40:43], a[168:171], a[152:155], v[40:43]
    ds_read_b64_tr_b16 a[206:207], v245 offset:18728
    v_mfma_f32_16x16x32_bf16 v[44:47], a[168:171], a[156:159], v[44:47]
    buffer_load_dwordx4 v237, s[8:11], s54 offen offset:1024 lds
    v_mfma_f32_16x16x32_bf16 v[48:51], a[172:175], a[144:147], v[48:51]
    ds_read_b64_tr_b16 a[208:209], v246 offset:16672
    v_mfma_f32_16x16x32_bf16 v[52:55], a[172:175], a[148:151], v[52:55]
    ds_read_b64_tr_b16 a[210:211], v246 offset:18720
    v_mfma_f32_16x16x32_bf16 v[56:59], a[172:175], a[152:155], v[56:59]
    buffer_load_dwordx4 v238, s[8:11], s54 offen offset:2048 lds
    v_mfma_f32_16x16x32_bf16 v[60:63], a[172:175], a[156:159], v[60:63]
    ds_read_b64_tr_b16 a[212:213], v246 offset:16680
    s_waitcnt lgkmcnt(15)
    v_mfma_f32_16x16x32_bf16 v[64:67], a[176:179], a[144:147], v[64:67]
    ds_read_b64_tr_b16 a[214:215], v246 offset:18728
    v_mfma_f32_16x16x32_bf16 v[68:71], a[176:179], a[148:151], v[68:71]
    buffer_load_dwordx4 v239, s[8:11], s54 offen offset:3072 lds
    v_mfma_f32_16x16x32_bf16 v[72:75], a[176:179], a[152:155], v[72:75]
    ds_read_b64_tr_b16 a[216:217], v247 offset:16672
    v_mfma_f32_16x16x32_bf16 v[76:79], a[176:179], a[156:159], v[76:79]
    ds_read_b64_tr_b16 a[218:219], v247 offset:18720
    v_mfma_f32_16x16x32_bf16 v[80:83], a[180:183], a[144:147], v[80:83]
    v_mfma_f32_16x16x32_bf16 v[84:87], a[180:183], a[148:151], v[84:87]
    ds_read_b64_tr_b16 a[220:221], v247 offset:16680
    v_mfma_f32_16x16x32_bf16 v[88:91], a[180:183], a[152:155], v[88:91]
    ds_read_b64_tr_b16 a[222:223], v247 offset:18728
    v_mfma_f32_16x16x32_bf16 v[92:95], a[180:183], a[156:159], v[92:95]
    s_waitcnt lgkmcnt(15)
    v_mfma_f32_16x16x32_bf16 v[96:99], a[184:187], a[144:147], v[96:99]
    v_mfma_f32_16x16x32_bf16 v[100:103], a[184:187], a[148:151], v[100:103]
    v_mfma_f32_16x16x32_bf16 v[104:107], a[184:187], a[152:155], v[104:107]
    v_mfma_f32_16x16x32_bf16 v[108:111], a[184:187], a[156:159], v[108:111]
    v_mfma_f32_16x16x32_bf16 v[112:115], a[188:191], a[144:147], v[112:115]
    v_mfma_f32_16x16x32_bf16 v[116:119], a[188:191], a[148:151], v[116:119]
    v_mfma_f32_16x16x32_bf16 v[120:123], a[188:191], a[152:155], v[120:123]
    v_mfma_f32_16x16x32_bf16 v[124:127], a[188:191], a[156:159], v[124:127]
    s_waitcnt vmcnt(11) lgkmcnt(0)
    s_barrier
    v_mfma_f32_16x16x32_bf16 a[0:3], a[192:195], a[144:147], a[0:3]
    ds_read_b128 a[128:131], v242 offset:0
    v_mfma_f32_16x16x32_bf16 a[4:7], a[192:195], a[148:151], a[4:7]
    ds_read_b128 a[132:135], v242 offset:2048
    v_mfma_f32_16x16x32_bf16 a[8:11], a[192:195], a[152:155], a[8:11]
    ds_read_b128 a[136:139], v242 offset:4096
    s_add_u32 m0, s44, 32640
    v_mfma_f32_16x16x32_bf16 a[12:15], a[192:195], a[156:159], a[12:15]
    v_mfma_f32_16x16x32_bf16 a[16:19], a[196:199], a[144:147], a[16:19]
    ds_read_b128 a[140:143], v242 offset:6144
    s_mov_b32 s53, 512
    v_mfma_f32_16x16x32_bf16 a[20:23], a[196:199], a[148:151], a[20:23]
    ds_read_b64_tr_b16 a[160:161], v244 offset:32832
    v_mfma_f32_16x16x32_bf16 a[24:27], a[196:199], a[152:155], a[24:27]
    buffer_load_dwordx4 v228, s[4:7], s53 offen offset:0 lds
    v_mfma_f32_16x16x32_bf16 a[28:31], a[196:199], a[156:159], a[28:31]
    ds_read_b64_tr_b16 a[162:163], v244 offset:34880
    v_mfma_f32_16x16x32_bf16 a[32:35], a[200:203], a[144:147], a[32:35]
    ds_read_b64_tr_b16 a[164:165], v244 offset:32840
    v_mfma_f32_16x16x32_bf16 a[36:39], a[200:203], a[148:151], a[36:39]
    ds_read_b64_tr_b16 a[166:167], v244 offset:34888
    buffer_load_dwordx4 v229, s[4:7], s53 offen offset:1024 lds
    v_mfma_f32_16x16x32_bf16 a[40:43], a[200:203], a[152:155], a[40:43]
    v_mfma_f32_16x16x32_bf16 a[44:47], a[200:203], a[156:159], a[44:47]
    ds_read_b64_tr_b16 a[168:169], v245 offset:32832
    buffer_load_dwordx4 v230, s[4:7], s53 offen offset:2048 lds
    v_mfma_f32_16x16x32_bf16 a[48:51], a[204:207], a[144:147], a[48:51]
    ds_read_b64_tr_b16 a[170:171], v245 offset:34880
    v_mfma_f32_16x16x32_bf16 a[52:55], a[204:207], a[148:151], a[52:55]
    buffer_load_dwordx4 v231, s[4:7], s53 offen offset:3072 lds
    v_mfma_f32_16x16x32_bf16 a[56:59], a[204:207], a[152:155], a[56:59]
    ds_read_b64_tr_b16 a[172:173], v245 offset:32840
    v_mfma_f32_16x16x32_bf16 a[60:63], a[204:207], a[156:159], a[60:63]
    ds_read_b64_tr_b16 a[174:175], v245 offset:34888
    v_mfma_f32_16x16x32_bf16 a[64:67], a[208:211], a[144:147], a[64:67]
    ds_read_b64_tr_b16 a[176:177], v246 offset:32832
    s_add_u32 m0, s44, 36736
    v_mfma_f32_16x16x32_bf16 a[68:71], a[208:211], a[148:151], a[68:71]
    v_mfma_f32_16x16x32_bf16 a[72:75], a[208:211], a[152:155], a[72:75]
    ds_read_b64_tr_b16 a[178:179], v246 offset:34880
    s_mov_b32 s53, 512
    v_mfma_f32_16x16x32_bf16 a[76:79], a[208:211], a[156:159], a[76:79]
    ds_read_b64_tr_b16 a[180:181], v246 offset:32840
    v_mfma_f32_16x16x32_bf16 a[80:83], a[212:215], a[144:147], a[80:83]
    v_mfma_f32_16x16x32_bf16 a[84:87], a[212:215], a[148:151], a[84:87]
    ds_read_b64_tr_b16 a[182:183], v246 offset:34888
    buffer_load_dwordx4 v232, s[4:7], s53 offen offset:0 lds
    v_mfma_f32_16x16x32_bf16 a[88:91], a[212:215], a[152:155], a[88:91]
    ds_read_b64_tr_b16 a[184:185], v247 offset:32832
    v_mfma_f32_16x16x32_bf16 a[92:95], a[212:215], a[156:159], a[92:95]
    ds_read_b64_tr_b16 a[186:187], v247 offset:34880
    v_mfma_f32_16x16x32_bf16 a[96:99], a[216:219], a[144:147], a[96:99]
    buffer_load_dwordx4 v233, s[4:7], s53 offen offset:1024 lds
    v_mfma_f32_16x16x32_bf16 a[100:103], a[216:219], a[148:151], a[100:103]
    ds_read_b64_tr_b16 a[188:189], v247 offset:32840
    v_mfma_f32_16x16x32_bf16 a[104:107], a[216:219], a[152:155], a[104:107]
    ds_read_b64_tr_b16 a[190:191], v247 offset:34888
    buffer_load_dwordx4 v234, s[4:7], s53 offen offset:2048 lds
    v_mfma_f32_16x16x32_bf16 a[108:111], a[216:219], a[156:159], a[108:111]
    v_mfma_f32_16x16x32_bf16 a[112:115], a[220:223], a[144:147], a[112:115]
    v_mfma_f32_16x16x32_bf16 a[116:119], a[220:223], a[148:151], a[116:119]
    buffer_load_dwordx4 v235, s[4:7], s53 offen offset:3072 lds
    v_mfma_f32_16x16x32_bf16 a[120:123], a[220:223], a[152:155], a[120:123]
    v_mfma_f32_16x16x32_bf16 a[124:127], a[220:223], a[156:159], a[124:127]
    s_waitcnt lgkmcnt(12)
    v_mfma_f32_16x16x32_bf16 v[0:3], a[160:163], a[128:131], v[0:3]
    ds_read_b64_tr_b16 a[192:193], v244 offset:33088
    v_mfma_f32_16x16x32_bf16 v[4:7], a[160:163], a[132:135], v[4:7]
    ds_read_b64_tr_b16 a[194:195], v244 offset:35136
    v_mfma_f32_16x16x32_bf16 v[8:11], a[160:163], a[136:139], v[8:11]
    s_add_u32 m0, s43, 81824
    v_mfma_f32_16x16x32_bf16 v[12:15], a[160:163], a[140:143], v[12:15]
    ds_read_b64_tr_b16 a[196:197], v244 offset:33096
    v_mfma_f32_16x16x32_bf16 v[16:19], a[164:167], a[128:131], v[16:19]
    ds_read_b64_tr_b16 a[198:199], v244 offset:35144
    s_mov_b32 s54, 2359296
    v_mfma_f32_16x16x32_bf16 v[20:23], a[164:167], a[132:135], v[20:23]
    v_mfma_f32_16x16x32_bf16 v[24:27], a[164:167], a[136:139], v[24:27]
    ds_read_b64_tr_b16 a[200:201], v245 offset:33088
    buffer_load_dwordx4 v236, s[8:11], s54 offen offset:0 lds
    v_mfma_f32_16x16x32_bf16 v[28:31], a[164:167], a[140:143], v[28:31]
    ds_read_b64_tr_b16 a[202:203], v245 offset:35136
    s_waitcnt lgkmcnt(14)
    v_mfma_f32_16x16x32_bf16 v[32:35], a[168:171], a[128:131], v[32:35]
    v_mfma_f32_16x16x32_bf16 v[36:39], a[168:171], a[132:135], v[36:39]
    ds_read_b64_tr_b16 a[204:205], v245 offset:33096
    buffer_load_dwordx4 v237, s[8:11], s54 offen offset:1024 lds
    v_mfma_f32_16x16x32_bf16 v[40:43], a[168:171], a[136:139], v[40:43]
    ds_read_b64_tr_b16 a[206:207], v245 offset:35144
    v_mfma_f32_16x16x32_bf16 v[44:47], a[168:171], a[140:143], v[44:47]
    buffer_load_dwordx4 v238, s[8:11], s54 offen offset:2048 lds
    v_mfma_f32_16x16x32_bf16 v[48:51], a[172:175], a[128:131], v[48:51]
    ds_read_b64_tr_b16 a[208:209], v246 offset:33088
    v_mfma_f32_16x16x32_bf16 v[52:55], a[172:175], a[132:135], v[52:55]
    ds_read_b64_tr_b16 a[210:211], v246 offset:35136
    buffer_load_dwordx4 v239, s[8:11], s54 offen offset:3072 lds
    v_mfma_f32_16x16x32_bf16 v[56:59], a[172:175], a[136:139], v[56:59]
    v_mfma_f32_16x16x32_bf16 v[60:63], a[172:175], a[140:143], v[60:63]
    ds_read_b64_tr_b16 a[212:213], v246 offset:33096
    s_waitcnt lgkmcnt(15)
    v_mfma_f32_16x16x32_bf16 v[64:67], a[176:179], a[128:131], v[64:67]
    ds_read_b64_tr_b16 a[214:215], v246 offset:35144
    v_mfma_f32_16x16x32_bf16 v[68:71], a[176:179], a[132:135], v[68:71]
    v_mfma_f32_16x16x32_bf16 v[72:75], a[176:179], a[136:139], v[72:75]
    ds_read_b64_tr_b16 a[216:217], v247 offset:33088
    buffer_load_dword v208, v206, s[24:27], s51 offen
    v_mfma_f32_16x16x32_bf16 v[76:79], a[176:179], a[140:143], v[76:79]
    ds_read_b64_tr_b16 a[218:219], v247 offset:35136
    s_add_u32 s51, s51, s50
    v_mfma_f32_16x16x32_bf16 v[80:83], a[180:183], a[128:131], v[80:83]
    s_mul_i32 s57, s40, 5120
    v_mfma_f32_16x16x32_bf16 v[84:87], a[180:183], a[132:135], v[84:87]
    ds_read_b64_tr_b16 a[220:221], v247 offset:33096
    s_add_u32 m0, s57, 12160
    v_mfma_f32_16x16x32_bf16 v[88:91], a[180:183], a[136:139], v[88:91]
    ds_read_b64_tr_b16 a[222:223], v247 offset:35144
    s_mov_b32 s58, 0
    v_mfma_f32_16x16x32_bf16 v[92:95], a[180:183], a[140:143], v[92:95]
    buffer_load_dwordx4 v130, s[32:35], s58 offen offset:2048 lds
    s_waitcnt lgkmcnt(15)
    v_mfma_f32_16x16x32_bf16 v[96:99], a[184:187], a[128:131], v[96:99]
    buffer_load_dwordx4 v131, s[32:35], s58 offen offset:3072 lds
    v_mfma_f32_16x16x32_bf16 v[100:103], a[184:187], a[132:135], v[100:103]
    s_mul_i32 s57, s40, 5120
    v_mfma_f32_16x16x32_bf16 v[104:107], a[184:187], a[136:139], v[104:107]
    s_mov_b32 s58, 0
    v_mfma_f32_16x16x32_bf16 v[108:111], a[184:187], a[140:143], v[108:111]
    s_add_u32 m0, s57, 16256
    v_mfma_f32_16x16x32_bf16 v[112:115], a[188:191], a[128:131], v[112:115]
    s_nop 0
    v_mfma_f32_16x16x32_bf16 v[116:119], a[188:191], a[132:135], v[116:119]
    buffer_load_dwordx4 v132, s[32:35], s58 offen lds
    v_mfma_f32_16x16x32_bf16 v[120:123], a[188:191], a[136:139], v[120:123]
    v_mfma_f32_16x16x32_bf16 v[124:127], a[188:191], a[140:143], v[124:127]
    s_waitcnt vmcnt(23) lgkmcnt(0)
    s_barrier
    v_mfma_f32_16x16x32_bf16 a[0:3], a[192:195], a[128:131], a[0:3]
    ds_read_b128 a[144:147], v243 offset:0
    v_mfma_f32_16x16x32_bf16 a[4:7], a[192:195], a[132:135], a[4:7]
    ds_read_b128 a[148:151], v243 offset:2048
    v_mfma_f32_16x16x32_bf16 a[8:11], a[192:195], a[136:139], a[8:11]
    ds_read_b128 a[152:155], v243 offset:4096
    v_mfma_f32_16x16x32_bf16 a[12:15], a[192:195], a[140:143], a[12:15]
    v_mfma_f32_16x16x32_bf16 a[16:19], a[196:199], a[128:131], a[16:19]
    ds_read_b128 a[156:159], v243 offset:6144
    v_mfma_f32_16x16x32_bf16 a[20:23], a[196:199], a[132:135], a[20:23]
    ds_read_b64_tr_b16 a[160:161], v244 offset:49248
    v_mfma_f32_16x16x32_bf16 a[24:27], a[196:199], a[136:139], a[24:27]
    v_mfma_f32_16x16x32_bf16 a[28:31], a[196:199], a[140:143], a[28:31]
    ds_read_b64_tr_b16 a[162:163], v244 offset:51296
    v_mfma_f32_16x16x32_bf16 a[32:35], a[200:203], a[128:131], a[32:35]
    ds_read_b64_tr_b16 a[164:165], v244 offset:49256
    v_mfma_f32_16x16x32_bf16 a[36:39], a[200:203], a[132:135], a[36:39]
    ds_read_b64_tr_b16 a[166:167], v244 offset:51304
    v_mfma_f32_16x16x32_bf16 a[40:43], a[200:203], a[136:139], a[40:43]
    v_mfma_f32_16x16x32_bf16 a[44:47], a[200:203], a[140:143], a[44:47]
    ds_read_b64_tr_b16 a[168:169], v245 offset:49248
    v_mfma_f32_16x16x32_bf16 a[48:51], a[204:207], a[128:131], a[48:51]
    ds_read_b64_tr_b16 a[170:171], v245 offset:51296
    v_mfma_f32_16x16x32_bf16 a[52:55], a[204:207], a[132:135], a[52:55]
    v_mfma_f32_16x16x32_bf16 a[56:59], a[204:207], a[136:139], a[56:59]
    ds_read_b64_tr_b16 a[172:173], v245 offset:49256
    v_mfma_f32_16x16x32_bf16 a[60:63], a[204:207], a[140:143], a[60:63]
    ds_read_b64_tr_b16 a[174:175], v245 offset:51304
    v_mfma_f32_16x16x32_bf16 a[64:67], a[208:211], a[128:131], a[64:67]
    ds_read_b64_tr_b16 a[176:177], v246 offset:49248
    v_mfma_f32_16x16x32_bf16 a[68:71], a[208:211], a[132:135], a[68:71]
    v_mfma_f32_16x16x32_bf16 a[72:75], a[208:211], a[136:139], a[72:75]
    ds_read_b64_tr_b16 a[178:179], v246 offset:51296
    v_mfma_f32_16x16x32_bf16 a[76:79], a[208:211], a[140:143], a[76:79]
    ds_read_b64_tr_b16 a[180:181], v246 offset:49256
    v_mfma_f32_16x16x32_bf16 a[80:83], a[212:215], a[128:131], a[80:83]
    v_mfma_f32_16x16x32_bf16 a[84:87], a[212:215], a[132:135], a[84:87]
    ds_read_b64_tr_b16 a[182:183], v246 offset:51304
    v_mfma_f32_16x16x32_bf16 a[88:91], a[212:215], a[136:139], a[88:91]
    ds_read_b64_tr_b16 a[184:185], v247 offset:49248
    v_mfma_f32_16x16x32_bf16 a[92:95], a[212:215], a[140:143], a[92:95]
    ds_read_b64_tr_b16 a[186:187], v247 offset:51296
    v_mfma_f32_16x16x32_bf16 a[96:99], a[216:219], a[128:131], a[96:99]
    v_mfma_f32_16x16x32_bf16 a[100:103], a[216:219], a[132:135], a[100:103]
    ds_read_b64_tr_b16 a[188:189], v247 offset:49256
    v_mfma_f32_16x16x32_bf16 a[104:107], a[216:219], a[136:139], a[104:107]
    ds_read_b64_tr_b16 a[190:191], v247 offset:51304
    v_mfma_f32_16x16x32_bf16 a[108:111], a[216:219], a[140:143], a[108:111]
    v_mfma_f32_16x16x32_bf16 a[112:115], a[220:223], a[128:131], a[112:115]
    v_mfma_f32_16x16x32_bf16 a[116:119], a[220:223], a[132:135], a[116:119]
    v_mfma_f32_16x16x32_bf16 a[120:123], a[220:223], a[136:139], a[120:123]
    v_mfma_f32_16x16x32_bf16 a[124:127], a[220:223], a[140:143], a[124:127]
    s_waitcnt lgkmcnt(12)
    v_mfma_f32_16x16x32_bf16 v[0:3], a[160:163], a[144:147], v[0:3]
    ds_read_b64_tr_b16 a[192:193], v244 offset:49504
    v_mfma_f32_16x16x32_bf16 v[4:7], a[160:163], a[148:151], v[4:7]
    ds_read_b64_tr_b16 a[194:195], v244 offset:51552
    v_mfma_f32_16x16x32_bf16 v[8:11], a[160:163], a[152:155], v[8:11]
    s_add_u32 m0, s43, 98240
    v_mfma_f32_16x16x32_bf16 v[12:15], a[160:163], a[156:159], v[12:15]
    ds_read_b64_tr_b16 a[196:197], v244 offset:49512
    v_mfma_f32_16x16x32_bf16 v[16:19], a[164:167], a[144:147], v[16:19]
    ds_read_b64_tr_b16 a[198:199], v244 offset:51560
    v_mfma_f32_16x16x32_bf16 v[20:23], a[164:167], a[148:151], v[20:23]
    s_mov_b32 s54, 2621440
    v_mfma_f32_16x16x32_bf16 v[24:27], a[164:167], a[152:155], v[24:27]
    ds_read_b64_tr_b16 a[200:201], v245 offset:49504
    v_mfma_f32_16x16x32_bf16 v[28:31], a[164:167], a[156:159], v[28:31]
    ds_read_b64_tr_b16 a[202:203], v245 offset:51552
    s_waitcnt lgkmcnt(14)
    v_mfma_f32_16x16x32_bf16 v[32:35], a[168:171], a[144:147], v[32:35]
    buffer_load_dwordx4 v236, s[8:11], s54 offen offset:0 lds
    v_mfma_f32_16x16x32_bf16 v[36:39], a[168:171], a[148:151], v[36:39]
    ds_read_b64_tr_b16 a[204:205], v245 offset:49512
    v_mfma_f32_16x16x32_bf16 v[40:43], a[168:171], a[152:155], v[40:43]
    ds_read_b64_tr_b16 a[206:207], v245 offset:51560
    v_mfma_f32_16x16x32_bf16 v[44:47], a[168:171], a[156:159], v[44:47]
    buffer_load_dwordx4 v237, s[8:11], s54 offen offset:1024 lds
    v_mfma_f32_16x16x32_bf16 v[48:51], a[172:175], a[144:147], v[48:51]
    ds_read_b64_tr_b16 a[208:209], v246 offset:49504
    v_mfma_f32_16x16x32_bf16 v[52:55], a[172:175], a[148:151], v[52:55]
    ds_read_b64_tr_b16 a[210:211], v246 offset:51552
    v_mfma_f32_16x16x32_bf16 v[56:59], a[172:175], a[152:155], v[56:59]
    buffer_load_dwordx4 v238, s[8:11], s54 offen offset:2048 lds
    v_mfma_f32_16x16x32_bf16 v[60:63], a[172:175], a[156:159], v[60:63]
    ds_read_b64_tr_b16 a[212:213], v246 offset:49512
    s_waitcnt lgkmcnt(15)
    v_mfma_f32_16x16x32_bf16 v[64:67], a[176:179], a[144:147], v[64:67]
    ds_read_b64_tr_b16 a[214:215], v246 offset:51560
    v_mfma_f32_16x16x32_bf16 v[68:71], a[176:179], a[148:151], v[68:71]
    buffer_load_dwordx4 v239, s[8:11], s54 offen offset:3072 lds
    v_mfma_f32_16x16x32_bf16 v[72:75], a[176:179], a[152:155], v[72:75]
    ds_read_b64_tr_b16 a[216:217], v247 offset:49504
    v_mfma_f32_16x16x32_bf16 v[76:79], a[176:179], a[156:159], v[76:79]
    ds_read_b64_tr_b16 a[218:219], v247 offset:51552
    v_mfma_f32_16x16x32_bf16 v[80:83], a[180:183], a[144:147], v[80:83]
    v_mfma_f32_16x16x32_bf16 v[84:87], a[180:183], a[148:151], v[84:87]
    ds_read_b64_tr_b16 a[220:221], v247 offset:49512
    v_mfma_f32_16x16x32_bf16 v[88:91], a[180:183], a[152:155], v[88:91]
    ds_read_b64_tr_b16 a[222:223], v247 offset:51560
    v_mfma_f32_16x16x32_bf16 v[92:95], a[180:183], a[156:159], v[92:95]
    s_waitcnt lgkmcnt(15)
    v_mfma_f32_16x16x32_bf16 v[96:99], a[184:187], a[144:147], v[96:99]
    v_mfma_f32_16x16x32_bf16 v[100:103], a[184:187], a[148:151], v[100:103]
    v_mfma_f32_16x16x32_bf16 v[104:107], a[184:187], a[152:155], v[104:107]
    v_mfma_f32_16x16x32_bf16 v[108:111], a[184:187], a[156:159], v[108:111]
    v_mfma_f32_16x16x32_bf16 v[112:115], a[188:191], a[144:147], v[112:115]
    v_mfma_f32_16x16x32_bf16 v[116:119], a[188:191], a[148:151], v[116:119]
    v_mfma_f32_16x16x32_bf16 v[120:123], a[188:191], a[152:155], v[120:123]
    v_mfma_f32_16x16x32_bf16 v[124:127], a[188:191], a[156:159], v[124:127]
    s_waitcnt vmcnt(12) lgkmcnt(0)
    s_barrier
    v_mfma_f32_16x16x32_bf16 a[0:3], a[192:195], a[144:147], a[0:3]
    ds_read_b128 a[128:131], v240 offset:0
    v_mfma_f32_16x16x32_bf16 a[4:7], a[192:195], a[148:151], a[4:7]
    ds_read_b128 a[132:135], v240 offset:2048
    v_mfma_f32_16x16x32_bf16 a[8:11], a[192:195], a[152:155], a[8:11]
    ds_read_b128 a[136:139], v240 offset:4096
    s_add_u32 m0, s44, 131072
    v_mfma_f32_16x16x32_bf16 a[12:15], a[192:195], a[156:159], a[12:15]
    v_mfma_f32_16x16x32_bf16 a[16:19], a[196:199], a[144:147], a[16:19]
    ds_read_b128 a[140:143], v240 offset:6144
    s_mov_b32 s53, 640
    v_mfma_f32_16x16x32_bf16 a[20:23], a[196:199], a[148:151], a[20:23]
    ds_read_b64_tr_b16 a[160:161], v244 offset:0
    v_mfma_f32_16x16x32_bf16 a[24:27], a[196:199], a[152:155], a[24:27]
    buffer_load_dwordx4 v228, s[4:7], s53 offen offset:0 lds
    v_mfma_f32_16x16x32_bf16 a[28:31], a[196:199], a[156:159], a[28:31]
    ds_read_b64_tr_b16 a[162:163], v244 offset:2048
    v_mfma_f32_16x16x32_bf16 a[32:35], a[200:203], a[144:147], a[32:35]
    ds_read_b64_tr_b16 a[164:165], v244 offset:8
    v_mfma_f32_16x16x32_bf16 a[36:39], a[200:203], a[148:151], a[36:39]
    ds_read_b64_tr_b16 a[166:167], v244 offset:2056
    buffer_load_dwordx4 v229, s[4:7], s53 offen offset:1024 lds
    v_mfma_f32_16x16x32_bf16 a[40:43], a[200:203], a[152:155], a[40:43]
    v_mfma_f32_16x16x32_bf16 a[44:47], a[200:203], a[156:159], a[44:47]
    ds_read_b64_tr_b16 a[168:169], v245 offset:0
    buffer_load_dwordx4 v230, s[4:7], s53 offen offset:2048 lds
    v_mfma_f32_16x16x32_bf16 a[48:51], a[204:207], a[144:147], a[48:51]
    ds_read_b64_tr_b16 a[170:171], v245 offset:2048
    v_mfma_f32_16x16x32_bf16 a[52:55], a[204:207], a[148:151], a[52:55]
    buffer_load_dwordx4 v231, s[4:7], s53 offen offset:3072 lds
    v_mfma_f32_16x16x32_bf16 a[56:59], a[204:207], a[152:155], a[56:59]
    ds_read_b64_tr_b16 a[172:173], v245 offset:8
    v_mfma_f32_16x16x32_bf16 a[60:63], a[204:207], a[156:159], a[60:63]
    ds_read_b64_tr_b16 a[174:175], v245 offset:2056
    v_mfma_f32_16x16x32_bf16 a[64:67], a[208:211], a[144:147], a[64:67]
    ds_read_b64_tr_b16 a[176:177], v246 offset:0
    s_add_u32 m0, s44, 135168
    v_mfma_f32_16x16x32_bf16 a[68:71], a[208:211], a[148:151], a[68:71]
    v_mfma_f32_16x16x32_bf16 a[72:75], a[208:211], a[152:155], a[72:75]
    ds_read_b64_tr_b16 a[178:179], v246 offset:2048
    s_mov_b32 s53, 640
    v_mfma_f32_16x16x32_bf16 a[76:79], a[208:211], a[156:159], a[76:79]
    ds_read_b64_tr_b16 a[180:181], v246 offset:8
    v_mfma_f32_16x16x32_bf16 a[80:83], a[212:215], a[144:147], a[80:83]
    v_mfma_f32_16x16x32_bf16 a[84:87], a[212:215], a[148:151], a[84:87]
    ds_read_b64_tr_b16 a[182:183], v246 offset:2056
    buffer_load_dwordx4 v232, s[4:7], s53 offen offset:0 lds
    v_mfma_f32_16x16x32_bf16 a[88:91], a[212:215], a[152:155], a[88:91]
    ds_read_b64_tr_b16 a[184:185], v247 offset:0
    v_mfma_f32_16x16x32_bf16 a[92:95], a[212:215], a[156:159], a[92:95]
    ds_read_b64_tr_b16 a[186:187], v247 offset:2048
    v_mfma_f32_16x16x32_bf16 a[96:99], a[216:219], a[144:147], a[96:99]
    buffer_load_dwordx4 v233, s[4:7], s53 offen offset:1024 lds
    v_mfma_f32_16x16x32_bf16 a[100:103], a[216:219], a[148:151], a[100:103]
    ds_read_b64_tr_b16 a[188:189], v247 offset:8
    v_mfma_f32_16x16x32_bf16 a[104:107], a[216:219], a[152:155], a[104:107]
    ds_read_b64_tr_b16 a[190:191], v247 offset:2056
    buffer_load_dwordx4 v234, s[4:7], s53 offen offset:2048 lds
    v_mfma_f32_16x16x32_bf16 a[108:111], a[216:219], a[156:159], a[108:111]
    v_mfma_f32_16x16x32_bf16 a[112:115], a[220:223], a[144:147], a[112:115]
    v_mfma_f32_16x16x32_bf16 a[116:119], a[220:223], a[148:151], a[116:119]
    buffer_load_dwordx4 v235, s[4:7], s53 offen offset:3072 lds
    v_mfma_f32_16x16x32_bf16 a[120:123], a[220:223], a[152:155], a[120:123]
    v_mfma_f32_16x16x32_bf16 a[124:127], a[220:223], a[156:159], a[124:127]
    s_waitcnt lgkmcnt(12)
    v_mfma_f32_16x16x32_bf16 v[0:3], a[160:163], a[128:131], v[0:3]
    ds_read_b64_tr_b16 a[192:193], v244 offset:256
    v_mfma_f32_16x16x32_bf16 v[4:7], a[160:163], a[132:135], v[4:7]
    ds_read_b64_tr_b16 a[194:195], v244 offset:2304
    v_mfma_f32_16x16x32_bf16 v[8:11], a[160:163], a[136:139], v[8:11]
    s_add_u32 m0, s43, 114656
    v_mfma_f32_16x16x32_bf16 v[12:15], a[160:163], a[140:143], v[12:15]
    ds_read_b64_tr_b16 a[196:197], v244 offset:264
    v_mfma_f32_16x16x32_bf16 v[16:19], a[164:167], a[128:131], v[16:19]
    ds_read_b64_tr_b16 a[198:199], v244 offset:2312
    s_mov_b32 s54, 2883584
    v_mfma_f32_16x16x32_bf16 v[20:23], a[164:167], a[132:135], v[20:23]
    v_mfma_f32_16x16x32_bf16 v[24:27], a[164:167], a[136:139], v[24:27]
    ds_read_b64_tr_b16 a[200:201], v245 offset:256
    buffer_load_dwordx4 v236, s[8:11], s54 offen offset:0 lds
    v_mfma_f32_16x16x32_bf16 v[28:31], a[164:167], a[140:143], v[28:31]
    ds_read_b64_tr_b16 a[202:203], v245 offset:2304
    s_waitcnt lgkmcnt(14)
    v_mfma_f32_16x16x32_bf16 v[32:35], a[168:171], a[128:131], v[32:35]
    v_mfma_f32_16x16x32_bf16 v[36:39], a[168:171], a[132:135], v[36:39]
    ds_read_b64_tr_b16 a[204:205], v245 offset:264
    buffer_load_dwordx4 v237, s[8:11], s54 offen offset:1024 lds
    v_mfma_f32_16x16x32_bf16 v[40:43], a[168:171], a[136:139], v[40:43]
    ds_read_b64_tr_b16 a[206:207], v245 offset:2312
    v_mfma_f32_16x16x32_bf16 v[44:47], a[168:171], a[140:143], v[44:47]
    buffer_load_dwordx4 v238, s[8:11], s54 offen offset:2048 lds
    v_mfma_f32_16x16x32_bf16 v[48:51], a[172:175], a[128:131], v[48:51]
    ds_read_b64_tr_b16 a[208:209], v246 offset:256
    v_mfma_f32_16x16x32_bf16 v[52:55], a[172:175], a[132:135], v[52:55]
    ds_read_b64_tr_b16 a[210:211], v246 offset:2304
    buffer_load_dwordx4 v239, s[8:11], s54 offen offset:3072 lds
    v_mfma_f32_16x16x32_bf16 v[56:59], a[172:175], a[136:139], v[56:59]
    v_mfma_f32_16x16x32_bf16 v[60:63], a[172:175], a[140:143], v[60:63]
    ds_read_b64_tr_b16 a[212:213], v246 offset:264
    s_waitcnt lgkmcnt(15)
    v_mfma_f32_16x16x32_bf16 v[64:67], a[176:179], a[128:131], v[64:67]
    ds_read_b64_tr_b16 a[214:215], v246 offset:2312
    v_mfma_f32_16x16x32_bf16 v[68:71], a[176:179], a[132:135], v[68:71]
    v_mfma_f32_16x16x32_bf16 v[72:75], a[176:179], a[136:139], v[72:75]
    ds_read_b64_tr_b16 a[216:217], v247 offset:256
    buffer_load_dword v208, v206, s[24:27], s51 offen
    v_mfma_f32_16x16x32_bf16 v[76:79], a[176:179], a[140:143], v[76:79]
    ds_read_b64_tr_b16 a[218:219], v247 offset:2304
    v_mfma_f32_16x16x32_bf16 v[80:83], a[180:183], a[128:131], v[80:83]
    v_mfma_f32_16x16x32_bf16 v[84:87], a[180:183], a[132:135], v[84:87]
    ds_read_b64_tr_b16 a[220:221], v247 offset:264
    v_mfma_f32_16x16x32_bf16 v[88:91], a[180:183], a[136:139], v[88:91]
    ds_read_b64_tr_b16 a[222:223], v247 offset:2312
    v_mfma_f32_16x16x32_bf16 v[92:95], a[180:183], a[140:143], v[92:95]
    s_waitcnt lgkmcnt(15)
    v_mfma_f32_16x16x32_bf16 v[96:99], a[184:187], a[128:131], v[96:99]
    s_add_u32 s51, s51, s50
    v_mfma_f32_16x16x32_bf16 v[100:103], a[184:187], a[132:135], v[100:103]
    v_mfma_f32_16x16x32_bf16 v[104:107], a[184:187], a[136:139], v[104:107]
    v_mfma_f32_16x16x32_bf16 v[108:111], a[184:187], a[140:143], v[108:111]
    v_mfma_f32_16x16x32_bf16 v[112:115], a[188:191], a[128:131], v[112:115]
    v_mfma_f32_16x16x32_bf16 v[116:119], a[188:191], a[132:135], v[116:119]
    v_mfma_f32_16x16x32_bf16 v[120:123], a[188:191], a[136:139], v[120:123]
    v_mfma_f32_16x16x32_bf16 v[124:127], a[188:191], a[140:143], v[124:127]
    s_waitcnt vmcnt(17) lgkmcnt(0)
    s_barrier
    v_mfma_f32_16x16x32_bf16 a[0:3], a[192:195], a[128:131], a[0:3]
    ds_read_b128 a[144:147], v241 offset:0
    v_mfma_f32_16x16x32_bf16 a[4:7], a[192:195], a[132:135], a[4:7]
    ds_read_b128 a[148:151], v241 offset:2048
    v_mfma_f32_16x16x32_bf16 a[8:11], a[192:195], a[136:139], a[8:11]
    ds_read_b128 a[152:155], v241 offset:4096
    v_mfma_f32_16x16x32_bf16 a[12:15], a[192:195], a[140:143], a[12:15]
    v_mfma_f32_16x16x32_bf16 a[16:19], a[196:199], a[128:131], a[16:19]
    ds_read_b128 a[156:159], v241 offset:6144
    v_mfma_f32_16x16x32_bf16 a[20:23], a[196:199], a[132:135], a[20:23]
    ds_read_b64_tr_b16 a[160:161], v244 offset:16416
    v_mfma_f32_16x16x32_bf16 a[24:27], a[196:199], a[136:139], a[24:27]
    v_mfma_f32_16x16x32_bf16 a[28:31], a[196:199], a[140:143], a[28:31]
    ds_read_b64_tr_b16 a[162:163], v244 offset:18464
    v_mfma_f32_16x16x32_bf16 a[32:35], a[200:203], a[128:131], a[32:35]
    ds_read_b64_tr_b16 a[164:165], v244 offset:16424
    ds_read_b64_tr_b16 a[224:225], v133 offset:12160
    v_mfma_f32_16x16x32_bf16 a[36:39], a[200:203], a[132:135], a[36:39]
    ds_read_b64_tr_b16 a[166:167], v244 offset:18472
    v_mfma_f32_16x16x32_bf16 a[40:43], a[200:203], a[136:139], a[40:43]
    ds_read_b64_tr_b16 a[226:227], v133 offset:22400
    v_mfma_f32_16x16x32_bf16 a[44:47], a[200:203], a[140:143], a[44:47]
    ds_read_b64_tr_b16 a[168:169], v245 offset:16416
    v_mfma_f32_16x16x32_bf16 a[48:51], a[204:207], a[128:131], a[48:51]
    ds_read_b64_tr_b16 a[170:171], v245 offset:18464
    ds_read_b64_tr_b16 a[228:229], v133 offset:12192
    v_mfma_f32_16x16x32_bf16 a[52:55], a[204:207], a[132:135], a[52:55]
    v_mfma_f32_16x16x32_bf16 a[56:59], a[204:207], a[136:139], a[56:59]
    ds_read_b64_tr_b16 a[172:173], v245 offset:16424
    v_mfma_f32_16x16x32_bf16 a[60:63], a[204:207], a[140:143], a[60:63]
    ds_read_b64_tr_b16 a[174:175], v245 offset:18472
    ds_read_b64_tr_b16 a[230:231], v133 offset:22432
    v_mfma_f32_16x16x32_bf16 a[64:67], a[208:211], a[128:131], a[64:67]
    ds_read_b64_tr_b16 a[176:177], v246 offset:16416
    v_mfma_f32_16x16x32_bf16 a[68:71], a[208:211], a[132:135], a[68:71]
    ds_read_b64_tr_b16 a[232:233], v133 offset:12224
    v_mfma_f32_16x16x32_bf16 a[72:75], a[208:211], a[136:139], a[72:75]
    ds_read_b64_tr_b16 a[178:179], v246 offset:18464
    v_mfma_f32_16x16x32_bf16 a[76:79], a[208:211], a[140:143], a[76:79]
    ds_read_b64_tr_b16 a[180:181], v246 offset:16424
    v_mfma_f32_16x16x32_bf16 a[80:83], a[212:215], a[128:131], a[80:83]
    ds_read_b64_tr_b16 a[234:235], v133 offset:22464
    v_mfma_f32_16x16x32_bf16 a[84:87], a[212:215], a[132:135], a[84:87]
    ds_read_b64_tr_b16 a[182:183], v246 offset:18472
    v_mfma_f32_16x16x32_bf16 a[88:91], a[212:215], a[136:139], a[88:91]
    ds_read_b64_tr_b16 a[184:185], v247 offset:16416
    ds_read_b64_tr_b16 a[236:237], v133 offset:12256
    v_mfma_f32_16x16x32_bf16 a[92:95], a[212:215], a[140:143], a[92:95]
    ds_read_b64_tr_b16 a[186:187], v247 offset:18464
    v_mfma_f32_16x16x32_bf16 a[96:99], a[216:219], a[128:131], a[96:99]
    ds_read_b64_tr_b16 a[238:239], v133 offset:22496
    v_mfma_f32_16x16x32_bf16 a[100:103], a[216:219], a[132:135], a[100:103]
    ds_read_b64_tr_b16 a[188:189], v247 offset:16424
    v_mfma_f32_16x16x32_bf16 a[104:107], a[216:219], a[136:139], a[104:107]
    ds_read_b64_tr_b16 a[190:191], v247 offset:18472
    v_mfma_f32_16x16x32_bf16 a[108:111], a[216:219], a[140:143], a[108:111]
    ds_read_b64_tr_b16 a[240:241], v133 offset:12288
    v_mfma_f32_16x16x32_bf16 a[112:115], a[220:223], a[128:131], a[112:115]
    v_mfma_f32_16x16x32_bf16 a[116:119], a[220:223], a[132:135], a[116:119]
    ds_read_b64_tr_b16 a[242:243], v133 offset:22528
    v_mfma_f32_16x16x32_bf16 a[120:123], a[220:223], a[136:139], a[120:123]
    v_mfma_f32_16x16x32_bf16 a[124:127], a[220:223], a[140:143], a[124:127]
    s_waitcnt lgkmcnt(15)
    v_mfma_f32_16x16x32_bf16 v[0:3], a[160:163], a[144:147], v[0:3]
    ds_read_b64_tr_b16 a[192:193], v244 offset:16672
    v_mfma_f32_16x16x32_bf16 v[4:7], a[160:163], a[148:151], v[4:7]
    ds_read_b64_tr_b16 a[194:195], v244 offset:18720
    v_mfma_f32_16x16x32_bf16 v[8:11], a[160:163], a[152:155], v[8:11]
    s_add_u32 m0, s43, 65408
    v_mfma_f32_16x16x32_bf16 v[12:15], a[160:163], a[156:159], v[12:15]
    ds_read_b64_tr_b16 a[196:197], v244 offset:16680
    v_mfma_f32_16x16x32_bf16 v[16:19], a[164:167], a[144:147], v[16:19]
    ds_read_b64_tr_b16 a[198:199], v244 offset:18728
    v_mfma_f32_16x16x32_bf16 v[20:23], a[164:167], a[148:151], v[20:23]
    s_mov_b32 s54, 3145728
    v_mfma_f32_16x16x32_bf16 v[24:27], a[164:167], a[152:155], v[24:27]
    ds_read_b64_tr_b16 a[200:201], v245 offset:16672
    v_mfma_f32_16x16x32_bf16 v[28:31], a[164:167], a[156:159], v[28:31]
    ds_read_b64_tr_b16 a[202:203], v245 offset:18720
    v_mfma_f32_16x16x32_bf16 v[32:35], a[168:171], a[144:147], v[32:35]
    buffer_load_dwordx4 v236, s[8:11], s54 offen offset:0 lds
    v_mfma_f32_16x16x32_bf16 v[36:39], a[168:171], a[148:151], v[36:39]
    ds_read_b64_tr_b16 a[204:205], v245 offset:16680
    v_mfma_f32_16x16x32_bf16 v[40:43], a[168:171], a[152:155], v[40:43]
    ds_read_b64_tr_b16 a[206:207], v245 offset:18728
    v_mfma_f32_16x16x32_bf16 v[44:47], a[168:171], a[156:159], v[44:47]
    buffer_load_dwordx4 v237, s[8:11], s54 offen offset:1024 lds
    v_mfma_f32_16x16x32_bf16 v[48:51], a[172:175], a[144:147], v[48:51]
    ds_read_b64_tr_b16 a[208:209], v246 offset:16672
    v_mfma_f32_16x16x32_bf16 v[52:55], a[172:175], a[148:151], v[52:55]
    ds_read_b64_tr_b16 a[210:211], v246 offset:18720
    v_mfma_f32_16x16x32_bf16 v[56:59], a[172:175], a[152:155], v[56:59]
    buffer_load_dwordx4 v238, s[8:11], s54 offen offset:2048 lds
    v_mfma_f32_16x16x32_bf16 v[60:63], a[172:175], a[156:159], v[60:63]
    ds_read_b64_tr_b16 a[212:213], v246 offset:16680
    s_waitcnt lgkmcnt(15)
    v_mfma_f32_16x16x32_bf16 v[64:67], a[176:179], a[144:147], v[64:67]
    ds_read_b64_tr_b16 a[214:215], v246 offset:18728
    v_mfma_f32_16x16x32_bf16 v[68:71], a[176:179], a[148:151], v[68:71]
    buffer_load_dwordx4 v239, s[8:11], s54 offen offset:3072 lds
    v_mfma_f32_16x16x32_bf16 v[72:75], a[176:179], a[152:155], v[72:75]
    ds_read_b64_tr_b16 a[216:217], v247 offset:16672
    v_mfma_f32_16x16x32_bf16 v[76:79], a[176:179], a[156:159], v[76:79]
    ds_read_b64_tr_b16 a[218:219], v247 offset:18720
    v_mfma_f32_16x16x32_bf16 v[80:83], a[180:183], a[144:147], v[80:83]
    v_mfma_f32_16x16x32_bf16 v[84:87], a[180:183], a[148:151], v[84:87]
    ds_read_b64_tr_b16 a[220:221], v247 offset:16680
    v_mfma_f32_16x16x32_bf16 v[88:91], a[180:183], a[152:155], v[88:91]
    ds_read_b64_tr_b16 a[222:223], v247 offset:18728
    v_mfma_f32_16x16x32_bf16 v[92:95], a[180:183], a[156:159], v[92:95]
    s_waitcnt lgkmcnt(15)
    v_mfma_f32_16x16x32_bf16 v[96:99], a[184:187], a[144:147], v[96:99]
    v_mfma_f32_16x16x32_bf16 v[100:103], a[184:187], a[148:151], v[100:103]
    v_mfma_f32_16x16x32_bf16 v[104:107], a[184:187], a[152:155], v[104:107]
    v_mfma_f32_16x16x32_bf16 v[108:111], a[184:187], a[156:159], v[108:111]
    v_mfma_f32_16x16x32_bf16 v[112:115], a[188:191], a[144:147], v[112:115]
    v_mfma_f32_16x16x32_bf16 v[116:119], a[188:191], a[148:151], v[116:119]
    v_mfma_f32_16x16x32_bf16 v[120:123], a[188:191], a[152:155], v[120:123]
    v_mfma_f32_16x16x32_bf16 v[124:127], a[188:191], a[156:159], v[124:127]
    s_waitcnt vmcnt(9) lgkmcnt(0)
    s_barrier
    v_mfma_f32_16x16x32_bf16 a[0:3], a[192:195], a[144:147], a[0:3]
    ds_read_b128 a[128:131], v242 offset:0
    v_mfma_f32_16x16x32_bf16 a[4:7], a[192:195], a[148:151], a[4:7]
    ds_read_b128 a[132:135], v242 offset:2048
    v_mfma_f32_16x16x32_bf16 a[8:11], a[192:195], a[152:155], a[8:11]
    ds_read_b128 a[136:139], v242 offset:4096
    s_add_u32 m0, s44, 32640
    v_mfma_f32_16x16x32_bf16 a[12:15], a[192:195], a[156:159], a[12:15]
    v_mfma_f32_16x16x32_bf16 a[16:19], a[196:199], a[144:147], a[16:19]
    ds_read_b128 a[140:143], v242 offset:6144
    s_mov_b32 s53, 768
    v_mfma_f32_16x16x32_bf16 a[20:23], a[196:199], a[148:151], a[20:23]
    ds_read_b64_tr_b16 a[160:161], v244 offset:32832
    v_mfma_f32_16x16x32_bf16 a[24:27], a[196:199], a[152:155], a[24:27]
    buffer_load_dwordx4 v228, s[4:7], s53 offen offset:0 lds
    v_mfma_f32_16x16x32_bf16 a[28:31], a[196:199], a[156:159], a[28:31]
    ds_read_b64_tr_b16 a[162:163], v244 offset:34880
    v_mfma_f32_16x16x32_bf16 a[32:35], a[200:203], a[144:147], a[32:35]
    ds_read_b64_tr_b16 a[164:165], v244 offset:32840
    v_mfma_f32_16x16x32_bf16 a[36:39], a[200:203], a[148:151], a[36:39]
    ds_read_b64_tr_b16 a[166:167], v244 offset:34888
    buffer_load_dwordx4 v229, s[4:7], s53 offen offset:1024 lds
    v_mfma_f32_16x16x32_bf16 a[40:43], a[200:203], a[152:155], a[40:43]
    v_mfma_f32_16x16x32_bf16 a[44:47], a[200:203], a[156:159], a[44:47]
    ds_read_b64_tr_b16 a[168:169], v245 offset:32832
    buffer_load_dwordx4 v230, s[4:7], s53 offen offset:2048 lds
    v_mfma_f32_16x16x32_bf16 a[48:51], a[204:207], a[144:147], a[48:51]
    ds_read_b64_tr_b16 a[170:171], v245 offset:34880
    v_mfma_f32_16x16x32_bf16 a[52:55], a[204:207], a[148:151], a[52:55]
    buffer_load_dwordx4 v231, s[4:7], s53 offen offset:3072 lds
    v_mfma_f32_16x16x32_bf16 a[56:59], a[204:207], a[152:155], a[56:59]
    ds_read_b64_tr_b16 a[172:173], v245 offset:32840
    v_mfma_f32_16x16x32_bf16 a[60:63], a[204:207], a[156:159], a[60:63]
    ds_read_b64_tr_b16 a[174:175], v245 offset:34888
    v_mfma_f32_16x16x32_bf16 a[64:67], a[208:211], a[144:147], a[64:67]
    ds_read_b64_tr_b16 a[176:177], v246 offset:32832
    s_add_u32 m0, s44, 36736
    v_mfma_f32_16x16x32_bf16 a[68:71], a[208:211], a[148:151], a[68:71]
    v_mfma_f32_16x16x32_bf16 a[72:75], a[208:211], a[152:155], a[72:75]
    ds_read_b64_tr_b16 a[178:179], v246 offset:34880
    s_mov_b32 s53, 768
    v_mfma_f32_16x16x32_bf16 a[76:79], a[208:211], a[156:159], a[76:79]
    ds_read_b64_tr_b16 a[180:181], v246 offset:32840
    v_mfma_f32_16x16x32_bf16 a[80:83], a[212:215], a[144:147], a[80:83]
    v_mfma_f32_16x16x32_bf16 a[84:87], a[212:215], a[148:151], a[84:87]
    ds_read_b64_tr_b16 a[182:183], v246 offset:34888
    buffer_load_dwordx4 v232, s[4:7], s53 offen offset:0 lds
    v_mfma_f32_16x16x32_bf16 a[88:91], a[212:215], a[152:155], a[88:91]
    ds_read_b64_tr_b16 a[184:185], v247 offset:32832
    v_mfma_f32_16x16x32_bf16 a[92:95], a[212:215], a[156:159], a[92:95]
    ds_read_b64_tr_b16 a[186:187], v247 offset:34880
    v_mfma_f32_16x16x32_bf16 a[96:99], a[216:219], a[144:147], a[96:99]
    buffer_load_dwordx4 v233, s[4:7], s53 offen offset:1024 lds
    v_mfma_f32_16x16x32_bf16 a[100:103], a[216:219], a[148:151], a[100:103]
    ds_read_b64_tr_b16 a[188:189], v247 offset:32840
    v_mfma_f32_16x16x32_bf16 a[104:107], a[216:219], a[152:155], a[104:107]
    ds_read_b64_tr_b16 a[190:191], v247 offset:34888
    buffer_load_dwordx4 v234, s[4:7], s53 offen offset:2048 lds
    v_mfma_f32_16x16x32_bf16 a[108:111], a[216:219], a[156:159], a[108:111]
    v_mfma_f32_16x16x32_bf16 a[112:115], a[220:223], a[144:147], a[112:115]
    v_mfma_f32_16x16x32_bf16 a[116:119], a[220:223], a[148:151], a[116:119]
    buffer_load_dwordx4 v235, s[4:7], s53 offen offset:3072 lds
    v_mfma_f32_16x16x32_bf16 a[120:123], a[220:223], a[152:155], a[120:123]
    v_mfma_f32_16x16x32_bf16 a[124:127], a[220:223], a[156:159], a[124:127]
    s_waitcnt lgkmcnt(12)
    v_mfma_f32_16x16x32_bf16 v[0:3], a[160:163], a[128:131], v[0:3]
    ds_read_b64_tr_b16 a[192:193], v244 offset:33088
    v_mfma_f32_16x16x32_bf16 v[4:7], a[160:163], a[132:135], v[4:7]
    ds_read_b64_tr_b16 a[194:195], v244 offset:35136
    v_mfma_f32_16x16x32_bf16 v[8:11], a[160:163], a[136:139], v[8:11]
    s_add_u32 m0, s43, 81824
    v_mfma_f32_16x16x32_bf16 v[12:15], a[160:163], a[140:143], v[12:15]
    ds_read_b64_tr_b16 a[196:197], v244 offset:33096
    v_mfma_f32_16x16x32_bf16 v[16:19], a[164:167], a[128:131], v[16:19]
    ds_read_b64_tr_b16 a[198:199], v244 offset:35144
    s_mov_b32 s54, 3407872
    v_mfma_f32_16x16x32_bf16 v[20:23], a[164:167], a[132:135], v[20:23]
    v_mfma_f32_16x16x32_bf16 v[24:27], a[164:167], a[136:139], v[24:27]
    ds_read_b64_tr_b16 a[200:201], v245 offset:33088
    buffer_load_dwordx4 v236, s[8:11], s54 offen offset:0 lds
    v_mfma_f32_16x16x32_bf16 v[28:31], a[164:167], a[140:143], v[28:31]
    ds_read_b64_tr_b16 a[202:203], v245 offset:35136
    s_waitcnt lgkmcnt(14)
    v_mfma_f32_16x16x32_bf16 v[32:35], a[168:171], a[128:131], v[32:35]
    v_mfma_f32_16x16x32_bf16 v[36:39], a[168:171], a[132:135], v[36:39]
    ds_read_b64_tr_b16 a[204:205], v245 offset:33096
    buffer_load_dwordx4 v237, s[8:11], s54 offen offset:1024 lds
    v_mfma_f32_16x16x32_bf16 v[40:43], a[168:171], a[136:139], v[40:43]
    ds_read_b64_tr_b16 a[206:207], v245 offset:35144
    v_mfma_f32_16x16x32_bf16 v[44:47], a[168:171], a[140:143], v[44:47]
    buffer_load_dwordx4 v238, s[8:11], s54 offen offset:2048 lds
    v_mfma_f32_16x16x32_bf16 v[48:51], a[172:175], a[128:131], v[48:51]
    ds_read_b64_tr_b16 a[208:209], v246 offset:33088
    v_mfma_f32_16x16x32_bf16 v[52:55], a[172:175], a[132:135], v[52:55]
    ds_read_b64_tr_b16 a[210:211], v246 offset:35136
    buffer_load_dwordx4 v239, s[8:11], s54 offen offset:3072 lds
    v_mfma_f32_16x16x32_bf16 v[56:59], a[172:175], a[136:139], v[56:59]
    v_mfma_f32_16x16x32_bf16 v[60:63], a[172:175], a[140:143], v[60:63]
    ds_read_b64_tr_b16 a[212:213], v246 offset:33096
    s_waitcnt lgkmcnt(15)
    v_mfma_f32_16x16x32_bf16 v[64:67], a[176:179], a[128:131], v[64:67]
    ds_read_b64_tr_b16 a[214:215], v246 offset:35144
    v_mfma_f32_16x16x32_bf16 v[68:71], a[176:179], a[132:135], v[68:71]
    v_mfma_f32_16x16x32_bf16 v[72:75], a[176:179], a[136:139], v[72:75]
    ds_read_b64_tr_b16 a[216:217], v247 offset:33088
    buffer_load_dword v208, v206, s[24:27], s51 offen
    v_mfma_f32_16x16x32_bf16 v[76:79], a[176:179], a[140:143], v[76:79]
    ds_read_b64_tr_b16 a[218:219], v247 offset:35136
    s_add_u32 s51, s51, s50
    v_mfma_f32_16x16x32_bf16 v[80:83], a[180:183], a[128:131], v[80:83]
    v_mfma_f32_16x16x32_bf16 v[84:87], a[180:183], a[132:135], v[84:87]
    ds_read_b64_tr_b16 a[220:221], v247 offset:33096
    s_mul_i32 s57, s40, 5120
    v_mfma_f32_16x16x32_bf16 v[88:91], a[180:183], a[136:139], v[88:91]
    ds_read_b64_tr_b16 a[222:223], v247 offset:35144
    v_mfma_f32_16x16x32_bf16 v[92:95], a[180:183], a[140:143], v[92:95]
    s_add_u32 m0, s57, 12160
    s_waitcnt lgkmcnt(15)
    v_mfma_f32_16x16x32_bf16 v[96:99], a[184:187], a[128:131], v[96:99]
    v_mfma_f32_16x16x32_bf16 v[100:103], a[184:187], a[132:135], v[100:103]
    s_mov_b32 s58, 640
    v_mfma_f32_16x16x32_bf16 v[104:107], a[184:187], a[136:139], v[104:107]
    v_mfma_f32_16x16x32_bf16 v[108:111], a[184:187], a[140:143], v[108:111]
    buffer_load_dwordx4 v128, s[32:35], s58 offen offset:0 lds
    v_mfma_f32_16x16x32_bf16 v[112:115], a[188:191], a[128:131], v[112:115]
    v_mfma_f32_16x16x32_bf16 v[116:119], a[188:191], a[132:135], v[116:119]
    buffer_load_dwordx4 v129, s[32:35], s58 offen offset:1024 lds
    v_mfma_f32_16x16x32_bf16 v[120:123], a[188:191], a[136:139], v[120:123]
    v_mfma_f32_16x16x32_bf16 v[124:127], a[188:191], a[140:143], v[124:127]
    s_waitcnt vmcnt(20) lgkmcnt(0)
    s_barrier
    v_mfma_f32_16x16x32_bf16 a[0:3], a[192:195], a[128:131], a[0:3]
    ds_read_b128 a[144:147], v243 offset:0
    v_mfma_f32_16x16x32_bf16 a[4:7], a[192:195], a[132:135], a[4:7]
    ds_read_b128 a[148:151], v243 offset:2048
    v_mfma_f32_16x16x32_bf16 a[8:11], a[192:195], a[136:139], a[8:11]
    ds_read_b128 a[152:155], v243 offset:4096
    v_mfma_f32_16x16x32_bf16 a[12:15], a[192:195], a[140:143], a[12:15]
    v_mfma_f32_16x16x32_bf16 a[16:19], a[196:199], a[128:131], a[16:19]
    ds_read_b128 a[156:159], v243 offset:6144
    v_mfma_f32_16x16x32_bf16 a[20:23], a[196:199], a[132:135], a[20:23]
    ds_read_b64_tr_b16 a[160:161], v244 offset:49248
    v_mfma_f32_16x16x32_bf16 a[24:27], a[196:199], a[136:139], a[24:27]
    v_mfma_f32_16x16x32_bf16 a[28:31], a[196:199], a[140:143], a[28:31]
    ds_read_b64_tr_b16 a[162:163], v244 offset:51296
    v_mfma_f32_16x16x32_bf16 a[32:35], a[200:203], a[128:131], a[32:35]
    ds_read_b64_tr_b16 a[164:165], v244 offset:49256
    v_mfma_f32_16x16x32_bf16 a[36:39], a[200:203], a[132:135], a[36:39]
    ds_read_b64_tr_b16 a[166:167], v244 offset:51304
    v_mfma_f32_16x16x32_bf16 a[40:43], a[200:203], a[136:139], a[40:43]
    v_mfma_f32_16x16x32_bf16 a[44:47], a[200:203], a[140:143], a[44:47]
    ds_read_b64_tr_b16 a[168:169], v245 offset:49248
    v_mfma_f32_16x16x32_bf16 a[48:51], a[204:207], a[128:131], a[48:51]
    ds_read_b64_tr_b16 a[170:171], v245 offset:51296
    v_mfma_f32_16x16x32_bf16 a[52:55], a[204:207], a[132:135], a[52:55]
    v_mfma_f32_16x16x32_bf16 a[56:59], a[204:207], a[136:139], a[56:59]
    ds_read_b64_tr_b16 a[172:173], v245 offset:49256
    v_mfma_f32_16x16x32_bf16 a[60:63], a[204:207], a[140:143], a[60:63]
    ds_read_b64_tr_b16 a[174:175], v245 offset:51304
    v_mfma_f32_16x16x32_bf16 a[64:67], a[208:211], a[128:131], a[64:67]
    ds_read_b64_tr_b16 a[176:177], v246 offset:49248
    v_mfma_f32_16x16x32_bf16 a[68:71], a[208:211], a[132:135], a[68:71]
    v_mfma_f32_16x16x32_bf16 a[72:75], a[208:211], a[136:139], a[72:75]
    ds_read_b64_tr_b16 a[178:179], v246 offset:51296
    v_mfma_f32_16x16x32_bf16 a[76:79], a[208:211], a[140:143], a[76:79]
    ds_read_b64_tr_b16 a[180:181], v246 offset:49256
    v_mfma_f32_16x16x32_bf16 a[80:83], a[212:215], a[128:131], a[80:83]
    v_mfma_f32_16x16x32_bf16 a[84:87], a[212:215], a[132:135], a[84:87]
    ds_read_b64_tr_b16 a[182:183], v246 offset:51304
    v_mfma_f32_16x16x32_bf16 a[88:91], a[212:215], a[136:139], a[88:91]
    ds_read_b64_tr_b16 a[184:185], v247 offset:49248
    v_mfma_f32_16x16x32_bf16 a[92:95], a[212:215], a[140:143], a[92:95]
    ds_read_b64_tr_b16 a[186:187], v247 offset:51296
    v_mfma_f32_16x16x32_bf16 a[96:99], a[216:219], a[128:131], a[96:99]
    v_mfma_f32_16x16x32_bf16 a[100:103], a[216:219], a[132:135], a[100:103]
    ds_read_b64_tr_b16 a[188:189], v247 offset:49256
    v_mfma_f32_16x16x32_bf16 a[104:107], a[216:219], a[136:139], a[104:107]
    ds_read_b64_tr_b16 a[190:191], v247 offset:51304
    v_mfma_f32_16x16x32_bf16 a[108:111], a[216:219], a[140:143], a[108:111]
    v_mfma_f32_16x16x32_bf16 a[112:115], a[220:223], a[128:131], a[112:115]
    v_mfma_f32_16x16x32_bf16 a[116:119], a[220:223], a[132:135], a[116:119]
    v_mfma_f32_16x16x32_bf16 a[120:123], a[220:223], a[136:139], a[120:123]
    v_mfma_f32_16x16x32_bf16 a[124:127], a[220:223], a[140:143], a[124:127]
    s_waitcnt lgkmcnt(12)
    v_mfma_f32_16x16x32_bf16 v[0:3], a[160:163], a[144:147], v[0:3]
    ds_read_b64_tr_b16 a[192:193], v244 offset:49504
    v_mfma_f32_16x16x32_bf16 v[4:7], a[160:163], a[148:151], v[4:7]
    ds_read_b64_tr_b16 a[194:195], v244 offset:51552
    v_mfma_f32_16x16x32_bf16 v[8:11], a[160:163], a[152:155], v[8:11]
    s_add_u32 m0, s43, 98240
    v_mfma_f32_16x16x32_bf16 v[12:15], a[160:163], a[156:159], v[12:15]
    ds_read_b64_tr_b16 a[196:197], v244 offset:49512
    v_mfma_f32_16x16x32_bf16 v[16:19], a[164:167], a[144:147], v[16:19]
    ds_read_b64_tr_b16 a[198:199], v244 offset:51560
    v_mfma_f32_16x16x32_bf16 v[20:23], a[164:167], a[148:151], v[20:23]
    s_mov_b32 s54, 3670016
    v_mfma_f32_16x16x32_bf16 v[24:27], a[164:167], a[152:155], v[24:27]
    ds_read_b64_tr_b16 a[200:201], v245 offset:49504
    v_mfma_f32_16x16x32_bf16 v[28:31], a[164:167], a[156:159], v[28:31]
    ds_read_b64_tr_b16 a[202:203], v245 offset:51552
    s_waitcnt lgkmcnt(14)
    v_mfma_f32_16x16x32_bf16 v[32:35], a[168:171], a[144:147], v[32:35]
    buffer_load_dwordx4 v236, s[8:11], s54 offen offset:0 lds
    v_mfma_f32_16x16x32_bf16 v[36:39], a[168:171], a[148:151], v[36:39]
    ds_read_b64_tr_b16 a[204:205], v245 offset:49512
    v_mfma_f32_16x16x32_bf16 v[40:43], a[168:171], a[152:155], v[40:43]
    ds_read_b64_tr_b16 a[206:207], v245 offset:51560
    v_mfma_f32_16x16x32_bf16 v[44:47], a[168:171], a[156:159], v[44:47]
    buffer_load_dwordx4 v237, s[8:11], s54 offen offset:1024 lds
    v_mfma_f32_16x16x32_bf16 v[48:51], a[172:175], a[144:147], v[48:51]
    ds_read_b64_tr_b16 a[208:209], v246 offset:49504
    v_mfma_f32_16x16x32_bf16 v[52:55], a[172:175], a[148:151], v[52:55]
    ds_read_b64_tr_b16 a[210:211], v246 offset:51552
    v_mfma_f32_16x16x32_bf16 v[56:59], a[172:175], a[152:155], v[56:59]
    buffer_load_dwordx4 v238, s[8:11], s54 offen offset:2048 lds
    v_mfma_f32_16x16x32_bf16 v[60:63], a[172:175], a[156:159], v[60:63]
    ds_read_b64_tr_b16 a[212:213], v246 offset:49512
    s_waitcnt lgkmcnt(15)
    v_mfma_f32_16x16x32_bf16 v[64:67], a[176:179], a[144:147], v[64:67]
    ds_read_b64_tr_b16 a[214:215], v246 offset:51560
    v_mfma_f32_16x16x32_bf16 v[68:71], a[176:179], a[148:151], v[68:71]
    buffer_load_dwordx4 v239, s[8:11], s54 offen offset:3072 lds
    v_mfma_f32_16x16x32_bf16 v[72:75], a[176:179], a[152:155], v[72:75]
    ds_read_b64_tr_b16 a[216:217], v247 offset:49504
    v_mfma_f32_16x16x32_bf16 v[76:79], a[176:179], a[156:159], v[76:79]
    ds_read_b64_tr_b16 a[218:219], v247 offset:51552
    v_mfma_f32_16x16x32_bf16 v[80:83], a[180:183], a[144:147], v[80:83]
    v_mfma_f32_16x16x32_bf16 v[84:87], a[180:183], a[148:151], v[84:87]
    ds_read_b64_tr_b16 a[220:221], v247 offset:49512
    v_mfma_f32_16x16x32_bf16 v[88:91], a[180:183], a[152:155], v[88:91]
    ds_read_b64_tr_b16 a[222:223], v247 offset:51560
    v_mfma_f32_16x16x32_bf16 v[92:95], a[180:183], a[156:159], v[92:95]
    s_waitcnt lgkmcnt(15)
    v_mfma_f32_16x16x32_bf16 v[96:99], a[184:187], a[144:147], v[96:99]
    v_mfma_f32_16x16x32_bf16 v[100:103], a[184:187], a[148:151], v[100:103]
    v_mfma_f32_16x16x32_bf16 v[104:107], a[184:187], a[152:155], v[104:107]
    v_mfma_f32_16x16x32_bf16 v[108:111], a[184:187], a[156:159], v[108:111]
    v_mfma_f32_16x16x32_bf16 v[112:115], a[188:191], a[144:147], v[112:115]
    v_mfma_f32_16x16x32_bf16 v[116:119], a[188:191], a[148:151], v[116:119]
    v_mfma_f32_16x16x32_bf16 v[120:123], a[188:191], a[152:155], v[120:123]
    v_mfma_f32_16x16x32_bf16 v[124:127], a[188:191], a[156:159], v[124:127]
    s_waitcnt vmcnt(11) lgkmcnt(0)
    s_barrier
    v_mfma_f32_16x16x32_bf16 a[0:3], a[192:195], a[144:147], a[0:3]
    ds_read_b128 a[128:131], v240 offset:0
    v_mfma_f32_16x16x32_bf16 a[4:7], a[192:195], a[148:151], a[4:7]
    ds_read_b128 a[132:135], v240 offset:2048
    v_mfma_f32_16x16x32_bf16 a[8:11], a[192:195], a[152:155], a[8:11]
    ds_read_b128 a[136:139], v240 offset:4096
    s_add_u32 m0, s44, 131072
    v_mfma_f32_16x16x32_bf16 a[12:15], a[192:195], a[156:159], a[12:15]
    v_mfma_f32_16x16x32_bf16 a[16:19], a[196:199], a[144:147], a[16:19]
    ds_read_b128 a[140:143], v240 offset:6144
    s_mov_b32 s53, 896
    v_mfma_f32_16x16x32_bf16 a[20:23], a[196:199], a[148:151], a[20:23]
    ds_read_b64_tr_b16 a[160:161], v244 offset:0
    v_mfma_f32_16x16x32_bf16 a[24:27], a[196:199], a[152:155], a[24:27]
    buffer_load_dwordx4 v228, s[4:7], s53 offen offset:0 lds
    v_mfma_f32_16x16x32_bf16 a[28:31], a[196:199], a[156:159], a[28:31]
    ds_read_b64_tr_b16 a[162:163], v244 offset:2048
    v_mfma_f32_16x16x32_bf16 a[32:35], a[200:203], a[144:147], a[32:35]
    ds_read_b64_tr_b16 a[164:165], v244 offset:8
    v_mfma_f32_16x16x32_bf16 a[36:39], a[200:203], a[148:151], a[36:39]
    ds_read_b64_tr_b16 a[166:167], v244 offset:2056
    buffer_load_dwordx4 v229, s[4:7], s53 offen offset:1024 lds
    v_mfma_f32_16x16x32_bf16 a[40:43], a[200:203], a[152:155], a[40:43]
    v_mfma_f32_16x16x32_bf16 a[44:47], a[200:203], a[156:159], a[44:47]
    ds_read_b64_tr_b16 a[168:169], v245 offset:0
    buffer_load_dwordx4 v230, s[4:7], s53 offen offset:2048 lds
    v_mfma_f32_16x16x32_bf16 a[48:51], a[204:207], a[144:147], a[48:51]
    ds_read_b64_tr_b16 a[170:171], v245 offset:2048
    v_mfma_f32_16x16x32_bf16 a[52:55], a[204:207], a[148:151], a[52:55]
    buffer_load_dwordx4 v231, s[4:7], s53 offen offset:3072 lds
    v_mfma_f32_16x16x32_bf16 a[56:59], a[204:207], a[152:155], a[56:59]
    ds_read_b64_tr_b16 a[172:173], v245 offset:8
    v_mfma_f32_16x16x32_bf16 a[60:63], a[204:207], a[156:159], a[60:63]
    ds_read_b64_tr_b16 a[174:175], v245 offset:2056
    v_mfma_f32_16x16x32_bf16 a[64:67], a[208:211], a[144:147], a[64:67]
    ds_read_b64_tr_b16 a[176:177], v246 offset:0
    s_add_u32 m0, s44, 135168
    v_mfma_f32_16x16x32_bf16 a[68:71], a[208:211], a[148:151], a[68:71]
    v_mfma_f32_16x16x32_bf16 a[72:75], a[208:211], a[152:155], a[72:75]
    ds_read_b64_tr_b16 a[178:179], v246 offset:2048
    s_mov_b32 s53, 896
    v_mfma_f32_16x16x32_bf16 a[76:79], a[208:211], a[156:159], a[76:79]
    ds_read_b64_tr_b16 a[180:181], v246 offset:8
    v_mfma_f32_16x16x32_bf16 a[80:83], a[212:215], a[144:147], a[80:83]
    v_mfma_f32_16x16x32_bf16 a[84:87], a[212:215], a[148:151], a[84:87]
    ds_read_b64_tr_b16 a[182:183], v246 offset:2056
    buffer_load_dwordx4 v232, s[4:7], s53 offen offset:0 lds
    v_mfma_f32_16x16x32_bf16 a[88:91], a[212:215], a[152:155], a[88:91]
    ds_read_b64_tr_b16 a[184:185], v247 offset:0
    v_mfma_f32_16x16x32_bf16 a[92:95], a[212:215], a[156:159], a[92:95]
    ds_read_b64_tr_b16 a[186:187], v247 offset:2048
    v_mfma_f32_16x16x32_bf16 a[96:99], a[216:219], a[144:147], a[96:99]
    buffer_load_dwordx4 v233, s[4:7], s53 offen offset:1024 lds
    v_mfma_f32_16x16x32_bf16 a[100:103], a[216:219], a[148:151], a[100:103]
    ds_read_b64_tr_b16 a[188:189], v247 offset:8
    v_mfma_f32_16x16x32_bf16 a[104:107], a[216:219], a[152:155], a[104:107]
    ds_read_b64_tr_b16 a[190:191], v247 offset:2056
    buffer_load_dwordx4 v234, s[4:7], s53 offen offset:2048 lds
    v_mfma_f32_16x16x32_bf16 a[108:111], a[216:219], a[156:159], a[108:111]
    v_mfma_f32_16x16x32_bf16 a[112:115], a[220:223], a[144:147], a[112:115]
    v_mfma_f32_16x16x32_bf16 a[116:119], a[220:223], a[148:151], a[116:119]
    buffer_load_dwordx4 v235, s[4:7], s53 offen offset:3072 lds
    v_mfma_f32_16x16x32_bf16 a[120:123], a[220:223], a[152:155], a[120:123]
    v_mfma_f32_16x16x32_bf16 a[124:127], a[220:223], a[156:159], a[124:127]
    s_waitcnt lgkmcnt(12)
    v_mfma_f32_16x16x32_bf16 v[0:3], a[160:163], a[128:131], v[0:3]
    ds_read_b64_tr_b16 a[192:193], v244 offset:256
    v_mfma_f32_16x16x32_bf16 v[4:7], a[160:163], a[132:135], v[4:7]
    ds_read_b64_tr_b16 a[194:195], v244 offset:2304
    v_mfma_f32_16x16x32_bf16 v[8:11], a[160:163], a[136:139], v[8:11]
    s_add_u32 m0, s43, 114656
    v_mfma_f32_16x16x32_bf16 v[12:15], a[160:163], a[140:143], v[12:15]
    ds_read_b64_tr_b16 a[196:197], v244 offset:264
    v_mfma_f32_16x16x32_bf16 v[16:19], a[164:167], a[128:131], v[16:19]
    ds_read_b64_tr_b16 a[198:199], v244 offset:2312
    s_mov_b32 s54, 3932160
    v_mfma_f32_16x16x32_bf16 v[20:23], a[164:167], a[132:135], v[20:23]
    v_mfma_f32_16x16x32_bf16 v[24:27], a[164:167], a[136:139], v[24:27]
    ds_read_b64_tr_b16 a[200:201], v245 offset:256
    buffer_load_dwordx4 v236, s[8:11], s54 offen offset:0 lds
    v_mfma_f32_16x16x32_bf16 v[28:31], a[164:167], a[140:143], v[28:31]
    ds_read_b64_tr_b16 a[202:203], v245 offset:2304
    s_waitcnt lgkmcnt(14)
    v_mfma_f32_16x16x32_bf16 v[32:35], a[168:171], a[128:131], v[32:35]
    v_mfma_f32_16x16x32_bf16 v[36:39], a[168:171], a[132:135], v[36:39]
    ds_read_b64_tr_b16 a[204:205], v245 offset:264
    buffer_load_dwordx4 v237, s[8:11], s54 offen offset:1024 lds
    v_mfma_f32_16x16x32_bf16 v[40:43], a[168:171], a[136:139], v[40:43]
    ds_read_b64_tr_b16 a[206:207], v245 offset:2312
    v_mfma_f32_16x16x32_bf16 v[44:47], a[168:171], a[140:143], v[44:47]
    buffer_load_dwordx4 v238, s[8:11], s54 offen offset:2048 lds
    v_mfma_f32_16x16x32_bf16 v[48:51], a[172:175], a[128:131], v[48:51]
    ds_read_b64_tr_b16 a[208:209], v246 offset:256
    v_mfma_f32_16x16x32_bf16 v[52:55], a[172:175], a[132:135], v[52:55]
    ds_read_b64_tr_b16 a[210:211], v246 offset:2304
    buffer_load_dwordx4 v239, s[8:11], s54 offen offset:3072 lds
    v_mfma_f32_16x16x32_bf16 v[56:59], a[172:175], a[136:139], v[56:59]
    v_mfma_f32_16x16x32_bf16 v[60:63], a[172:175], a[140:143], v[60:63]
    ds_read_b64_tr_b16 a[212:213], v246 offset:264
    s_waitcnt lgkmcnt(15)
    v_mfma_f32_16x16x32_bf16 v[64:67], a[176:179], a[128:131], v[64:67]
    ds_read_b64_tr_b16 a[214:215], v246 offset:2312
    v_mfma_f32_16x16x32_bf16 v[68:71], a[176:179], a[132:135], v[68:71]
    v_mfma_f32_16x16x32_bf16 v[72:75], a[176:179], a[136:139], v[72:75]
    ds_read_b64_tr_b16 a[216:217], v247 offset:256
    buffer_load_dword v208, v206, s[24:27], s51 offen
    v_mfma_f32_16x16x32_bf16 v[76:79], a[176:179], a[140:143], v[76:79]
    ds_read_b64_tr_b16 a[218:219], v247 offset:2304
    s_add_u32 s51, s51, s50
    v_mfma_f32_16x16x32_bf16 v[80:83], a[180:183], a[128:131], v[80:83]
    v_mfma_f32_16x16x32_bf16 v[84:87], a[180:183], a[132:135], v[84:87]
    ds_read_b64_tr_b16 a[220:221], v247 offset:264
    s_mul_i32 s57, s40, 5120
    v_mfma_f32_16x16x32_bf16 v[88:91], a[180:183], a[136:139], v[88:91]
    ds_read_b64_tr_b16 a[222:223], v247 offset:2312
    v_mfma_f32_16x16x32_bf16 v[92:95], a[180:183], a[140:143], v[92:95]
    s_add_u32 m0, s57, 12160
    s_waitcnt lgkmcnt(15)
    v_mfma_f32_16x16x32_bf16 v[96:99], a[184:187], a[128:131], v[96:99]
    v_mfma_f32_16x16x32_bf16 v[100:103], a[184:187], a[132:135], v[100:103]
    s_mov_b32 s58, 640
    v_mfma_f32_16x16x32_bf16 v[104:107], a[184:187], a[136:139], v[104:107]
    v_mfma_f32_16x16x32_bf16 v[108:111], a[184:187], a[140:143], v[108:111]
    buffer_load_dwordx4 v130, s[32:35], s58 offen offset:2048 lds
    v_mfma_f32_16x16x32_bf16 v[112:115], a[188:191], a[128:131], v[112:115]
    v_mfma_f32_16x16x32_bf16 v[116:119], a[188:191], a[132:135], v[116:119]
    buffer_load_dwordx4 v131, s[32:35], s58 offen offset:3072 lds
    v_mfma_f32_16x16x32_bf16 v[120:123], a[188:191], a[136:139], v[120:123]
    v_mfma_f32_16x16x32_bf16 v[124:127], a[188:191], a[140:143], v[124:127]
    s_waitcnt vmcnt(22) lgkmcnt(0)
    s_barrier
    v_mfma_f32_16x16x32_bf16 a[0:3], a[192:195], a[128:131], a[0:3]
    ds_read_b128 a[144:147], v241 offset:0
    v_mfma_f32_16x16x32_bf16 a[4:7], a[192:195], a[132:135], a[4:7]
    ds_read_b128 a[148:151], v241 offset:2048
    v_mfma_f32_16x16x32_bf16 a[8:11], a[192:195], a[136:139], a[8:11]
    ds_read_b128 a[152:155], v241 offset:4096
    v_mfma_f32_16x16x32_bf16 a[12:15], a[192:195], a[140:143], a[12:15]
    v_mfma_f32_16x16x32_bf16 a[16:19], a[196:199], a[128:131], a[16:19]
    ds_read_b128 a[156:159], v241 offset:6144
    v_mfma_f32_16x16x32_bf16 a[20:23], a[196:199], a[132:135], a[20:23]
    ds_read_b64_tr_b16 a[160:161], v244 offset:16416
    v_mfma_f32_16x16x32_bf16 a[24:27], a[196:199], a[136:139], a[24:27]
    v_mfma_f32_16x16x32_bf16 a[28:31], a[196:199], a[140:143], a[28:31]
    ds_read_b64_tr_b16 a[162:163], v244 offset:18464
    v_mfma_f32_16x16x32_bf16 a[32:35], a[200:203], a[128:131], a[32:35]
    ds_read_b64_tr_b16 a[164:165], v244 offset:16424
    v_mfma_f32_16x16x32_bf16 a[36:39], a[200:203], a[132:135], a[36:39]
    ds_read_b64_tr_b16 a[166:167], v244 offset:18472
    v_mfma_f32_16x16x32_bf16 a[40:43], a[200:203], a[136:139], a[40:43]
    v_mfma_f32_16x16x32_bf16 a[44:47], a[200:203], a[140:143], a[44:47]
    ds_read_b64_tr_b16 a[168:169], v245 offset:16416
    v_mfma_f32_16x16x32_bf16 a[48:51], a[204:207], a[128:131], a[48:51]
    ds_read_b64_tr_b16 a[170:171], v245 offset:18464
    v_mfma_f32_16x16x32_bf16 a[52:55], a[204:207], a[132:135], a[52:55]
    v_mfma_f32_16x16x32_bf16 a[56:59], a[204:207], a[136:139], a[56:59]
    ds_read_b64_tr_b16 a[172:173], v245 offset:16424
    v_mfma_f32_16x16x32_bf16 a[60:63], a[204:207], a[140:143], a[60:63]
    ds_read_b64_tr_b16 a[174:175], v245 offset:18472
    v_mfma_f32_16x16x32_bf16 a[64:67], a[208:211], a[128:131], a[64:67]
    ds_read_b64_tr_b16 a[176:177], v246 offset:16416
    v_mfma_f32_16x16x32_bf16 a[68:71], a[208:211], a[132:135], a[68:71]
    v_mfma_f32_16x16x32_bf16 a[72:75], a[208:211], a[136:139], a[72:75]
    ds_read_b64_tr_b16 a[178:179], v246 offset:18464
    v_mfma_f32_16x16x32_bf16 a[76:79], a[208:211], a[140:143], a[76:79]
    ds_read_b64_tr_b16 a[180:181], v246 offset:16424
    v_mfma_f32_16x16x32_bf16 a[80:83], a[212:215], a[128:131], a[80:83]
    v_mfma_f32_16x16x32_bf16 a[84:87], a[212:215], a[132:135], a[84:87]
    ds_read_b64_tr_b16 a[182:183], v246 offset:18472
    v_mfma_f32_16x16x32_bf16 a[88:91], a[212:215], a[136:139], a[88:91]
    ds_read_b64_tr_b16 a[184:185], v247 offset:16416
    v_mfma_f32_16x16x32_bf16 a[92:95], a[212:215], a[140:143], a[92:95]
    ds_read_b64_tr_b16 a[186:187], v247 offset:18464
    v_mfma_f32_16x16x32_bf16 a[96:99], a[216:219], a[128:131], a[96:99]
    v_mfma_f32_16x16x32_bf16 a[100:103], a[216:219], a[132:135], a[100:103]
    ds_read_b64_tr_b16 a[188:189], v247 offset:16424
    v_mfma_f32_16x16x32_bf16 a[104:107], a[216:219], a[136:139], a[104:107]
    ds_read_b64_tr_b16 a[190:191], v247 offset:18472
    v_mfma_f32_16x16x32_bf16 a[108:111], a[216:219], a[140:143], a[108:111]
    v_mfma_f32_16x16x32_bf16 a[112:115], a[220:223], a[128:131], a[112:115]
    v_mfma_f32_16x16x32_bf16 a[116:119], a[220:223], a[132:135], a[116:119]
    v_mfma_f32_16x16x32_bf16 a[120:123], a[220:223], a[136:139], a[120:123]
    v_mfma_f32_16x16x32_bf16 a[124:127], a[220:223], a[140:143], a[124:127]
    s_waitcnt lgkmcnt(12)
    v_mfma_f32_16x16x32_bf16 v[0:3], a[160:163], a[144:147], v[0:3]
    ds_read_b64_tr_b16 a[192:193], v244 offset:16672
    v_mfma_f32_16x16x32_bf16 v[4:7], a[160:163], a[148:151], v[4:7]
    ds_read_b64_tr_b16 a[194:195], v244 offset:18720
    v_mfma_f32_16x16x32_bf16 v[8:11], a[160:163], a[152:155], v[8:11]
    s_add_u32 m0, s43, 65408
    v_mfma_f32_16x16x32_bf16 v[12:15], a[160:163], a[156:159], v[12:15]
    ds_read_b64_tr_b16 a[196:197], v244 offset:16680
    v_mfma_f32_16x16x32_bf16 v[16:19], a[164:167], a[144:147], v[16:19]
    ds_read_b64_tr_b16 a[198:199], v244 offset:18728
    v_mfma_f32_16x16x32_bf16 v[20:23], a[164:167], a[148:151], v[20:23]
    s_mov_b32 s54, 4194304
    v_mfma_f32_16x16x32_bf16 v[24:27], a[164:167], a[152:155], v[24:27]
    ds_read_b64_tr_b16 a[200:201], v245 offset:16672
    v_mfma_f32_16x16x32_bf16 v[28:31], a[164:167], a[156:159], v[28:31]
    ds_read_b64_tr_b16 a[202:203], v245 offset:18720
    s_waitcnt lgkmcnt(14)
    v_mfma_f32_16x16x32_bf16 v[32:35], a[168:171], a[144:147], v[32:35]
    buffer_load_dwordx4 v236, s[8:11], s54 offen offset:0 lds
    v_mfma_f32_16x16x32_bf16 v[36:39], a[168:171], a[148:151], v[36:39]
    ds_read_b64_tr_b16 a[204:205], v245 offset:16680
    v_mfma_f32_16x16x32_bf16 v[40:43], a[168:171], a[152:155], v[40:43]
    ds_read_b64_tr_b16 a[206:207], v245 offset:18728
    v_mfma_f32_16x16x32_bf16 v[44:47], a[168:171], a[156:159], v[44:47]
    buffer_load_dwordx4 v237, s[8:11], s54 offen offset:1024 lds
    v_mfma_f32_16x16x32_bf16 v[48:51], a[172:175], a[144:147], v[48:51]
    ds_read_b64_tr_b16 a[208:209], v246 offset:16672
    v_mfma_f32_16x16x32_bf16 v[52:55], a[172:175], a[148:151], v[52:55]
    ds_read_b64_tr_b16 a[210:211], v246 offset:18720
    v_mfma_f32_16x16x32_bf16 v[56:59], a[172:175], a[152:155], v[56:59]
    buffer_load_dwordx4 v238, s[8:11], s54 offen offset:2048 lds
    v_mfma_f32_16x16x32_bf16 v[60:63], a[172:175], a[156:159], v[60:63]
    ds_read_b64_tr_b16 a[212:213], v246 offset:16680
    s_waitcnt lgkmcnt(15)
    v_mfma_f32_16x16x32_bf16 v[64:67], a[176:179], a[144:147], v[64:67]
    ds_read_b64_tr_b16 a[214:215], v246 offset:18728
    v_mfma_f32_16x16x32_bf16 v[68:71], a[176:179], a[148:151], v[68:71]
    buffer_load_dwordx4 v239, s[8:11], s54 offen offset:3072 lds
    v_mfma_f32_16x16x32_bf16 v[72:75], a[176:179], a[152:155], v[72:75]
    ds_read_b64_tr_b16 a[216:217], v247 offset:16672
    v_mfma_f32_16x16x32_bf16 v[76:79], a[176:179], a[156:159], v[76:79]
    ds_read_b64_tr_b16 a[218:219], v247 offset:18720
    v_mfma_f32_16x16x32_bf16 v[80:83], a[180:183], a[144:147], v[80:83]
    v_mfma_f32_16x16x32_bf16 v[84:87], a[180:183], a[148:151], v[84:87]
    ds_read_b64_tr_b16 a[220:221], v247 offset:16680
    v_mfma_f32_16x16x32_bf16 v[88:91], a[180:183], a[152:155], v[88:91]
    ds_read_b64_tr_b16 a[222:223], v247 offset:18728
    v_mfma_f32_16x16x32_bf16 v[92:95], a[180:183], a[156:159], v[92:95]
    s_waitcnt lgkmcnt(15)
    v_mfma_f32_16x16x32_bf16 v[96:99], a[184:187], a[144:147], v[96:99]
    v_mfma_f32_16x16x32_bf16 v[100:103], a[184:187], a[148:151], v[100:103]
    v_mfma_f32_16x16x32_bf16 v[104:107], a[184:187], a[152:155], v[104:107]
    v_mfma_f32_16x16x32_bf16 v[108:111], a[184:187], a[156:159], v[108:111]
    v_mfma_f32_16x16x32_bf16 v[112:115], a[188:191], a[144:147], v[112:115]
    v_mfma_f32_16x16x32_bf16 v[116:119], a[188:191], a[148:151], v[116:119]
    v_mfma_f32_16x16x32_bf16 v[120:123], a[188:191], a[152:155], v[120:123]
    v_mfma_f32_16x16x32_bf16 v[124:127], a[188:191], a[156:159], v[124:127]
    s_waitcnt vmcnt(11) lgkmcnt(0)
    s_barrier
    v_mfma_f32_16x16x32_bf16 a[0:3], a[192:195], a[144:147], a[0:3]
    ds_read_b128 a[128:131], v242 offset:0
    v_mfma_f32_16x16x32_bf16 a[4:7], a[192:195], a[148:151], a[4:7]
    ds_read_b128 a[132:135], v242 offset:2048
    v_mfma_f32_16x16x32_bf16 a[8:11], a[192:195], a[152:155], a[8:11]
    ds_read_b128 a[136:139], v242 offset:4096
    s_add_u32 m0, s44, 32640
    v_mfma_f32_16x16x32_bf16 a[12:15], a[192:195], a[156:159], a[12:15]
    v_mfma_f32_16x16x32_bf16 a[16:19], a[196:199], a[144:147], a[16:19]
    ds_read_b128 a[140:143], v242 offset:6144
    s_mov_b32 s53, 1024
    v_mfma_f32_16x16x32_bf16 a[20:23], a[196:199], a[148:151], a[20:23]
    ds_read_b64_tr_b16 a[160:161], v244 offset:32832
    v_mfma_f32_16x16x32_bf16 a[24:27], a[196:199], a[152:155], a[24:27]
    buffer_load_dwordx4 v228, s[4:7], s53 offen offset:0 lds
    v_mfma_f32_16x16x32_bf16 a[28:31], a[196:199], a[156:159], a[28:31]
    ds_read_b64_tr_b16 a[162:163], v244 offset:34880
    v_mfma_f32_16x16x32_bf16 a[32:35], a[200:203], a[144:147], a[32:35]
    ds_read_b64_tr_b16 a[164:165], v244 offset:32840
    v_mfma_f32_16x16x32_bf16 a[36:39], a[200:203], a[148:151], a[36:39]
    ds_read_b64_tr_b16 a[166:167], v244 offset:34888
    buffer_load_dwordx4 v229, s[4:7], s53 offen offset:1024 lds
    v_mfma_f32_16x16x32_bf16 a[40:43], a[200:203], a[152:155], a[40:43]
    v_mfma_f32_16x16x32_bf16 a[44:47], a[200:203], a[156:159], a[44:47]
    ds_read_b64_tr_b16 a[168:169], v245 offset:32832
    buffer_load_dwordx4 v230, s[4:7], s53 offen offset:2048 lds
    v_mfma_f32_16x16x32_bf16 a[48:51], a[204:207], a[144:147], a[48:51]
    ds_read_b64_tr_b16 a[170:171], v245 offset:34880
    v_mfma_f32_16x16x32_bf16 a[52:55], a[204:207], a[148:151], a[52:55]
    buffer_load_dwordx4 v231, s[4:7], s53 offen offset:3072 lds
    v_mfma_f32_16x16x32_bf16 a[56:59], a[204:207], a[152:155], a[56:59]
    ds_read_b64_tr_b16 a[172:173], v245 offset:32840
    v_mfma_f32_16x16x32_bf16 a[60:63], a[204:207], a[156:159], a[60:63]
    ds_read_b64_tr_b16 a[174:175], v245 offset:34888
    v_mfma_f32_16x16x32_bf16 a[64:67], a[208:211], a[144:147], a[64:67]
    ds_read_b64_tr_b16 a[176:177], v246 offset:32832
    s_add_u32 m0, s44, 36736
    v_mfma_f32_16x16x32_bf16 a[68:71], a[208:211], a[148:151], a[68:71]
    v_mfma_f32_16x16x32_bf16 a[72:75], a[208:211], a[152:155], a[72:75]
    ds_read_b64_tr_b16 a[178:179], v246 offset:34880
    s_mov_b32 s53, 1024
    v_mfma_f32_16x16x32_bf16 a[76:79], a[208:211], a[156:159], a[76:79]
    ds_read_b64_tr_b16 a[180:181], v246 offset:32840
    v_mfma_f32_16x16x32_bf16 a[80:83], a[212:215], a[144:147], a[80:83]
    v_mfma_f32_16x16x32_bf16 a[84:87], a[212:215], a[148:151], a[84:87]
    ds_read_b64_tr_b16 a[182:183], v246 offset:34888
    buffer_load_dwordx4 v232, s[4:7], s53 offen offset:0 lds
    v_mfma_f32_16x16x32_bf16 a[88:91], a[212:215], a[152:155], a[88:91]
    ds_read_b64_tr_b16 a[184:185], v247 offset:32832
    v_mfma_f32_16x16x32_bf16 a[92:95], a[212:215], a[156:159], a[92:95]
    ds_read_b64_tr_b16 a[186:187], v247 offset:34880
    v_mfma_f32_16x16x32_bf16 a[96:99], a[216:219], a[144:147], a[96:99]
    buffer_load_dwordx4 v233, s[4:7], s53 offen offset:1024 lds
    v_mfma_f32_16x16x32_bf16 a[100:103], a[216:219], a[148:151], a[100:103]
    ds_read_b64_tr_b16 a[188:189], v247 offset:32840
    v_mfma_f32_16x16x32_bf16 a[104:107], a[216:219], a[152:155], a[104:107]
    ds_read_b64_tr_b16 a[190:191], v247 offset:34888
    buffer_load_dwordx4 v234, s[4:7], s53 offen offset:2048 lds
    v_mfma_f32_16x16x32_bf16 a[108:111], a[216:219], a[156:159], a[108:111]
    v_mfma_f32_16x16x32_bf16 a[112:115], a[220:223], a[144:147], a[112:115]
    v_mfma_f32_16x16x32_bf16 a[116:119], a[220:223], a[148:151], a[116:119]
    buffer_load_dwordx4 v235, s[4:7], s53 offen offset:3072 lds
    v_mfma_f32_16x16x32_bf16 a[120:123], a[220:223], a[152:155], a[120:123]
    v_mfma_f32_16x16x32_bf16 a[124:127], a[220:223], a[156:159], a[124:127]
    s_waitcnt lgkmcnt(12)
    v_mfma_f32_16x16x32_bf16 v[0:3], a[160:163], a[128:131], v[0:3]
    ds_read_b64_tr_b16 a[192:193], v244 offset:33088
    v_mfma_f32_16x16x32_bf16 v[4:7], a[160:163], a[132:135], v[4:7]
    ds_read_b64_tr_b16 a[194:195], v244 offset:35136
    v_mfma_f32_16x16x32_bf16 v[8:11], a[160:163], a[136:139], v[8:11]
    s_add_u32 m0, s43, 81824
    v_mfma_f32_16x16x32_bf16 v[12:15], a[160:163], a[140:143], v[12:15]
    ds_read_b64_tr_b16 a[196:197], v244 offset:33096
    v_mfma_f32_16x16x32_bf16 v[16:19], a[164:167], a[128:131], v[16:19]
    ds_read_b64_tr_b16 a[198:199], v244 offset:35144
    s_mov_b32 s54, 4456448
    v_mfma_f32_16x16x32_bf16 v[20:23], a[164:167], a[132:135], v[20:23]
    v_mfma_f32_16x16x32_bf16 v[24:27], a[164:167], a[136:139], v[24:27]
    ds_read_b64_tr_b16 a[200:201], v245 offset:33088
    buffer_load_dwordx4 v236, s[8:11], s54 offen offset:0 lds
    v_mfma_f32_16x16x32_bf16 v[28:31], a[164:167], a[140:143], v[28:31]
    ds_read_b64_tr_b16 a[202:203], v245 offset:35136
    s_waitcnt lgkmcnt(14)
    v_mfma_f32_16x16x32_bf16 v[32:35], a[168:171], a[128:131], v[32:35]
    v_mfma_f32_16x16x32_bf16 v[36:39], a[168:171], a[132:135], v[36:39]
    ds_read_b64_tr_b16 a[204:205], v245 offset:33096
    buffer_load_dwordx4 v237, s[8:11], s54 offen offset:1024 lds
    v_mfma_f32_16x16x32_bf16 v[40:43], a[168:171], a[136:139], v[40:43]
    ds_read_b64_tr_b16 a[206:207], v245 offset:35144
    v_mfma_f32_16x16x32_bf16 v[44:47], a[168:171], a[140:143], v[44:47]
    buffer_load_dwordx4 v238, s[8:11], s54 offen offset:2048 lds
    v_mfma_f32_16x16x32_bf16 v[48:51], a[172:175], a[128:131], v[48:51]
    ds_read_b64_tr_b16 a[208:209], v246 offset:33088
    v_mfma_f32_16x16x32_bf16 v[52:55], a[172:175], a[132:135], v[52:55]
    ds_read_b64_tr_b16 a[210:211], v246 offset:35136
    buffer_load_dwordx4 v239, s[8:11], s54 offen offset:3072 lds
    v_mfma_f32_16x16x32_bf16 v[56:59], a[172:175], a[136:139], v[56:59]
    v_mfma_f32_16x16x32_bf16 v[60:63], a[172:175], a[140:143], v[60:63]
    ds_read_b64_tr_b16 a[212:213], v246 offset:33096
    s_waitcnt lgkmcnt(15)
    v_mfma_f32_16x16x32_bf16 v[64:67], a[176:179], a[128:131], v[64:67]
    ds_read_b64_tr_b16 a[214:215], v246 offset:35144
    v_mfma_f32_16x16x32_bf16 v[68:71], a[176:179], a[132:135], v[68:71]
    v_mfma_f32_16x16x32_bf16 v[72:75], a[176:179], a[136:139], v[72:75]
    ds_read_b64_tr_b16 a[216:217], v247 offset:33088
    s_mul_i32 s57, s40, 5120
    v_mfma_f32_16x16x32_bf16 v[76:79], a[176:179], a[140:143], v[76:79]
    ds_read_b64_tr_b16 a[218:219], v247 offset:35136
    v_mfma_f32_16x16x32_bf16 v[80:83], a[180:183], a[128:131], v[80:83]
    s_mov_b32 s58, 640
    v_mfma_f32_16x16x32_bf16 v[84:87], a[180:183], a[132:135], v[84:87]
    ds_read_b64_tr_b16 a[220:221], v247 offset:33096
    v_mfma_f32_16x16x32_bf16 v[88:91], a[180:183], a[136:139], v[88:91]
    ds_read_b64_tr_b16 a[222:223], v247 offset:35144
    v_mfma_f32_16x16x32_bf16 v[92:95], a[180:183], a[140:143], v[92:95]
    s_add_u32 m0, s57, 16256
    s_waitcnt lgkmcnt(15)
    v_mfma_f32_16x16x32_bf16 v[96:99], a[184:187], a[128:131], v[96:99]
    v_mfma_f32_16x16x32_bf16 v[100:103], a[184:187], a[132:135], v[100:103]
    s_nop 0
    v_mfma_f32_16x16x32_bf16 v[104:107], a[184:187], a[136:139], v[104:107]
    v_mfma_f32_16x16x32_bf16 v[108:111], a[184:187], a[140:143], v[108:111]
    v_mfma_f32_16x16x32_bf16 v[112:115], a[188:191], a[128:131], v[112:115]
    buffer_load_dwordx4 v132, s[32:35], s58 offen lds
    v_mfma_f32_16x16x32_bf16 v[116:119], a[188:191], a[132:135], v[116:119]
    v_mfma_f32_16x16x32_bf16 v[120:123], a[188:191], a[136:139], v[120:123]
    v_mfma_f32_16x16x32_bf16 v[124:127], a[188:191], a[140:143], v[124:127]
    s_waitcnt vmcnt(20) lgkmcnt(0)
    s_barrier
    v_mfma_f32_16x16x32_bf16 a[0:3], a[192:195], a[128:131], a[0:3]
    ds_read_b128 a[144:147], v243 offset:0
    v_mfma_f32_16x16x32_bf16 a[4:7], a[192:195], a[132:135], a[4:7]
    ds_read_b128 a[148:151], v243 offset:2048
    v_mfma_f32_16x16x32_bf16 a[8:11], a[192:195], a[136:139], a[8:11]
    ds_read_b128 a[152:155], v243 offset:4096
    v_mfma_f32_16x16x32_bf16 a[12:15], a[192:195], a[140:143], a[12:15]
    v_mfma_f32_16x16x32_bf16 a[16:19], a[196:199], a[128:131], a[16:19]
    ds_read_b128 a[156:159], v243 offset:6144
    v_mfma_f32_16x16x32_bf16 a[20:23], a[196:199], a[132:135], a[20:23]
    ds_read_b64_tr_b16 a[160:161], v244 offset:49248
    v_mfma_f32_16x16x32_bf16 a[24:27], a[196:199], a[136:139], a[24:27]
    v_mfma_f32_16x16x32_bf16 a[28:31], a[196:199], a[140:143], a[28:31]
    ds_read_b64_tr_b16 a[162:163], v244 offset:51296
    v_mfma_f32_16x16x32_bf16 a[32:35], a[200:203], a[128:131], a[32:35]
    ds_read_b64_tr_b16 a[164:165], v244 offset:49256
    v_mfma_f32_16x16x32_bf16 a[36:39], a[200:203], a[132:135], a[36:39]
    ds_read_b64_tr_b16 a[166:167], v244 offset:51304
    v_mfma_f32_16x16x32_bf16 a[40:43], a[200:203], a[136:139], a[40:43]
    v_mfma_f32_16x16x32_bf16 a[44:47], a[200:203], a[140:143], a[44:47]
    ds_read_b64_tr_b16 a[168:169], v245 offset:49248
    v_mfma_f32_16x16x32_bf16 a[48:51], a[204:207], a[128:131], a[48:51]
    ds_read_b64_tr_b16 a[170:171], v245 offset:51296
    v_mfma_f32_16x16x32_bf16 a[52:55], a[204:207], a[132:135], a[52:55]
    v_mfma_f32_16x16x32_bf16 a[56:59], a[204:207], a[136:139], a[56:59]
    ds_read_b64_tr_b16 a[172:173], v245 offset:49256
    v_mfma_f32_16x16x32_bf16 a[60:63], a[204:207], a[140:143], a[60:63]
    ds_read_b64_tr_b16 a[174:175], v245 offset:51304
    v_mfma_f32_16x16x32_bf16 a[64:67], a[208:211], a[128:131], a[64:67]
    ds_read_b64_tr_b16 a[176:177], v246 offset:49248
    v_mfma_f32_16x16x32_bf16 a[68:71], a[208:211], a[132:135], a[68:71]
    v_mfma_f32_16x16x32_bf16 a[72:75], a[208:211], a[136:139], a[72:75]
    ds_read_b64_tr_b16 a[178:179], v246 offset:51296
    v_mfma_f32_16x16x32_bf16 a[76:79], a[208:211], a[140:143], a[76:79]
    ds_read_b64_tr_b16 a[180:181], v246 offset:49256
    v_mfma_f32_16x16x32_bf16 a[80:83], a[212:215], a[128:131], a[80:83]
    v_mfma_f32_16x16x32_bf16 a[84:87], a[212:215], a[132:135], a[84:87]
    ds_read_b64_tr_b16 a[182:183], v246 offset:51304
    v_mfma_f32_16x16x32_bf16 a[88:91], a[212:215], a[136:139], a[88:91]
    ds_read_b64_tr_b16 a[184:185], v247 offset:49248
    v_mfma_f32_16x16x32_bf16 a[92:95], a[212:215], a[140:143], a[92:95]
    ds_read_b64_tr_b16 a[186:187], v247 offset:51296
    v_mfma_f32_16x16x32_bf16 a[96:99], a[216:219], a[128:131], a[96:99]
    v_mfma_f32_16x16x32_bf16 a[100:103], a[216:219], a[132:135], a[100:103]
    ds_read_b64_tr_b16 a[188:189], v247 offset:49256
    v_mfma_f32_16x16x32_bf16 a[104:107], a[216:219], a[136:139], a[104:107]
    ds_read_b64_tr_b16 a[190:191], v247 offset:51304
    v_mfma_f32_16x16x32_bf16 a[108:111], a[216:219], a[140:143], a[108:111]
    v_mfma_f32_16x16x32_bf16 a[112:115], a[220:223], a[128:131], a[112:115]
    v_mfma_f32_16x16x32_bf16 a[116:119], a[220:223], a[132:135], a[116:119]
    v_mfma_f32_16x16x32_bf16 a[120:123], a[220:223], a[136:139], a[120:123]
    v_mfma_f32_16x16x32_bf16 a[124:127], a[220:223], a[140:143], a[124:127]
    s_waitcnt lgkmcnt(12)
    v_mfma_f32_16x16x32_bf16 v[0:3], a[160:163], a[144:147], v[0:3]
    ds_read_b64_tr_b16 a[192:193], v244 offset:49504
    v_mfma_f32_16x16x32_bf16 v[4:7], a[160:163], a[148:151], v[4:7]
    ds_read_b64_tr_b16 a[194:195], v244 offset:51552
    v_mfma_f32_16x16x32_bf16 v[8:11], a[160:163], a[152:155], v[8:11]
    s_add_u32 m0, s43, 98240
    v_mfma_f32_16x16x32_bf16 v[12:15], a[160:163], a[156:159], v[12:15]
    ds_read_b64_tr_b16 a[196:197], v244 offset:49512
    v_mfma_f32_16x16x32_bf16 v[16:19], a[164:167], a[144:147], v[16:19]
    ds_read_b64_tr_b16 a[198:199], v244 offset:51560
    v_mfma_f32_16x16x32_bf16 v[20:23], a[164:167], a[148:151], v[20:23]
    s_mov_b32 s54, 4718592
    v_mfma_f32_16x16x32_bf16 v[24:27], a[164:167], a[152:155], v[24:27]
    ds_read_b64_tr_b16 a[200:201], v245 offset:49504
    v_mfma_f32_16x16x32_bf16 v[28:31], a[164:167], a[156:159], v[28:31]
    ds_read_b64_tr_b16 a[202:203], v245 offset:51552
    s_waitcnt lgkmcnt(14)
    v_mfma_f32_16x16x32_bf16 v[32:35], a[168:171], a[144:147], v[32:35]
    buffer_load_dwordx4 v236, s[8:11], s54 offen offset:0 lds
    v_mfma_f32_16x16x32_bf16 v[36:39], a[168:171], a[148:151], v[36:39]
    ds_read_b64_tr_b16 a[204:205], v245 offset:49512
    v_mfma_f32_16x16x32_bf16 v[40:43], a[168:171], a[152:155], v[40:43]
    ds_read_b64_tr_b16 a[206:207], v245 offset:51560
    v_mfma_f32_16x16x32_bf16 v[44:47], a[168:171], a[156:159], v[44:47]
    buffer_load_dwordx4 v237, s[8:11], s54 offen offset:1024 lds
    v_mfma_f32_16x16x32_bf16 v[48:51], a[172:175], a[144:147], v[48:51]
    ds_read_b64_tr_b16 a[208:209], v246 offset:49504
    v_mfma_f32_16x16x32_bf16 v[52:55], a[172:175], a[148:151], v[52:55]
    ds_read_b64_tr_b16 a[210:211], v246 offset:51552
    v_mfma_f32_16x16x32_bf16 v[56:59], a[172:175], a[152:155], v[56:59]
    buffer_load_dwordx4 v238, s[8:11], s54 offen offset:2048 lds
    v_mfma_f32_16x16x32_bf16 v[60:63], a[172:175], a[156:159], v[60:63]
    ds_read_b64_tr_b16 a[212:213], v246 offset:49512
    s_waitcnt lgkmcnt(15)
    v_mfma_f32_16x16x32_bf16 v[64:67], a[176:179], a[144:147], v[64:67]
    ds_read_b64_tr_b16 a[214:215], v246 offset:51560
    v_mfma_f32_16x16x32_bf16 v[68:71], a[176:179], a[148:151], v[68:71]
    buffer_load_dwordx4 v239, s[8:11], s54 offen offset:3072 lds
    v_mfma_f32_16x16x32_bf16 v[72:75], a[176:179], a[152:155], v[72:75]
    ds_read_b64_tr_b16 a[216:217], v247 offset:49504
    v_mfma_f32_16x16x32_bf16 v[76:79], a[176:179], a[156:159], v[76:79]
    ds_read_b64_tr_b16 a[218:219], v247 offset:51552
    v_mfma_f32_16x16x32_bf16 v[80:83], a[180:183], a[144:147], v[80:83]
    v_mfma_f32_16x16x32_bf16 v[84:87], a[180:183], a[148:151], v[84:87]
    ds_read_b64_tr_b16 a[220:221], v247 offset:49512
    v_mfma_f32_16x16x32_bf16 v[88:91], a[180:183], a[152:155], v[88:91]
    ds_read_b64_tr_b16 a[222:223], v247 offset:51560
    v_mfma_f32_16x16x32_bf16 v[92:95], a[180:183], a[156:159], v[92:95]
    s_waitcnt lgkmcnt(15)
    v_mfma_f32_16x16x32_bf16 v[96:99], a[184:187], a[144:147], v[96:99]
    v_mfma_f32_16x16x32_bf16 v[100:103], a[184:187], a[148:151], v[100:103]
    v_mfma_f32_16x16x32_bf16 v[104:107], a[184:187], a[152:155], v[104:107]
    v_mfma_f32_16x16x32_bf16 v[108:111], a[184:187], a[156:159], v[108:111]
    v_mfma_f32_16x16x32_bf16 v[112:115], a[188:191], a[144:147], v[112:115]
    v_mfma_f32_16x16x32_bf16 v[116:119], a[188:191], a[148:151], v[116:119]
    v_mfma_f32_16x16x32_bf16 v[120:123], a[188:191], a[152:155], v[120:123]
    v_mfma_f32_16x16x32_bf16 v[124:127], a[188:191], a[156:159], v[124:127]
    s_waitcnt vmcnt(9) lgkmcnt(0)
    s_barrier
    v_mfma_f32_16x16x32_bf16 a[0:3], a[192:195], a[144:147], a[0:3]
    ds_read_b128 a[128:131], v240 offset:0
    v_mfma_f32_16x16x32_bf16 a[4:7], a[192:195], a[148:151], a[4:7]
    ds_read_b128 a[132:135], v240 offset:2048
    v_mfma_f32_16x16x32_bf16 a[8:11], a[192:195], a[152:155], a[8:11]
    ds_read_b128 a[136:139], v240 offset:4096
    s_add_u32 m0, s44, 131072
    v_mfma_f32_16x16x32_bf16 a[12:15], a[192:195], a[156:159], a[12:15]
    v_mfma_f32_16x16x32_bf16 a[16:19], a[196:199], a[144:147], a[16:19]
    ds_read_b128 a[140:143], v240 offset:6144
    s_mov_b32 s53, 1152
    v_mfma_f32_16x16x32_bf16 a[20:23], a[196:199], a[148:151], a[20:23]
    ds_read_b64_tr_b16 a[160:161], v244 offset:0
    v_mfma_f32_16x16x32_bf16 a[24:27], a[196:199], a[152:155], a[24:27]
    buffer_load_dwordx4 v228, s[4:7], s53 offen offset:0 lds
    v_mfma_f32_16x16x32_bf16 a[28:31], a[196:199], a[156:159], a[28:31]
    ds_read_b64_tr_b16 a[162:163], v244 offset:2048
    v_mfma_f32_16x16x32_bf16 a[32:35], a[200:203], a[144:147], a[32:35]
    ds_read_b64_tr_b16 a[164:165], v244 offset:8
    v_mfma_f32_16x16x32_bf16 a[36:39], a[200:203], a[148:151], a[36:39]
    ds_read_b64_tr_b16 a[166:167], v244 offset:2056
    buffer_load_dwordx4 v229, s[4:7], s53 offen offset:1024 lds
    v_mfma_f32_16x16x32_bf16 a[40:43], a[200:203], a[152:155], a[40:43]
    v_mfma_f32_16x16x32_bf16 a[44:47], a[200:203], a[156:159], a[44:47]
    ds_read_b64_tr_b16 a[168:169], v245 offset:0
    buffer_load_dwordx4 v230, s[4:7], s53 offen offset:2048 lds
    v_mfma_f32_16x16x32_bf16 a[48:51], a[204:207], a[144:147], a[48:51]
    ds_read_b64_tr_b16 a[170:171], v245 offset:2048
    v_mfma_f32_16x16x32_bf16 a[52:55], a[204:207], a[148:151], a[52:55]
    buffer_load_dwordx4 v231, s[4:7], s53 offen offset:3072 lds
    v_mfma_f32_16x16x32_bf16 a[56:59], a[204:207], a[152:155], a[56:59]
    ds_read_b64_tr_b16 a[172:173], v245 offset:8
    v_mfma_f32_16x16x32_bf16 a[60:63], a[204:207], a[156:159], a[60:63]
    ds_read_b64_tr_b16 a[174:175], v245 offset:2056
    v_mfma_f32_16x16x32_bf16 a[64:67], a[208:211], a[144:147], a[64:67]
    ds_read_b64_tr_b16 a[176:177], v246 offset:0
    s_add_u32 m0, s44, 135168
    v_mfma_f32_16x16x32_bf16 a[68:71], a[208:211], a[148:151], a[68:71]
    v_mfma_f32_16x16x32_bf16 a[72:75], a[208:211], a[152:155], a[72:75]
    ds_read_b64_tr_b16 a[178:179], v246 offset:2048
    s_mov_b32 s53, 1152
    v_mfma_f32_16x16x32_bf16 a[76:79], a[208:211], a[156:159], a[76:79]
    ds_read_b64_tr_b16 a[180:181], v246 offset:8
    v_mfma_f32_16x16x32_bf16 a[80:83], a[212:215], a[144:147], a[80:83]
    v_mfma_f32_16x16x32_bf16 a[84:87], a[212:215], a[148:151], a[84:87]
    ds_read_b64_tr_b16 a[182:183], v246 offset:2056
    buffer_load_dwordx4 v232, s[4:7], s53 offen offset:0 lds
    v_mfma_f32_16x16x32_bf16 a[88:91], a[212:215], a[152:155], a[88:91]
    ds_read_b64_tr_b16 a[184:185], v247 offset:0
    v_mfma_f32_16x16x32_bf16 a[92:95], a[212:215], a[156:159], a[92:95]
    ds_read_b64_tr_b16 a[186:187], v247 offset:2048
    v_mfma_f32_16x16x32_bf16 a[96:99], a[216:219], a[144:147], a[96:99]
    buffer_load_dwordx4 v233, s[4:7], s53 offen offset:1024 lds
    v_mfma_f32_16x16x32_bf16 a[100:103], a[216:219], a[148:151], a[100:103]
    ds_read_b64_tr_b16 a[188:189], v247 offset:8
    v_mfma_f32_16x16x32_bf16 a[104:107], a[216:219], a[152:155], a[104:107]
    ds_read_b64_tr_b16 a[190:191], v247 offset:2056
    buffer_load_dwordx4 v234, s[4:7], s53 offen offset:2048 lds
    v_mfma_f32_16x16x32_bf16 a[108:111], a[216:219], a[156:159], a[108:111]
    v_mfma_f32_16x16x32_bf16 a[112:115], a[220:223], a[144:147], a[112:115]
    v_mfma_f32_16x16x32_bf16 a[116:119], a[220:223], a[148:151], a[116:119]
    buffer_load_dwordx4 v235, s[4:7], s53 offen offset:3072 lds
    v_mfma_f32_16x16x32_bf16 a[120:123], a[220:223], a[152:155], a[120:123]
    v_mfma_f32_16x16x32_bf16 a[124:127], a[220:223], a[156:159], a[124:127]
    s_waitcnt lgkmcnt(12)
    v_mfma_f32_16x16x32_bf16 v[0:3], a[160:163], a[128:131], v[0:3]
    ds_read_b64_tr_b16 a[192:193], v244 offset:256
    v_mfma_f32_16x16x32_bf16 v[4:7], a[160:163], a[132:135], v[4:7]
    ds_read_b64_tr_b16 a[194:195], v244 offset:2304
    v_mfma_f32_16x16x32_bf16 v[8:11], a[160:163], a[136:139], v[8:11]
    s_add_u32 m0, s43, 114656
    v_mfma_f32_16x16x32_bf16 v[12:15], a[160:163], a[140:143], v[12:15]
    ds_read_b64_tr_b16 a[196:197], v244 offset:264
    v_mfma_f32_16x16x32_bf16 v[16:19], a[164:167], a[128:131], v[16:19]
    ds_read_b64_tr_b16 a[198:199], v244 offset:2312
    s_mov_b32 s54, 4980736
    v_mfma_f32_16x16x32_bf16 v[20:23], a[164:167], a[132:135], v[20:23]
    v_mfma_f32_16x16x32_bf16 v[24:27], a[164:167], a[136:139], v[24:27]
    ds_read_b64_tr_b16 a[200:201], v245 offset:256
    buffer_load_dwordx4 v236, s[8:11], s54 offen offset:0 lds
    v_mfma_f32_16x16x32_bf16 v[28:31], a[164:167], a[140:143], v[28:31]
    ds_read_b64_tr_b16 a[202:203], v245 offset:2304
    s_waitcnt lgkmcnt(14)
    v_mfma_f32_16x16x32_bf16 v[32:35], a[168:171], a[128:131], v[32:35]
    v_mfma_f32_16x16x32_bf16 v[36:39], a[168:171], a[132:135], v[36:39]
    ds_read_b64_tr_b16 a[204:205], v245 offset:264
    buffer_load_dwordx4 v237, s[8:11], s54 offen offset:1024 lds
    v_mfma_f32_16x16x32_bf16 v[40:43], a[168:171], a[136:139], v[40:43]
    ds_read_b64_tr_b16 a[206:207], v245 offset:2312
    v_mfma_f32_16x16x32_bf16 v[44:47], a[168:171], a[140:143], v[44:47]
    buffer_load_dwordx4 v238, s[8:11], s54 offen offset:2048 lds
    v_mfma_f32_16x16x32_bf16 v[48:51], a[172:175], a[128:131], v[48:51]
    ds_read_b64_tr_b16 a[208:209], v246 offset:256
    v_mfma_f32_16x16x32_bf16 v[52:55], a[172:175], a[132:135], v[52:55]
    ds_read_b64_tr_b16 a[210:211], v246 offset:2304
    buffer_load_dwordx4 v239, s[8:11], s54 offen offset:3072 lds
    v_mfma_f32_16x16x32_bf16 v[56:59], a[172:175], a[136:139], v[56:59]
    v_mfma_f32_16x16x32_bf16 v[60:63], a[172:175], a[140:143], v[60:63]
    ds_read_b64_tr_b16 a[212:213], v246 offset:264
    s_waitcnt lgkmcnt(15)
    v_mfma_f32_16x16x32_bf16 v[64:67], a[176:179], a[128:131], v[64:67]
    ds_read_b64_tr_b16 a[214:215], v246 offset:2312
    v_mfma_f32_16x16x32_bf16 v[68:71], a[176:179], a[132:135], v[68:71]
    v_mfma_f32_16x16x32_bf16 v[72:75], a[176:179], a[136:139], v[72:75]
    ds_read_b64_tr_b16 a[216:217], v247 offset:256
    v_mfma_f32_16x16x32_bf16 v[76:79], a[176:179], a[140:143], v[76:79]
    ds_read_b64_tr_b16 a[218:219], v247 offset:2304
    v_mfma_f32_16x16x32_bf16 v[80:83], a[180:183], a[128:131], v[80:83]
    v_mfma_f32_16x16x32_bf16 v[84:87], a[180:183], a[132:135], v[84:87]
    ds_read_b64_tr_b16 a[220:221], v247 offset:264
    v_mfma_f32_16x16x32_bf16 v[88:91], a[180:183], a[136:139], v[88:91]
    ds_read_b64_tr_b16 a[222:223], v247 offset:2312
    v_mfma_f32_16x16x32_bf16 v[92:95], a[180:183], a[140:143], v[92:95]
    s_waitcnt lgkmcnt(15)
    v_mfma_f32_16x16x32_bf16 v[96:99], a[184:187], a[128:131], v[96:99]
    v_mfma_f32_16x16x32_bf16 v[100:103], a[184:187], a[132:135], v[100:103]
    v_mfma_f32_16x16x32_bf16 v[104:107], a[184:187], a[136:139], v[104:107]
    v_mfma_f32_16x16x32_bf16 v[108:111], a[184:187], a[140:143], v[108:111]
    v_mfma_f32_16x16x32_bf16 v[112:115], a[188:191], a[128:131], v[112:115]
    v_mfma_f32_16x16x32_bf16 v[116:119], a[188:191], a[132:135], v[116:119]
    v_mfma_f32_16x16x32_bf16 v[120:123], a[188:191], a[136:139], v[120:123]
    v_mfma_f32_16x16x32_bf16 v[124:127], a[188:191], a[140:143], v[124:127]
    s_waitcnt vmcnt(16) lgkmcnt(0)
    s_barrier
    v_mfma_f32_16x16x32_bf16 a[0:3], a[192:195], a[128:131], a[0:3]
    ds_read_b128 a[144:147], v241 offset:0
    v_mfma_f32_16x16x32_bf16 a[4:7], a[192:195], a[132:135], a[4:7]
    ds_read_b128 a[148:151], v241 offset:2048
    v_mfma_f32_16x16x32_bf16 a[8:11], a[192:195], a[136:139], a[8:11]
    ds_read_b128 a[152:155], v241 offset:4096
    s_add_u32 m0, s41, 0
    v_mfma_f32_16x16x32_bf16 a[12:15], a[192:195], a[140:143], a[12:15]
    v_mfma_f32_16x16x32_bf16 a[16:19], a[196:199], a[128:131], a[16:19]
    ds_read_b128 a[156:159], v241 offset:6144
    s_add_u32 s59, s29, 0
    v_mfma_f32_16x16x32_bf16 a[20:23], a[196:199], a[132:135], a[20:23]
    ds_read_b64_tr_b16 a[160:161], v244 offset:16416
    v_mfma_f32_16x16x32_bf16 a[24:27], a[196:199], a[136:139], a[24:27]
    v_mfma_f32_16x16x32_bf16 a[28:31], a[196:199], a[140:143], a[28:31]
    ds_read_b64_tr_b16 a[162:163], v244 offset:18464
    buffer_load_dwordx4 v198, s[12:15], s59 offen nt lds
    v_mfma_f32_16x16x32_bf16 a[32:35], a[200:203], a[128:131], a[32:35]
    ds_read_b64_tr_b16 a[164:165], v244 offset:16424
    ds_read_b64_tr_b16 a[244:245], v133 offset:12160
    v_mfma_f32_16x16x32_bf16 a[36:39], a[200:203], a[132:135], a[36:39]
    ds_read_b64_tr_b16 a[166:167], v244 offset:18472
    s_add_u32 m0, s41, 1056
    v_mfma_f32_16x16x32_bf16 a[40:43], a[200:203], a[136:139], a[40:43]
    ds_read_b64_tr_b16 a[246:247], v133 offset:22400
    v_mfma_f32_16x16x32_bf16 a[44:47], a[200:203], a[140:143], a[44:47]
    ds_read_b64_tr_b16 a[168:169], v245 offset:16416
    v_mfma_f32_16x16x32_bf16 a[48:51], a[204:207], a[128:131], a[48:51]
    ds_read_b64_tr_b16 a[170:171], v245 offset:18464
    ds_read_b64_tr_b16 a[248:249], v133 offset:12192
    s_nop 0
    v_mfma_f32_16x16x32_bf16 a[52:55], a[204:207], a[132:135], a[52:55]
    v_mfma_f32_16x16x32_bf16 a[56:59], a[204:207], a[136:139], a[56:59]
    ds_read_b64_tr_b16 a[172:173], v245 offset:16424
    buffer_load_dwordx4 v199, s[12:15], s59 offen nt lds
    v_mfma_f32_16x16x32_bf16 a[60:63], a[204:207], a[140:143], a[60:63]
    ds_read_b64_tr_b16 a[174:175], v245 offset:18472
    ds_read_b64_tr_b16 a[250:251], v133 offset:22432
    v_mfma_f32_16x16x32_bf16 a[64:67], a[208:211], a[128:131], a[64:67]
    ds_read_b64_tr_b16 a[176:177], v246 offset:16416
    v_mfma_f32_16x16x32_bf16 a[68:71], a[208:211], a[132:135], a[68:71]
    ds_read_b64_tr_b16 a[252:253], v133 offset:12224
    s_add_u32 m0, s42, 0
    v_mfma_f32_16x16x32_bf16 a[72:75], a[208:211], a[136:139], a[72:75]
    ds_read_b64_tr_b16 a[178:179], v246 offset:18464
    v_mfma_f32_16x16x32_bf16 a[76:79], a[208:211], a[140:143], a[76:79]
    ds_read_b64_tr_b16 a[180:181], v246 offset:16424
    s_add_u32 s59, s29, 0
    v_mfma_f32_16x16x32_bf16 a[80:83], a[212:215], a[128:131], a[80:83]
    ds_read_b64_tr_b16 a[254:255], v133 offset:22464
    v_mfma_f32_16x16x32_bf16 a[84:87], a[212:215], a[132:135], a[84:87]
    ds_read_b64_tr_b16 a[182:183], v246 offset:18472
    v_mfma_f32_16x16x32_bf16 a[88:91], a[212:215], a[136:139], a[88:91]
    ds_read_b64_tr_b16 a[184:185], v247 offset:16416
    ds_read_b64_tr_b16 v[220:221], v133 offset:12256
    buffer_load_dwordx4 v198, s[16:19], s59 offen nt lds
    v_mfma_f32_16x16x32_bf16 a[92:95], a[212:215], a[140:143], a[92:95]
    ds_read_b64_tr_b16 a[186:187], v247 offset:18464
    v_mfma_f32_16x16x32_bf16 a[96:99], a[216:219], a[128:131], a[96:99]
    ds_read_b64_tr_b16 v[222:223], v133 offset:22496
    s_add_u32 m0, s42, 1056
    v_mfma_f32_16x16x32_bf16 a[100:103], a[216:219], a[132:135], a[100:103]
    ds_read_b64_tr_b16 a[188:189], v247 offset:16424
    v_mfma_f32_16x16x32_bf16 a[104:107], a[216:219], a[136:139], a[104:107]
    ds_read_b64_tr_b16 a[190:191], v247 offset:18472
    v_mfma_f32_16x16x32_bf16 a[108:111], a[216:219], a[140:143], a[108:111]
    ds_read_b64_tr_b16 v[224:225], v133 offset:12288
    s_nop 0
    v_mfma_f32_16x16x32_bf16 a[112:115], a[220:223], a[128:131], a[112:115]
    v_mfma_f32_16x16x32_bf16 a[116:119], a[220:223], a[132:135], a[116:119]
    ds_read_b64_tr_b16 v[226:227], v133 offset:22528
    buffer_load_dwordx4 v199, s[16:19], s59 offen nt lds
    v_mfma_f32_16x16x32_bf16 a[120:123], a[220:223], a[136:139], a[120:123]
    v_mfma_f32_16x16x32_bf16 a[124:127], a[220:223], a[140:143], a[124:127]
    s_waitcnt lgkmcnt(15)
    v_mfma_f32_16x16x32_bf16 v[0:3], a[160:163], a[144:147], v[0:3]
    ds_read_b64_tr_b16 a[192:193], v244 offset:16672
    v_mfma_f32_16x16x32_bf16 v[4:7], a[160:163], a[148:151], v[4:7]
    ds_read_b64_tr_b16 a[194:195], v244 offset:18720
    v_mfma_f32_16x16x32_bf16 v[8:11], a[160:163], a[152:155], v[8:11]
    v_mfma_f32_16x16x32_bf16 v[12:15], a[160:163], a[156:159], v[12:15]
    ds_read_b64_tr_b16 a[196:197], v244 offset:16680
    v_mfma_f32_16x16x32_bf16 v[16:19], a[164:167], a[144:147], v[16:19]
    ds_read_b64_tr_b16 a[198:199], v244 offset:18728
    v_mfma_f32_16x16x32_bf16 v[20:23], a[164:167], a[148:151], v[20:23]
    v_mfma_f32_16x16x32_bf16 v[24:27], a[164:167], a[152:155], v[24:27]
    ds_read_b64_tr_b16 a[200:201], v245 offset:16672
    v_mfma_f32_16x16x32_bf16 v[28:31], a[164:167], a[156:159], v[28:31]
    ds_read_b64_tr_b16 a[202:203], v245 offset:18720
    v_mfma_f32_16x16x32_bf16 v[32:35], a[168:171], a[144:147], v[32:35]
    v_mfma_f32_16x16x32_bf16 v[36:39], a[168:171], a[148:151], v[36:39]
    ds_read_b64_tr_b16 a[204:205], v245 offset:16680
    v_mfma_f32_16x16x32_bf16 v[40:43], a[168:171], a[152:155], v[40:43]
    ds_read_b64_tr_b16 a[206:207], v245 offset:18728
    v_mfma_f32_16x16x32_bf16 v[44:47], a[168:171], a[156:159], v[44:47]
    v_mfma_f32_16x16x32_bf16 v[48:51], a[172:175], a[144:147], v[48:51]
    ds_read_b64_tr_b16 a[208:209], v246 offset:16672
    v_mfma_f32_16x16x32_bf16 v[52:55], a[172:175], a[148:151], v[52:55]
    ds_read_b64_tr_b16 a[210:211], v246 offset:18720
    v_mfma_f32_16x16x32_bf16 v[56:59], a[172:175], a[152:155], v[56:59]
    v_mfma_f32_16x16x32_bf16 v[60:63], a[172:175], a[156:159], v[60:63]
    ds_read_b64_tr_b16 a[212:213], v246 offset:16680
    s_waitcnt lgkmcnt(15)
    v_mfma_f32_16x16x32_bf16 v[64:67], a[176:179], a[144:147], v[64:67]
    ds_read_b64_tr_b16 a[214:215], v246 offset:18728
    v_mfma_f32_16x16x32_bf16 v[68:71], a[176:179], a[148:151], v[68:71]
    v_mfma_f32_16x16x32_bf16 v[72:75], a[176:179], a[152:155], v[72:75]
    ds_read_b64_tr_b16 a[216:217], v247 offset:16672
    v_mfma_f32_16x16x32_bf16 v[76:79], a[176:179], a[156:159], v[76:79]
    ds_read_b64_tr_b16 a[218:219], v247 offset:18720
    v_mfma_f32_16x16x32_bf16 v[80:83], a[180:183], a[144:147], v[80:83]
    v_mfma_f32_16x16x32_bf16 v[84:87], a[180:183], a[148:151], v[84:87]
    ds_read_b64_tr_b16 a[220:221], v247 offset:16680
    v_mfma_f32_16x16x32_bf16 v[88:91], a[180:183], a[152:155], v[88:91]
    ds_read_b64_tr_b16 a[222:223], v247 offset:18728
    v_mfma_f32_16x16x32_bf16 v[92:95], a[180:183], a[156:159], v[92:95]
    s_waitcnt lgkmcnt(15)
    v_mfma_f32_16x16x32_bf16 v[96:99], a[184:187], a[144:147], v[96:99]
    v_mfma_f32_16x16x32_bf16 v[100:103], a[184:187], a[148:151], v[100:103]
    v_mfma_f32_16x16x32_bf16 v[104:107], a[184:187], a[152:155], v[104:107]
    v_mfma_f32_16x16x32_bf16 v[108:111], a[184:187], a[156:159], v[108:111]
    v_mfma_f32_16x16x32_bf16 v[112:115], a[188:191], a[144:147], v[112:115]
    v_mfma_f32_16x16x32_bf16 v[116:119], a[188:191], a[148:151], v[116:119]
    v_mfma_f32_16x16x32_bf16 v[120:123], a[188:191], a[152:155], v[120:123]
    v_mfma_f32_16x16x32_bf16 v[124:127], a[188:191], a[156:159], v[124:127]
    s_waitcnt vmcnt(8) lgkmcnt(0)
    s_barrier
    v_mfma_f32_16x16x32_bf16 a[0:3], a[192:195], a[144:147], a[0:3]
    ds_read_b128 a[128:131], v242 offset:0
    v_mfma_f32_16x16x32_bf16 a[4:7], a[192:195], a[148:151], a[4:7]
    ds_read_b128 a[132:135], v242 offset:2048
    v_mfma_f32_16x16x32_bf16 a[8:11], a[192:195], a[152:155], a[8:11]
    ds_read_b128 a[136:139], v242 offset:4096
    s_add_u32 m0, s41, 8448
    v_mfma_f32_16x16x32_bf16 a[12:15], a[192:195], a[156:159], a[12:15]
    v_mfma_f32_16x16x32_bf16 a[16:19], a[196:199], a[144:147], a[16:19]
    ds_read_b128 a[140:143], v242 offset:6144
    s_add_u32 s59, s29, 8192
    v_mfma_f32_16x16x32_bf16 a[20:23], a[196:199], a[148:151], a[20:23]
    ds_read_b64_tr_b16 a[160:161], v244 offset:32832
    v_mfma_f32_16x16x32_bf16 a[24:27], a[196:199], a[152:155], a[24:27]
    v_mfma_f32_16x16x32_bf16 a[28:31], a[196:199], a[156:159], a[28:31]
    ds_read_b64_tr_b16 a[162:163], v244 offset:34880
    buffer_load_dwordx4 v198, s[12:15], s59 offen nt lds
    v_mfma_f32_16x16x32_bf16 a[32:35], a[200:203], a[144:147], a[32:35]
    ds_read_b64_tr_b16 a[164:165], v244 offset:32840
    v_mfma_f32_16x16x32_bf16 a[36:39], a[200:203], a[148:151], a[36:39]
    ds_read_b64_tr_b16 a[166:167], v244 offset:34888
    s_add_u32 m0, s41, 9504
    v_mfma_f32_16x16x32_bf16 a[40:43], a[200:203], a[152:155], a[40:43]
    v_mfma_f32_16x16x32_bf16 a[44:47], a[200:203], a[156:159], a[44:47]
    ds_read_b64_tr_b16 a[168:169], v245 offset:32832
    v_mfma_f32_16x16x32_bf16 a[48:51], a[204:207], a[144:147], a[48:51]
    ds_read_b64_tr_b16 a[170:171], v245 offset:34880
    s_nop 0
    v_mfma_f32_16x16x32_bf16 a[52:55], a[204:207], a[148:151], a[52:55]
    v_mfma_f32_16x16x32_bf16 a[56:59], a[204:207], a[152:155], a[56:59]
    ds_read_b64_tr_b16 a[172:173], v245 offset:32840
    buffer_load_dwordx4 v199, s[12:15], s59 offen nt lds
    v_mfma_f32_16x16x32_bf16 a[60:63], a[204:207], a[156:159], a[60:63]
    ds_read_b64_tr_b16 a[174:175], v245 offset:34888
    v_mfma_f32_16x16x32_bf16 a[64:67], a[208:211], a[144:147], a[64:67]
    ds_read_b64_tr_b16 a[176:177], v246 offset:32832
    v_mfma_f32_16x16x32_bf16 a[68:71], a[208:211], a[148:151], a[68:71]
    s_add_u32 m0, s41, 16896
    v_mfma_f32_16x16x32_bf16 a[72:75], a[208:211], a[152:155], a[72:75]
    ds_read_b64_tr_b16 a[178:179], v246 offset:34880
    v_mfma_f32_16x16x32_bf16 a[76:79], a[208:211], a[156:159], a[76:79]
    ds_read_b64_tr_b16 a[180:181], v246 offset:32840
    s_add_u32 s59, s29, 16384
    v_mfma_f32_16x16x32_bf16 a[80:83], a[212:215], a[144:147], a[80:83]
    v_mfma_f32_16x16x32_bf16 a[84:87], a[212:215], a[148:151], a[84:87]
    ds_read_b64_tr_b16 a[182:183], v246 offset:34888
    v_mfma_f32_16x16x32_bf16 a[88:91], a[212:215], a[152:155], a[88:91]
    ds_read_b64_tr_b16 a[184:185], v247 offset:32832
    buffer_load_dwordx4 v198, s[12:15], s59 offen nt lds
    v_mfma_f32_16x16x32_bf16 a[92:95], a[212:215], a[156:159], a[92:95]
    ds_read_b64_tr_b16 a[186:187], v247 offset:34880
    v_mfma_f32_16x16x32_bf16 a[96:99], a[216:219], a[144:147], a[96:99]
    s_add_u32 m0, s41, 17952
    v_mfma_f32_16x16x32_bf16 a[100:103], a[216:219], a[148:151], a[100:103]
    ds_read_b64_tr_b16 a[188:189], v247 offset:32840
    v_mfma_f32_16x16x32_bf16 a[104:107], a[216:219], a[152:155], a[104:107]
    ds_read_b64_tr_b16 a[190:191], v247 offset:34888
    v_mfma_f32_16x16x32_bf16 a[108:111], a[216:219], a[156:159], a[108:111]
    s_nop 0
    v_mfma_f32_16x16x32_bf16 a[112:115], a[220:223], a[144:147], a[112:115]
    v_mfma_f32_16x16x32_bf16 a[116:119], a[220:223], a[148:151], a[116:119]
    buffer_load_dwordx4 v199, s[12:15], s59 offen nt lds
    v_mfma_f32_16x16x32_bf16 a[120:123], a[220:223], a[152:155], a[120:123]
    v_mfma_f32_16x16x32_bf16 a[124:127], a[220:223], a[156:159], a[124:127]
    s_waitcnt lgkmcnt(12)
    v_mfma_f32_16x16x32_bf16 v[0:3], a[160:163], a[128:131], v[0:3]
    ds_read_b64_tr_b16 a[192:193], v244 offset:33088
    s_lshl_b32 s101, s98, 3
    v_mfma_f32_16x16x32_bf16 v[4:7], a[160:163], a[132:135], v[4:7]
    ds_read_b64_tr_b16 a[194:195], v244 offset:35136
    s_mov_b32 s58, 0
    s_add_u32 s101, s101, s99
    v_mfma_f32_16x16x32_bf16 v[8:11], a[160:163], a[136:139], v[8:11]
    s_add_u32 m0, s41, 25344
    s_lshl_b32 s101, s101, 1
    v_mfma_f32_16x16x32_bf16 v[12:15], a[160:163], a[140:143], v[12:15]
    ds_read_b64_tr_b16 a[196:197], v244 offset:33096
    s_and_b32 s55, s96, 1
    v_mfma_f32_16x16x32_bf16 v[16:19], a[164:167], a[128:131], v[16:19]
    ds_read_b64_tr_b16 a[198:199], v244 offset:35144
    v_mfma_f32_16x16x32_bf16 v[20:23], a[164:167], a[132:135], v[20:23]
    s_add_u32 s101, s101, s55
    v_mfma_f32_16x16x32_bf16 v[24:27], a[164:167], a[136:139], v[24:27]
    ds_read_b64_tr_b16 a[200:201], v245 offset:33088
    s_add_u32 s59, s29, 24576
    s_lshl_b32 s101, s101, 20
    v_mfma_f32_16x16x32_bf16 v[28:31], a[164:167], a[140:143], v[28:31]
    ds_read_b64_tr_b16 a[202:203], v245 offset:35136
    s_mov_b32 s57, 4096
    s_lshr_b32 s100, s96, 1
    s_waitcnt lgkmcnt(14)
    v_mfma_f32_16x16x32_bf16 v[32:35], a[168:171], a[128:131], v[32:35]
    v_mfma_f32_16x16x32_bf16 v[36:39], a[168:171], a[132:135], v[36:39]
    ds_read_b64_tr_b16 a[204:205], v245 offset:33096
    s_lshl_b32 s56, s100, 19
    v_mfma_f32_16x16x32_bf16 v[40:43], a[168:171], a[136:139], v[40:43]
    ds_read_b64_tr_b16 a[206:207], v245 offset:35144
    s_add_u32 s101, s101, s56
    v_mfma_f32_16x16x32_bf16 v[44:47], a[168:171], a[140:143], v[44:47]
    buffer_load_dwordx4 v198, s[12:15], s59 offen nt lds
    s_add_u32 s4, s94, s101
    s_addc_u32 s5, s95, 0
    v_mfma_f32_16x16x32_bf16 v[48:51], a[172:175], a[128:131], v[48:51]
    ds_read_b64_tr_b16 a[208:209], v246 offset:33088
    s_mov_b32 s6, 524288
    v_mfma_f32_16x16x32_bf16 v[52:55], a[172:175], a[132:135], v[52:55]
    ds_read_b64_tr_b16 a[210:211], v246 offset:35136
    v_mfma_f32_16x16x32_bf16 v[56:59], a[172:175], a[136:139], v[56:59]
    s_mov_b32 s7, 0x20000
    v_mfma_f32_16x16x32_bf16 v[60:63], a[172:175], a[140:143], v[60:63]
    ds_read_b64_tr_b16 a[212:213], v246 offset:33096
    s_and_b32 s56, s97, 3
    s_waitcnt lgkmcnt(15)
    v_mfma_f32_16x16x32_bf16 v[64:67], a[176:179], a[128:131], v[64:67]
    ds_read_b64_tr_b16 a[214:215], v246 offset:35144
    s_add_u32 m0, s41, 26400
    s_lshl_b32 s101, s98, 2
    v_mfma_f32_16x16x32_bf16 v[68:71], a[176:179], a[132:135], v[68:71]
    v_mfma_f32_16x16x32_bf16 v[72:75], a[176:179], a[136:139], v[72:75]
    ds_read_b64_tr_b16 a[216:217], v247 offset:33088
    s_add_u32 s101, s101, s56
    v_mfma_f32_16x16x32_bf16 v[76:79], a[176:179], a[140:143], v[76:79]
    ds_read_b64_tr_b16 a[218:219], v247 offset:35136
    buffer_store_dwordx4 a[224:227], v218, s[36:39], s58 offen offset:0 sc1
    s_lshl_b32 s101, s101, 1
    v_mfma_f32_16x16x32_bf16 v[80:83], a[180:183], a[128:131], v[80:83]
    s_add_u32 s101, s101, s100
    v_mfma_f32_16x16x32_bf16 v[84:87], a[180:183], a[132:135], v[84:87]
    ds_read_b64_tr_b16 a[220:221], v247 offset:33096
    s_nop 0
    s_mul_i32 s101, s101, 655360
    v_mfma_f32_16x16x32_bf16 v[88:91], a[180:183], a[136:139], v[88:91]
    ds_read_b64_tr_b16 a[222:223], v247 offset:35144
    v_mfma_f32_16x16x32_bf16 v[92:95], a[180:183], a[140:143], v[92:95]
    s_add_u32 s101, s101, 33554432
    s_waitcnt lgkmcnt(15)
    v_mfma_f32_16x16x32_bf16 v[96:99], a[184:187], a[128:131], v[96:99]
    s_add_u32 s8, s94, s101
    s_addc_u32 s9, s95, 0
    v_mfma_f32_16x16x32_bf16 v[100:103], a[184:187], a[132:135], v[100:103]
    buffer_store_dwordx4 a[228:231], v218, s[36:39], s58 offen offset:1024 sc1
    s_mov_b32 s10, 655360
    v_mfma_f32_16x16x32_bf16 v[104:107], a[184:187], a[136:139], v[104:107]
    buffer_load_dwordx4 v199, s[12:15], s59 offen nt lds
    v_mfma_f32_16x16x32_bf16 v[108:111], a[184:187], a[140:143], v[108:111]
    s_mov_b32 s11, 0x20000
    v_mfma_f32_16x16x32_bf16 v[112:115], a[188:191], a[128:131], v[112:115]
    s_lshl_b32 s101, s99, 1
    v_mfma_f32_16x16x32_bf16 v[116:119], a[188:191], a[132:135], v[116:119]
    s_add_u32 s101, s101, s55
    v_mfma_f32_16x16x32_bf16 v[120:123], a[188:191], a[136:139], v[120:123]
    v_mfma_f32_16x16x32_bf16 v[124:127], a[188:191], a[140:143], v[124:127]
    s_waitcnt vmcnt(12) lgkmcnt(0)
    s_barrier
    v_mfma_f32_16x16x32_bf16 a[0:3], a[192:195], a[128:131], a[0:3]
    ds_read_b128 a[144:147], v243 offset:0
    s_mul_i32 s101, s101, 327680
    v_mfma_f32_16x16x32_bf16 a[4:7], a[192:195], a[132:135], a[4:7]
    ds_read_b128 a[148:151], v243 offset:2048
    buffer_store_dwordx4 a[232:235], v218, s[36:39], s58 offen offset:2048 sc1
    s_mul_i32 s55, s98, 1280
    v_mfma_f32_16x16x32_bf16 a[8:11], a[192:195], a[136:139], a[8:11]
    ds_read_b128 a[152:155], v243 offset:4096
    s_add_u32 m0, s42, 8448
    s_add_u32 s101, s101, s55
    v_mfma_f32_16x16x32_bf16 a[12:15], a[192:195], a[140:143], a[12:15]
    v_mfma_f32_16x16x32_bf16 a[16:19], a[196:199], a[128:131], a[16:19]
    ds_read_b128 a[156:159], v243 offset:6144
    s_lshl_b32 s55, s56, 1
    v_mfma_f32_16x16x32_bf16 a[20:23], a[196:199], a[132:135], a[20:23]
    ds_read_b64_tr_b16 a[160:161], v244 offset:49248
    s_add_u32 s55, s55, s100
    v_mfma_f32_16x16x32_bf16 a[24:27], a[196:199], a[136:139], a[24:27]
    s_mul_i32 s55, s55, 160
    v_mfma_f32_16x16x32_bf16 a[28:31], a[196:199], a[140:143], a[28:31]
    ds_read_b64_tr_b16 a[162:163], v244 offset:51296
    s_add_u32 s59, s29, 8192
    v_mfma_f32_16x16x32_bf16 a[32:35], a[200:203], a[128:131], a[32:35]
    ds_read_b64_tr_b16 a[164:165], v244 offset:49256
    s_add_u32 s101, s101, s55
    v_mfma_f32_16x16x32_bf16 a[36:39], a[200:203], a[132:135], a[36:39]
    ds_read_b64_tr_b16 a[166:167], v244 offset:51304
    s_add_u32 s24, s92, s101
    s_addc_u32 s25, s93, 0
    v_mfma_f32_16x16x32_bf16 a[40:43], a[200:203], a[136:139], a[40:43]
    s_sub_u32 s26, 5242880, s101
    v_mfma_f32_16x16x32_bf16 a[44:47], a[200:203], a[140:143], a[44:47]
    ds_read_b64_tr_b16 a[168:169], v245 offset:49248
    buffer_store_dwordx4 a[236:239], v218, s[36:39], s58 offen offset:3072 sc1
    v_mfma_f32_16x16x32_bf16 a[48:51], a[204:207], a[128:131], a[48:51]
    ds_read_b64_tr_b16 a[170:171], v245 offset:51296
    buffer_load_dwordx4 v198, s[16:19], s59 offen nt lds
    s_mov_b32 s27, 0x20000
    v_mfma_f32_16x16x32_bf16 a[52:55], a[204:207], a[132:135], a[52:55]
    s_lshl_b32 s101, s99, 3
    v_mfma_f32_16x16x32_bf16 a[56:59], a[204:207], a[136:139], a[56:59]
    ds_read_b64_tr_b16 a[172:173], v245 offset:49256
    s_mov_b64 s[32:33], 0xff
    v_mfma_f32_16x16x32_bf16 a[60:63], a[204:207], a[140:143], a[60:63]
    ds_read_b64_tr_b16 a[174:175], v245 offset:51304
    v_mfma_f32_16x16x32_bf16 a[64:67], a[208:211], a[128:131], a[64:67]
    ds_read_b64_tr_b16 a[176:177], v246 offset:49248
    s_lshl_b64 s[32:33], s[32:33], s101
    v_mfma_f32_16x16x32_bf16 a[68:71], a[208:211], a[132:135], a[68:71]
    s_add_u32 m0, s42, 9504
    s_lshl_b32 s101, s99, 2
    v_mfma_f32_16x16x32_bf16 a[72:75], a[208:211], a[136:139], a[72:75]
    ds_read_b64_tr_b16 a[178:179], v246 offset:51296
    s_add_u32 s101, s101, s96
    v_mfma_f32_16x16x32_bf16 a[76:79], a[208:211], a[140:143], a[76:79]
    ds_read_b64_tr_b16 a[180:181], v246 offset:49256
    v_mfma_f32_16x16x32_bf16 a[80:83], a[212:215], a[128:131], a[80:83]
    s_lshl_b32 s101, s101, 2
    v_mfma_f32_16x16x32_bf16 a[84:87], a[212:215], a[132:135], a[84:87]
    ds_read_b64_tr_b16 a[182:183], v246 offset:51304
    buffer_store_dwordx4 a[240:243], v218, s[36:39], s57 offen sc1
    s_add_u32 s101, s101, s56
    v_mfma_f32_16x16x32_bf16 a[88:91], a[212:215], a[136:139], a[88:91]
    ds_read_b64_tr_b16 a[184:185], v247 offset:49248
    s_nop 0
    v_add_u32 v254, 1, v254
    v_mfma_f32_16x16x32_bf16 a[92:95], a[212:215], a[140:143], a[92:95]
    ds_read_b64_tr_b16 a[186:187], v247 offset:51296
    v_mfma_f32_16x16x32_bf16 a[96:99], a[216:219], a[128:131], a[96:99]
    v_add_u32 v255, 1, v255
    v_mfma_f32_16x16x32_bf16 a[100:103], a[216:219], a[132:135], a[100:103]
    ds_read_b64_tr_b16 a[188:189], v247 offset:49256
    s_lshr_b32 s55, s101, 1
    v_mfma_f32_16x16x32_bf16 a[104:107], a[216:219], a[136:139], a[104:107]
    ds_read_b64_tr_b16 a[190:191], v247 offset:51304
    s_lshl_b32 s43, s98, 7
    v_mfma_f32_16x16x32_bf16 a[108:111], a[216:219], a[140:143], a[108:111]
    buffer_load_dwordx4 v199, s[16:19], s59 offen nt lds
    v_mfma_f32_16x16x32_bf16 a[112:115], a[220:223], a[128:131], a[112:115]
    s_add_u32 s43, s43, s101
    v_mfma_f32_16x16x32_bf16 a[116:119], a[220:223], a[132:135], a[116:119]
    s_lshl_b32 s43, s43, 2
    v_mfma_f32_16x16x32_bf16 a[120:123], a[220:223], a[136:139], a[120:123]
    s_add_u32 s43, s43, 58720256
    v_mfma_f32_16x16x32_bf16 a[124:127], a[220:223], a[140:143], a[124:127]
    s_waitcnt lgkmcnt(12)
    v_mfma_f32_16x16x32_bf16 v[0:3], a[160:163], a[144:147], v[0:3]
    ds_read_b64_tr_b16 a[192:193], v244 offset:49504
    v_readlane_b32 s52, v254, s55
    v_mfma_f32_16x16x32_bf16 v[4:7], a[160:163], a[148:151], v[4:7]
    ds_read_b64_tr_b16 a[194:195], v244 offset:51552
    s_mov_b32 s58, 2621440
    v_readlane_b32 s55, v255, s55
    v_mfma_f32_16x16x32_bf16 v[8:11], a[160:163], a[152:155], v[8:11]
    s_bitcmp1_b32 s101, 0
    s_cselect_b32 s52, s55, s52
    v_mfma_f32_16x16x32_bf16 v[12:15], a[160:163], a[156:159], v[12:15]
    ds_read_b64_tr_b16 a[196:197], v244 offset:49512
    s_mul_i32 s50, s40, 5120
    v_mfma_f32_16x16x32_bf16 v[16:19], a[164:167], a[144:147], v[16:19]
    ds_read_b64_tr_b16 a[198:199], v244 offset:51560
    v_lshlrev_b32 v212, 4, v204
    v_mfma_f32_16x16x32_bf16 v[20:23], a[164:167], a[148:151], v[20:23]
    v_mfma_f32_16x16x32_bf16 v[24:27], a[164:167], a[152:155], v[24:27]
    ds_read_b64_tr_b16 a[200:201], v245 offset:49504
    s_lshl_b32 s101, s40, 12
    v_mfma_f32_16x16x32_bf16 v[28:31], a[164:167], a[156:159], v[28:31]
    ds_read_b64_tr_b16 a[202:203], v245 offset:51552
    s_mov_b32 s57, 2625536
    v_add_u32 v228, s101, v212
    s_waitcnt lgkmcnt(14)
    v_mfma_f32_16x16x32_bf16 v[32:35], a[168:171], a[144:147], v[32:35]
    v_add_u32 v229, s50, v212
    v_mfma_f32_16x16x32_bf16 v[36:39], a[168:171], a[148:151], v[36:39]
    ds_read_b64_tr_b16 a[204:205], v245 offset:49512
    v_add_u32 v230, 4096, v229
    v_mfma_f32_16x16x32_bf16 v[40:43], a[168:171], a[152:155], v[40:43]
    ds_read_b64_tr_b16 a[206:207], v245 offset:51560
    v_mfma_f32_16x16x32_bf16 v[44:47], a[168:171], a[156:159], v[44:47]
    s_mul_i32 s101, s100, 5120
    v_mfma_f32_16x16x32_bf16 v[48:51], a[172:175], a[144:147], v[48:51]
    ds_read_b64_tr_b16 a[208:209], v246 offset:49504
    v_add_u32 v231, s101, v212
    v_mfma_f32_16x16x32_bf16 v[52:55], a[172:175], a[148:151], v[52:55]
    ds_read_b64_tr_b16 a[210:211], v246 offset:51552
    s_sub_u32 s101, 5120, s101
    v_mfma_f32_16x16x32_bf16 v[56:59], a[172:175], a[152:155], v[56:59]
    v_add_u32 v234, s101, v212
    v_mfma_f32_16x16x32_bf16 v[60:63], a[172:175], a[156:159], v[60:63]
    ds_read_b64_tr_b16 a[212:213], v246 offset:49512
    s_waitcnt lgkmcnt(15)
    v_mfma_f32_16x16x32_bf16 v[64:67], a[176:179], a[144:147], v[64:67]
    ds_read_b64_tr_b16 a[214:215], v246 offset:51560
    v_add_u32 v232, 61440, v231
    v_mfma_f32_16x16x32_bf16 v[68:71], a[176:179], a[148:151], v[68:71]
    v_add_u32 v233, 122880, v231
    v_mfma_f32_16x16x32_bf16 v[72:75], a[176:179], a[152:155], v[72:75]
    ds_read_b64_tr_b16 a[216:217], v247 offset:49504
    v_add_u32 v235, 61440, v234
    v_mfma_f32_16x16x32_bf16 v[76:79], a[176:179], a[156:159], v[76:79]
    ds_read_b64_tr_b16 a[218:219], v247 offset:51552
    buffer_store_dwordx4 a[244:247], v218, s[36:39], s58 offen offset:0 sc1
    v_add_u32 v236, 122880, v234
    v_mfma_f32_16x16x32_bf16 v[80:83], a[180:183], a[144:147], v[80:83]
    v_mfma_f32_16x16x32_bf16 v[84:87], a[180:183], a[148:151], v[84:87]
    ds_read_b64_tr_b16 a[220:221], v247 offset:49512
    v_and_b32 v212, 15, v204
    v_mfma_f32_16x16x32_bf16 v[88:91], a[180:183], a[152:155], v[88:91]
    ds_read_b64_tr_b16 a[222:223], v247 offset:51560
    s_lshl_b32 s101, s40, 5
    v_mfma_f32_16x16x32_bf16 v[92:95], a[180:183], a[156:159], v[92:95]
    v_add_u32 v212, s101, v212
    s_waitcnt lgkmcnt(15)
    v_mfma_f32_16x16x32_bf16 v[96:99], a[184:187], a[144:147], v[96:99]
    v_mul_u32_u24 v212, 2560, v212
    v_mfma_f32_16x16x32_bf16 v[100:103], a[184:187], a[148:151], v[100:103]
    buffer_store_dwordx4 a[248:251], v218, s[36:39], s58 offen offset:1024 sc1
    v_mfma_f32_16x16x32_bf16 v[104:107], a[184:187], a[152:155], v[104:107]
    v_lshrrev_b32 v213, 4, v204
    v_mfma_f32_16x16x32_bf16 v[108:111], a[184:187], a[156:159], v[108:111]
    v_lshl_add_u32 v237, v213, 3, v212
    v_mfma_f32_16x16x32_bf16 v[112:115], a[188:191], a[144:147], v[112:115]
    v_mov_b32 v238, v219
    v_mfma_f32_16x16x32_bf16 v[116:119], a[188:191], a[148:151], v[116:119]
    v_add_u32 v239, 8192, v219
    v_mfma_f32_16x16x32_bf16 v[120:123], a[188:191], a[152:155], v[120:123]
    v_mfma_f32_16x16x32_bf16 v[124:127], a[188:191], a[156:159], v[124:127]
    s_waitcnt lgkmcnt(0)
    s_barrier
    v_mfma_f32_16x16x32_bf16 a[0:3], a[192:195], a[144:147], a[0:3]
    v_pk_mul_f32 v[0:1], v[0:1], s[48:49] op_sel_hi:[1,0]
    v_pk_mul_f32 v[2:3], v[2:3], s[48:49] op_sel_hi:[1,0]
    v_pk_mul_f32 v[16:17], v[16:17], s[48:49] op_sel_hi:[1,0]
    v_pk_mul_f32 v[18:19], v[18:19], s[48:49] op_sel_hi:[1,0]
    v_mfma_f32_16x16x32_bf16 a[4:7], a[192:195], a[148:151], a[4:7]
    buffer_store_dwordx4 a[252:255], v218, s[36:39], s58 offen offset:2048 sc1
    v_cvt_pk_bf16_f32 v128, v0, v1
    v_cvt_pk_bf16_f32 v129, v2, v3
    v_cvt_pk_bf16_f32 v130, v16, v17
    v_cvt_pk_bf16_f32 v131, v18, v19
    v_mfma_f32_16x16x32_bf16 a[8:11], a[192:195], a[152:155], a[8:11]
    v_pk_mul_f32 v[4:5], v[4:5], s[48:49] op_sel_hi:[1,0]
    v_pk_mul_f32 v[6:7], v[6:7], s[48:49] op_sel_hi:[1,0]
    v_pk_mul_f32 v[20:21], v[20:21], s[48:49] op_sel_hi:[1,0]
    v_pk_mul_f32 v[22:23], v[22:23], s[48:49] op_sel_hi:[1,0]
    v_mfma_f32_16x16x32_bf16 a[12:15], a[192:195], a[156:159], a[12:15]
    v_cvt_pk_bf16_f32 v144, v4, v5
    v_cvt_pk_bf16_f32 v145, v6, v7
    v_cvt_pk_bf16_f32 v146, v20, v21
    v_cvt_pk_bf16_f32 v147, v22, v23
    v_mfma_f32_16x16x32_bf16 a[16:19], a[196:199], a[144:147], a[16:19]
    v_pk_mul_f32 v[8:9], v[8:9], s[48:49] op_sel_hi:[1,0]
    v_pk_mul_f32 v[10:11], v[10:11], s[48:49] op_sel_hi:[1,0]
    v_pk_mul_f32 v[24:25], v[24:25], s[48:49] op_sel_hi:[1,0]
    v_pk_mul_f32 v[26:27], v[26:27], s[48:49] op_sel_hi:[1,0]
    v_mfma_f32_16x16x32_bf16 a[20:23], a[196:199], a[148:151], a[20:23]
    v_cvt_pk_bf16_f32 v160, v8, v9
    v_cvt_pk_bf16_f32 v161, v10, v11
    v_cvt_pk_bf16_f32 v162, v24, v25
    v_cvt_pk_bf16_f32 v163, v26, v27
    v_mfma_f32_16x16x32_bf16 a[24:27], a[196:199], a[152:155], a[24:27]
    v_pk_mul_f32 v[12:13], v[12:13], s[48:49] op_sel_hi:[1,0]
    v_pk_mul_f32 v[14:15], v[14:15], s[48:49] op_sel_hi:[1,0]
    v_pk_mul_f32 v[28:29], v[28:29], s[48:49] op_sel_hi:[1,0]
    v_pk_mul_f32 v[30:31], v[30:31], s[48:49] op_sel_hi:[1,0]
    v_mfma_f32_16x16x32_bf16 a[28:31], a[196:199], a[156:159], a[28:31]
    v_cvt_pk_bf16_f32 v176, v12, v13
    v_cvt_pk_bf16_f32 v177, v14, v15
    v_cvt_pk_bf16_f32 v178, v28, v29
    v_cvt_pk_bf16_f32 v179, v30, v31
    v_mfma_f32_16x16x32_bf16 a[32:35], a[200:203], a[144:147], a[32:35]
    v_pk_mul_f32 v[32:33], v[32:33], s[48:49] op_sel_hi:[1,0]
    v_pk_mul_f32 v[34:35], v[34:35], s[48:49] op_sel_hi:[1,0]
    v_pk_mul_f32 v[48:49], v[48:49], s[48:49] op_sel_hi:[1,0]
    v_pk_mul_f32 v[50:51], v[50:51], s[48:49] op_sel_hi:[1,0]
    v_mfma_f32_16x16x32_bf16 a[36:39], a[200:203], a[148:151], a[36:39]
    v_cvt_pk_bf16_f32 v132, v32, v33
    v_cvt_pk_bf16_f32 v133, v34, v35
    v_cvt_pk_bf16_f32 v134, v48, v49
    v_cvt_pk_bf16_f32 v135, v50, v51
    v_mfma_f32_16x16x32_bf16 a[40:43], a[200:203], a[152:155], a[40:43]
    v_pk_mul_f32 v[36:37], v[36:37], s[48:49] op_sel_hi:[1,0]
    v_pk_mul_f32 v[38:39], v[38:39], s[48:49] op_sel_hi:[1,0]
    v_pk_mul_f32 v[52:53], v[52:53], s[48:49] op_sel_hi:[1,0]
    v_pk_mul_f32 v[54:55], v[54:55], s[48:49] op_sel_hi:[1,0]
    v_mfma_f32_16x16x32_bf16 a[44:47], a[200:203], a[156:159], a[44:47]
    buffer_store_dwordx4 v[220:223], v218, s[36:39], s58 offen offset:3072 sc1
    v_cvt_pk_bf16_f32 v148, v36, v37
    v_cvt_pk_bf16_f32 v149, v38, v39
    v_cvt_pk_bf16_f32 v150, v52, v53
    v_cvt_pk_bf16_f32 v151, v54, v55
    v_mfma_f32_16x16x32_bf16 a[48:51], a[204:207], a[144:147], a[48:51]
    v_pk_mul_f32 v[40:41], v[40:41], s[48:49] op_sel_hi:[1,0]
    v_pk_mul_f32 v[42:43], v[42:43], s[48:49] op_sel_hi:[1,0]
    v_pk_mul_f32 v[56:57], v[56:57], s[48:49] op_sel_hi:[1,0]
    v_pk_mul_f32 v[58:59], v[58:59], s[48:49] op_sel_hi:[1,0]
    v_mfma_f32_16x16x32_bf16 a[52:55], a[204:207], a[148:151], a[52:55]
    v_cvt_pk_bf16_f32 v164, v40, v41
    v_cvt_pk_bf16_f32 v165, v42, v43
    v_cvt_pk_bf16_f32 v166, v56, v57
    v_cvt_pk_bf16_f32 v167, v58, v59
    v_mfma_f32_16x16x32_bf16 a[56:59], a[204:207], a[152:155], a[56:59]
    v_pk_mul_f32 v[44:45], v[44:45], s[48:49] op_sel_hi:[1,0]
    v_pk_mul_f32 v[46:47], v[46:47], s[48:49] op_sel_hi:[1,0]
    v_pk_mul_f32 v[60:61], v[60:61], s[48:49] op_sel_hi:[1,0]
    v_pk_mul_f32 v[62:63], v[62:63], s[48:49] op_sel_hi:[1,0]
    v_mfma_f32_16x16x32_bf16 a[60:63], a[204:207], a[156:159], a[60:63]
    v_cvt_pk_bf16_f32 v180, v44, v45
    v_cvt_pk_bf16_f32 v181, v46, v47
    v_cvt_pk_bf16_f32 v182, v60, v61
    v_cvt_pk_bf16_f32 v183, v62, v63
    v_mfma_f32_16x16x32_bf16 a[64:67], a[208:211], a[144:147], a[64:67]
    v_pk_mul_f32 v[64:65], v[64:65], s[48:49] op_sel_hi:[1,0]
    v_pk_mul_f32 v[66:67], v[66:67], s[48:49] op_sel_hi:[1,0]
    v_pk_mul_f32 v[80:81], v[80:81], s[48:49] op_sel_hi:[1,0]
    v_pk_mul_f32 v[82:83], v[82:83], s[48:49] op_sel_hi:[1,0]
    v_mfma_f32_16x16x32_bf16 a[68:71], a[208:211], a[148:151], a[68:71]
    v_cvt_pk_bf16_f32 v136, v64, v65
    v_cvt_pk_bf16_f32 v137, v66, v67
    v_cvt_pk_bf16_f32 v138, v80, v81
    v_cvt_pk_bf16_f32 v139, v82, v83
    v_mfma_f32_16x16x32_bf16 a[72:75], a[208:211], a[152:155], a[72:75]
    v_pk_mul_f32 v[68:69], v[68:69], s[48:49] op_sel_hi:[1,0]
    v_pk_mul_f32 v[70:71], v[70:71], s[48:49] op_sel_hi:[1,0]
    v_pk_mul_f32 v[84:85], v[84:85], s[48:49] op_sel_hi:[1,0]
    v_pk_mul_f32 v[86:87], v[86:87], s[48:49] op_sel_hi:[1,0]
    v_mfma_f32_16x16x32_bf16 a[76:79], a[208:211], a[156:159], a[76:79]
    v_cvt_pk_bf16_f32 v152, v68, v69
    v_cvt_pk_bf16_f32 v153, v70, v71
    v_cvt_pk_bf16_f32 v154, v84, v85
    v_cvt_pk_bf16_f32 v155, v86, v87
    v_mfma_f32_16x16x32_bf16 a[80:83], a[212:215], a[144:147], a[80:83]
    v_pk_mul_f32 v[72:73], v[72:73], s[48:49] op_sel_hi:[1,0]
    v_pk_mul_f32 v[74:75], v[74:75], s[48:49] op_sel_hi:[1,0]
    v_pk_mul_f32 v[88:89], v[88:89], s[48:49] op_sel_hi:[1,0]
    v_pk_mul_f32 v[90:91], v[90:91], s[48:49] op_sel_hi:[1,0]
    v_mfma_f32_16x16x32_bf16 a[84:87], a[212:215], a[148:151], a[84:87]
    buffer_store_dwordx4 v[224:227], v218, s[36:39], s57 offen sc1
    v_cvt_pk_bf16_f32 v168, v72, v73
    v_cvt_pk_bf16_f32 v169, v74, v75
    v_cvt_pk_bf16_f32 v170, v88, v89
    v_cvt_pk_bf16_f32 v171, v90, v91
    v_mfma_f32_16x16x32_bf16 a[88:91], a[212:215], a[152:155], a[88:91]
    v_pk_mul_f32 v[76:77], v[76:77], s[48:49] op_sel_hi:[1,0]
    v_pk_mul_f32 v[78:79], v[78:79], s[48:49] op_sel_hi:[1,0]
    v_pk_mul_f32 v[92:93], v[92:93], s[48:49] op_sel_hi:[1,0]
    v_pk_mul_f32 v[94:95], v[94:95], s[48:49] op_sel_hi:[1,0]
    v_mfma_f32_16x16x32_bf16 a[92:95], a[212:215], a[156:159], a[92:95]
    v_cvt_pk_bf16_f32 v184, v76, v77
    v_cvt_pk_bf16_f32 v185, v78, v79
    v_cvt_pk_bf16_f32 v186, v92, v93
    v_cvt_pk_bf16_f32 v187, v94, v95
    v_mfma_f32_16x16x32_bf16 a[96:99], a[216:219], a[144:147], a[96:99]
    v_pk_mul_f32 v[96:97], v[96:97], s[48:49] op_sel_hi:[1,0]
    v_pk_mul_f32 v[98:99], v[98:99], s[48:49] op_sel_hi:[1,0]
    v_pk_mul_f32 v[112:113], v[112:113], s[48:49] op_sel_hi:[1,0]
    v_pk_mul_f32 v[114:115], v[114:115], s[48:49] op_sel_hi:[1,0]
    v_mfma_f32_16x16x32_bf16 a[100:103], a[216:219], a[148:151], a[100:103]
    v_cvt_pk_bf16_f32 v140, v96, v97
    v_cvt_pk_bf16_f32 v141, v98, v99
    v_cvt_pk_bf16_f32 v142, v112, v113
    v_cvt_pk_bf16_f32 v143, v114, v115
    v_mfma_f32_16x16x32_bf16 a[104:107], a[216:219], a[152:155], a[104:107]
    v_pk_mul_f32 v[100:101], v[100:101], s[48:49] op_sel_hi:[1,0]
    v_pk_mul_f32 v[102:103], v[102:103], s[48:49] op_sel_hi:[1,0]
    v_pk_mul_f32 v[116:117], v[116:117], s[48:49] op_sel_hi:[1,0]
    v_pk_mul_f32 v[118:119], v[118:119], s[48:49] op_sel_hi:[1,0]
    v_mfma_f32_16x16x32_bf16 a[108:111], a[216:219], a[156:159], a[108:111]
    v_cvt_pk_bf16_f32 v156, v100, v101
    v_cvt_pk_bf16_f32 v157, v102, v103
    v_cvt_pk_bf16_f32 v158, v116, v117
    v_cvt_pk_bf16_f32 v159, v118, v119
    v_mfma_f32_16x16x32_bf16 a[112:115], a[220:223], a[144:147], a[112:115]
    v_pk_mul_f32 v[104:105], v[104:105], s[48:49] op_sel_hi:[1,0]
    v_pk_mul_f32 v[106:107], v[106:107], s[48:49] op_sel_hi:[1,0]
    v_pk_mul_f32 v[120:121], v[120:121], s[48:49] op_sel_hi:[1,0]
    v_pk_mul_f32 v[122:123], v[122:123], s[48:49] op_sel_hi:[1,0]
    v_mfma_f32_16x16x32_bf16 a[116:119], a[220:223], a[148:151], a[116:119]
    v_cvt_pk_bf16_f32 v172, v104, v105
    v_cvt_pk_bf16_f32 v173, v106, v107
    v_cvt_pk_bf16_f32 v174, v120, v121
    v_cvt_pk_bf16_f32 v175, v122, v123
    v_mfma_f32_16x16x32_bf16 a[120:123], a[220:223], a[152:155], a[120:123]
    s_getpc_b64 s[30:31]
K1_PF3:
    v_lshlrev_b32 v217, 7, v204
    v_add_u32 v217, s44, v217
    v_add_u32 v217, K1_HM-K1_PF3, v217
    v_min_u32 v217, K1_END-K1_PF3, v217
    global_load_dword v208, v217, s[30:31]
    v_add_u32 v217, 32768, v217
    v_min_u32 v217, K1_END-K1_PF3, v217
    global_load_dword v208, v217, s[30:31]
    s_mov_b32 s31, 99
    v_pk_mul_f32 v[108:109], v[108:109], s[48:49] op_sel_hi:[1,0]
    v_pk_mul_f32 v[110:111], v[110:111], s[48:49] op_sel_hi:[1,0]
    v_pk_mul_f32 v[124:125], v[124:125], s[48:49] op_sel_hi:[1,0]
    v_pk_mul_f32 v[126:127], v[126:127], s[48:49] op_sel_hi:[1,0]
    v_mfma_f32_16x16x32_bf16 a[124:127], a[220:223], a[156:159], a[124:127]
    v_cvt_pk_bf16_f32 v188, v108, v109
    v_cvt_pk_bf16_f32 v189, v110, v111
    v_cvt_pk_bf16_f32 v190, v124, v125
    v_cvt_pk_bf16_f32 v191, v126, v127
    v_accvgpr_read_b32 v32, a0
    v_accvgpr_read_b32 v33, a1
    v_accvgpr_read_b32 v34, a2
    v_accvgpr_read_b32 v35, a3
    v_accvgpr_read_b32 v36, a16
    v_accvgpr_read_b32 v37, a17
    v_accvgpr_read_b32 v38, a18
    v_accvgpr_read_b32 v39, a19
    v_accvgpr_read_b32 v40, a4
    v_accvgpr_read_b32 v41, a5
    v_accvgpr_read_b32 v42, a6
    v_accvgpr_read_b32 v43, a7
    v_accvgpr_read_b32 v44, a20
    v_accvgpr_read_b32 v45, a21
    v_accvgpr_read_b32 v46, a22
    v_accvgpr_read_b32 v47, a23
    v_pk_mul_f32 v[32:33], v[32:33], s[48:49] op_sel_hi:[1,0]
    v_pk_mul_f32 v[34:35], v[34:35], s[48:49] op_sel_hi:[1,0]
    v_pk_mul_f32 v[36:37], v[36:37], s[48:49] op_sel_hi:[1,0]
    v_pk_mul_f32 v[38:39], v[38:39], s[48:49] op_sel_hi:[1,0]
    v_pk_mul_f32 v[40:41], v[40:41], s[48:49] op_sel_hi:[1,0]
    v_pk_mul_f32 v[42:43], v[42:43], s[48:49] op_sel_hi:[1,0]
    v_pk_mul_f32 v[44:45], v[44:45], s[48:49] op_sel_hi:[1,0]
    v_pk_mul_f32 v[46:47], v[46:47], s[48:49] op_sel_hi:[1,0]
    v_cvt_pk_bf16_f32 v48, v32, v33
    v_cvt_pk_bf16_f32 v49, v34, v35
    v_cvt_pk_bf16_f32 v50, v36, v37
    v_cvt_pk_bf16_f32 v51, v38, v39
    v_cvt_pk_bf16_f32 v52, v40, v41
    v_cvt_pk_bf16_f32 v53, v42, v43
    v_cvt_pk_bf16_f32 v54, v44, v45
    v_cvt_pk_bf16_f32 v55, v46, v47
    v_accvgpr_write_b32 a128, v48
    v_accvgpr_write_b32 a129, v49
    v_accvgpr_write_b32 a130, v50
    v_accvgpr_write_b32 a131, v51
    v_accvgpr_write_b32 a144, v52
    v_accvgpr_write_b32 a145, v53
    v_accvgpr_write_b32 a146, v54
    v_accvgpr_write_b32 a147, v55
    s_mov_b32 s46, 8192
    s_mov_b32 s36, s41
    s_mov_b32 s37, s41
    s_mov_b32 s38, s42
    s_mov_b32 s39, s42
    s_waitcnt vmcnt(18)
    s_barrier
    ds_read_b128 a[192:195], v196 offset:0
    ds_read_b128 a[196:199], v196 offset:512
    ds_read_b128 a[200:203], v196 offset:64
    ds_read_b128 a[204:207], v196 offset:576
    ds_read_b128 a[208:211], v196 offset:128
    ds_read_b128 a[212:215], v196 offset:640
    ds_read_b128 a[216:219], v196 offset:192
    ds_read_b128 a[220:223], v196 offset:704
    v_accvgpr_read_b32 v32, a8
    v_accvgpr_read_b32 v33, a9
    v_accvgpr_read_b32 v34, a10
    v_accvgpr_read_b32 v35, a11
    v_accvgpr_read_b32 v36, a24
    v_accvgpr_read_b32 v37, a25
    v_accvgpr_read_b32 v38, a26
    v_accvgpr_read_b32 v39, a27
    v_accvgpr_read_b32 v40, a12
    v_accvgpr_read_b32 v41, a13
    v_accvgpr_read_b32 v42, a14
    v_accvgpr_read_b32 v43, a15
    v_accvgpr_read_b32 v44, a28
    v_accvgpr_read_b32 v45, a29
    v_accvgpr_read_b32 v46, a30
    v_accvgpr_read_b32 v47, a31
    v_pk_mul_f32 v[32:33], v[32:33], s[48:49] op_sel_hi:[1,0]
    v_pk_mul_f32 v[34:35], v[34:35], s[48:49] op_sel_hi:[1,0]
    v_pk_mul_f32 v[36:37], v[36:37], s[48:49] op_sel_hi:[1,0]
    v_pk_mul_f32 v[38:39], v[38:39], s[48:49] op_sel_hi:[1,0]
    v_pk_mul_f32 v[40:41], v[40:41], s[48:49] op_sel_hi:[1,0]
    v_pk_mul_f32 v[42:43], v[42:43], s[48:49] op_sel_hi:[1,0]
    v_pk_mul_f32 v[44:45], v[44:45], s[48:49] op_sel_hi:[1,0]
    v_pk_mul_f32 v[46:47], v[46:47], s[48:49] op_sel_hi:[1,0]
    v_cvt_pk_bf16_f32 v48, v32, v33
    v_cvt_pk_bf16_f32 v49, v34, v35
    v_cvt_pk_bf16_f32 v50, v36, v37
    v_cvt_pk_bf16_f32 v51, v38, v39
    v_cvt_pk_bf16_f32 v52, v40, v41
    v_cvt_pk_bf16_f32 v53, v42, v43
    v_cvt_pk_bf16_f32 v54, v44, v45
    v_cvt_pk_bf16_f32 v55, v46, v47
    v_accvgpr_write_b32 a160, v48
    v_accvgpr_write_b32 a161, v49
    v_accvgpr_write_b32 a162, v50
    v_accvgpr_write_b32 a163, v51
    v_accvgpr_write_b32 a176, v52
    v_accvgpr_write_b32 a177, v53
    v_accvgpr_write_b32 a178, v54
    v_accvgpr_write_b32 a179, v55
    v_accvgpr_read_b32 v32, a32
    v_accvgpr_read_b32 v33, a33
    v_accvgpr_read_b32 v34, a34
    v_accvgpr_read_b32 v35, a35
    v_accvgpr_read_b32 v36, a48
    v_accvgpr_read_b32 v37, a49
    v_accvgpr_read_b32 v38, a50
    v_accvgpr_read_b32 v39, a51
    v_accvgpr_read_b32 v40, a36
    v_accvgpr_read_b32 v41, a37
    v_accvgpr_read_b32 v42, a38
    v_accvgpr_read_b32 v43, a39
    v_accvgpr_read_b32 v44, a52
    v_accvgpr_read_b32 v45, a53
    v_accvgpr_read_b32 v46, a54
    v_accvgpr_read_b32 v47, a55
    v_pk_mul_f32 v[32:33], v[32:33], s[48:49] op_sel_hi:[1,0]
    v_pk_mul_f32 v[34:35], v[34:35], s[48:49] op_sel_hi:[1,0]
    v_pk_mul_f32 v[36:37], v[36:37], s[48:49] op_sel_hi:[1,0]
    v_pk_mul_f32 v[38:39], v[38:39], s[48:49] op_sel_hi:[1,0]
    v_pk_mul_f32 v[40:41], v[40:41], s[48:49] op_sel_hi:[1,0]
    v_pk_mul_f32 v[42:43], v[42:43], s[48:49] op_sel_hi:[1,0]
    v_pk_mul_f32 v[44:45], v[44:45], s[48:49] op_sel_hi:[1,0]
    v_pk_mul_f32 v[46:47], v[46:47], s[48:49] op_sel_hi:[1,0]
    v_cvt_pk_bf16_f32 v48, v32, v33
    v_cvt_pk_bf16_f32 v49, v34, v35
    v_cvt_pk_bf16_f32 v50, v36, v37
    v_cvt_pk_bf16_f32 v51, v38, v39
    v_cvt_pk_bf16_f32 v52, v40, v41
    v_cvt_pk_bf16_f32 v53, v42, v43
    v_cvt_pk_bf16_f32 v54, v44, v45
    v_cvt_pk_bf16_f32 v55, v46, v47
    v_accvgpr_write_b32 a132, v48
    v_accvgpr_write_b32 a133, v49
    v_accvgpr_write_b32 a134, v50
    v_accvgpr_write_b32 a135, v51
    v_accvgpr_write_b32 a148, v52
    v_accvgpr_write_b32 a149, v53
    v_accvgpr_write_b32 a150, v54
    v_accvgpr_write_b32 a151, v55
    v_accvgpr_read_b32 v32, a40
    v_accvgpr_read_b32 v33, a41
    v_accvgpr_read_b32 v34, a42
    v_accvgpr_read_b32 v35, a43
    v_accvgpr_read_b32 v36, a56
    v_accvgpr_read_b32 v37, a57
    v_accvgpr_read_b32 v38, a58
    v_accvgpr_read_b32 v39, a59
    v_accvgpr_read_b32 v40, a44
    v_accvgpr_read_b32 v41, a45
    v_accvgpr_read_b32 v42, a46
    v_accvgpr_read_b32 v43, a47
    v_accvgpr_read_b32 v44, a60
    v_accvgpr_read_b32 v45, a61
    v_accvgpr_read_b32 v46, a62
    v_accvgpr_read_b32 v47, a63
    v_pk_mul_f32 v[32:33], v[32:33], s[48:49] op_sel_hi:[1,0]
    v_pk_mul_f32 v[34:35], v[34:35], s[48:49] op_sel_hi:[1,0]
    v_pk_mul_f32 v[36:37], v[36:37], s[48:49] op_sel_hi:[1,0]
    v_pk_mul_f32 v[38:39], v[38:39], s[48:49] op_sel_hi:[1,0]
    v_pk_mul_f32 v[40:41], v[40:41], s[48:49] op_sel_hi:[1,0]
    v_pk_mul_f32 v[42:43], v[42:43], s[48:49] op_sel_hi:[1,0]
    v_pk_mul_f32 v[44:45], v[44:45], s[48:49] op_sel_hi:[1,0]
    v_pk_mul_f32 v[46:47], v[46:47], s[48:49] op_sel_hi:[1,0]
    v_cvt_pk_bf16_f32 v48, v32, v33
    v_cvt_pk_bf16_f32 v49, v34, v35
    v_cvt_pk_bf16_f32 v50, v36, v37
    v_cvt_pk_bf16_f32 v51, v38, v39
    v_cvt_pk_bf16_f32 v52, v40, v41
    v_cvt_pk_bf16_f32 v53, v42, v43
    v_cvt_pk_bf16_f32 v54, v44, v45
    v_cvt_pk_bf16_f32 v55, v46, v47
    v_accvgpr_write_b32 a164, v48
    v_accvgpr_write_b32 a165, v49
    v_accvgpr_write_b32 a166, v50
    v_accvgpr_write_b32 a167, v51
    v_accvgpr_write_b32 a180, v52
    v_accvgpr_write_b32 a181, v53
    v_accvgpr_write_b32 a182, v54
    v_accvgpr_write_b32 a183, v55
    v_accvgpr_read_b32 v32, a64
    v_accvgpr_read_b32 v33, a65
    v_accvgpr_read_b32 v34, a66
    v_accvgpr_read_b32 v35, a67
    v_accvgpr_read_b32 v36, a80
    v_accvgpr_read_b32 v37, a81
    v_accvgpr_read_b32 v38, a82
    v_accvgpr_read_b32 v39, a83
    v_accvgpr_read_b32 v40, a68
    v_accvgpr_read_b32 v41, a69
    v_accvgpr_read_b32 v42, a70
    v_accvgpr_read_b32 v43, a71
    v_accvgpr_read_b32 v44, a84
    v_accvgpr_read_b32 v45, a85
    v_accvgpr_read_b32 v46, a86
    v_accvgpr_read_b32 v47, a87
    v_pk_mul_f32 v[32:33], v[32:33], s[48:49] op_sel_hi:[1,0]
    v_pk_mul_f32 v[34:35], v[34:35], s[48:49] op_sel_hi:[1,0]
    v_pk_mul_f32 v[36:37], v[36:37], s[48:49] op_sel_hi:[1,0]
    v_pk_mul_f32 v[38:39], v[38:39], s[48:49] op_sel_hi:[1,0]
    v_pk_mul_f32 v[40:41], v[40:41], s[48:49] op_sel_hi:[1,0]
    v_pk_mul_f32 v[42:43], v[42:43], s[48:49] op_sel_hi:[1,0]
    v_pk_mul_f32 v[44:45], v[44:45], s[48:49] op_sel_hi:[1,0]
    v_pk_mul_f32 v[46:47], v[46:47], s[48:49] op_sel_hi:[1,0]
    v_cvt_pk_bf16_f32 v48, v32, v33
    v_cvt_pk_bf16_f32 v49, v34, v35
    v_cvt_pk_bf16_f32 v50, v36, v37
    v_cvt_pk_bf16_f32 v51, v38, v39
    v_cvt_pk_bf16_f32 v52, v40, v41
    v_cvt_pk_bf16_f32 v53, v42, v43
    v_cvt_pk_bf16_f32 v54, v44, v45
    v_cvt_pk_bf16_f32 v55, v46, v47
    v_accvgpr_write_b32 a136, v48
    v_accvgpr_write_b32 a137, v49
    v_accvgpr_write_b32 a138, v50
    v_accvgpr_write_b32 a139, v51
    v_accvgpr_write_b32 a152, v52
    v_accvgpr_write_b32 a153, v53
    v_accvgpr_write_b32 a154, v54
    v_accvgpr_write_b32 a155, v55
    v_accvgpr_read_b32 v32, a72
    v_accvgpr_read_b32 v33, a73
    v_accvgpr_read_b32 v34, a74
    v_accvgpr_read_b32 v35, a75
    v_accvgpr_read_b32 v36, a88
    v_accvgpr_read_b32 v37, a89
    v_accvgpr_read_b32 v38, a90
    v_accvgpr_read_b32 v39, a91
    v_accvgpr_read_b32 v40, a76
    v_accvgpr_read_b32 v41, a77
    v_accvgpr_read_b32 v42, a78
    v_accvgpr_read_b32 v43, a79
    v_accvgpr_read_b32 v44, a92
    v_accvgpr_read_b32 v45, a93
    v_accvgpr_read_b32 v46, a94
    v_accvgpr_read_b32 v47, a95
    v_pk_mul_f32 v[32:33], v[32:33], s[48:49] op_sel_hi:[1,0]
    v_pk_mul_f32 v[34:35], v[34:35], s[48:49] op_sel_hi:[1,0]
    v_pk_mul_f32 v[36:37], v[36:37], s[48:49] op_sel_hi:[1,0]
    v_pk_mul_f32 v[38:39], v[38:39], s[48:49] op_sel_hi:[1,0]
    v_pk_mul_f32 v[40:41], v[40:41], s[48:49] op_sel_hi:[1,0]
    v_pk_mul_f32 v[42:43], v[42:43], s[48:49] op_sel_hi:[1,0]
    v_pk_mul_f32 v[44:45], v[44:45], s[48:49] op_sel_hi:[1,0]
    v_pk_mul_f32 v[46:47], v[46:47], s[48:49] op_sel_hi:[1,0]
    s_waitcnt lgkmcnt(7)
    v_mfma_f32_16x16x32_bf16 v[0:3], a[192:195], v[128:131], 0
    v_cvt_pk_bf16_f32 v48, v32, v33
    v_cvt_pk_bf16_f32 v49, v34, v35
    v_cvt_pk_bf16_f32 v50, v36, v37
    v_mfma_f32_16x16x32_bf16 v[4:7], a[192:195], v[144:147], 0
    v_cvt_pk_bf16_f32 v51, v38, v39
    v_cvt_pk_bf16_f32 v52, v40, v41
    v_cvt_pk_bf16_f32 v53, v42, v43
    v_mfma_f32_16x16x32_bf16 v[8:11], a[192:195], v[160:163], 0
    v_cvt_pk_bf16_f32 v54, v44, v45
    v_cvt_pk_bf16_f32 v55, v46, v47
    v_accvgpr_write_b32 a168, v48
    v_mfma_f32_16x16x32_bf16 v[12:15], a[192:195], v[176:179], 0
    v_accvgpr_write_b32 a169, v49
    v_accvgpr_write_b32 a170, v50
    v_accvgpr_write_b32 a171, v51
    s_waitcnt lgkmcnt(6)
    v_mfma_f32_16x16x32_bf16 v[16:19], a[196:199], v[128:131], 0
    v_accvgpr_write_b32 a184, v52
    v_accvgpr_write_b32 a185, v53
    v_accvgpr_write_b32 a186, v54
    v_mfma_f32_16x16x32_bf16 v[20:23], a[196:199], v[144:147], 0
    v_accvgpr_write_b32 a187, v55
    v_accvgpr_read_b32 v32, a96
    v_accvgpr_read_b32 v33, a97
    v_mfma_f32_16x16x32_bf16 v[24:27], a[196:199], v[160:163], 0
    v_accvgpr_read_b32 v34, a98
    v_accvgpr_read_b32 v35, a99
    v_accvgpr_read_b32 v36, a112
    v_mfma_f32_16x16x32_bf16 v[28:31], a[196:199], v[176:179], 0
    v_accvgpr_read_b32 v37, a113
    v_accvgpr_read_b32 v38, a114
    v_accvgpr_read_b32 v39, a115
    s_waitcnt lgkmcnt(5)
    v_mfma_f32_16x16x32_bf16 v[0:3], a[200:203], v[132:135], v[0:3]
    v_accvgpr_read_b32 v40, a100
    v_accvgpr_read_b32 v41, a101
    v_accvgpr_read_b32 v42, a102
    v_mfma_f32_16x16x32_bf16 v[4:7], a[200:203], v[148:151], v[4:7]
    v_accvgpr_read_b32 v43, a103
    v_accvgpr_read_b32 v44, a116
    v_accvgpr_read_b32 v45, a117
    v_mfma_f32_16x16x32_bf16 v[8:11], a[200:203], v[164:167], v[8:11]
    v_accvgpr_read_b32 v46, a118
    v_accvgpr_read_b32 v47, a119
    v_pk_mul_f32 v[32:33], v[32:33], s[48:49] op_sel_hi:[1,0]
    v_mfma_f32_16x16x32_bf16 v[12:15], a[200:203], v[180:183], v[12:15]
    v_pk_mul_f32 v[34:35], v[34:35], s[48:49] op_sel_hi:[1,0]
    v_pk_mul_f32 v[36:37], v[36:37], s[48:49] op_sel_hi:[1,0]
    v_pk_mul_f32 v[38:39], v[38:39], s[48:49] op_sel_hi:[1,0]
    s_waitcnt lgkmcnt(4)
    v_mfma_f32_16x16x32_bf16 v[16:19], a[204:207], v[132:135], v[16:19]
    v_pk_mul_f32 v[40:41], v[40:41], s[48:49] op_sel_hi:[1,0]
    v_pk_mul_f32 v[42:43], v[42:43], s[48:49] op_sel_hi:[1,0]
    v_pk_mul_f32 v[44:45], v[44:45], s[48:49] op_sel_hi:[1,0]
    v_mfma_f32_16x16x32_bf16 v[20:23], a[204:207], v[148:151], v[20:23]
    v_pk_mul_f32 v[46:47], v[46:47], s[48:49] op_sel_hi:[1,0]
    v_cvt_pk_bf16_f32 v48, v32, v33
    v_cvt_pk_bf16_f32 v49, v34, v35
    v_mfma_f32_16x16x32_bf16 v[24:27], a[204:207], v[164:167], v[24:27]
    v_cvt_pk_bf16_f32 v50, v36, v37
    v_cvt_pk_bf16_f32 v51, v38, v39
    v_cvt_pk_bf16_f32 v52, v40, v41
    v_mfma_f32_16x16x32_bf16 v[28:31], a[204:207], v[180:183], v[28:31]
    v_cvt_pk_bf16_f32 v53, v42, v43
    v_cvt_pk_bf16_f32 v54, v44, v45
    v_cvt_pk_bf16_f32 v55, v46, v47
    s_waitcnt lgkmcnt(3)
    v_mfma_f32_16x16x32_bf16 v[0:3], a[208:211], v[136:139], v[0:3]
    v_accvgpr_write_b32 a140, v48
    v_accvgpr_write_b32 a141, v49
    v_accvgpr_write_b32 a142, v50
    v_mfma_f32_16x16x32_bf16 v[4:7], a[208:211], v[152:155], v[4:7]
    ds_read_b128 a[192:195], v196 offset:8448
    v_accvgpr_write_b32 a143, v51
    v_accvgpr_write_b32 a156, v52
    v_accvgpr_write_b32 a157, v53
    v_mfma_f32_16x16x32_bf16 v[8:11], a[208:211], v[168:171], v[8:11]
    v_accvgpr_write_b32 a158, v54
    v_accvgpr_write_b32 a159, v55
    v_accvgpr_read_b32 v32, a104
    v_mfma_f32_16x16x32_bf16 v[12:15], a[208:211], v[184:187], v[12:15]
    v_accvgpr_read_b32 v33, a105
    v_accvgpr_read_b32 v34, a106
    v_accvgpr_read_b32 v35, a107
    s_waitcnt lgkmcnt(3)
    v_mfma_f32_16x16x32_bf16 v[16:19], a[212:215], v[136:139], v[16:19]
    v_accvgpr_read_b32 v36, a120
    v_accvgpr_read_b32 v37, a121
    v_accvgpr_read_b32 v38, a122
    v_mfma_f32_16x16x32_bf16 v[20:23], a[212:215], v[152:155], v[20:23]
    ds_read_b128 a[196:199], v196 offset:8960
    v_accvgpr_read_b32 v39, a123
    v_accvgpr_read_b32 v40, a108
    v_accvgpr_read_b32 v41, a109
    v_mfma_f32_16x16x32_bf16 v[24:27], a[212:215], v[168:171], v[24:27]
    v_accvgpr_read_b32 v42, a110
    v_accvgpr_read_b32 v43, a111
    v_accvgpr_read_b32 v44, a124
    v_mfma_f32_16x16x32_bf16 v[28:31], a[212:215], v[184:187], v[28:31]
    v_accvgpr_read_b32 v45, a125
    v_accvgpr_read_b32 v46, a126
    v_accvgpr_read_b32 v47, a127
    s_waitcnt lgkmcnt(3)
    v_mfma_f32_16x16x32_bf16 v[0:3], a[216:219], v[140:143], v[0:3]
    v_pk_mul_f32 v[32:33], v[32:33], s[48:49] op_sel_hi:[1,0]
    v_pk_mul_f32 v[34:35], v[34:35], s[48:49] op_sel_hi:[1,0]
    v_pk_mul_f32 v[36:37], v[36:37], s[48:49] op_sel_hi:[1,0]
    v_mfma_f32_16x16x32_bf16 v[4:7], a[216:219], v[156:159], v[4:7]
    ds_read_b128 a[200:203], v196 offset:8512
    v_pk_mul_f32 v[38:39], v[38:39], s[48:49] op_sel_hi:[1,0]
    v_pk_mul_f32 v[40:41], v[40:41], s[48:49] op_sel_hi:[1,0]
    v_pk_mul_f32 v[42:43], v[42:43], s[48:49] op_sel_hi:[1,0]
    v_mfma_f32_16x16x32_bf16 v[8:11], a[216:219], v[172:175], v[8:11]
    v_pk_mul_f32 v[44:45], v[44:45], s[48:49] op_sel_hi:[1,0]
    v_pk_mul_f32 v[46:47], v[46:47], s[48:49] op_sel_hi:[1,0]
    v_cvt_pk_bf16_f32 v48, v32, v33
    v_mfma_f32_16x16x32_bf16 v[12:15], a[216:219], v[188:191], v[12:15]
    v_cvt_pk_bf16_f32 v49, v34, v35
    v_cvt_pk_bf16_f32 v50, v36, v37
    v_cvt_pk_bf16_f32 v51, v38, v39
    s_waitcnt lgkmcnt(3)
    v_mfma_f32_16x16x32_bf16 v[16:19], a[220:223], v[140:143], v[16:19]
    v_cvt_pk_bf16_f32 v52, v40, v41
    v_cvt_pk_bf16_f32 v53, v42, v43
    v_cvt_pk_bf16_f32 v54, v44, v45
    v_mfma_f32_16x16x32_bf16 v[20:23], a[220:223], v[156:159], v[20:23]
    ds_read_b128 a[204:207], v196 offset:9024
    v_cvt_pk_bf16_f32 v55, v46, v47
    v_accvgpr_write_b32 a172, v48
    v_accvgpr_write_b32 a173, v49
    v_mfma_f32_16x16x32_bf16 v[24:27], a[220:223], v[172:175], v[24:27]
    v_accvgpr_write_b32 a174, v50
    v_accvgpr_write_b32 a175, v51
    v_accvgpr_write_b32 a188, v52
    v_mfma_f32_16x16x32_bf16 v[28:31], a[220:223], v[188:191], v[28:31]
    v_accvgpr_write_b32 a189, v53
    v_accvgpr_write_b32 a190, v54
    v_accvgpr_write_b32 a191, v55
    s_nop 4
K1_HM:
    v_max3_f32 v212, v0, v1, v248
    v_max3_f32 v212, v212, v2, v3
    v_max3_f32 v212, v212, v16, v17
    v_max3_f32 v212, v212, v18, v19
    v_max3_f32 v213, v4, v5, v249
    v_max3_f32 v213, v213, v6, v7
    v_max3_f32 v213, v213, v20, v21
    v_max3_f32 v213, v213, v22, v23
    v_max3_f32 v214, v8, v9, v250
    v_max3_f32 v214, v214, v10, v11
    v_max3_f32 v214, v214, v24, v25
    v_max3_f32 v214, v214, v26, v27
    v_max3_f32 v215, v12, v13, v251
    v_max3_f32 v215, v215, v14, v15
    v_max3_f32 v215, v215, v28, v29
    v_max3_f32 v215, v215, v30, v31
    v_mov_b32 v216, v212
    v_mov_b32 v217, v213
    v_mov_b32 v218, v214
    v_mov_b32 v219, v215
    v_permlane16_swap_b32 v212, v216
    v_permlane16_swap_b32 v213, v217
    v_permlane16_swap_b32 v214, v218
    v_permlane16_swap_b32 v215, v219
    v_max_f32 v212, v212, v216
    v_max_f32 v213, v213, v217
    v_max_f32 v214, v214, v218
    v_max_f32 v215, v215, v219
    v_mov_b32 v216, v212
    v_mov_b32 v217, v213
    v_mov_b32 v218, v214
    v_mov_b32 v219, v215
    v_permlane32_swap_b32 v212, v216
    v_permlane32_swap_b32 v213, v217
    v_permlane32_swap_b32 v214, v218
    v_permlane32_swap_b32 v215, v219
    v_max_f32 v212, v212, v216
    v_max_f32 v213, v213, v217
    v_max_f32 v214, v214, v218
    v_max_f32 v215, v215, v219
    v_sub_f32 v212, 0, v212
    v_sub_f32 v213, 0, v213
    v_sub_f32 v214, 0, v214
    v_sub_f32 v215, 0, v215
    v_mov_b32 v96, v212
    v_mov_b32 v97, v212
    v_mov_b32 v98, v212
    v_mov_b32 v99, v212
    v_mov_b32 v100, v213
    v_mov_b32 v101, v213
    v_mov_b32 v102, v213
    v_mov_b32 v103, v213
    v_mov_b32 v104, v214
    v_mov_b32 v105, v214
    v_mov_b32 v106, v214
    v_mov_b32 v107, v214
    v_mov_b32 v108, v215
    v_mov_b32 v109, v215
    v_mov_b32 v110, v215
    v_mov_b32 v111, v215
    v_add_f32 v0, v0, v212
    v_add_f32 v1, v1, v212
    v_add_f32 v2, v2, v212
    v_add_f32 v3, v3, v212
    v_add_f32 v16, v16, v212
    v_add_f32 v17, v17, v212
    v_add_f32 v18, v18, v212
    v_add_f32 v19, v19, v212
    v_add_f32 v4, v4, v213
    v_add_f32 v5, v5, v213
    v_add_f32 v6, v6, v213
    v_add_f32 v7, v7, v213
    v_add_f32 v20, v20, v213
    v_add_f32 v21, v21, v213
    v_add_f32 v22, v22, v213
    v_add_f32 v23, v23, v213
    v_add_f32 v8, v8, v214
    v_add_f32 v9, v9, v214
    v_add_f32 v10, v10, v214
    v_add_f32 v11, v11, v214
    v_add_f32 v24, v24, v214
    v_add_f32 v25, v25, v214
    v_add_f32 v26, v26, v214
    v_add_f32 v27, v27, v214
    v_add_f32 v12, v12, v215
    v_add_f32 v13, v13, v215
    v_add_f32 v14, v14, v215
    v_add_f32 v15, v15, v215
    v_add_f32 v28, v28, v215
    v_add_f32 v29, v29, v215
    v_add_f32 v30, v30, v215
    v_add_f32 v31, v31, v215
    s_waitcnt lgkmcnt(2)
    v_mfma_f32_16x16x32_bf16 v[32:35], a[192:195], v[128:131], v[96:99]
    v_exp_f32 v0, v0
    ds_read_b128 a[208:211], v196 offset:8576
    v_mfma_f32_16x16x32_bf16 v[36:39], a[192:195], v[144:147], v[100:103]
    v_exp_f32 v1, v1
    v_mfma_f32_16x16x32_bf16 v[40:43], a[192:195], v[160:163], v[104:107]
    v_exp_f32 v2, v2
    v_cvt_pk_bf16_f32 v64, v0, v1
    v_mfma_f32_16x16x32_bf16 v[44:47], a[192:195], v[176:179], v[108:111]
    v_exp_f32 v3, v3
    v_mfma_f32_16x16x32_bf16 v[48:51], a[196:199], v[128:131], v[96:99]
    v_exp_f32 v16, v16
    ds_read_b128 a[212:215], v196 offset:9088
    v_cvt_pk_bf16_f32 v65, v2, v3
    v_mfma_f32_16x16x32_bf16 v[52:55], a[196:199], v[144:147], v[100:103]
    v_exp_f32 v17, v17
    v_mfma_f32_16x16x32_bf16 v[56:59], a[196:199], v[160:163], v[104:107]
    v_exp_f32 v18, v18
    v_cvt_pk_bf16_f32 v66, v16, v17
    v_mfma_f32_16x16x32_bf16 v[60:63], a[196:199], v[176:179], v[108:111]
    v_exp_f32 v19, v19
    s_waitcnt lgkmcnt(2)
    v_mfma_f32_16x16x32_bf16 v[32:35], a[200:203], v[132:135], v[32:35]
    v_exp_f32 v4, v4
    ds_read_b128 a[216:219], v196 offset:8640
    v_cvt_pk_bf16_f32 v67, v18, v19
    v_mfma_f32_16x16x32_bf16 v[36:39], a[200:203], v[148:151], v[36:39]
    v_exp_f32 v5, v5
    v_mfma_f32_16x16x32_bf16 v[40:43], a[200:203], v[164:167], v[40:43]
    v_exp_f32 v6, v6
    v_cvt_pk_bf16_f32 v68, v4, v5
    v_mfma_f32_16x16x32_bf16 v[44:47], a[200:203], v[180:183], v[44:47]
    v_exp_f32 v7, v7
    v_mfma_f32_16x16x32_bf16 v[48:51], a[204:207], v[132:135], v[48:51]
    v_exp_f32 v20, v20
    ds_read_b128 a[220:223], v196 offset:9152
    v_cvt_pk_bf16_f32 v69, v6, v7
    v_mfma_f32_16x16x32_bf16 v[52:55], a[204:207], v[148:151], v[52:55]
    v_exp_f32 v21, v21
    v_mfma_f32_16x16x32_bf16 v[56:59], a[204:207], v[164:167], v[56:59]
    v_exp_f32 v22, v22
    v_cvt_pk_bf16_f32 v70, v20, v21
    v_mfma_f32_16x16x32_bf16 v[60:63], a[204:207], v[180:183], v[60:63]
    v_exp_f32 v23, v23
    s_waitcnt vmcnt(3) lgkmcnt(2)
    s_barrier
    v_mfma_f32_16x16x32_bf16 v[32:35], a[208:211], v[136:139], v[32:35]
    v_exp_f32 v8, v8
    ds_read_b128 a[192:195], v196 offset:16896
    v_cvt_pk_bf16_f32 v71, v22, v23
    v_mfma_f32_16x16x32_bf16 v[36:39], a[208:211], v[152:155], v[36:39]
    v_exp_f32 v9, v9
    ds_read_b64_tr_b16 a[224:225], v197 offset:0
    v_mfma_f32_16x16x32_bf16 v[40:43], a[208:211], v[168:171], v[40:43]
    v_exp_f32 v10, v10
    v_cvt_pk_bf16_f32 v72, v8, v9
    ds_read_b64_tr_b16 a[226:227], v197 offset:512
    v_mfma_f32_16x16x32_bf16 v[44:47], a[208:211], v[184:187], v[44:47]
    v_exp_f32 v11, v11
    v_mfma_f32_16x16x32_bf16 v[48:51], a[212:215], v[136:139], v[48:51]
    v_exp_f32 v24, v24
    ds_read_b128 a[196:199], v196 offset:17408
    v_cvt_pk_bf16_f32 v73, v10, v11
    s_add_u32 m0, s37, 33792
    v_mfma_f32_16x16x32_bf16 v[52:55], a[212:215], v[152:155], v[52:55]
    v_exp_f32 v25, v25
    ds_read_b64_tr_b16 a[228:229], v197 offset:32
    buffer_load_dwordx4 v200, s[12:15], s46 offen nt lds
    v_mfma_f32_16x16x32_bf16 v[56:59], a[212:215], v[168:171], v[56:59]
    v_exp_f32 v26, v26
    v_cvt_pk_bf16_f32 v74, v24, v25
    ds_read_b64_tr_b16 a[230:231], v197 offset:544
    v_mfma_f32_16x16x32_bf16 v[60:63], a[212:215], v[184:187], v[60:63]
    v_exp_f32 v27, v27
    s_waitcnt lgkmcnt(6)
    v_mfma_f32_16x16x32_bf16 v[32:35], a[216:219], v[140:143], v[32:35]
    v_exp_f32 v12, v12
    ds_read_b128 a[200:203], v196 offset:16960
    v_cvt_pk_bf16_f32 v75, v26, v27
    v_mfma_f32_16x16x32_bf16 v[36:39], a[216:219], v[156:159], v[36:39]
    v_exp_f32 v13, v13
    ds_read_b64_tr_b16 a[232:233], v197 offset:64
    v_mfma_f32_16x16x32_bf16 v[40:43], a[216:219], v[172:175], v[40:43]
    v_exp_f32 v14, v14
    v_cvt_pk_bf16_f32 v76, v12, v13
    ds_read_b64_tr_b16 a[234:235], v197 offset:576
    v_mfma_f32_16x16x32_bf16 v[44:47], a[216:219], v[188:191], v[44:47]
    v_exp_f32 v15, v15
    buffer_load_dwordx4 v201, s[12:15], s46 offen offset:1056 nt lds
    v_mfma_f32_16x16x32_bf16 v[48:51], a[220:223], v[140:143], v[48:51]
    v_exp_f32 v28, v28
    ds_read_b128 a[204:207], v196 offset:17472
    v_cvt_pk_bf16_f32 v77, v14, v15
    v_mfma_f32_16x16x32_bf16 v[52:55], a[220:223], v[156:159], v[52:55]
    v_exp_f32 v29, v29
    ds_read_b64_tr_b16 a[236:237], v197 offset:96
    v_mfma_f32_16x16x32_bf16 v[56:59], a[220:223], v[172:175], v[56:59]
    v_exp_f32 v30, v30
    v_cvt_pk_bf16_f32 v78, v28, v29
    ds_read_b64_tr_b16 a[238:239], v197 offset:608
    v_mfma_f32_16x16x32_bf16 v[60:63], a[220:223], v[188:191], v[60:63]
    v_exp_f32 v31, v31
    s_waitcnt vmcnt(3)
    s_waitcnt lgkmcnt(6)
    v_mfma_f32_16x16x32_bf16 v[0:3], a[192:195], v[128:131], v[96:99]
    v_exp_f32 v32, v32
    v_mfma_f32_16x16x32_bf16 v[4:7], a[192:195], v[144:147], v[100:103]
    ds_read_b128 a[208:211], v196 offset:17024
    v_cvt_pk_bf16_f32 v79, v30, v31
    v_mfma_f32_16x16x32_bf16 v[8:11], a[192:195], v[160:163], v[104:107]
    v_exp_f32 v33, v33
    v_mfma_f32_16x16x32_bf16 v[12:15], a[192:195], v[176:179], v[108:111]
    ds_read_b64_tr_b16 a[240:241], v197 offset:128
    v_cvt_pk_bf16_f32 v80, v32, v33
    v_mfma_f32_16x16x32_bf16 a[0:3], a[224:227], v[64:67], 0
    v_exp_f32 v34, v34
    v_mfma_f32_16x16x32_bf16 a[4:7], a[224:227], v[68:71], 0
    ds_read_b64_tr_b16 a[242:243], v197 offset:640
    v_mfma_f32_16x16x32_bf16 a[8:11], a[224:227], v[72:75], 0
    v_exp_f32 v35, v35
    v_mfma_f32_16x16x32_bf16 a[12:15], a[224:227], v[76:79], 0
    s_add_u32 m0, s38, 16896
    v_mfma_f32_16x16x32_bf16 v[16:19], a[196:199], v[128:131], v[96:99]
    v_exp_f32 v48, v48
    v_mfma_f32_16x16x32_bf16 v[20:23], a[196:199], v[144:147], v[100:103]
    ds_read_b128 a[212:215], v196 offset:17536
    v_cvt_pk_bf16_f32 v81, v34, v35
    buffer_load_dwordx4 v202, s[16:19], s46 offen nt lds
    v_mfma_f32_16x16x32_bf16 v[24:27], a[196:199], v[160:163], v[104:107]
    v_exp_f32 v49, v49
    v_mfma_f32_16x16x32_bf16 v[28:31], a[196:199], v[176:179], v[108:111]
    ds_read_b64_tr_b16 a[244:245], v197 offset:160
    v_cvt_pk_bf16_f32 v82, v48, v49
    v_mfma_f32_16x16x32_bf16 a[16:19], a[228:231], v[64:67], 0
    v_exp_f32 v50, v50
    v_mfma_f32_16x16x32_bf16 a[20:23], a[228:231], v[68:71], 0
    ds_read_b64_tr_b16 a[246:247], v197 offset:672
    v_mfma_f32_16x16x32_bf16 a[24:27], a[228:231], v[72:75], 0
    v_exp_f32 v51, v51
    v_mfma_f32_16x16x32_bf16 a[28:31], a[228:231], v[76:79], 0
    v_mfma_f32_16x16x32_bf16 v[112:115], v[192:195], v[64:67], 0
    s_waitcnt lgkmcnt(6)
    v_mfma_f32_16x16x32_bf16 v[0:3], a[200:203], v[132:135], v[0:3]
    v_exp_f32 v36, v36
    v_mfma_f32_16x16x32_bf16 v[4:7], a[200:203], v[148:151], v[4:7]
    ds_read_b128 a[216:219], v196 offset:17088
    v_cvt_pk_bf16_f32 v83, v50, v51
    v_mfma_f32_16x16x32_bf16 v[8:11], a[200:203], v[164:167], v[8:11]
    v_exp_f32 v37, v37
    v_mfma_f32_16x16x32_bf16 v[12:15], a[200:203], v[180:183], v[12:15]
    ds_read_b64_tr_b16 a[248:249], v197 offset:192
    v_cvt_pk_bf16_f32 v84, v36, v37
    v_mfma_f32_16x16x32_bf16 a[32:35], a[232:235], v[64:67], 0
    v_exp_f32 v38, v38
    v_mfma_f32_16x16x32_bf16 a[36:39], a[232:235], v[68:71], 0
    ds_read_b64_tr_b16 a[250:251], v197 offset:704
    v_mfma_f32_16x16x32_bf16 a[40:43], a[232:235], v[72:75], 0
    v_exp_f32 v39, v39
    v_mfma_f32_16x16x32_bf16 a[44:47], a[232:235], v[76:79], 0
    buffer_load_dwordx4 v203, s[16:19], s46 offen offset:1056 nt lds
    v_mfma_f32_16x16x32_bf16 v[16:19], a[204:207], v[132:135], v[16:19]
    v_exp_f32 v52, v52
    v_mfma_f32_16x16x32_bf16 v[20:23], a[204:207], v[148:151], v[20:23]
    ds_read_b128 a[220:223], v196 offset:17600
    v_cvt_pk_bf16_f32 v85, v38, v39
    v_mfma_f32_16x16x32_bf16 v[24:27], a[204:207], v[164:167], v[24:27]
    v_exp_f32 v53, v53
    v_mfma_f32_16x16x32_bf16 v[28:31], a[204:207], v[180:183], v[28:31]
    ds_read_b64_tr_b16 a[252:253], v197 offset:224
    v_cvt_pk_bf16_f32 v86, v52, v53
    v_mfma_f32_16x16x32_bf16 a[48:51], a[236:239], v[64:67], 0
    v_exp_f32 v54, v54
    v_mfma_f32_16x16x32_bf16 a[52:55], a[236:239], v[68:71], 0
    ds_read_b64_tr_b16 a[254:255], v197 offset:736
    s_add_u32 s46, s46, 8192
    v_mfma_f32_16x16x32_bf16 a[56:59], a[236:239], v[72:75], 0
    v_exp_f32 v55, v55
    v_mfma_f32_16x16x32_bf16 a[60:63], a[236:239], v[76:79], 0
    v_mfma_f32_16x16x32_bf16 v[116:119], v[192:195], v[68:71], 0
    s_waitcnt vmcnt(3) lgkmcnt(6)
    s_barrier
    v_mfma_f32_16x16x32_bf16 v[0:3], a[208:211], v[136:139], v[0:3]
    v_exp_f32 v40, v40
    v_mfma_f32_16x16x32_bf16 v[4:7], a[208:211], v[152:155], v[4:7]
    ds_read_b128 a[192:195], v196 offset:25344
    v_cvt_pk_bf16_f32 v87, v54, v55
    v_mfma_f32_16x16x32_bf16 v[8:11], a[208:211], v[168:171], v[8:11]
    v_exp_f32 v41, v41
    v_mfma_f32_16x16x32_bf16 v[12:15], a[208:211], v[184:187], v[12:15]
    ds_read_b64_tr_b16 a[224:225], v197 offset:8448
    v_cvt_pk_bf16_f32 v88, v40, v41
    v_mfma_f32_16x16x32_bf16 a[64:67], a[240:243], v[64:67], 0
    v_exp_f32 v42, v42
    v_mfma_f32_16x16x32_bf16 a[68:71], a[240:243], v[68:71], 0
    ds_read_b64_tr_b16 a[226:227], v197 offset:8960
    v_mfma_f32_16x16x32_bf16 a[72:75], a[240:243], v[72:75], 0
    v_exp_f32 v43, v43
    v_mfma_f32_16x16x32_bf16 a[76:79], a[240:243], v[76:79], 0
    v_mfma_f32_16x16x32_bf16 v[16:19], a[212:215], v[136:139], v[16:19]
    v_exp_f32 v56, v56
    v_mfma_f32_16x16x32_bf16 v[20:23], a[212:215], v[152:155], v[20:23]
    ds_read_b128 a[196:199], v196 offset:25856
    v_cvt_pk_bf16_f32 v89, v42, v43
    s_add_u32 m0, s37, 42240
    v_mfma_f32_16x16x32_bf16 v[24:27], a[212:215], v[168:171], v[24:27]
    v_exp_f32 v57, v57
    v_mfma_f32_16x16x32_bf16 v[28:31], a[212:215], v[184:187], v[28:31]
    ds_read_b64_tr_b16 a[228:229], v197 offset:8480
    v_cvt_pk_bf16_f32 v90, v56, v57
    buffer_load_dwordx4 v200, s[12:15], s46 offen nt lds
    v_mfma_f32_16x16x32_bf16 a[80:83], a[244:247], v[64:67], 0
    v_exp_f32 v58, v58
    v_mfma_f32_16x16x32_bf16 a[84:87], a[244:247], v[68:71], 0
    ds_read_b64_tr_b16 a[230:231], v197 offset:8992
    v_mfma_f32_16x16x32_bf16 a[88:91], a[244:247], v[72:75], 0
    v_exp_f32 v59, v59
    v_mfma_f32_16x16x32_bf16 a[92:95], a[244:247], v[76:79], 0
    v_mfma_f32_16x16x32_bf16 v[120:123], v[192:195], v[72:75], 0
    s_waitcnt lgkmcnt(6)
    v_mfma_f32_16x16x32_bf16 v[0:3], a[216:219], v[140:143], v[0:3]
    v_exp_f32 v44, v44
    v_mfma_f32_16x16x32_bf16 v[4:7], a[216:219], v[156:159], v[4:7]
    ds_read_b128 a[200:203], v196 offset:25408
    v_cvt_pk_bf16_f32 v91, v58, v59
    v_mfma_f32_16x16x32_bf16 v[8:11], a[216:219], v[172:175], v[8:11]
    v_exp_f32 v45, v45
    v_mfma_f32_16x16x32_bf16 v[12:15], a[216:219], v[188:191], v[12:15]
    ds_read_b64_tr_b16 a[232:233], v197 offset:8512
    v_cvt_pk_bf16_f32 v92, v44, v45
    v_mfma_f32_16x16x32_bf16 a[96:99], a[248:251], v[64:67], 0
    v_exp_f32 v46, v46
    v_mfma_f32_16x16x32_bf16 a[100:103], a[248:251], v[68:71], 0
    ds_read_b64_tr_b16 a[234:235], v197 offset:9024
    v_mfma_f32_16x16x32_bf16 a[104:107], a[248:251], v[72:75], 0
    v_exp_f32 v47, v47
    v_mfma_f32_16x16x32_bf16 a[108:111], a[248:251], v[76:79], 0
    buffer_load_dwordx4 v201, s[12:15], s46 offen offset:1056 nt lds
    v_mfma_f32_16x16x32_bf16 v[16:19], a[220:223], v[140:143], v[16:19]
    v_exp_f32 v60, v60
    v_mfma_f32_16x16x32_bf16 v[20:23], a[220:223], v[156:159], v[20:23]
    ds_read_b128 a[204:207], v196 offset:25920
    v_cvt_pk_bf16_f32 v93, v46, v47
    v_mfma_f32_16x16x32_bf16 v[24:27], a[220:223], v[172:175], v[24:27]
    v_exp_f32 v61, v61
    v_mfma_f32_16x16x32_bf16 v[28:31], a[220:223], v[188:191], v[28:31]
    ds_read_b64_tr_b16 a[236:237], v197 offset:8544
    v_cvt_pk_bf16_f32 v94, v60, v61
    v_mfma_f32_16x16x32_bf16 a[112:115], a[252:255], v[64:67], 0
    v_exp_f32 v62, v62
    v_mfma_f32_16x16x32_bf16 a[116:119], a[252:255], v[68:71], 0
    ds_read_b64_tr_b16 a[238:239], v197 offset:9056
    v_mfma_f32_16x16x32_bf16 a[120:123], a[252:255], v[72:75], 0
    v_exp_f32 v63, v63
    v_mfma_f32_16x16x32_bf16 a[124:127], a[252:255], v[76:79], 0
    v_mfma_f32_16x16x32_bf16 v[124:127], v[192:195], v[76:79], 0
    s_waitcnt vmcnt(3)
    s_mov_b32 s45, 4
    s_waitcnt lgkmcnt(6)
K1_ALOOP:
    v_mfma_f32_16x16x32_bf16 v[32:35], a[192:195], v[128:131], v[96:99]
    v_exp_f32 v0, v0
    v_mfma_f32_16x16x32_bf16 v[36:39], a[192:195], v[144:147], v[100:103]
    ds_read_b128 a[208:211], v196 offset:25472
    v_cvt_pk_bf16_f32 v95, v62, v63
    v_mfma_f32_16x16x32_bf16 v[40:43], a[192:195], v[160:163], v[104:107]
    v_exp_f32 v1, v1
    v_mfma_f32_16x16x32_bf16 v[44:47], a[192:195], v[176:179], v[108:111]
    ds_read_b64_tr_b16 a[240:241], v197 offset:8576
    v_cvt_pk_bf16_f32 v64, v0, v1
    v_mfma_f32_16x16x32_bf16 a[0:3], a[224:227], v[80:83], a[0:3]
    v_exp_f32 v2, v2
    v_mfma_f32_16x16x32_bf16 a[4:7], a[224:227], v[84:87], a[4:7]
    ds_read_b64_tr_b16 a[242:243], v197 offset:9088
    v_mfma_f32_16x16x32_bf16 a[8:11], a[224:227], v[88:91], a[8:11]
    v_exp_f32 v3, v3
    v_mfma_f32_16x16x32_bf16 a[12:15], a[224:227], v[92:95], a[12:15]
    s_add_u32 m0, s38, 25344
    v_mfma_f32_16x16x32_bf16 v[48:51], a[196:199], v[128:131], v[96:99]
    v_exp_f32 v16, v16
    v_mfma_f32_16x16x32_bf16 v[52:55], a[196:199], v[144:147], v[100:103]
    ds_read_b128 a[212:215], v196 offset:25984
    v_cvt_pk_bf16_f32 v65, v2, v3
    buffer_load_dwordx4 v202, s[16:19], s46 offen nt lds
    v_mfma_f32_16x16x32_bf16 v[56:59], a[196:199], v[160:163], v[104:107]
    v_exp_f32 v17, v17
    v_mfma_f32_16x16x32_bf16 v[60:63], a[196:199], v[176:179], v[108:111]
    ds_read_b64_tr_b16 a[244:245], v197 offset:8608
    v_cvt_pk_bf16_f32 v66, v16, v17
    v_mfma_f32_16x16x32_bf16 a[16:19], a[228:231], v[80:83], a[16:19]
    v_exp_f32 v18, v18
    v_mfma_f32_16x16x32_bf16 a[20:23], a[228:231], v[84:87], a[20:23]
    ds_read_b64_tr_b16 a[246:247], v197 offset:9120
    v_mfma_f32_16x16x32_bf16 a[24:27], a[228:231], v[88:91], a[24:27]
    v_exp_f32 v19, v19
    v_mfma_f32_16x16x32_bf16 a[28:31], a[228:231], v[92:95], a[28:31]
    v_mfma_f32_16x16x32_bf16 v[112:115], v[192:195], v[80:83], v[112:115]
    s_waitcnt lgkmcnt(6)
    v_mfma_f32_16x16x32_bf16 v[32:35], a[200:203], v[132:135], v[32:35]
    v_exp_f32 v4, v4
    v_mfma_f32_16x16x32_bf16 v[36:39], a[200:203], v[148:151], v[36:39]
    ds_read_b128 a[216:219], v196 offset:25536
    v_cvt_pk_bf16_f32 v67, v18, v19
    v_mfma_f32_16x16x32_bf16 v[40:43], a[200:203], v[164:167], v[40:43]
    v_exp_f32 v5, v5
    v_mfma_f32_16x16x32_bf16 v[44:47], a[200:203], v[180:183], v[44:47]
    ds_read_b64_tr_b16 a[248:249], v197 offset:8640
    v_cvt_pk_bf16_f32 v68, v4, v5
    v_mfma_f32_16x16x32_bf16 a[32:35], a[232:235], v[80:83], a[32:35]
    v_exp_f32 v6, v6
    v_mfma_f32_16x16x32_bf16 a[36:39], a[232:235], v[84:87], a[36:39]
    ds_read_b64_tr_b16 a[250:251], v197 offset:9152
    v_mfma_f32_16x16x32_bf16 a[40:43], a[232:235], v[88:91], a[40:43]
    v_exp_f32 v7, v7
    v_mfma_f32_16x16x32_bf16 a[44:47], a[232:235], v[92:95], a[44:47]
    buffer_load_dwordx4 v203, s[16:19], s46 offen offset:1056 nt lds
    v_mfma_f32_16x16x32_bf16 v[48:51], a[204:207], v[132:135], v[48:51]
    v_exp_f32 v20, v20
    v_mfma_f32_16x16x32_bf16 v[52:55], a[204:207], v[148:151], v[52:55]
    ds_read_b128 a[220:223], v196 offset:26048
    v_cvt_pk_bf16_f32 v69, v6, v7
    v_mfma_f32_16x16x32_bf16 v[56:59], a[204:207], v[164:167], v[56:59]
    v_exp_f32 v21, v21
    v_mfma_f32_16x16x32_bf16 v[60:63], a[204:207], v[180:183], v[60:63]
    ds_read_b64_tr_b16 a[252:253], v197 offset:8672
    v_cvt_pk_bf16_f32 v70, v20, v21
    v_mfma_f32_16x16x32_bf16 a[48:51], a[236:239], v[80:83], a[48:51]
    v_exp_f32 v22, v22
    v_mfma_f32_16x16x32_bf16 a[52:55], a[236:239], v[84:87], a[52:55]
    ds_read_b64_tr_b16 a[254:255], v197 offset:9184
    s_add_u32 s46, s46, 8192
    v_mfma_f32_16x16x32_bf16 a[56:59], a[236:239], v[88:91], a[56:59]
    v_exp_f32 v23, v23
    v_mfma_f32_16x16x32_bf16 a[60:63], a[236:239], v[92:95], a[60:63]
    v_mfma_f32_16x16x32_bf16 v[116:119], v[192:195], v[84:87], v[116:119]
    s_waitcnt vmcnt(3) lgkmcnt(6)
    s_barrier
    v_mfma_f32_16x16x32_bf16 v[32:35], a[208:211], v[136:139], v[32:35]
    v_exp_f32 v8, v8
    v_mfma_f32_16x16x32_bf16 v[36:39], a[208:211], v[152:155], v[36:39]
    ds_read_b128 a[192:195], v196 offset:33792
    v_cvt_pk_bf16_f32 v71, v22, v23
    v_mfma_f32_16x16x32_bf16 v[40:43], a[208:211], v[168:171], v[40:43]
    v_exp_f32 v9, v9
    v_mfma_f32_16x16x32_bf16 v[44:47], a[208:211], v[184:187], v[44:47]
    ds_read_b64_tr_b16 a[224:225], v197 offset:16896
    v_cvt_pk_bf16_f32 v72, v8, v9
    v_mfma_f32_16x16x32_bf16 a[64:67], a[240:243], v[80:83], a[64:67]
    v_exp_f32 v10, v10
    v_mfma_f32_16x16x32_bf16 a[68:71], a[240:243], v[84:87], a[68:71]
    ds_read_b64_tr_b16 a[226:227], v197 offset:17408
    v_mfma_f32_16x16x32_bf16 a[72:75], a[240:243], v[88:91], a[72:75]
    v_exp_f32 v11, v11
    v_mfma_f32_16x16x32_bf16 a[76:79], a[240:243], v[92:95], a[76:79]
    v_mfma_f32_16x16x32_bf16 v[48:51], a[212:215], v[136:139], v[48:51]
    v_exp_f32 v24, v24
    v_mfma_f32_16x16x32_bf16 v[52:55], a[212:215], v[152:155], v[52:55]
    ds_read_b128 a[196:199], v196 offset:34304
    v_cvt_pk_bf16_f32 v73, v10, v11
    s_add_u32 m0, s37, 50688
    v_mfma_f32_16x16x32_bf16 v[56:59], a[212:215], v[168:171], v[56:59]
    v_exp_f32 v25, v25
    v_mfma_f32_16x16x32_bf16 v[60:63], a[212:215], v[184:187], v[60:63]
    ds_read_b64_tr_b16 a[228:229], v197 offset:16928
    v_cvt_pk_bf16_f32 v74, v24, v25
    buffer_load_dwordx4 v200, s[12:15], s46 offen nt lds
    v_mfma_f32_16x16x32_bf16 a[80:83], a[244:247], v[80:83], a[80:83]
    v_exp_f32 v26, v26
    v_mfma_f32_16x16x32_bf16 a[84:87], a[244:247], v[84:87], a[84:87]
    ds_read_b64_tr_b16 a[230:231], v197 offset:17440
    v_mfma_f32_16x16x32_bf16 a[88:91], a[244:247], v[88:91], a[88:91]
    v_exp_f32 v27, v27
    v_mfma_f32_16x16x32_bf16 a[92:95], a[244:247], v[92:95], a[92:95]
    v_mfma_f32_16x16x32_bf16 v[120:123], v[192:195], v[88:91], v[120:123]
    s_waitcnt lgkmcnt(6)
    v_mfma_f32_16x16x32_bf16 v[32:35], a[216:219], v[140:143], v[32:35]
    v_exp_f32 v12, v12
    v_mfma_f32_16x16x32_bf16 v[36:39], a[216:219], v[156:159], v[36:39]
    ds_read_b128 a[200:203], v196 offset:33856
    v_cvt_pk_bf16_f32 v75, v26, v27
    v_mfma_f32_16x16x32_bf16 v[40:43], a[216:219], v[172:175], v[40:43]
    v_exp_f32 v13, v13
    v_mfma_f32_16x16x32_bf16 v[44:47], a[216:219], v[188:191], v[44:47]
    ds_read_b64_tr_b16 a[232:233], v197 offset:16960
    v_cvt_pk_bf16_f32 v76, v12, v13
    v_mfma_f32_16x16x32_bf16 a[96:99], a[248:251], v[80:83], a[96:99]
    v_exp_f32 v14, v14
    v_mfma_f32_16x16x32_bf16 a[100:103], a[248:251], v[84:87], a[100:103]
    ds_read_b64_tr_b16 a[234:235], v197 offset:17472
    v_mfma_f32_16x16x32_bf16 a[104:107], a[248:251], v[88:91], a[104:107]
    v_exp_f32 v15, v15
    v_mfma_f32_16x16x32_bf16 a[108:111], a[248:251], v[92:95], a[108:111]
    buffer_load_dwordx4 v201, s[12:15], s46 offen offset:1056 nt lds
    v_mfma_f32_16x16x32_bf16 v[48:51], a[220:223], v[140:143], v[48:51]
    v_exp_f32 v28, v28
    v_mfma_f32_16x16x32_bf16 v[52:55], a[220:223], v[156:159], v[52:55]
    ds_read_b128 a[204:207], v196 offset:34368
    v_cvt_pk_bf16_f32 v77, v14, v15
    v_mfma_f32_16x16x32_bf16 v[56:59], a[220:223], v[172:175], v[56:59]
    v_exp_f32 v29, v29
    v_mfma_f32_16x16x32_bf16 v[60:63], a[220:223], v[188:191], v[60:63]
    ds_read_b64_tr_b16 a[236:237], v197 offset:16992
    v_cvt_pk_bf16_f32 v78, v28, v29
    v_mfma_f32_16x16x32_bf16 a[112:115], a[252:255], v[80:83], a[112:115]
    v_exp_f32 v30, v30
    v_mfma_f32_16x16x32_bf16 a[116:119], a[252:255], v[84:87], a[116:119]
    ds_read_b64_tr_b16 a[238:239], v197 offset:17504
    v_mfma_f32_16x16x32_bf16 a[120:123], a[252:255], v[88:91], a[120:123]
    v_exp_f32 v31, v31
    v_mfma_f32_16x16x32_bf16 a[124:127], a[252:255], v[92:95], a[124:127]
    v_mfma_f32_16x16x32_bf16 v[124:127], v[192:195], v[92:95], v[124:127]
    s_waitcnt vmcnt(3)
    s_waitcnt lgkmcnt(6)
    v_mfma_f32_16x16x32_bf16 v[0:3], a[192:195], v[128:131], v[96:99]
    v_exp_f32 v32, v32
    v_mfma_f32_16x16x32_bf16 v[4:7], a[192:195], v[144:147], v[100:103]
    ds_read_b128 a[208:211], v196 offset:33920
    v_cvt_pk_bf16_f32 v79, v30, v31
    v_mfma_f32_16x16x32_bf16 v[8:11], a[192:195], v[160:163], v[104:107]
    v_exp_f32 v33, v33
    v_mfma_f32_16x16x32_bf16 v[12:15], a[192:195], v[176:179], v[108:111]
    ds_read_b64_tr_b16 a[240:241], v197 offset:17024
    v_cvt_pk_bf16_f32 v80, v32, v33
    v_mfma_f32_16x16x32_bf16 a[0:3], a[224:227], v[64:67], a[0:3]
    v_exp_f32 v34, v34
    v_mfma_f32_16x16x32_bf16 a[4:7], a[224:227], v[68:71], a[4:7]
    ds_read_b64_tr_b16 a[242:243], v197 offset:17536
    v_mfma_f32_16x16x32_bf16 a[8:11], a[224:227], v[72:75], a[8:11]
    v_exp_f32 v35, v35
    v_mfma_f32_16x16x32_bf16 a[12:15], a[224:227], v[76:79], a[12:15]
    s_add_u32 m0, s39, 33792
    v_mfma_f32_16x16x32_bf16 v[16:19], a[196:199], v[128:131], v[96:99]
    v_exp_f32 v48, v48
    v_mfma_f32_16x16x32_bf16 v[20:23], a[196:199], v[144:147], v[100:103]
    ds_read_b128 a[212:215], v196 offset:34432
    v_cvt_pk_bf16_f32 v81, v34, v35
    buffer_load_dwordx4 v202, s[16:19], s46 offen nt lds
    v_mfma_f32_16x16x32_bf16 v[24:27], a[196:199], v[160:163], v[104:107]
    v_exp_f32 v49, v49
    v_mfma_f32_16x16x32_bf16 v[28:31], a[196:199], v[176:179], v[108:111]
    ds_read_b64_tr_b16 a[244:245], v197 offset:17056
    v_cvt_pk_bf16_f32 v82, v48, v49
    v_mfma_f32_16x16x32_bf16 a[16:19], a[228:231], v[64:67], a[16:19]
    v_exp_f32 v50, v50
    v_mfma_f32_16x16x32_bf16 a[20:23], a[228:231], v[68:71], a[20:23]
    ds_read_b64_tr_b16 a[246:247], v197 offset:17568
    v_mfma_f32_16x16x32_bf16 a[24:27], a[228:231], v[72:75], a[24:27]
    v_exp_f32 v51, v51
    v_mfma_f32_16x16x32_bf16 a[28:31], a[228:231], v[76:79], a[28:31]
    v_mfma_f32_16x16x32_bf16 v[112:115], v[192:195], v[64:67], v[112:115]
    s_waitcnt lgkmcnt(6)
    v_mfma_f32_16x16x32_bf16 v[0:3], a[200:203], v[132:135], v[0:3]
    v_exp_f32 v36, v36
    v_mfma_f32_16x16x32_bf16 v[4:7], a[200:203], v[148:151], v[4:7]
    ds_read_b128 a[216:219], v196 offset:33984
    v_cvt_pk_bf16_f32 v83, v50, v51
    v_mfma_f32_16x16x32_bf16 v[8:11], a[200:203], v[164:167], v[8:11]
    v_exp_f32 v37, v37
    v_mfma_f32_16x16x32_bf16 v[12:15], a[200:203], v[180:183], v[12:15]
    ds_read_b64_tr_b16 a[248:249], v197 offset:17088
    v_cvt_pk_bf16_f32 v84, v36, v37
    v_mfma_f32_16x16x32_bf16 a[32:35], a[232:235], v[64:67], a[32:35]
    v_exp_f32 v38, v38
    v_mfma_f32_16x16x32_bf16 a[36:39], a[232:235], v[68:71], a[36:39]
    ds_read_b64_tr_b16 a[250:251], v197 offset:17600
    v_mfma_f32_16x16x32_bf16 a[40:43], a[232:235], v[72:75], a[40:43]
    v_exp_f32 v39, v39
    v_mfma_f32_16x16x32_bf16 a[44:47], a[232:235], v[76:79], a[44:47]
    buffer_load_dwordx4 v203, s[16:19], s46 offen offset:1056 nt lds
    v_mfma_f32_16x16x32_bf16 v[16:19], a[204:207], v[132:135], v[16:19]
    v_exp_f32 v52, v52
    v_mfma_f32_16x16x32_bf16 v[20:23], a[204:207], v[148:151], v[20:23]
    ds_read_b128 a[220:223], v196 offset:34496
    v_cvt_pk_bf16_f32 v85, v38, v39
    v_mfma_f32_16x16x32_bf16 v[24:27], a[204:207], v[164:167], v[24:27]
    v_exp_f32 v53, v53
    v_mfma_f32_16x16x32_bf16 v[28:31], a[204:207], v[180:183], v[28:31]
    ds_read_b64_tr_b16 a[252:253], v197 offset:17120
    v_cvt_pk_bf16_f32 v86, v52, v53
    v_mfma_f32_16x16x32_bf16 a[48:51], a[236:239], v[64:67], a[48:51]
    v_exp_f32 v54, v54
    v_mfma_f32_16x16x32_bf16 a[52:55], a[236:239], v[68:71], a[52:55]
    ds_read_b64_tr_b16 a[254:255], v197 offset:17632
    s_add_u32 s46, s46, 8192
    v_mfma_f32_16x16x32_bf16 a[56:59], a[236:239], v[72:75], a[56:59]
    v_exp_f32 v55, v55
    v_mfma_f32_16x16x32_bf16 a[60:63], a[236:239], v[76:79], a[60:63]
    v_mfma_f32_16x16x32_bf16 v[116:119], v[192:195], v[68:71], v[116:119]
    s_waitcnt vmcnt(3) lgkmcnt(6)
    s_barrier
    v_mfma_f32_16x16x32_bf16 v[0:3], a[208:211], v[136:139], v[0:3]
    v_exp_f32 v40, v40
    v_mfma_f32_16x16x32_bf16 v[4:7], a[208:211], v[152:155], v[4:7]
    ds_read_b128 a[192:195], v196 offset:42240
    v_cvt_pk_bf16_f32 v87, v54, v55
    v_mfma_f32_16x16x32_bf16 v[8:11], a[208:211], v[168:171], v[8:11]
    v_exp_f32 v41, v41
    v_mfma_f32_16x16x32_bf16 v[12:15], a[208:211], v[184:187], v[12:15]
    ds_read_b64_tr_b16 a[224:225], v197 offset:25344
    v_cvt_pk_bf16_f32 v88, v40, v41
    v_mfma_f32_16x16x32_bf16 a[64:67], a[240:243], v[64:67], a[64:67]
    v_exp_f32 v42, v42
    v_mfma_f32_16x16x32_bf16 a[68:71], a[240:243], v[68:71], a[68:71]
    ds_read_b64_tr_b16 a[226:227], v197 offset:25856
    v_mfma_f32_16x16x32_bf16 a[72:75], a[240:243], v[72:75], a[72:75]
    v_exp_f32 v43, v43
    v_mfma_f32_16x16x32_bf16 a[76:79], a[240:243], v[76:79], a[76:79]
    v_mfma_f32_16x16x32_bf16 v[16:19], a[212:215], v[136:139], v[16:19]
    v_exp_f32 v56, v56
    v_mfma_f32_16x16x32_bf16 v[20:23], a[212:215], v[152:155], v[20:23]
    ds_read_b128 a[196:199], v196 offset:42752
    v_cvt_pk_bf16_f32 v89, v42, v43
    s_add_u32 m0, s37, 59136
    v_mfma_f32_16x16x32_bf16 v[24:27], a[212:215], v[168:171], v[24:27]
    v_exp_f32 v57, v57
    v_mfma_f32_16x16x32_bf16 v[28:31], a[212:215], v[184:187], v[28:31]
    ds_read_b64_tr_b16 a[228:229], v197 offset:25376
    v_cvt_pk_bf16_f32 v90, v56, v57
    buffer_load_dwordx4 v200, s[12:15], s46 offen nt lds
    v_mfma_f32_16x16x32_bf16 a[80:83], a[244:247], v[64:67], a[80:83]
    v_exp_f32 v58, v58
    v_mfma_f32_16x16x32_bf16 a[84:87], a[244:247], v[68:71], a[84:87]
    ds_read_b64_tr_b16 a[230:231], v197 offset:25888
    v_mfma_f32_16x16x32_bf16 a[88:91], a[244:247], v[72:75], a[88:91]
    v_exp_f32 v59, v59
    v_mfma_f32_16x16x32_bf16 a[92:95], a[244:247], v[76:79], a[92:95]
    v_mfma_f32_16x16x32_bf16 v[120:123], v[192:195], v[72:75], v[120:123]
    s_waitcnt lgkmcnt(6)
    v_mfma_f32_16x16x32_bf16 v[0:3], a[216:219], v[140:143], v[0:3]
    v_exp_f32 v44, v44
    v_mfma_f32_16x16x32_bf16 v[4:7], a[216:219], v[156:159], v[4:7]
    ds_read_b128 a[200:203], v196 offset:42304
    v_cvt_pk_bf16_f32 v91, v58, v59
    v_mfma_f32_16x16x32_bf16 v[8:11], a[216:219], v[172:175], v[8:11]
    v_exp_f32 v45, v45
    v_mfma_f32_16x16x32_bf16 v[12:15], a[216:219], v[188:191], v[12:15]
    ds_read_b64_tr_b16 a[232:233], v197 offset:25408
    v_cvt_pk_bf16_f32 v92, v44, v45
    v_mfma_f32_16x16x32_bf16 a[96:99], a[248:251], v[64:67], a[96:99]
    v_exp_f32 v46, v46
    v_mfma_f32_16x16x32_bf16 a[100:103], a[248:251], v[68:71], a[100:103]
    ds_read_b64_tr_b16 a[234:235], v197 offset:25920
    v_mfma_f32_16x16x32_bf16 a[104:107], a[248:251], v[72:75], a[104:107]
    v_exp_f32 v47, v47
    v_mfma_f32_16x16x32_bf16 a[108:111], a[248:251], v[76:79], a[108:111]
    buffer_load_dwordx4 v201, s[12:15], s46 offen offset:1056 nt lds
    v_mfma_f32_16x16x32_bf16 v[16:19], a[220:223], v[140:143], v[16:19]
    v_exp_f32 v60, v60
    v_mfma_f32_16x16x32_bf16 v[20:23], a[220:223], v[156:159], v[20:23]
    ds_read_b128 a[204:207], v196 offset:42816
    v_cvt_pk_bf16_f32 v93, v46, v47
    v_mfma_f32_16x16x32_bf16 v[24:27], a[220:223], v[172:175], v[24:27]
    v_exp_f32 v61, v61
    v_mfma_f32_16x16x32_bf16 v[28:31], a[220:223], v[188:191], v[28:31]
    ds_read_b64_tr_b16 a[236:237], v197 offset:25440
    v_cvt_pk_bf16_f32 v94, v60, v61
    v_mfma_f32_16x16x32_bf16 a[112:115], a[252:255], v[64:67], a[112:115]
    v_exp_f32 v62, v62
    v_mfma_f32_16x16x32_bf16 a[116:119], a[252:255], v[68:71], a[116:119]
    ds_read_b64_tr_b16 a[238:239], v197 offset:25952
    v_mfma_f32_16x16x32_bf16 a[120:123], a[252:255], v[72:75], a[120:123]
    v_exp_f32 v63, v63
    v_mfma_f32_16x16x32_bf16 a[124:127], a[252:255], v[76:79], a[124:127]
    v_mfma_f32_16x16x32_bf16 v[124:127], v[192:195], v[76:79], v[124:127]
    s_waitcnt vmcnt(3)
    s_waitcnt lgkmcnt(6)
    v_mfma_f32_16x16x32_bf16 v[32:35], a[192:195], v[128:131], v[96:99]
    v_exp_f32 v0, v0
    v_mfma_f32_16x16x32_bf16 v[36:39], a[192:195], v[144:147], v[100:103]
    ds_read_b128 a[208:211], v196 offset:42368
    v_cvt_pk_bf16_f32 v95, v62, v63
    v_mfma_f32_16x16x32_bf16 v[40:43], a[192:195], v[160:163], v[104:107]
    v_exp_f32 v1, v1
    v_mfma_f32_16x16x32_bf16 v[44:47], a[192:195], v[176:179], v[108:111]
    ds_read_b64_tr_b16 a[240:241], v197 offset:25472
    v_cvt_pk_bf16_f32 v64, v0, v1
    v_mfma_f32_16x16x32_bf16 a[0:3], a[224:227], v[80:83], a[0:3]
    v_exp_f32 v2, v2
    v_mfma_f32_16x16x32_bf16 a[4:7], a[224:227], v[84:87], a[4:7]
    ds_read_b64_tr_b16 a[242:243], v197 offset:25984
    v_mfma_f32_16x16x32_bf16 a[8:11], a[224:227], v[88:91], a[8:11]
    v_exp_f32 v3, v3
    v_mfma_f32_16x16x32_bf16 a[12:15], a[224:227], v[92:95], a[12:15]
    s_add_u32 m0, s39, 42240
    v_mfma_f32_16x16x32_bf16 v[48:51], a[196:199], v[128:131], v[96:99]
    v_exp_f32 v16, v16
    v_mfma_f32_16x16x32_bf16 v[52:55], a[196:199], v[144:147], v[100:103]
    ds_read_b128 a[212:215], v196 offset:42880
    v_cvt_pk_bf16_f32 v65, v2, v3
    buffer_load_dwordx4 v202, s[16:19], s46 offen nt lds
    v_mfma_f32_16x16x32_bf16 v[56:59], a[196:199], v[160:163], v[104:107]
    v_exp_f32 v17, v17
    v_mfma_f32_16x16x32_bf16 v[60:63], a[196:199], v[176:179], v[108:111]
    ds_read_b64_tr_b16 a[244:245], v197 offset:25504
    v_cvt_pk_bf16_f32 v66, v16, v17
    v_mfma_f32_16x16x32_bf16 a[16:19], a[228:231], v[80:83], a[16:19]
    v_exp_f32 v18, v18
    v_mfma_f32_16x16x32_bf16 a[20:23], a[228:231], v[84:87], a[20:23]
    ds_read_b64_tr_b16 a[246:247], v197 offset:26016
    v_mfma_f32_16x16x32_bf16 a[24:27], a[228:231], v[88:91], a[24:27]
    v_exp_f32 v19, v19
    v_mfma_f32_16x16x32_bf16 a[28:31], a[228:231], v[92:95], a[28:31]
    v_mfma_f32_16x16x32_bf16 v[112:115], v[192:195], v[80:83], v[112:115]
    s_waitcnt lgkmcnt(6)
    v_mfma_f32_16x16x32_bf16 v[32:35], a[200:203], v[132:135], v[32:35]
    v_exp_f32 v4, v4
    v_mfma_f32_16x16x32_bf16 v[36:39], a[200:203], v[148:151], v[36:39]
    ds_read_b128 a[216:219], v196 offset:42432
    v_cvt_pk_bf16_f32 v67, v18, v19
    v_mfma_f32_16x16x32_bf16 v[40:43], a[200:203], v[164:167], v[40:43]
    v_exp_f32 v5, v5
    v_mfma_f32_16x16x32_bf16 v[44:47], a[200:203], v[180:183], v[44:47]
    ds_read_b64_tr_b16 a[248:249], v197 offset:25536
    v_cvt_pk_bf16_f32 v68, v4, v5
    v_mfma_f32_16x16x32_bf16 a[32:35], a[232:235], v[80:83], a[32:35]
    v_exp_f32 v6, v6
    v_mfma_f32_16x16x32_bf16 a[36:39], a[232:235], v[84:87], a[36:39]
    ds_read_b64_tr_b16 a[250:251], v197 offset:26048
    v_mfma_f32_16x16x32_bf16 a[40:43], a[232:235], v[88:91], a[40:43]
    v_exp_f32 v7, v7
    v_mfma_f32_16x16x32_bf16 a[44:47], a[232:235], v[92:95], a[44:47]
    buffer_load_dwordx4 v203, s[16:19], s46 offen offset:1056 nt lds
    v_mfma_f32_16x16x32_bf16 v[48:51], a[204:207], v[132:135], v[48:51]
    v_exp_f32 v20, v20
    v_mfma_f32_16x16x32_bf16 v[52:55], a[204:207], v[148:151], v[52:55]
    ds_read_b128 a[220:223], v196 offset:42944
    v_cvt_pk_bf16_f32 v69, v6, v7
    v_mfma_f32_16x16x32_bf16 v[56:59], a[204:207], v[164:167], v[56:59]
    v_exp_f32 v21, v21
    v_mfma_f32_16x16x32_bf16 v[60:63], a[204:207], v[180:183], v[60:63]
    ds_read_b64_tr_b16 a[252:253], v197 offset:25568
    v_cvt_pk_bf16_f32 v70, v20, v21
    v_mfma_f32_16x16x32_bf16 a[48:51], a[236:239], v[80:83], a[48:51]
    v_exp_f32 v22, v22
    v_mfma_f32_16x16x32_bf16 a[52:55], a[236:239], v[84:87], a[52:55]
    ds_read_b64_tr_b16 a[254:255], v197 offset:26080
    s_add_u32 s46, s46, 8192
    v_mfma_f32_16x16x32_bf16 a[56:59], a[236:239], v[88:91], a[56:59]
    v_exp_f32 v23, v23
    v_mfma_f32_16x16x32_bf16 a[60:63], a[236:239], v[92:95], a[60:63]
    v_mfma_f32_16x16x32_bf16 v[116:119], v[192:195], v[84:87], v[116:119]
    s_waitcnt vmcnt(3) lgkmcnt(6)
    s_barrier
    v_mfma_f32_16x16x32_bf16 v[32:35], a[208:211], v[136:139], v[32:35]
    v_exp_f32 v8, v8
    v_mfma_f32_16x16x32_bf16 v[36:39], a[208:211], v[152:155], v[36:39]
    ds_read_b128 a[192:195], v196 offset:50688
    v_cvt_pk_bf16_f32 v71, v22, v23
    v_mfma_f32_16x16x32_bf16 v[40:43], a[208:211], v[168:171], v[40:43]
    v_exp_f32 v9, v9
    v_mfma_f32_16x16x32_bf16 v[44:47], a[208:211], v[184:187], v[44:47]
    ds_read_b64_tr_b16 a[224:225], v197 offset:33792
    v_cvt_pk_bf16_f32 v72, v8, v9
    v_mfma_f32_16x16x32_bf16 a[64:67], a[240:243], v[80:83], a[64:67]
    v_exp_f32 v10, v10
    v_mfma_f32_16x16x32_bf16 a[68:71], a[240:243], v[84:87], a[68:71]
    ds_read_b64_tr_b16 a[226:227], v197 offset:34304
    v_mfma_f32_16x16x32_bf16 a[72:75], a[240:243], v[88:91], a[72:75]
    v_exp_f32 v11, v11
    v_mfma_f32_16x16x32_bf16 a[76:79], a[240:243], v[92:95], a[76:79]
    v_mfma_f32_16x16x32_bf16 v[48:51], a[212:215], v[136:139], v[48:51]
    v_exp_f32 v24, v24
    v_mfma_f32_16x16x32_bf16 v[52:55], a[212:215], v[152:155], v[52:55]
    ds_read_b128 a[196:199], v196 offset:51200
    v_cvt_pk_bf16_f32 v73, v10, v11
    s_add_u32 m0, s36, 0
    v_mfma_f32_16x16x32_bf16 v[56:59], a[212:215], v[168:171], v[56:59]
    v_exp_f32 v25, v25
    v_mfma_f32_16x16x32_bf16 v[60:63], a[212:215], v[184:187], v[60:63]
    ds_read_b64_tr_b16 a[228:229], v197 offset:33824
    v_cvt_pk_bf16_f32 v74, v24, v25
    buffer_load_dwordx4 v200, s[12:15], s46 offen nt lds
    v_mfma_f32_16x16x32_bf16 a[80:83], a[244:247], v[80:83], a[80:83]
    v_exp_f32 v26, v26
    v_mfma_f32_16x16x32_bf16 a[84:87], a[244:247], v[84:87], a[84:87]
    ds_read_b64_tr_b16 a[230:231], v197 offset:34336
    v_mfma_f32_16x16x32_bf16 a[88:91], a[244:247], v[88:91], a[88:91]
    v_exp_f32 v27, v27
    v_mfma_f32_16x16x32_bf16 a[92:95], a[244:247], v[92:95], a[92:95]
    v_mfma_f32_16x16x32_bf16 v[120:123], v[192:195], v[88:91], v[120:123]
    s_waitcnt lgkmcnt(6)
    v_mfma_f32_16x16x32_bf16 v[32:35], a[216:219], v[140:143], v[32:35]
    v_exp_f32 v12, v12
    v_mfma_f32_16x16x32_bf16 v[36:39], a[216:219], v[156:159], v[36:39]
    ds_read_b128 a[200:203], v196 offset:50752
    v_cvt_pk_bf16_f32 v75, v26, v27
    v_mfma_f32_16x16x32_bf16 v[40:43], a[216:219], v[172:175], v[40:43]
    v_exp_f32 v13, v13
    v_mfma_f32_16x16x32_bf16 v[44:47], a[216:219], v[188:191], v[44:47]
    ds_read_b64_tr_b16 a[232:233], v197 offset:33856
    v_cvt_pk_bf16_f32 v76, v12, v13
    v_mfma_f32_16x16x32_bf16 a[96:99], a[248:251], v[80:83], a[96:99]
    v_exp_f32 v14, v14
    v_mfma_f32_16x16x32_bf16 a[100:103], a[248:251], v[84:87], a[100:103]
    ds_read_b64_tr_b16 a[234:235], v197 offset:34368
    v_mfma_f32_16x16x32_bf16 a[104:107], a[248:251], v[88:91], a[104:107]
    v_exp_f32 v15, v15
    v_mfma_f32_16x16x32_bf16 a[108:111], a[248:251], v[92:95], a[108:111]
    buffer_load_dwordx4 v201, s[12:15], s46 offen offset:1056 nt lds
    v_mfma_f32_16x16x32_bf16 v[48:51], a[220:223], v[140:143], v[48:51]
    v_exp_f32 v28, v28
    v_mfma_f32_16x16x32_bf16 v[52:55], a[220:223], v[156:159], v[52:55]
    ds_read_b128 a[204:207], v196 offset:51264
    v_cvt_pk_bf16_f32 v77, v14, v15
    v_mfma_f32_16x16x32_bf16 v[56:59], a[220:223], v[172:175], v[56:59]
    v_exp_f32 v29, v29
    v_mfma_f32_16x16x32_bf16 v[60:63], a[220:223], v[188:191], v[60:63]
    ds_read_b64_tr_b16 a[236:237], v197 offset:33888
    v_cvt_pk_bf16_f32 v78, v28, v29
    v_mfma_f32_16x16x32_bf16 a[112:115], a[252:255], v[80:83], a[112:115]
    v_exp_f32 v30, v30
    v_mfma_f32_16x16x32_bf16 a[116:119], a[252:255], v[84:87], a[116:119]
    ds_read_b64_tr_b16 a[238:239], v197 offset:34400
    v_mfma_f32_16x16x32_bf16 a[120:123], a[252:255], v[88:91], a[120:123]
    v_exp_f32 v31, v31
    v_mfma_f32_16x16x32_bf16 a[124:127], a[252:255], v[92:95], a[124:127]
    v_mfma_f32_16x16x32_bf16 v[124:127], v[192:195], v[92:95], v[124:127]
    s_waitcnt vmcnt(3)
    s_waitcnt lgkmcnt(6)
    v_mfma_f32_16x16x32_bf16 v[0:3], a[192:195], v[128:131], v[96:99]
    v_exp_f32 v32, v32
    v_mfma_f32_16x16x32_bf16 v[4:7], a[192:195], v[144:147], v[100:103]
    ds_read_b128 a[208:211], v196 offset:50816
    v_cvt_pk_bf16_f32 v79, v30, v31
    v_mfma_f32_16x16x32_bf16 v[8:11], a[192:195], v[160:163], v[104:107]
    v_exp_f32 v33, v33
    v_mfma_f32_16x16x32_bf16 v[12:15], a[192:195], v[176:179], v[108:111]
    ds_read_b64_tr_b16 a[240:241], v197 offset:33920
    v_cvt_pk_bf16_f32 v80, v32, v33
    v_mfma_f32_16x16x32_bf16 a[0:3], a[224:227], v[64:67], a[0:3]
    v_exp_f32 v34, v34
    v_mfma_f32_16x16x32_bf16 a[4:7], a[224:227], v[68:71], a[4:7]
    ds_read_b64_tr_b16 a[242:243], v197 offset:34432
    v_mfma_f32_16x16x32_bf16 a[8:11], a[224:227], v[72:75], a[8:11]
    v_exp_f32 v35, v35
    v_mfma_f32_16x16x32_bf16 a[12:15], a[224:227], v[76:79], a[12:15]
    s_add_u32 m0, s39, 50688
    v_mfma_f32_16x16x32_bf16 v[16:19], a[196:199], v[128:131], v[96:99]
    v_exp_f32 v48, v48
    v_mfma_f32_16x16x32_bf16 v[20:23], a[196:199], v[144:147], v[100:103]
    ds_read_b128 a[212:215], v196 offset:51328
    v_cvt_pk_bf16_f32 v81, v34, v35
    buffer_load_dwordx4 v202, s[16:19], s46 offen nt lds
    v_mfma_f32_16x16x32_bf16 v[24:27], a[196:199], v[160:163], v[104:107]
    v_exp_f32 v49, v49
    v_mfma_f32_16x16x32_bf16 v[28:31], a[196:199], v[176:179], v[108:111]
    ds_read_b64_tr_b16 a[244:245], v197 offset:33952
    v_cvt_pk_bf16_f32 v82, v48, v49
    v_mfma_f32_16x16x32_bf16 a[16:19], a[228:231], v[64:67], a[16:19]
    v_exp_f32 v50, v50
    v_mfma_f32_16x16x32_bf16 a[20:23], a[228:231], v[68:71], a[20:23]
    ds_read_b64_tr_b16 a[246:247], v197 offset:34464
    v_mfma_f32_16x16x32_bf16 a[24:27], a[228:231], v[72:75], a[24:27]
    v_exp_f32 v51, v51
    v_mfma_f32_16x16x32_bf16 a[28:31], a[228:231], v[76:79], a[28:31]
    v_mfma_f32_16x16x32_bf16 v[112:115], v[192:195], v[64:67], v[112:115]
    s_waitcnt lgkmcnt(6)
    v_mfma_f32_16x16x32_bf16 v[0:3], a[200:203], v[132:135], v[0:3]
    v_exp_f32 v36, v36
    v_mfma_f32_16x16x32_bf16 v[4:7], a[200:203], v[148:151], v[4:7]
    ds_read_b128 a[216:219], v196 offset:50880
    v_cvt_pk_bf16_f32 v83, v50, v51
    v_mfma_f32_16x16x32_bf16 v[8:11], a[200:203], v[164:167], v[8:11]
    v_exp_f32 v37, v37
    v_mfma_f32_16x16x32_bf16 v[12:15], a[200:203], v[180:183], v[12:15]
    ds_read_b64_tr_b16 a[248:249], v197 offset:33984
    v_cvt_pk_bf16_f32 v84, v36, v37
    v_mfma_f32_16x16x32_bf16 a[32:35], a[232:235], v[64:67], a[32:35]
    v_exp_f32 v38, v38
    v_mfma_f32_16x16x32_bf16 a[36:39], a[232:235], v[68:71], a[36:39]
    ds_read_b64_tr_b16 a[250:251], v197 offset:34496
    v_mfma_f32_16x16x32_bf16 a[40:43], a[232:235], v[72:75], a[40:43]
    v_exp_f32 v39, v39
    v_mfma_f32_16x16x32_bf16 a[44:47], a[232:235], v[76:79], a[44:47]
    buffer_load_dwordx4 v203, s[16:19], s46 offen offset:1056 nt lds
    v_mfma_f32_16x16x32_bf16 v[16:19], a[204:207], v[132:135], v[16:19]
    v_exp_f32 v52, v52
    v_mfma_f32_16x16x32_bf16 v[20:23], a[204:207], v[148:151], v[20:23]
    ds_read_b128 a[220:223], v196 offset:51392
    v_cvt_pk_bf16_f32 v85, v38, v39
    v_mfma_f32_16x16x32_bf16 v[24:27], a[204:207], v[164:167], v[24:27]
    v_exp_f32 v53, v53
    v_mfma_f32_16x16x32_bf16 v[28:31], a[204:207], v[180:183], v[28:31]
    ds_read_b64_tr_b16 a[252:253], v197 offset:34016
    v_cvt_pk_bf16_f32 v86, v52, v53
    v_mfma_f32_16x16x32_bf16 a[48:51], a[236:239], v[64:67], a[48:51]
    v_exp_f32 v54, v54
    v_mfma_f32_16x16x32_bf16 a[52:55], a[236:239], v[68:71], a[52:55]
    ds_read_b64_tr_b16 a[254:255], v197 offset:34528
    s_add_u32 s46, s46, 8192
    v_mfma_f32_16x16x32_bf16 a[56:59], a[236:239], v[72:75], a[56:59]
    v_exp_f32 v55, v55
    v_mfma_f32_16x16x32_bf16 a[60:63], a[236:239], v[76:79], a[60:63]
    v_mfma_f32_16x16x32_bf16 v[116:119], v[192:195], v[68:71], v[116:119]
    s_waitcnt vmcnt(3) lgkmcnt(6)
    s_barrier
    v_mfma_f32_16x16x32_bf16 v[0:3], a[208:211], v[136:139], v[0:3]
    v_exp_f32 v40, v40
    v_mfma_f32_16x16x32_bf16 v[4:7], a[208:211], v[152:155], v[4:7]
    ds_read_b128 a[192:195], v196 offset:59136
    v_cvt_pk_bf16_f32 v87, v54, v55
    v_mfma_f32_16x16x32_bf16 v[8:11], a[208:211], v[168:171], v[8:11]
    v_exp_f32 v41, v41
    v_mfma_f32_16x16x32_bf16 v[12:15], a[208:211], v[184:187], v[12:15]
    ds_read_b64_tr_b16 a[224:225], v197 offset:42240
    v_cvt_pk_bf16_f32 v88, v40, v41
    v_mfma_f32_16x16x32_bf16 a[64:67], a[240:243], v[64:67], a[64:67]
    v_exp_f32 v42, v42
    v_mfma_f32_16x16x32_bf16 a[68:71], a[240:243], v[68:71], a[68:71]
    ds_read_b64_tr_b16 a[226:227], v197 offset:42752
    v_mfma_f32_16x16x32_bf16 a[72:75], a[240:243], v[72:75], a[72:75]
    v_exp_f32 v43, v43
    v_mfma_f32_16x16x32_bf16 a[76:79], a[240:243], v[76:79], a[76:79]
    v_mfma_f32_16x16x32_bf16 v[16:19], a[212:215], v[136:139], v[16:19]
    v_exp_f32 v56, v56
    v_mfma_f32_16x16x32_bf16 v[20:23], a[212:215], v[152:155], v[20:23]
    ds_read_b128 a[196:199], v196 offset:59648
    v_cvt_pk_bf16_f32 v89, v42, v43
    s_add_u32 m0, s36, 8448
    v_mfma_f32_16x16x32_bf16 v[24:27], a[212:215], v[168:171], v[24:27]
    v_exp_f32 v57, v57
    v_mfma_f32_16x16x32_bf16 v[28:31], a[212:215], v[184:187], v[28:31]
    ds_read_b64_tr_b16 a[228:229], v197 offset:42272
    v_cvt_pk_bf16_f32 v90, v56, v57
    buffer_load_dwordx4 v200, s[12:15], s46 offen nt lds
    v_mfma_f32_16x16x32_bf16 a[80:83], a[244:247], v[64:67], a[80:83]
    v_exp_f32 v58, v58
    v_mfma_f32_16x16x32_bf16 a[84:87], a[244:247], v[68:71], a[84:87]
    ds_read_b64_tr_b16 a[230:231], v197 offset:42784
    v_mfma_f32_16x16x32_bf16 a[88:91], a[244:247], v[72:75], a[88:91]
    v_exp_f32 v59, v59
    v_mfma_f32_16x16x32_bf16 a[92:95], a[244:247], v[76:79], a[92:95]
    v_mfma_f32_16x16x32_bf16 v[120:123], v[192:195], v[72:75], v[120:123]
    s_waitcnt lgkmcnt(6)
    v_mfma_f32_16x16x32_bf16 v[0:3], a[216:219], v[140:143], v[0:3]
    v_exp_f32 v44, v44
    v_mfma_f32_16x16x32_bf16 v[4:7], a[216:219], v[156:159], v[4:7]
    ds_read_b128 a[200:203], v196 offset:59200
    v_cvt_pk_bf16_f32 v91, v58, v59
    v_mfma_f32_16x16x32_bf16 v[8:11], a[216:219], v[172:175], v[8:11]
    v_exp_f32 v45, v45
    v_mfma_f32_16x16x32_bf16 v[12:15], a[216:219], v[188:191], v[12:15]
    ds_read_b64_tr_b16 a[232:233], v197 offset:42304
    v_cvt_pk_bf16_f32 v92, v44, v45
    v_mfma_f32_16x16x32_bf16 a[96:99], a[248:251], v[64:67], a[96:99]
    v_exp_f32 v46, v46
    v_mfma_f32_16x16x32_bf16 a[100:103], a[248:251], v[68:71], a[100:103]
    ds_read_b64_tr_b16 a[234:235], v197 offset:42816
    v_mfma_f32_16x16x32_bf16 a[104:107], a[248:251], v[72:75], a[104:107]
    v_exp_f32 v47, v47
    v_mfma_f32_16x16x32_bf16 a[108:111], a[248:251], v[76:79], a[108:111]
    buffer_load_dwordx4 v201, s[12:15], s46 offen offset:1056 nt lds
    v_mfma_f32_16x16x32_bf16 v[16:19], a[220:223], v[140:143], v[16:19]
    v_exp_f32 v60, v60
    v_mfma_f32_16x16x32_bf16 v[20:23], a[220:223], v[156:159], v[20:23]
    ds_read_b128 a[204:207], v196 offset:59712
    v_cvt_pk_bf16_f32 v93, v46, v47
    v_mfma_f32_16x16x32_bf16 v[24:27], a[220:223], v[172:175], v[24:27]
    v_exp_f32 v61, v61
    v_mfma_f32_16x16x32_bf16 v[28:31], a[220:223], v[188:191], v[28:31]
    ds_read_b64_tr_b16 a[236:237], v197 offset:42336
    v_cvt_pk_bf16_f32 v94, v60, v61
    v_mfma_f32_16x16x32_bf16 a[112:115], a[252:255], v[64:67], a[112:115]
    v_exp_f32 v62, v62
    v_mfma_f32_16x16x32_bf16 a[116:119], a[252:255], v[68:71], a[116:119]
    ds_read_b64_tr_b16 a[238:239], v197 offset:42848
    v_mfma_f32_16x16x32_bf16 a[120:123], a[252:255], v[72:75], a[120:123]
    v_exp_f32 v63, v63
    v_mfma_f32_16x16x32_bf16 a[124:127], a[252:255], v[76:79], a[124:127]
    v_mfma_f32_16x16x32_bf16 v[124:127], v[192:195], v[76:79], v[124:127]
    s_waitcnt vmcnt(3)
    s_sub_u32 s45, s45, 1
    s_waitcnt lgkmcnt(6)
    v_mfma_f32_16x16x32_bf16 v[32:35], a[192:195], v[128:131], v[96:99]
    v_exp_f32 v0, v0
    v_mfma_f32_16x16x32_bf16 v[36:39], a[192:195], v[144:147], v[100:103]
    ds_read_b128 a[208:211], v196 offset:59264
    v_cvt_pk_bf16_f32 v95, v62, v63
    v_mfma_f32_16x16x32_bf16 v[40:43], a[192:195], v[160:163], v[104:107]
    v_exp_f32 v1, v1
    v_mfma_f32_16x16x32_bf16 v[44:47], a[192:195], v[176:179], v[108:111]
    ds_read_b64_tr_b16 a[240:241], v197 offset:42368
    v_cvt_pk_bf16_f32 v64, v0, v1
    v_mfma_f32_16x16x32_bf16 a[0:3], a[224:227], v[80:83], a[0:3]
    v_exp_f32 v2, v2
    v_mfma_f32_16x16x32_bf16 a[4:7], a[224:227], v[84:87], a[4:7]
    ds_read_b64_tr_b16 a[242:243], v197 offset:42880
    v_mfma_f32_16x16x32_bf16 a[8:11], a[224:227], v[88:91], a[8:11]
    v_exp_f32 v3, v3
    v_mfma_f32_16x16x32_bf16 a[12:15], a[224:227], v[92:95], a[12:15]
    s_add_u32 m0, s39, 59136
    v_mfma_f32_16x16x32_bf16 v[48:51], a[196:199], v[128:131], v[96:99]
    v_exp_f32 v16, v16
    v_mfma_f32_16x16x32_bf16 v[52:55], a[196:199], v[144:147], v[100:103]
    ds_read_b128 a[212:215], v196 offset:59776
    v_cvt_pk_bf16_f32 v65, v2, v3
    buffer_load_dwordx4 v202, s[16:19], s46 offen nt lds
    v_mfma_f32_16x16x32_bf16 v[56:59], a[196:199], v[160:163], v[104:107]
    v_exp_f32 v17, v17
    v_mfma_f32_16x16x32_bf16 v[60:63], a[196:199], v[176:179], v[108:111]
    ds_read_b64_tr_b16 a[244:245], v197 offset:42400
    v_cvt_pk_bf16_f32 v66, v16, v17
    v_mfma_f32_16x16x32_bf16 a[16:19], a[228:231], v[80:83], a[16:19]
    v_exp_f32 v18, v18
    v_mfma_f32_16x16x32_bf16 a[20:23], a[228:231], v[84:87], a[20:23]
    ds_read_b64_tr_b16 a[246:247], v197 offset:42912
    v_mfma_f32_16x16x32_bf16 a[24:27], a[228:231], v[88:91], a[24:27]
    v_exp_f32 v19, v19
    v_mfma_f32_16x16x32_bf16 a[28:31], a[228:231], v[92:95], a[28:31]
    v_mfma_f32_16x16x32_bf16 v[112:115], v[192:195], v[80:83], v[112:115]
    s_waitcnt lgkmcnt(6)
    v_mfma_f32_16x16x32_bf16 v[32:35], a[200:203], v[132:135], v[32:35]
    v_exp_f32 v4, v4
    v_mfma_f32_16x16x32_bf16 v[36:39], a[200:203], v[148:151], v[36:39]
    ds_read_b128 a[216:219], v196 offset:59328
    v_cvt_pk_bf16_f32 v67, v18, v19
    v_mfma_f32_16x16x32_bf16 v[40:43], a[200:203], v[164:167], v[40:43]
    v_exp_f32 v5, v5
    v_mfma_f32_16x16x32_bf16 v[44:47], a[200:203], v[180:183], v[44:47]
    ds_read_b64_tr_b16 a[248:249], v197 offset:42432
    v_cvt_pk_bf16_f32 v68, v4, v5
    v_mfma_f32_16x16x32_bf16 a[32:35], a[232:235], v[80:83], a[32:35]
    v_exp_f32 v6, v6
    v_mfma_f32_16x16x32_bf16 a[36:39], a[232:235], v[84:87], a[36:39]
    ds_read_b64_tr_b16 a[250:251], v197 offset:42944
    v_mfma_f32_16x16x32_bf16 a[40:43], a[232:235], v[88:91], a[40:43]
    v_exp_f32 v7, v7
    v_mfma_f32_16x16x32_bf16 a[44:47], a[232:235], v[92:95], a[44:47]
    buffer_load_dwordx4 v203, s[16:19], s46 offen offset:1056 nt lds
    v_mfma_f32_16x16x32_bf16 v[48:51], a[204:207], v[132:135], v[48:51]
    v_exp_f32 v20, v20
    v_mfma_f32_16x16x32_bf16 v[52:55], a[204:207], v[148:151], v[52:55]
    ds_read_b128 a[220:223], v196 offset:59840
    v_cvt_pk_bf16_f32 v69, v6, v7
    v_mfma_f32_16x16x32_bf16 v[56:59], a[204:207], v[164:167], v[56:59]
    v_exp_f32 v21, v21
    v_mfma_f32_16x16x32_bf16 v[60:63], a[204:207], v[180:183], v[60:63]
    ds_read_b64_tr_b16 a[252:253], v197 offset:42464
    v_cvt_pk_bf16_f32 v70, v20, v21
    v_mfma_f32_16x16x32_bf16 a[48:51], a[236:239], v[80:83], a[48:51]
    v_exp_f32 v22, v22
    v_mfma_f32_16x16x32_bf16 a[52:55], a[236:239], v[84:87], a[52:55]
    ds_read_b64_tr_b16 a[254:255], v197 offset:42976
    s_add_u32 s46, s46, 8192
    v_mfma_f32_16x16x32_bf16 a[56:59], a[236:239], v[88:91], a[56:59]
    v_exp_f32 v23, v23
    v_mfma_f32_16x16x32_bf16 a[60:63], a[236:239], v[92:95], a[60:63]
    v_mfma_f32_16x16x32_bf16 v[116:119], v[192:195], v[84:87], v[116:119]
    s_waitcnt vmcnt(3) lgkmcnt(6)
    s_barrier
    v_mfma_f32_16x16x32_bf16 v[32:35], a[208:211], v[136:139], v[32:35]
    v_exp_f32 v8, v8
    v_mfma_f32_16x16x32_bf16 v[36:39], a[208:211], v[152:155], v[36:39]
    ds_read_b128 a[192:195], v196 offset:0
    v_cvt_pk_bf16_f32 v71, v22, v23
    v_mfma_f32_16x16x32_bf16 v[40:43], a[208:211], v[168:171], v[40:43]
    v_exp_f32 v9, v9
    v_mfma_f32_16x16x32_bf16 v[44:47], a[208:211], v[184:187], v[44:47]
    ds_read_b64_tr_b16 a[224:225], v197 offset:50688
    v_cvt_pk_bf16_f32 v72, v8, v9
    v_mfma_f32_16x16x32_bf16 a[64:67], a[240:243], v[80:83], a[64:67]
    v_exp_f32 v10, v10
    v_mfma_f32_16x16x32_bf16 a[68:71], a[240:243], v[84:87], a[68:71]
    ds_read_b64_tr_b16 a[226:227], v197 offset:51200
    v_mfma_f32_16x16x32_bf16 a[72:75], a[240:243], v[88:91], a[72:75]
    v_exp_f32 v11, v11
    v_mfma_f32_16x16x32_bf16 a[76:79], a[240:243], v[92:95], a[76:79]
    v_mfma_f32_16x16x32_bf16 v[48:51], a[212:215], v[136:139], v[48:51]
    v_exp_f32 v24, v24
    v_mfma_f32_16x16x32_bf16 v[52:55], a[212:215], v[152:155], v[52:55]
    ds_read_b128 a[196:199], v196 offset:512
    v_cvt_pk_bf16_f32 v73, v10, v11
    s_add_u32 m0, s36, 16896
    v_mfma_f32_16x16x32_bf16 v[56:59], a[212:215], v[168:171], v[56:59]
    v_exp_f32 v25, v25
    v_mfma_f32_16x16x32_bf16 v[60:63], a[212:215], v[184:187], v[60:63]
    ds_read_b64_tr_b16 a[228:229], v197 offset:50720
    v_cvt_pk_bf16_f32 v74, v24, v25
    buffer_load_dwordx4 v200, s[12:15], s46 offen nt lds
    v_mfma_f32_16x16x32_bf16 a[80:83], a[244:247], v[80:83], a[80:83]
    v_exp_f32 v26, v26
    v_mfma_f32_16x16x32_bf16 a[84:87], a[244:247], v[84:87], a[84:87]
    ds_read_b64_tr_b16 a[230:231], v197 offset:51232
    v_mfma_f32_16x16x32_bf16 a[88:91], a[244:247], v[88:91], a[88:91]
    v_exp_f32 v27, v27
    v_mfma_f32_16x16x32_bf16 a[92:95], a[244:247], v[92:95], a[92:95]
    v_mfma_f32_16x16x32_bf16 v[120:123], v[192:195], v[88:91], v[120:123]
    s_waitcnt lgkmcnt(6)
    v_mfma_f32_16x16x32_bf16 v[32:35], a[216:219], v[140:143], v[32:35]
    v_exp_f32 v12, v12
    v_mfma_f32_16x16x32_bf16 v[36:39], a[216:219], v[156:159], v[36:39]
    ds_read_b128 a[200:203], v196 offset:64
    v_cvt_pk_bf16_f32 v75, v26, v27
    v_mfma_f32_16x16x32_bf16 v[40:43], a[216:219], v[172:175], v[40:43]
    v_exp_f32 v13, v13
    v_mfma_f32_16x16x32_bf16 v[44:47], a[216:219], v[188:191], v[44:47]
    ds_read_b64_tr_b16 a[232:233], v197 offset:50752
    v_cvt_pk_bf16_f32 v76, v12, v13
    v_mfma_f32_16x16x32_bf16 a[96:99], a[248:251], v[80:83], a[96:99]
    v_exp_f32 v14, v14
    v_mfma_f32_16x16x32_bf16 a[100:103], a[248:251], v[84:87], a[100:103]
    ds_read_b64_tr_b16 a[234:235], v197 offset:51264
    v_mfma_f32_16x16x32_bf16 a[104:107], a[248:251], v[88:91], a[104:107]
    v_exp_f32 v15, v15
    v_mfma_f32_16x16x32_bf16 a[108:111], a[248:251], v[92:95], a[108:111]
    buffer_load_dwordx4 v201, s[12:15], s46 offen offset:1056 nt lds
    v_mfma_f32_16x16x32_bf16 v[48:51], a[220:223], v[140:143], v[48:51]
    v_exp_f32 v28, v28
    v_mfma_f32_16x16x32_bf16 v[52:55], a[220:223], v[156:159], v[52:55]
    ds_read_b128 a[204:207], v196 offset:576
    v_cvt_pk_bf16_f32 v77, v14, v15
    v_mfma_f32_16x16x32_bf16 v[56:59], a[220:223], v[172:175], v[56:59]
    v_exp_f32 v29, v29
    v_mfma_f32_16x16x32_bf16 v[60:63], a[220:223], v[188:191], v[60:63]
    ds_read_b64_tr_b16 a[236:237], v197 offset:50784
    v_cvt_pk_bf16_f32 v78, v28, v29
    v_mfma_f32_16x16x32_bf16 a[112:115], a[252:255], v[80:83], a[112:115]
    v_exp_f32 v30, v30
    v_mfma_f32_16x16x32_bf16 a[116:119], a[252:255], v[84:87], a[116:119]
    ds_read_b64_tr_b16 a[238:239], v197 offset:51296
    v_mfma_f32_16x16x32_bf16 a[120:123], a[252:255], v[88:91], a[120:123]
    v_exp_f32 v31, v31
    v_mfma_f32_16x16x32_bf16 a[124:127], a[252:255], v[92:95], a[124:127]
    v_mfma_f32_16x16x32_bf16 v[124:127], v[192:195], v[92:95], v[124:127]
    s_waitcnt vmcnt(3)
    s_cmp_eq_u32 s45, 0
    s_waitcnt lgkmcnt(6)
    s_cbranch_scc1 K1_AEXIT
    v_mfma_f32_16x16x32_bf16 v[0:3], a[192:195], v[128:131], v[96:99]
    v_exp_f32 v32, v32
    v_mfma_f32_16x16x32_bf16 v[4:7], a[192:195], v[144:147], v[100:103]
    ds_read_b128 a[208:211], v196 offset:128
    v_cvt_pk_bf16_f32 v79, v30, v31
    v_mfma_f32_16x16x32_bf16 v[8:11], a[192:195], v[160:163], v[104:107]
    v_exp_f32 v33, v33
    v_mfma_f32_16x16x32_bf16 v[12:15], a[192:195], v[176:179], v[108:111]
    ds_read_b64_tr_b16 a[240:241], v197 offset:50816
    v_cvt_pk_bf16_f32 v80, v32, v33
    v_mfma_f32_16x16x32_bf16 a[0:3], a[224:227], v[64:67], a[0:3]
    v_exp_f32 v34, v34
    v_mfma_f32_16x16x32_bf16 a[4:7], a[224:227], v[68:71], a[4:7]
    ds_read_b64_tr_b16 a[242:243], v197 offset:51328
    v_mfma_f32_16x16x32_bf16 a[8:11], a[224:227], v[72:75], a[8:11]
    v_exp_f32 v35, v35
    v_mfma_f32_16x16x32_bf16 a[12:15], a[224:227], v[76:79], a[12:15]
    s_add_u32 m0, s38, 0
    v_mfma_f32_16x16x32_bf16 v[16:19], a[196:199], v[128:131], v[96:99]
    v_exp_f32 v48, v48
    v_mfma_f32_16x16x32_bf16 v[20:23], a[196:199], v[144:147], v[100:103]
    ds_read_b128 a[212:215], v196 offset:640
    v_cvt_pk_bf16_f32 v81, v34, v35
    buffer_load_dwordx4 v202, s[16:19], s46 offen nt lds
    v_mfma_f32_16x16x32_bf16 v[24:27], a[196:199], v[160:163], v[104:107]
    v_exp_f32 v49, v49
    v_mfma_f32_16x16x32_bf16 v[28:31], a[196:199], v[176:179], v[108:111]
    ds_read_b64_tr_b16 a[244:245], v197 offset:50848
    v_cvt_pk_bf16_f32 v82, v48, v49
    v_mfma_f32_16x16x32_bf16 a[16:19], a[228:231], v[64:67], a[16:19]
    v_exp_f32 v50, v50
    v_mfma_f32_16x16x32_bf16 a[20:23], a[228:231], v[68:71], a[20:23]
    ds_read_b64_tr_b16 a[246:247], v197 offset:51360
    v_mfma_f32_16x16x32_bf16 a[24:27], a[228:231], v[72:75], a[24:27]
    v_exp_f32 v51, v51
    v_mfma_f32_16x16x32_bf16 a[28:31], a[228:231], v[76:79], a[28:31]
    v_mfma_f32_16x16x32_bf16 v[112:115], v[192:195], v[64:67], v[112:115]
    s_waitcnt lgkmcnt(6)
    v_mfma_f32_16x16x32_bf16 v[0:3], a[200:203], v[132:135], v[0:3]
    v_exp_f32 v36, v36
    v_mfma_f32_16x16x32_bf16 v[4:7], a[200:203], v[148:151], v[4:7]
    ds_read_b128 a[216:219], v196 offset:192
    v_cvt_pk_bf16_f32 v83, v50, v51
    v_mfma_f32_16x16x32_bf16 v[8:11], a[200:203], v[164:167], v[8:11]
    v_exp_f32 v37, v37
    v_mfma_f32_16x16x32_bf16 v[12:15], a[200:203], v[180:183], v[12:15]
    ds_read_b64_tr_b16 a[248:249], v197 offset:50880
    v_cvt_pk_bf16_f32 v84, v36, v37
    v_mfma_f32_16x16x32_bf16 a[32:35], a[232:235], v[64:67], a[32:35]
    v_exp_f32 v38, v38
    v_mfma_f32_16x16x32_bf16 a[36:39], a[232:235], v[68:71], a[36:39]
    ds_read_b64_tr_b16 a[250:251], v197 offset:51392
    v_mfma_f32_16x16x32_bf16 a[40:43], a[232:235], v[72:75], a[40:43]
    v_exp_f32 v39, v39
    v_mfma_f32_16x16x32_bf16 a[44:47], a[232:235], v[76:79], a[44:47]
    buffer_load_dwordx4 v203, s[16:19], s46 offen offset:1056 nt lds
    v_mfma_f32_16x16x32_bf16 v[16:19], a[204:207], v[132:135], v[16:19]
    v_exp_f32 v52, v52
    v_mfma_f32_16x16x32_bf16 v[20:23], a[204:207], v[148:151], v[20:23]
    ds_read_b128 a[220:223], v196 offset:704
    v_cvt_pk_bf16_f32 v85, v38, v39
    v_mfma_f32_16x16x32_bf16 v[24:27], a[204:207], v[164:167], v[24:27]
    v_exp_f32 v53, v53
    v_mfma_f32_16x16x32_bf16 v[28:31], a[204:207], v[180:183], v[28:31]
    ds_read_b64_tr_b16 a[252:253], v197 offset:50912
    v_cvt_pk_bf16_f32 v86, v52, v53
    v_mfma_f32_16x16x32_bf16 a[48:51], a[236:239], v[64:67], a[48:51]
    v_exp_f32 v54, v54
    v_mfma_f32_16x16x32_bf16 a[52:55], a[236:239], v[68:71], a[52:55]
    ds_read_b64_tr_b16 a[254:255], v197 offset:51424
    s_add_u32 s46, s46, 8192
    v_mfma_f32_16x16x32_bf16 a[56:59], a[236:239], v[72:75], a[56:59]
    v_exp_f32 v55, v55
    v_mfma_f32_16x16x32_bf16 a[60:63], a[236:239], v[76:79], a[60:63]
    v_mfma_f32_16x16x32_bf16 v[116:119], v[192:195], v[68:71], v[116:119]
    s_waitcnt vmcnt(3) lgkmcnt(6)
    s_barrier
    v_mfma_f32_16x16x32_bf16 v[0:3], a[208:211], v[136:139], v[0:3]
    v_exp_f32 v40, v40
    v_mfma_f32_16x16x32_bf16 v[4:7], a[208:211], v[152:155], v[4:7]
    ds_read_b128 a[192:195], v196 offset:8448
    v_cvt_pk_bf16_f32 v87, v54, v55
    v_mfma_f32_16x16x32_bf16 v[8:11], a[208:211], v[168:171], v[8:11]
    v_exp_f32 v41, v41
    v_mfma_f32_16x16x32_bf16 v[12:15], a[208:211], v[184:187], v[12:15]
    ds_read_b64_tr_b16 a[224:225], v197 offset:59136
    v_cvt_pk_bf16_f32 v88, v40, v41
    v_mfma_f32_16x16x32_bf16 a[64:67], a[240:243], v[64:67], a[64:67]
    v_exp_f32 v42, v42
    v_mfma_f32_16x16x32_bf16 a[68:71], a[240:243], v[68:71], a[68:71]
    ds_read_b64_tr_b16 a[226:227], v197 offset:59648
    v_mfma_f32_16x16x32_bf16 a[72:75], a[240:243], v[72:75], a[72:75]
    v_exp_f32 v43, v43
    v_mfma_f32_16x16x32_bf16 a[76:79], a[240:243], v[76:79], a[76:79]
    v_mfma_f32_16x16x32_bf16 v[16:19], a[212:215], v[136:139], v[16:19]
    v_exp_f32 v56, v56
    v_mfma_f32_16x16x32_bf16 v[20:23], a[212:215], v[152:155], v[20:23]
    ds_read_b128 a[196:199], v196 offset:8960
    v_cvt_pk_bf16_f32 v89, v42, v43
    s_add_u32 m0, s36, 25344
    v_mfma_f32_16x16x32_bf16 v[24:27], a[212:215], v[168:171], v[24:27]
    v_exp_f32 v57, v57
    v_mfma_f32_16x16x32_bf16 v[28:31], a[212:215], v[184:187], v[28:31]
    ds_read_b64_tr_b16 a[228:229], v197 offset:59168
    v_cvt_pk_bf16_f32 v90, v56, v57
    buffer_load_dwordx4 v200, s[12:15], s46 offen nt lds
    v_mfma_f32_16x16x32_bf16 a[80:83], a[244:247], v[64:67], a[80:83]
    v_exp_f32 v58, v58
    v_mfma_f32_16x16x32_bf16 a[84:87], a[244:247], v[68:71], a[84:87]
    ds_read_b64_tr_b16 a[230:231], v197 offset:59680
    v_mfma_f32_16x16x32_bf16 a[88:91], a[244:247], v[72:75], a[88:91]
    v_exp_f32 v59, v59
    v_mfma_f32_16x16x32_bf16 a[92:95], a[244:247], v[76:79], a[92:95]
    v_mfma_f32_16x16x32_bf16 v[120:123], v[192:195], v[72:75], v[120:123]
    s_waitcnt lgkmcnt(6)
    v_mfma_f32_16x16x32_bf16 v[0:3], a[216:219], v[140:143], v[0:3]
    v_exp_f32 v44, v44
    v_mfma_f32_16x16x32_bf16 v[4:7], a[216:219], v[156:159], v[4:7]
    ds_read_b128 a[200:203], v196 offset:8512
    v_cvt_pk_bf16_f32 v91, v58, v59
    v_mfma_f32_16x16x32_bf16 v[8:11], a[216:219], v[172:175], v[8:11]
    v_exp_f32 v45, v45
    v_mfma_f32_16x16x32_bf16 v[12:15], a[216:219], v[188:191], v[12:15]
    ds_read_b64_tr_b16 a[232:233], v197 offset:59200
    v_cvt_pk_bf16_f32 v92, v44, v45
    v_mfma_f32_16x16x32_bf16 a[96:99], a[248:251], v[64:67], a[96:99]
    v_exp_f32 v46, v46
    v_mfma_f32_16x16x32_bf16 a[100:103], a[248:251], v[68:71], a[100:103]
    ds_read_b64_tr_b16 a[234:235], v197 offset:59712
    v_mfma_f32_16x16x32_bf16 a[104:107], a[248:251], v[72:75], a[104:107]
    v_exp_f32 v47, v47
    v_mfma_f32_16x16x32_bf16 a[108:111], a[248:251], v[76:79], a[108:111]
    buffer_load_dwordx4 v201, s[12:15], s46 offen offset:1056 nt lds
    v_mfma_f32_16x16x32_bf16 v[16:19], a[220:223], v[140:143], v[16:19]
    v_exp_f32 v60, v60
    v_mfma_f32_16x16x32_bf16 v[20:23], a[220:223], v[156:159], v[20:23]
    ds_read_b128 a[204:207], v196 offset:9024
    v_cvt_pk_bf16_f32 v93, v46, v47
    v_mfma_f32_16x16x32_bf16 v[24:27], a[220:223], v[172:175], v[24:27]
    v_exp_f32 v61, v61
    v_mfma_f32_16x16x32_bf16 v[28:31], a[220:223], v[188:191], v[28:31]
    ds_read_b64_tr_b16 a[236:237], v197 offset:59232
    v_cvt_pk_bf16_f32 v94, v60, v61
    v_mfma_f32_16x16x32_bf16 a[112:115], a[252:255], v[64:67], a[112:115]
    v_exp_f32 v62, v62
    v_mfma_f32_16x16x32_bf16 a[116:119], a[252:255], v[68:71], a[116:119]
    ds_read_b64_tr_b16 a[238:239], v197 offset:59744
    v_mfma_f32_16x16x32_bf16 a[120:123], a[252:255], v[72:75], a[120:123]
    v_exp_f32 v63, v63
    v_mfma_f32_16x16x32_bf16 a[124:127], a[252:255], v[76:79], a[124:127]
    v_mfma_f32_16x16x32_bf16 v[124:127], v[192:195], v[76:79], v[124:127]
    s_waitcnt vmcnt(3)
    s_cmp_eq_u32 s45, s31
    s_waitcnt lgkmcnt(6)
    s_cbranch_scc1 K1_TAIL
    v_mfma_f32_16x16x32_bf16 v[32:35], a[192:195], v[128:131], v[96:99]
    v_exp_f32 v0, v0
    v_mfma_f32_16x16x32_bf16 v[36:39], a[192:195], v[144:147], v[100:103]
    ds_read_b128 a[208:211], v196 offset:8576
    v_cvt_pk_bf16_f32 v95, v62, v63
    v_mfma_f32_16x16x32_bf16 v[40:43], a[192:195], v[160:163], v[104:107]
    v_exp_f32 v1, v1
    v_mfma_f32_16x16x32_bf16 v[44:47], a[192:195], v[176:179], v[108:111]
    ds_read_b64_tr_b16 a[240:241], v197 offset:59264
    v_cvt_pk_bf16_f32 v64, v0, v1
    v_mfma_f32_16x16x32_bf16 a[0:3], a[224:227], v[80:83], a[0:3]
    v_exp_f32 v2, v2
    v_mfma_f32_16x16x32_bf16 a[4:7], a[224:227], v[84:87], a[4:7]
    ds_read_b64_tr_b16 a[242:243], v197 offset:59776
    v_mfma_f32_16x16x32_bf16 a[8:11], a[224:227], v[88:91], a[8:11]
    v_exp_f32 v3, v3
    v_mfma_f32_16x16x32_bf16 a[12:15], a[224:227], v[92:95], a[12:15]
    s_add_u32 m0, s38, 8448
    v_mfma_f32_16x16x32_bf16 v[48:51], a[196:199], v[128:131], v[96:99]
    v_exp_f32 v16, v16
    v_mfma_f32_16x16x32_bf16 v[52:55], a[196:199], v[144:147], v[100:103]
    ds_read_b128 a[212:215], v196 offset:9088
    v_cvt_pk_bf16_f32 v65, v2, v3
    buffer_load_dwordx4 v202, s[16:19], s46 offen nt lds
    v_mfma_f32_16x16x32_bf16 v[56:59], a[196:199], v[160:163], v[104:107]
    v_exp_f32 v17, v17
    v_mfma_f32_16x16x32_bf16 v[60:63], a[196:199], v[176:179], v[108:111]
    ds_read_b64_tr_b16 a[244:245], v197 offset:59296
    v_cvt_pk_bf16_f32 v66, v16, v17
    v_mfma_f32_16x16x32_bf16 a[16:19], a[228:231], v[80:83], a[16:19]
    v_exp_f32 v18, v18
    v_mfma_f32_16x16x32_bf16 a[20:23], a[228:231], v[84:87], a[20:23]
    ds_read_b64_tr_b16 a[246:247], v197 offset:59808
    v_mfma_f32_16x16x32_bf16 a[24:27], a[228:231], v[88:91], a[24:27]
    v_exp_f32 v19, v19
    v_mfma_f32_16x16x32_bf16 a[28:31], a[228:231], v[92:95], a[28:31]
    v_mfma_f32_16x16x32_bf16 v[112:115], v[192:195], v[80:83], v[112:115]
    s_waitcnt lgkmcnt(6)
    v_mfma_f32_16x16x32_bf16 v[32:35], a[200:203], v[132:135], v[32:35]
    v_exp_f32 v4, v4
    v_mfma_f32_16x16x32_bf16 v[36:39], a[200:203], v[148:151], v[36:39]
    ds_read_b128 a[216:219], v196 offset:8640
    v_cvt_pk_bf16_f32 v67, v18, v19
    v_mfma_f32_16x16x32_bf16 v[40:43], a[200:203], v[164:167], v[40:43]
    v_exp_f32 v5, v5
    v_mfma_f32_16x16x32_bf16 v[44:47], a[200:203], v[180:183], v[44:47]
    ds_read_b64_tr_b16 a[248:249], v197 offset:59328
    v_cvt_pk_bf16_f32 v68, v4, v5
    v_mfma_f32_16x16x32_bf16 a[32:35], a[232:235], v[80:83], a[32:35]
    v_exp_f32 v6, v6
    v_mfma_f32_16x16x32_bf16 a[36:39], a[232:235], v[84:87], a[36:39]
    ds_read_b64_tr_b16 a[250:251], v197 offset:59840
    v_mfma_f32_16x16x32_bf16 a[40:43], a[232:235], v[88:91], a[40:43]
    v_exp_f32 v7, v7
    v_mfma_f32_16x16x32_bf16 a[44:47], a[232:235], v[92:95], a[44:47]
    buffer_load_dwordx4 v203, s[16:19], s46 offen offset:1056 nt lds
    v_mfma_f32_16x16x32_bf16 v[48:51], a[204:207], v[132:135], v[48:51]
    v_exp_f32 v20, v20
    v_mfma_f32_16x16x32_bf16 v[52:55], a[204:207], v[148:151], v[52:55]
    ds_read_b128 a[220:223], v196 offset:9152
    v_cvt_pk_bf16_f32 v69, v6, v7
    v_mfma_f32_16x16x32_bf16 v[56:59], a[204:207], v[164:167], v[56:59]
    v_exp_f32 v21, v21
    v_mfma_f32_16x16x32_bf16 v[60:63], a[204:207], v[180:183], v[60:63]
    ds_read_b64_tr_b16 a[252:253], v197 offset:59360
    v_cvt_pk_bf16_f32 v70, v20, v21
    v_mfma_f32_16x16x32_bf16 a[48:51], a[236:239], v[80:83], a[48:51]
    v_exp_f32 v22, v22
    v_mfma_f32_16x16x32_bf16 a[52:55], a[236:239], v[84:87], a[52:55]
    ds_read_b64_tr_b16 a[254:255], v197 offset:59872
    s_add_u32 s46, s46, 8192
    v_mfma_f32_16x16x32_bf16 a[56:59], a[236:239], v[88:91], a[56:59]
    v_exp_f32 v23, v23
    v_mfma_f32_16x16x32_bf16 a[60:63], a[236:239], v[92:95], a[60:63]
    v_mfma_f32_16x16x32_bf16 v[116:119], v[192:195], v[84:87], v[116:119]
    s_waitcnt vmcnt(3) lgkmcnt(6)
    s_barrier
    v_mfma_f32_16x16x32_bf16 v[32:35], a[208:211], v[136:139], v[32:35]
    v_exp_f32 v8, v8
    v_mfma_f32_16x16x32_bf16 v[36:39], a[208:211], v[152:155], v[36:39]
    ds_read_b128 a[192:195], v196 offset:16896
    v_cvt_pk_bf16_f32 v71, v22, v23
    v_mfma_f32_16x16x32_bf16 v[40:43], a[208:211], v[168:171], v[40:43]
    v_exp_f32 v9, v9
    v_mfma_f32_16x16x32_bf16 v[44:47], a[208:211], v[184:187], v[44:47]
    ds_read_b64_tr_b16 a[224:225], v197 offset:0
    v_cvt_pk_bf16_f32 v72, v8, v9
    v_mfma_f32_16x16x32_bf16 a[64:67], a[240:243], v[80:83], a[64:67]
    v_exp_f32 v10, v10
    v_mfma_f32_16x16x32_bf16 a[68:71], a[240:243], v[84:87], a[68:71]
    ds_read_b64_tr_b16 a[226:227], v197 offset:512
    v_mfma_f32_16x16x32_bf16 a[72:75], a[240:243], v[88:91], a[72:75]
    v_exp_f32 v11, v11
    v_mfma_f32_16x16x32_bf16 a[76:79], a[240:243], v[92:95], a[76:79]
    v_mfma_f32_16x16x32_bf16 v[48:51], a[212:215], v[136:139], v[48:51]
    v_exp_f32 v24, v24
    v_mfma_f32_16x16x32_bf16 v[52:55], a[212:215], v[152:155], v[52:55]
    ds_read_b128 a[196:199], v196 offset:17408
    v_cvt_pk_bf16_f32 v73, v10, v11
    s_add_u32 m0, s37, 33792
    v_mfma_f32_16x16x32_bf16 v[56:59], a[212:215], v[168:171], v[56:59]
    v_exp_f32 v25, v25
    v_mfma_f32_16x16x32_bf16 v[60:63], a[212:215], v[184:187], v[60:63]
    ds_read_b64_tr_b16 a[228:229], v197 offset:32
    v_cvt_pk_bf16_f32 v74, v24, v25
    buffer_load_dwordx4 v200, s[12:15], s46 offen nt lds
    v_mfma_f32_16x16x32_bf16 a[80:83], a[244:247], v[80:83], a[80:83]
    v_exp_f32 v26, v26
    v_mfma_f32_16x16x32_bf16 a[84:87], a[244:247], v[84:87], a[84:87]
    ds_read_b64_tr_b16 a[230:231], v197 offset:544
    v_mfma_f32_16x16x32_bf16 a[88:91], a[244:247], v[88:91], a[88:91]
    v_exp_f32 v27, v27
    v_mfma_f32_16x16x32_bf16 a[92:95], a[244:247], v[92:95], a[92:95]
    v_mfma_f32_16x16x32_bf16 v[120:123], v[192:195], v[88:91], v[120:123]
    s_waitcnt lgkmcnt(6)
    v_mfma_f32_16x16x32_bf16 v[32:35], a[216:219], v[140:143], v[32:35]
    v_exp_f32 v12, v12
    v_mfma_f32_16x16x32_bf16 v[36:39], a[216:219], v[156:159], v[36:39]
    ds_read_b128 a[200:203], v196 offset:16960
    v_cvt_pk_bf16_f32 v75, v26, v27
    v_mfma_f32_16x16x32_bf16 v[40:43], a[216:219], v[172:175], v[40:43]
    v_exp_f32 v13, v13
    v_mfma_f32_16x16x32_bf16 v[44:47], a[216:219], v[188:191], v[44:47]
    ds_read_b64_tr_b16 a[232:233], v197 offset:64
    v_cvt_pk_bf16_f32 v76, v12, v13
    v_mfma_f32_16x16x32_bf16 a[96:99], a[248:251], v[80:83], a[96:99]
    v_exp_f32 v14, v14
    v_mfma_f32_16x16x32_bf16 a[100:103], a[248:251], v[84:87], a[100:103]
    ds_read_b64_tr_b16 a[234:235], v197 offset:576
    v_mfma_f32_16x16x32_bf16 a[104:107], a[248:251], v[88:91], a[104:107]
    v_exp_f32 v15, v15
    v_mfma_f32_16x16x32_bf16 a[108:111], a[248:251], v[92:95], a[108:111]
    buffer_load_dwordx4 v201, s[12:15], s46 offen offset:1056 nt lds
    v_mfma_f32_16x16x32_bf16 v[48:51], a[220:223], v[140:143], v[48:51]
    v_exp_f32 v28, v28
    v_mfma_f32_16x16x32_bf16 v[52:55], a[220:223], v[156:159], v[52:55]
    ds_read_b128 a[204:207], v196 offset:17472
    v_cvt_pk_bf16_f32 v77, v14, v15
    v_mfma_f32_16x16x32_bf16 v[56:59], a[220:223], v[172:175], v[56:59]
    v_exp_f32 v29, v29
    v_mfma_f32_16x16x32_bf16 v[60:63], a[220:223], v[188:191], v[60:63]
    ds_read_b64_tr_b16 a[236:237], v197 offset:96
    v_cvt_pk_bf16_f32 v78, v28, v29
    v_mfma_f32_16x16x32_bf16 a[112:115], a[252:255], v[80:83], a[112:115]
    v_exp_f32 v30, v30
    v_mfma_f32_16x16x32_bf16 a[116:119], a[252:255], v[84:87], a[116:119]
    ds_read_b64_tr_b16 a[238:239], v197 offset:608
    v_mfma_f32_16x16x32_bf16 a[120:123], a[252:255], v[88:91], a[120:123]
    v_exp_f32 v31, v31
    v_mfma_f32_16x16x32_bf16 a[124:127], a[252:255], v[92:95], a[124:127]
    v_mfma_f32_16x16x32_bf16 v[124:127], v[192:195], v[92:95], v[124:127]
    s_waitcnt vmcnt(3)
    s_waitcnt lgkmcnt(6)
    v_mfma_f32_16x16x32_bf16 v[0:3], a[192:195], v[128:131], v[96:99]
    v_exp_f32 v32, v32
    v_mfma_f32_16x16x32_bf16 v[4:7], a[192:195], v[144:147], v[100:103]
    ds_read_b128 a[208:211], v196 offset:17024
    v_cvt_pk_bf16_f32 v79, v30, v31
    v_mfma_f32_16x16x32_bf16 v[8:11], a[192:195], v[160:163], v[104:107]
    v_exp_f32 v33, v33
    v_mfma_f32_16x16x32_bf16 v[12:15], a[192:195], v[176:179], v[108:111]
    ds_read_b64_tr_b16 a[240:241], v197 offset:128
    v_cvt_pk_bf16_f32 v80, v32, v33
    v_mfma_f32_16x16x32_bf16 a[0:3], a[224:227], v[64:67], a[0:3]
    v_exp_f32 v34, v34
    v_mfma_f32_16x16x32_bf16 a[4:7], a[224:227], v[68:71], a[4:7]
    ds_read_b64_tr_b16 a[242:243], v197 offset:640
    v_mfma_f32_16x16x32_bf16 a[8:11], a[224:227], v[72:75], a[8:11]
    v_exp_f32 v35, v35
    v_mfma_f32_16x16x32_bf16 a[12:15], a[224:227], v[76:79], a[12:15]
    s_add_u32 m0, s38, 16896
    v_mfma_f32_16x16x32_bf16 v[16:19], a[196:199], v[128:131], v[96:99]
    v_exp_f32 v48, v48
    v_mfma_f32_16x16x32_bf16 v[20:23], a[196:199], v[144:147], v[100:103]
    ds_read_b128 a[212:215], v196 offset:17536
    v_cvt_pk_bf16_f32 v81, v34, v35
    buffer_load_dwordx4 v202, s[16:19], s46 offen nt lds
    v_mfma_f32_16x16x32_bf16 v[24:27], a[196:199], v[160:163], v[104:107]
    v_exp_f32 v49, v49
    v_mfma_f32_16x16x32_bf16 v[28:31], a[196:199], v[176:179], v[108:111]
    ds_read_b64_tr_b16 a[244:245], v197 offset:160
    v_cvt_pk_bf16_f32 v82, v48, v49
    v_mfma_f32_16x16x32_bf16 a[16:19], a[228:231], v[64:67], a[16:19]
    v_exp_f32 v50, v50
    v_mfma_f32_16x16x32_bf16 a[20:23], a[228:231], v[68:71], a[20:23]
    ds_read_b64_tr_b16 a[246:247], v197 offset:672
    v_mfma_f32_16x16x32_bf16 a[24:27], a[228:231], v[72:75], a[24:27]
    v_exp_f32 v51, v51
    v_mfma_f32_16x16x32_bf16 a[28:31], a[228:231], v[76:79], a[28:31]
    v_mfma_f32_16x16x32_bf16 v[112:115], v[192:195], v[64:67], v[112:115]
    s_waitcnt lgkmcnt(6)
    v_mfma_f32_16x16x32_bf16 v[0:3], a[200:203], v[132:135], v[0:3]
    v_exp_f32 v36, v36
    v_mfma_f32_16x16x32_bf16 v[4:7], a[200:203], v[148:151], v[4:7]
    ds_read_b128 a[216:219], v196 offset:17088
    v_cvt_pk_bf16_f32 v83, v50, v51
    v_mfma_f32_16x16x32_bf16 v[8:11], a[200:203], v[164:167], v[8:11]
    v_exp_f32 v37, v37
    v_mfma_f32_16x16x32_bf16 v[12:15], a[200:203], v[180:183], v[12:15]
    ds_read_b64_tr_b16 a[248:249], v197 offset:192
    v_cvt_pk_bf16_f32 v84, v36, v37
    v_mfma_f32_16x16x32_bf16 a[32:35], a[232:235], v[64:67], a[32:35]
    v_exp_f32 v38, v38
    v_mfma_f32_16x16x32_bf16 a[36:39], a[232:235], v[68:71], a[36:39]
    ds_read_b64_tr_b16 a[250:251], v197 offset:704
    v_mfma_f32_16x16x32_bf16 a[40:43], a[232:235], v[72:75], a[40:43]
    v_exp_f32 v39, v39
    v_mfma_f32_16x16x32_bf16 a[44:47], a[232:235], v[76:79], a[44:47]
    buffer_load_dwordx4 v203, s[16:19], s46 offen offset:1056 nt lds
    v_mfma_f32_16x16x32_bf16 v[16:19], a[204:207], v[132:135], v[16:19]
    v_exp_f32 v52, v52
    v_mfma_f32_16x16x32_bf16 v[20:23], a[204:207], v[148:151], v[20:23]
    ds_read_b128 a[220:223], v196 offset:17600
    v_cvt_pk_bf16_f32 v85, v38, v39
    v_mfma_f32_16x16x32_bf16 v[24:27], a[204:207], v[164:167], v[24:27]
    v_exp_f32 v53, v53
    v_mfma_f32_16x16x32_bf16 v[28:31], a[204:207], v[180:183], v[28:31]
    ds_read_b64_tr_b16 a[252:253], v197 offset:224
    v_cvt_pk_bf16_f32 v86, v52, v53
    v_mfma_f32_16x16x32_bf16 a[48:51], a[236:239], v[64:67], a[48:51]
    v_exp_f32 v54, v54
    v_mfma_f32_16x16x32_bf16 a[52:55], a[236:239], v[68:71], a[52:55]
    ds_read_b64_tr_b16 a[254:255], v197 offset:736
    s_add_u32 s46, s46, 8192
    v_mfma_f32_16x16x32_bf16 a[56:59], a[236:239], v[72:75], a[56:59]
    v_exp_f32 v55, v55
    v_mfma_f32_16x16x32_bf16 a[60:63], a[236:239], v[76:79], a[60:63]
    v_mfma_f32_16x16x32_bf16 v[116:119], v[192:195], v[68:71], v[116:119]
    s_waitcnt vmcnt(3) lgkmcnt(6)
    s_barrier
    v_mfma_f32_16x16x32_bf16 v[0:3], a[208:211], v[136:139], v[0:3]
    v_exp_f32 v40, v40
    v_mfma_f32_16x16x32_bf16 v[4:7], a[208:211], v[152:155], v[4:7]
    ds_read_b128 a[192:195], v196 offset:25344
    v_cvt_pk_bf16_f32 v87, v54, v55
    v_mfma_f32_16x16x32_bf16 v[8:11], a[208:211], v[168:171], v[8:11]
    v_exp_f32 v41, v41
    v_mfma_f32_16x16x32_bf16 v[12:15], a[208:211], v[184:187], v[12:15]
    ds_read_b64_tr_b16 a[224:225], v197 offset:8448
    v_cvt_pk_bf16_f32 v88, v40, v41
    v_mfma_f32_16x16x32_bf16 a[64:67], a[240:243], v[64:67], a[64:67]
    v_exp_f32 v42, v42
    v_mfma_f32_16x16x32_bf16 a[68:71], a[240:243], v[68:71], a[68:71]
    ds_read_b64_tr_b16 a[226:227], v197 offset:8960
    v_mfma_f32_16x16x32_bf16 a[72:75], a[240:243], v[72:75], a[72:75]
    v_exp_f32 v43, v43
    v_mfma_f32_16x16x32_bf16 a[76:79], a[240:243], v[76:79], a[76:79]
    v_mfma_f32_16x16x32_bf16 v[16:19], a[212:215], v[136:139], v[16:19]
    v_exp_f32 v56, v56
    v_mfma_f32_16x16x32_bf16 v[20:23], a[212:215], v[152:155], v[20:23]
    ds_read_b128 a[196:199], v196 offset:25856
    v_cvt_pk_bf16_f32 v89, v42, v43
    s_add_u32 m0, s37, 42240
    v_mfma_f32_16x16x32_bf16 v[24:27], a[212:215], v[168:171], v[24:27]
    v_exp_f32 v57, v57
    v_mfma_f32_16x16x32_bf16 v[28:31], a[212:215], v[184:187], v[28:31]
    ds_read_b64_tr_b16 a[228:229], v197 offset:8480
    v_cvt_pk_bf16_f32 v90, v56, v57
    buffer_load_dwordx4 v200, s[12:15], s46 offen nt lds
    v_mfma_f32_16x16x32_bf16 a[80:83], a[244:247], v[64:67], a[80:83]
    v_exp_f32 v58, v58
    v_mfma_f32_16x16x32_bf16 a[84:87], a[244:247], v[68:71], a[84:87]
    ds_read_b64_tr_b16 a[230:231], v197 offset:8992
    v_mfma_f32_16x16x32_bf16 a[88:91], a[244:247], v[72:75], a[88:91]
    v_exp_f32 v59, v59
    v_mfma_f32_16x16x32_bf16 a[92:95], a[244:247], v[76:79], a[92:95]
    v_mfma_f32_16x16x32_bf16 v[120:123], v[192:195], v[72:75], v[120:123]
    s_waitcnt lgkmcnt(6)
    v_mfma_f32_16x16x32_bf16 v[0:3], a[216:219], v[140:143], v[0:3]
    v_exp_f32 v44, v44
    v_mfma_f32_16x16x32_bf16 v[4:7], a[216:219], v[156:159], v[4:7]
    ds_read_b128 a[200:203], v196 offset:25408
    v_cvt_pk_bf16_f32 v91, v58, v59
    v_mfma_f32_16x16x32_bf16 v[8:11], a[216:219], v[172:175], v[8:11]
    v_exp_f32 v45, v45
    v_mfma_f32_16x16x32_bf16 v[12:15], a[216:219], v[188:191], v[12:15]
    ds_read_b64_tr_b16 a[232:233], v197 offset:8512
    v_cvt_pk_bf16_f32 v92, v44, v45
    v_mfma_f32_16x16x32_bf16 a[96:99], a[248:251], v[64:67], a[96:99]
    v_exp_f32 v46, v46
    v_mfma_f32_16x16x32_bf16 a[100:103], a[248:251], v[68:71], a[100:103]
    ds_read_b64_tr_b16 a[234:235], v197 offset:9024
    v_mfma_f32_16x16x32_bf16 a[104:107], a[248:251], v[72:75], a[104:107]
    v_exp_f32 v47, v47
    v_mfma_f32_16x16x32_bf16 a[108:111], a[248:251], v[76:79], a[108:111]
    buffer_load_dwordx4 v201, s[12:15], s46 offen offset:1056 nt lds
    v_mfma_f32_16x16x32_bf16 v[16:19], a[220:223], v[140:143], v[16:19]
    v_exp_f32 v60, v60
    v_mfma_f32_16x16x32_bf16 v[20:23], a[220:223], v[156:159], v[20:23]
    ds_read_b128 a[204:207], v196 offset:25920
    v_cvt_pk_bf16_f32 v93, v46, v47
    v_mfma_f32_16x16x32_bf16 v[24:27], a[220:223], v[172:175], v[24:27]
    v_exp_f32 v61, v61
    v_mfma_f32_16x16x32_bf16 v[28:31], a[220:223], v[188:191], v[28:31]
    ds_read_b64_tr_b16 a[236:237], v197 offset:8544
    v_cvt_pk_bf16_f32 v94, v60, v61
    v_mfma_f32_16x16x32_bf16 a[112:115], a[252:255], v[64:67], a[112:115]
    v_exp_f32 v62, v62
    v_mfma_f32_16x16x32_bf16 a[116:119], a[252:255], v[68:71], a[116:119]
    ds_read_b64_tr_b16 a[238:239], v197 offset:9056
    v_mfma_f32_16x16x32_bf16 a[120:123], a[252:255], v[72:75], a[120:123]
    v_exp_f32 v63, v63
    v_mfma_f32_16x16x32_bf16 a[124:127], a[252:255], v[76:79], a[124:127]
    v_mfma_f32_16x16x32_bf16 v[124:127], v[192:195], v[76:79], v[124:127]
    s_waitcnt vmcnt(3)
    s_waitcnt lgkmcnt(6)
    s_branch K1_ALOOP
K1_AEXIT:
    v_mfma_f32_16x16x32_bf16 a[0:3], a[224:227], v[64:67], a[0:3]
    v_exp_f32 v32, v32
    v_cvt_pk_bf16_f32 v79, v30, v31
    v_mfma_f32_16x16x32_bf16 a[4:7], a[224:227], v[68:71], a[4:7]
    v_exp_f32 v33, v33
    ds_read_b64_tr_b16 a[240:241], v197 offset:50816
    v_mfma_f32_16x16x32_bf16 a[8:11], a[224:227], v[72:75], a[8:11]
    v_exp_f32 v34, v34
    v_cvt_pk_bf16_f32 v80, v32, v33
    ds_read_b64_tr_b16 a[242:243], v197 offset:51328
    v_mfma_f32_16x16x32_bf16 a[12:15], a[224:227], v[76:79], a[12:15]
    v_exp_f32 v35, v35
    s_add_u32 m0, s38, 0
    v_mfma_f32_16x16x32_bf16 a[16:19], a[228:231], v[64:67], a[16:19]
    v_exp_f32 v48, v48
    v_cvt_pk_bf16_f32 v81, v34, v35
    buffer_load_dwordx4 v202, s[16:19], s46 offen nt lds
    v_mfma_f32_16x16x32_bf16 a[20:23], a[228:231], v[68:71], a[20:23]
    v_exp_f32 v49, v49
    ds_read_b64_tr_b16 a[244:245], v197 offset:50848
    v_mfma_f32_16x16x32_bf16 a[24:27], a[228:231], v[72:75], a[24:27]
    v_exp_f32 v50, v50
    v_cvt_pk_bf16_f32 v82, v48, v49
    ds_read_b64_tr_b16 a[246:247], v197 offset:51360
    v_mfma_f32_16x16x32_bf16 a[28:31], a[228:231], v[76:79], a[28:31]
    v_exp_f32 v51, v51
    v_mfma_f32_16x16x32_bf16 v[112:115], v[192:195], v[64:67], v[112:115]
    s_waitcnt lgkmcnt(4)
    v_mfma_f32_16x16x32_bf16 a[32:35], a[232:235], v[64:67], a[32:35]
    v_exp_f32 v36, v36
    v_cvt_pk_bf16_f32 v83, v50, v51
    v_mfma_f32_16x16x32_bf16 a[36:39], a[232:235], v[68:71], a[36:39]
    v_exp_f32 v37, v37
    ds_read_b64_tr_b16 a[248:249], v197 offset:50880
    v_mfma_f32_16x16x32_bf16 a[40:43], a[232:235], v[72:75], a[40:43]
    v_exp_f32 v38, v38
    v_cvt_pk_bf16_f32 v84, v36, v37
    ds_read_b64_tr_b16 a[250:251], v197 offset:51392
    v_mfma_f32_16x16x32_bf16 a[44:47], a[232:235], v[76:79], a[44:47]
    v_exp_f32 v39, v39
    buffer_load_dwordx4 v203, s[16:19], s46 offen offset:1056 nt lds
    v_mfma_f32_16x16x32_bf16 a[48:51], a[236:239], v[64:67], a[48:51]
    v_exp_f32 v52, v52
    v_cvt_pk_bf16_f32 v85, v38, v39
    v_mfma_f32_16x16x32_bf16 a[52:55], a[236:239], v[68:71], a[52:55]
    v_exp_f32 v53, v53
    ds_read_b64_tr_b16 a[252:253], v197 offset:50912
    v_mfma_f32_16x16x32_bf16 a[56:59], a[236:239], v[72:75], a[56:59]
    v_exp_f32 v54, v54
    v_cvt_pk_bf16_f32 v86, v52, v53
    ds_read_b64_tr_b16 a[254:255], v197 offset:51424
    s_add_u32 s46, s46, 8192
    v_mfma_f32_16x16x32_bf16 a[60:63], a[236:239], v[76:79], a[60:63]
    v_exp_f32 v55, v55
    v_mfma_f32_16x16x32_bf16 v[116:119], v[192:195], v[68:71], v[116:119]
    s_waitcnt vmcnt(3) lgkmcnt(4)
    s_barrier
    v_mfma_f32_16x16x32_bf16 a[64:67], a[240:243], v[64:67], a[64:67]
    v_exp_f32 v40, v40
    v_cvt_pk_bf16_f32 v87, v54, v55
    v_mfma_f32_16x16x32_bf16 a[68:71], a[240:243], v[68:71], a[68:71]
    v_exp_f32 v41, v41
    ds_read_b64_tr_b16 a[224:225], v197 offset:59136
    v_mfma_f32_16x16x32_bf16 a[72:75], a[240:243], v[72:75], a[72:75]
    v_exp_f32 v42, v42
    v_cvt_pk_bf16_f32 v88, v40, v41
    ds_read_b64_tr_b16 a[226:227], v197 offset:59648
    v_mfma_f32_16x16x32_bf16 a[76:79], a[240:243], v[76:79], a[76:79]
    v_exp_f32 v43, v43
    v_mfma_f32_16x16x32_bf16 a[80:83], a[244:247], v[64:67], a[80:83]
    v_exp_f32 v56, v56
    v_cvt_pk_bf16_f32 v89, v42, v43
    s_add_u32 m0, s36, 25344
    v_mfma_f32_16x16x32_bf16 a[84:87], a[244:247], v[68:71], a[84:87]
    v_exp_f32 v57, v57
    ds_read_b64_tr_b16 a[228:229], v197 offset:59168
    buffer_load_dwordx4 v200, s[12:15], s46 offen nt lds
    v_mfma_f32_16x16x32_bf16 a[88:91], a[244:247], v[72:75], a[88:91]
    v_exp_f32 v58, v58
    v_cvt_pk_bf16_f32 v90, v56, v57
    ds_read_b64_tr_b16 a[230:231], v197 offset:59680
    v_mfma_f32_16x16x32_bf16 a[92:95], a[244:247], v[76:79], a[92:95]
    v_exp_f32 v59, v59
    v_mfma_f32_16x16x32_bf16 v[120:123], v[192:195], v[72:75], v[120:123]
    s_waitcnt lgkmcnt(4)
    v_mfma_f32_16x16x32_bf16 a[96:99], a[248:251], v[64:67], a[96:99]
    v_exp_f32 v44, v44
    v_cvt_pk_bf16_f32 v91, v58, v59
    v_mfma_f32_16x16x32_bf16 a[100:103], a[248:251], v[68:71], a[100:103]
    v_exp_f32 v45, v45
    ds_read_b64_tr_b16 a[232:233], v197 offset:59200
    v_mfma_f32_16x16x32_bf16 a[104:107], a[248:251], v[72:75], a[104:107]
    v_exp_f32 v46, v46
    v_cvt_pk_bf16_f32 v92, v44, v45
    ds_read_b64_tr_b16 a[234:235], v197 offset:59712
    v_mfma_f32_16x16x32_bf16 a[108:111], a[248:251], v[76:79], a[108:111]
    v_exp_f32 v47, v47
    buffer_load_dwordx4 v201, s[12:15], s46 offen offset:1056 nt lds
    v_mfma_f32_16x16x32_bf16 a[112:115], a[252:255], v[64:67], a[112:115]
    v_exp_f32 v60, v60
    v_cvt_pk_bf16_f32 v93, v46, v47
    v_mfma_f32_16x16x32_bf16 a[116:119], a[252:255], v[68:71], a[116:119]
    v_exp_f32 v61, v61
    ds_read_b64_tr_b16 a[236:237], v197 offset:59232
    v_mfma_f32_16x16x32_bf16 a[120:123], a[252:255], v[72:75], a[120:123]
    v_exp_f32 v62, v62
    v_cvt_pk_bf16_f32 v94, v60, v61
    ds_read_b64_tr_b16 a[238:239], v197 offset:59744
    v_mfma_f32_16x16x32_bf16 a[124:127], a[252:255], v[76:79], a[124:127]
    v_exp_f32 v63, v63
    v_mfma_f32_16x16x32_bf16 v[124:127], v[192:195], v[76:79], v[124:127]
    s_waitcnt vmcnt(3)
    ds_read_b64_tr_b16 a[240:241], v197 offset:59264
    ds_read_b64_tr_b16 a[242:243], v197 offset:59776
    ds_read_b64_tr_b16 a[244:245], v197 offset:59296
    ds_read_b64_tr_b16 a[246:247], v197 offset:59808
    ds_read_b64_tr_b16 a[248:249], v197 offset:59328
    ds_read_b64_tr_b16 a[250:251], v197 offset:59840
    ds_read_b64_tr_b16 a[252:253], v197 offset:59360
    ds_read_b64_tr_b16 a[254:255], v197 offset:59872
    v_cvt_pk_bf16_f32 v95, v62, v63
    s_waitcnt lgkmcnt(14)
    v_mfma_f32_16x16x32_bf16 a[0:3], a[224:227], v[80:83], a[0:3]
    v_mfma_f32_16x16x32_bf16 a[4:7], a[224:227], v[84:87], a[4:7]
    v_mfma_f32_16x16x32_bf16 a[8:11], a[224:227], v[88:91], a[8:11]
    v_mfma_f32_16x16x32_bf16 a[12:15], a[224:227], v[92:95], a[12:15]
    v_mfma_f32_16x16x32_bf16 v[112:115], v[192:195], v[80:83], v[112:115]
    s_add_u32 m0, s38, 8448
    v_mfma_f32_16x16x32_bf16 v[116:119], v[192:195], v[84:87], v[116:119]
    v_mfma_f32_16x16x32_bf16 v[120:123], v[192:195], v[88:91], v[120:123]
    buffer_load_dwordx4 v202, s[16:19], s46 offen nt lds
    v_mfma_f32_16x16x32_bf16 v[124:127], v[192:195], v[92:95], v[124:127]
    s_waitcnt lgkmcnt(12)
    v_mfma_f32_16x16x32_bf16 a[16:19], a[228:231], v[80:83], a[16:19]
    v_mfma_f32_16x16x32_bf16 a[20:23], a[228:231], v[84:87], a[20:23]
    v_mfma_f32_16x16x32_bf16 a[24:27], a[228:231], v[88:91], a[24:27]
    v_mfma_f32_16x16x32_bf16 a[28:31], a[228:231], v[92:95], a[28:31]
    s_waitcnt lgkmcnt(10)
    v_mfma_f32_16x16x32_bf16 a[32:35], a[232:235], v[80:83], a[32:35]
    s_mov_b32 s55, 1317011456
    s_mov_b64 s[56:57], -1
    v_mfma_f32_16x16x32_bf16 a[36:39], a[232:235], v[84:87], a[36:39]
    v_mfma_f32_16x16x32_bf16 a[40:43], a[232:235], v[88:91], a[40:43]
    buffer_load_dwordx4 v203, s[16:19], s46 offen offset:1056 nt lds
    v_mfma_f32_16x16x32_bf16 a[44:47], a[232:235], v[92:95], a[44:47]
    s_add_u32 s46, s46, 8192
    s_waitcnt lgkmcnt(8)
    v_mfma_f32_16x16x32_bf16 a[48:51], a[236:239], v[80:83], a[48:51]
    v_mfma_f32_16x16x32_bf16 a[52:55], a[236:239], v[84:87], a[52:55]
    v_cmp_gt_f32 vcc, s55, v112
    v_mfma_f32_16x16x32_bf16 a[56:59], a[236:239], v[88:91], a[56:59]
    s_and_b64 s[56:57], s[56:57], vcc
    s_add_u32 m0, s41, 33792
    s_mov_b32 s59, 294912
    buffer_load_dwordx4 v198, s[12:15], s59 offen nt lds
    v_mfma_f32_16x16x32_bf16 a[60:63], a[236:239], v[92:95], a[60:63]
    v_cmp_gt_f32 vcc, s55, v116
    s_waitcnt lgkmcnt(6)
    v_mfma_f32_16x16x32_bf16 a[64:67], a[240:243], v[80:83], a[64:67]
    s_and_b64 s[56:57], s[56:57], vcc
    v_mfma_f32_16x16x32_bf16 a[68:71], a[240:243], v[84:87], a[68:71]
    v_cmp_gt_f32 vcc, s55, v120
    v_mfma_f32_16x16x32_bf16 a[72:75], a[240:243], v[88:91], a[72:75]
    s_and_b64 s[56:57], s[56:57], vcc
    v_mfma_f32_16x16x32_bf16 a[76:79], a[240:243], v[92:95], a[76:79]
    v_cmp_gt_f32 vcc, s55, v124
    s_waitcnt lgkmcnt(4)
    v_mfma_f32_16x16x32_bf16 a[80:83], a[244:247], v[80:83], a[80:83]
    s_and_b64 s[56:57], s[56:57], vcc
    v_mfma_f32_16x16x32_bf16 a[84:87], a[244:247], v[84:87], a[84:87]
    s_cmp_eq_u64 s[56:57], -1
    v_mfma_f32_16x16x32_bf16 a[88:91], a[244:247], v[88:91], a[88:91]
    s_cselect_b32 s55, 0, 1
    v_mfma_f32_16x16x32_bf16 a[92:95], a[244:247], v[92:95], a[92:95]
    s_andn2_b32 s55, s55, s28
    s_waitcnt lgkmcnt(2)
    v_mfma_f32_16x16x32_bf16 a[96:99], a[248:251], v[80:83], a[96:99]
    v_mov_b32 v220, s55
    v_mfma_f32_16x16x32_bf16 a[100:103], a[248:251], v[84:87], a[100:103]
    ds_write_b32 v207, v220
    v_mfma_f32_16x16x32_bf16 a[104:107], a[248:251], v[88:91], a[104:107]
    v_mov_b32 v221, 135168
    s_add_u32 m0, s41, 34848
    s_mov_b32 s59, 294912
    buffer_load_dwordx4 v199, s[12:15], s59 offen nt lds
    v_mfma_f32_16x16x32_bf16 a[108:111], a[248:251], v[92:95], a[108:111]
    v_rcp_f32 v212, v112
    s_waitcnt lgkmcnt(1)
    v_mfma_f32_16x16x32_bf16 a[112:115], a[252:255], v[80:83], a[112:115]
    v_rcp_f32 v214, v116
    v_mfma_f32_16x16x32_bf16 a[116:119], a[252:255], v[84:87], a[116:119]
    v_rcp_f32 v216, v120
    v_mfma_f32_16x16x32_bf16 a[120:123], a[252:255], v[88:91], a[120:123]
    v_rcp_f32 v218, v124
    v_mfma_f32_16x16x32_bf16 a[124:127], a[252:255], v[92:95], a[124:127]
    s_waitcnt lgkmcnt(0)
    s_barrier
    ds_read_b128 v[224:227], v221
    ds_read_b128 a[192:195], v196 offset:0
    ds_read_b128 a[196:199], v196 offset:512
    ds_read_b128 a[200:203], v196 offset:64
    ds_read_b128 a[204:207], v196 offset:576
    ds_read_b128 a[208:211], v196 offset:128
    ds_read_b128 a[212:215], v196 offset:640
    ds_read_b128 a[216:219], v196 offset:192
    ds_read_b128 a[220:223], v196 offset:704
    v_accvgpr_read_b32 v32, a0
    v_accvgpr_read_b32 v33, a1
    v_accvgpr_read_b32 v34, a2
    v_accvgpr_read_b32 v35, a3
    v_accvgpr_read_b32 v36, a16
    v_accvgpr_read_b32 v37, a17
    v_accvgpr_read_b32 v38, a18
    v_accvgpr_read_b32 v39, a19
    v_accvgpr_read_b32 v40, a4
    v_accvgpr_read_b32 v41, a5
    v_accvgpr_read_b32 v42, a6
    v_accvgpr_read_b32 v43, a7
    v_accvgpr_read_b32 v44, a20
    v_accvgpr_read_b32 v45, a21
    v_accvgpr_read_b32 v46, a22
    v_accvgpr_read_b32 v47, a23
    v_pk_mul_f32 v[32:33], v[32:33], v[212:213] op_sel_hi:[1,0]
    v_pk_mul_f32 v[34:35], v[34:35], v[212:213] op_sel_hi:[1,0]
    v_pk_mul_f32 v[36:37], v[36:37], v[212:213] op_sel_hi:[1,0]
    v_pk_mul_f32 v[38:39], v[38:39], v[212:213] op_sel_hi:[1,0]
    v_pk_mul_f32 v[40:41], v[40:41], v[214:215] op_sel_hi:[1,0]
    v_pk_mul_f32 v[42:43], v[42:43], v[214:215] op_sel_hi:[1,0]
    v_pk_mul_f32 v[44:45], v[44:45], v[214:215] op_sel_hi:[1,0]
    v_pk_mul_f32 v[46:47], v[46:47], v[214:215] op_sel_hi:[1,0]
    v_cvt_pk_bf16_f32 v48, v32, v33
    v_cvt_pk_bf16_f32 v49, v34, v35
    v_cvt_pk_bf16_f32 v50, v36, v37
    v_cvt_pk_bf16_f32 v51, v38, v39
    v_cvt_pk_bf16_f32 v52, v40, v41
    v_cvt_pk_bf16_f32 v53, v42, v43
    s_add_u32 m0, s42, 16896
    s_mov_b32 s59, 278528
    buffer_load_dwordx4 v198, s[16:19], s59 offen nt lds
    v_cvt_pk_bf16_f32 v54, v44, v45
    v_cvt_pk_bf16_f32 v55, v46, v47
    v_mov_b32 v248, 0xff800000
    v_mov_b32 v249, 0xff800000
    v_mov_b32 v250, 0xff800000
    v_mov_b32 v251, 0xff800000
    s_waitcnt lgkmcnt(8)
    v_or3_b32 v224, v224, v225, v226
    v_or_b32 v224, v224, v227
    s_nop 0
    v_readfirstlane_b32 s56, v224
    s_cmp_lg_u32 s56, 0
    s_cbranch_scc1 K1_FB
    v_accvgpr_read_b32 v128, a128
    v_accvgpr_read_b32 v129, a129
    v_accvgpr_read_b32 v130, a130
    v_accvgpr_read_b32 v131, a131
    v_accvgpr_read_b32 v132, a132
    v_accvgpr_read_b32 v133, a133
    v_accvgpr_read_b32 v134, a134
    v_accvgpr_read_b32 v135, a135
    v_accvgpr_read_b32 v136, a136
    v_accvgpr_read_b32 v137, a137
    v_accvgpr_read_b32 v138, a138
    v_accvgpr_read_b32 v139, a139
    v_accvgpr_read_b32 v140, a140
    v_accvgpr_read_b32 v141, a141
    v_accvgpr_read_b32 v142, a142
    v_accvgpr_read_b32 v143, a143
    v_accvgpr_read_b32 v144, a144
    v_accvgpr_read_b32 v145, a145
    v_accvgpr_read_b32 v146, a146
    v_accvgpr_read_b32 v147, a147
    v_accvgpr_read_b32 v148, a148
    v_accvgpr_read_b32 v149, a149
    v_accvgpr_read_b32 v150, a150
    v_accvgpr_read_b32 v151, a151
    v_accvgpr_read_b32 v152, a152
    v_accvgpr_read_b32 v153, a153
    v_accvgpr_read_b32 v154, a154
    v_accvgpr_read_b32 v155, a155
    v_accvgpr_read_b32 v156, a156
    v_accvgpr_read_b32 v157, a157
    v_accvgpr_read_b32 v158, a158
    v_accvgpr_read_b32 v159, a159
    v_accvgpr_read_b32 v160, a160
    v_accvgpr_read_b32 v161, a161
    v_accvgpr_read_b32 v162, a162
    v_accvgpr_read_b32 v163, a163
    v_accvgpr_read_b32 v164, a164
    v_accvgpr_read_b32 v165, a165
    v_accvgpr_read_b32 v166, a166
    v_accvgpr_read_b32 v167, a167
    v_accvgpr_read_b32 v168, a168
    v_accvgpr_read_b32 v169, a169
    v_accvgpr_read_b32 v170, a170
    v_accvgpr_read_b32 v171, a171
    v_accvgpr_read_b32 v172, a172
    v_accvgpr_read_b32 v173, a173
    v_accvgpr_read_b32 v174, a174
    s_add_u32 m0, s42, 17952
    s_mov_b32 s59, 278528
    buffer_load_dwordx4 v199, s[16:19], s59 offen nt lds
    v_accvgpr_read_b32 v175, a175
    v_accvgpr_read_b32 v176, a176
    v_accvgpr_read_b32 v177, a177
    v_accvgpr_read_b32 v178, a178
    v_accvgpr_read_b32 v179, a179
    v_accvgpr_read_b32 v180, a180
    v_accvgpr_read_b32 v181, a181
    v_accvgpr_read_b32 v182, a182
    v_accvgpr_read_b32 v183, a183
    v_accvgpr_read_b32 v184, a184
    v_accvgpr_read_b32 v185, a185
    v_accvgpr_read_b32 v186, a186
    v_accvgpr_read_b32 v187, a187
    v_accvgpr_read_b32 v188, a188
    v_accvgpr_read_b32 v189, a189
    v_accvgpr_read_b32 v190, a190
    v_accvgpr_read_b32 v191, a191
    s_mov_b32 s28, 0
    s_mov_b32 s47, 1
    s_mov_b32 s29, 262144
    s_mov_b32 s31, 1
    s_add_u32 s49, s49, 262144
    s_add_u32 s46, s46, 32768
    s_add_u32 s36, s36, 33792
    s_add_u32 s37, s37, 4294933504
    s_add_u32 s38, s38, 33792
    s_add_u32 s39, s39, 4294933504
    v_accvgpr_write_b32 a128, v48
    v_accvgpr_write_b32 a129, v49
    v_accvgpr_write_b32 a130, v50
    v_accvgpr_write_b32 a131, v51
    v_accvgpr_write_b32 a132, v52
    v_accvgpr_write_b32 a133, v53
    v_accvgpr_write_b32 a134, v54
    v_accvgpr_write_b32 a135, v55
    v_accvgpr_read_b32 v64, a32
    v_accvgpr_read_b32 v65, a33
    v_accvgpr_read_b32 v66, a34
    v_accvgpr_read_b32 v67, a35
    v_accvgpr_read_b32 v68, a48
    v_accvgpr_read_b32 v69, a49
    v_accvgpr_read_b32 v70, a50
    v_accvgpr_read_b32 v71, a51
    v_accvgpr_read_b32 v72, a36
    v_accvgpr_read_b32 v73, a37
    v_accvgpr_read_b32 v74, a38
    v_accvgpr_read_b32 v75, a39
    v_accvgpr_read_b32 v76, a52
    v_accvgpr_read_b32 v77, a53
    v_accvgpr_read_b32 v78, a54
    v_accvgpr_read_b32 v79, a55
    v_pk_mul_f32 v[64:65], v[64:65], v[212:213] op_sel_hi:[1,0]
    v_pk_mul_f32 v[66:67], v[66:67], v[212:213] op_sel_hi:[1,0]
    v_pk_mul_f32 v[68:69], v[68:69], v[212:213] op_sel_hi:[1,0]
    v_pk_mul_f32 v[70:71], v[70:71], v[212:213] op_sel_hi:[1,0]
    v_pk_mul_f32 v[72:73], v[72:73], v[214:215] op_sel_hi:[1,0]
    v_pk_mul_f32 v[74:75], v[74:75], v[214:215] op_sel_hi:[1,0]
    v_pk_mul_f32 v[76:77], v[76:77], v[214:215] op_sel_hi:[1,0]
    v_pk_mul_f32 v[78:79], v[78:79], v[214:215] op_sel_hi:[1,0]
    v_cvt_pk_bf16_f32 v80, v64, v65
    s_add_u32 m0, s41, 42240
    s_mov_b32 s59, 303104
    buffer_load_dwordx4 v198, s[12:15], s59 offen nt lds
    v_cvt_pk_bf16_f32 v81, v66, v67
    v_cvt_pk_bf16_f32 v82, v68, v69
    v_cvt_pk_bf16_f32 v83, v70, v71
    v_cvt_pk_bf16_f32 v84, v72, v73
    v_cvt_pk_bf16_f32 v85, v74, v75
    v_cvt_pk_bf16_f32 v86, v76, v77
    v_cvt_pk_bf16_f32 v87, v78, v79
    v_accvgpr_write_b32 a136, v80
    v_accvgpr_write_b32 a137, v81
    v_accvgpr_write_b32 a138, v82
    v_accvgpr_write_b32 a139, v83
    v_accvgpr_write_b32 a140, v84
    v_accvgpr_write_b32 a141, v85
    v_accvgpr_write_b32 a142, v86
    v_accvgpr_write_b32 a143, v87
    v_accvgpr_read_b32 v32, a8
    v_accvgpr_read_b32 v33, a9
    v_accvgpr_read_b32 v34, a10
    v_accvgpr_read_b32 v35, a11
    v_accvgpr_read_b32 v36, a24
    v_accvgpr_read_b32 v37, a25
    v_accvgpr_read_b32 v38, a26
    v_accvgpr_read_b32 v39, a27
    v_accvgpr_read_b32 v40, a12
    v_accvgpr_read_b32 v41, a13
    v_accvgpr_read_b32 v42, a14
    v_accvgpr_read_b32 v43, a15
    v_accvgpr_read_b32 v44, a28
    v_accvgpr_read_b32 v45, a29
    v_accvgpr_read_b32 v46, a30
    v_accvgpr_read_b32 v47, a31
    v_pk_mul_f32 v[32:33], v[32:33], v[216:217] op_sel_hi:[1,0]
    v_pk_mul_f32 v[34:35], v[34:35], v[216:217] op_sel_hi:[1,0]
    v_pk_mul_f32 v[36:37], v[36:37], v[216:217] op_sel_hi:[1,0]
    v_pk_mul_f32 v[38:39], v[38:39], v[216:217] op_sel_hi:[1,0]
    v_pk_mul_f32 v[40:41], v[40:41], v[218:219] op_sel_hi:[1,0]
    v_pk_mul_f32 v[42:43], v[42:43], v[218:219] op_sel_hi:[1,0]
    v_pk_mul_f32 v[44:45], v[44:45], v[218:219] op_sel_hi:[1,0]
    v_pk_mul_f32 v[46:47], v[46:47], v[218:219] op_sel_hi:[1,0]
    v_cvt_pk_bf16_f32 v48, v32, v33
    v_cvt_pk_bf16_f32 v49, v34, v35
    v_cvt_pk_bf16_f32 v50, v36, v37
    v_cvt_pk_bf16_f32 v51, v38, v39
    v_cvt_pk_bf16_f32 v52, v40, v41
    v_cvt_pk_bf16_f32 v53, v42, v43
    v_cvt_pk_bf16_f32 v54, v44, v45
    v_cvt_pk_bf16_f32 v55, v46, v47
    v_accvgpr_write_b32 a144, v48
    v_accvgpr_write_b32 a145, v49
    v_accvgpr_write_b32 a146, v50
    v_accvgpr_write_b32 a147, v51
    v_accvgpr_write_b32 a148, v52
    v_accvgpr_write_b32 a149, v53
    v_accvgpr_write_b32 a150, v54
    v_accvgpr_write_b32 a151, v55
    v_accvgpr_read_b32 v64, a40
    v_accvgpr_read_b32 v65, a41
    v_accvgpr_read_b32 v66, a42
    v_accvgpr_read_b32 v67, a43
    v_accvgpr_read_b32 v68, a56
    s_add_u32 m0, s41, 43296
    s_mov_b32 s59, 303104
    buffer_load_dwordx4 v199, s[12:15], s59 offen nt lds
    v_accvgpr_read_b32 v69, a57
    v_accvgpr_read_b32 v70, a58
    v_accvgpr_read_b32 v71, a59
    v_accvgpr_read_b32 v72, a44
    v_accvgpr_read_b32 v73, a45
    v_accvgpr_read_b32 v74, a46
    v_accvgpr_read_b32 v75, a47
    v_accvgpr_read_b32 v76, a60
    v_accvgpr_read_b32 v77, a61
    v_accvgpr_read_b32 v78, a62
    v_accvgpr_read_b32 v79, a63
    v_pk_mul_f32 v[64:65], v[64:65], v[216:217] op_sel_hi:[1,0]
    v_pk_mul_f32 v[66:67], v[66:67], v[216:217] op_sel_hi:[1,0]
    v_pk_mul_f32 v[68:69], v[68:69], v[216:217] op_sel_hi:[1,0]
    v_pk_mul_f32 v[70:71], v[70:71], v[216:217] op_sel_hi:[1,0]
    v_pk_mul_f32 v[72:73], v[72:73], v[218:219] op_sel_hi:[1,0]
    v_pk_mul_f32 v[74:75], v[74:75], v[218:219] op_sel_hi:[1,0]
    v_pk_mul_f32 v[76:77], v[76:77], v[218:219] op_sel_hi:[1,0]
    v_pk_mul_f32 v[78:79], v[78:79], v[218:219] op_sel_hi:[1,0]
    v_cvt_pk_bf16_f32 v80, v64, v65
    v_cvt_pk_bf16_f32 v81, v66, v67
    v_cvt_pk_bf16_f32 v82, v68, v69
    v_cvt_pk_bf16_f32 v83, v70, v71
    v_cvt_pk_bf16_f32 v84, v72, v73
    v_cvt_pk_bf16_f32 v85, v74, v75
    v_cvt_pk_bf16_f32 v86, v76, v77
    v_cvt_pk_bf16_f32 v87, v78, v79
    v_accvgpr_write_b32 a152, v80
    v_accvgpr_write_b32 a153, v81
    v_accvgpr_write_b32 a154, v82
    v_accvgpr_write_b32 a155, v83
    v_accvgpr_write_b32 a156, v84
    v_accvgpr_write_b32 a157, v85
    v_accvgpr_write_b32 a158, v86
    v_accvgpr_write_b32 a159, v87
    v_accvgpr_read_b32 v32, a64
    v_accvgpr_read_b32 v33, a65
    v_accvgpr_read_b32 v34, a66
    v_accvgpr_read_b32 v35, a67
    v_accvgpr_read_b32 v36, a80
    v_accvgpr_read_b32 v37, a81
    v_accvgpr_read_b32 v38, a82
    v_accvgpr_read_b32 v39, a83
    v_accvgpr_read_b32 v40, a68
    v_accvgpr_read_b32 v41, a69
    v_accvgpr_read_b32 v42, a70
    v_accvgpr_read_b32 v43, a71
    v_accvgpr_read_b32 v44, a84
    v_accvgpr_read_b32 v45, a85
    v_accvgpr_read_b32 v46, a86
    v_accvgpr_read_b32 v47, a87
    v_pk_mul_f32 v[32:33], v[32:33], v[212:213] op_sel_hi:[1,0]
    v_pk_mul_f32 v[34:35], v[34:35], v[212:213] op_sel_hi:[1,0]
    v_pk_mul_f32 v[36:37], v[36:37], v[212:213] op_sel_hi:[1,0]
    v_pk_mul_f32 v[38:39], v[38:39], v[212:213] op_sel_hi:[1,0]
    v_pk_mul_f32 v[40:41], v[40:41], v[214:215] op_sel_hi:[1,0]
    v_pk_mul_f32 v[42:43], v[42:43], v[214:215] op_sel_hi:[1,0]
    v_pk_mul_f32 v[44:45], v[44:45], v[214:215] op_sel_hi:[1,0]
    v_pk_mul_f32 v[46:47], v[46:47], v[214:215] op_sel_hi:[1,0]
    v_cvt_pk_bf16_f32 v48, v32, v33
    s_add_u32 m0, s42, 25344
    s_mov_b32 s59, 286720
    buffer_load_dwordx4 v198, s[16:19], s59 offen nt lds
    v_cvt_pk_bf16_f32 v49, v34, v35
    v_cvt_pk_bf16_f32 v50, v36, v37
    v_cvt_pk_bf16_f32 v51, v38, v39
    v_cvt_pk_bf16_f32 v52, v40, v41
    v_cvt_pk_bf16_f32 v53, v42, v43
    v_cvt_pk_bf16_f32 v54, v44, v45
    v_cvt_pk_bf16_f32 v55, v46, v47
    v_accvgpr_write_b32 a160, v48
    v_accvgpr_write_b32 a161, v49
    v_accvgpr_write_b32 a162, v50
    v_accvgpr_write_b32 a163, v51
    v_accvgpr_write_b32 a164, v52
    v_accvgpr_write_b32 a165, v53
    v_accvgpr_write_b32 a166, v54
    v_accvgpr_write_b32 a167, v55
    v_accvgpr_read_b32 v64, a96
    v_accvgpr_read_b32 v65, a97
    v_accvgpr_read_b32 v66, a98
    v_accvgpr_read_b32 v67, a99
    v_accvgpr_read_b32 v68, a112
    v_accvgpr_read_b32 v69, a113
    v_accvgpr_read_b32 v70, a114
    v_accvgpr_read_b32 v71, a115
    v_accvgpr_read_b32 v72, a100
    v_accvgpr_read_b32 v73, a101
    v_accvgpr_read_b32 v74, a102
    v_accvgpr_read_b32 v75, a103
    v_accvgpr_read_b32 v76, a116
    v_accvgpr_read_b32 v77, a117
    v_accvgpr_read_b32 v78, a118
    v_accvgpr_read_b32 v79, a119
    v_pk_mul_f32 v[64:65], v[64:65], v[212:213] op_sel_hi:[1,0]
    v_pk_mul_f32 v[66:67], v[66:67], v[212:213] op_sel_hi:[1,0]
    v_pk_mul_f32 v[68:69], v[68:69], v[212:213] op_sel_hi:[1,0]
    v_pk_mul_f32 v[70:71], v[70:71], v[212:213] op_sel_hi:[1,0]
    v_pk_mul_f32 v[72:73], v[72:73], v[214:215] op_sel_hi:[1,0]
    v_pk_mul_f32 v[74:75], v[74:75], v[214:215] op_sel_hi:[1,0]
    v_pk_mul_f32 v[76:77], v[76:77], v[214:215] op_sel_hi:[1,0]
    v_pk_mul_f32 v[78:79], v[78:79], v[214:215] op_sel_hi:[1,0]
    s_waitcnt lgkmcnt(7)
    v_mfma_f32_16x16x32_bf16 v[0:3], a[192:195], v[128:131], 0
    v_cvt_pk_bf16_f32 v80, v64, v65
    v_cvt_pk_bf16_f32 v81, v66, v67
    v_cvt_pk_bf16_f32 v82, v68, v69
    v_cvt_pk_bf16_f32 v83, v70, v71
    v_mfma_f32_16x16x32_bf16 v[4:7], a[192:195], v[144:147], 0
    v_cvt_pk_bf16_f32 v84, v72, v73
    v_cvt_pk_bf16_f32 v85, v74, v75
    v_cvt_pk_bf16_f32 v86, v76, v77
    v_mfma_f32_16x16x32_bf16 v[8:11], a[192:195], v[160:163], 0
    v_cvt_pk_bf16_f32 v87, v78, v79
    v_accvgpr_write_b32 a168, v80
    v_accvgpr_write_b32 a169, v81
    v_mfma_f32_16x16x32_bf16 v[12:15], a[192:195], v[176:179], 0
    v_accvgpr_write_b32 a170, v82
    s_add_u32 m0, s42, 26400
    s_mov_b32 s59, 286720
    buffer_load_dwordx4 v199, s[16:19], s59 offen nt lds
    v_accvgpr_write_b32 a171, v83
    s_waitcnt lgkmcnt(6)
    v_mfma_f32_16x16x32_bf16 v[16:19], a[196:199], v[128:131], 0
    v_accvgpr_write_b32 a172, v84
    v_accvgpr_write_b32 a173, v85
    v_accvgpr_write_b32 a174, v86
    v_mfma_f32_16x16x32_bf16 v[20:23], a[196:199], v[144:147], 0
    v_accvgpr_write_b32 a175, v87
    v_accvgpr_read_b32 v32, a72
    v_accvgpr_read_b32 v33, a73
    v_mfma_f32_16x16x32_bf16 v[24:27], a[196:199], v[160:163], 0
    v_accvgpr_read_b32 v34, a74
    v_accvgpr_read_b32 v35, a75
    v_accvgpr_read_b32 v36, a88
    v_mfma_f32_16x16x32_bf16 v[28:31], a[196:199], v[176:179], 0
    v_accvgpr_read_b32 v37, a89
    v_accvgpr_read_b32 v38, a90
    v_accvgpr_read_b32 v39, a91
    s_waitcnt lgkmcnt(5)
    v_mfma_f32_16x16x32_bf16 v[0:3], a[200:203], v[132:135], v[0:3]
    v_accvgpr_read_b32 v40, a76
    v_accvgpr_read_b32 v41, a77
    v_accvgpr_read_b32 v42, a78
    v_mfma_f32_16x16x32_bf16 v[4:7], a[200:203], v[148:151], v[4:7]
    v_accvgpr_read_b32 v43, a79
    v_accvgpr_read_b32 v44, a92
    v_accvgpr_read_b32 v45, a93
    v_mfma_f32_16x16x32_bf16 v[8:11], a[200:203], v[164:167], v[8:11]
    v_accvgpr_read_b32 v46, a94
    v_accvgpr_read_b32 v47, a95
    v_pk_mul_f32 v[32:33], v[32:33], v[216:217] op_sel_hi:[1,0]
    v_mfma_f32_16x16x32_bf16 v[12:15], a[200:203], v[180:183], v[12:15]
    v_pk_mul_f32 v[34:35], v[34:35], v[216:217] op_sel_hi:[1,0]
    v_pk_mul_f32 v[36:37], v[36:37], v[216:217] op_sel_hi:[1,0]
    v_pk_mul_f32 v[38:39], v[38:39], v[216:217] op_sel_hi:[1,0]
    s_waitcnt lgkmcnt(4)
    v_mfma_f32_16x16x32_bf16 v[16:19], a[204:207], v[132:135], v[16:19]
    v_pk_mul_f32 v[40:41], v[40:41], v[218:219] op_sel_hi:[1,0]
    v_pk_mul_f32 v[42:43], v[42:43], v[218:219] op_sel_hi:[1,0]
    v_pk_mul_f32 v[44:45], v[44:45], v[218:219] op_sel_hi:[1,0]
    v_mfma_f32_16x16x32_bf16 v[20:23], a[204:207], v[148:151], v[20:23]
    v_pk_mul_f32 v[46:47], v[46:47], v[218:219] op_sel_hi:[1,0]
    v_cvt_pk_bf16_f32 v48, v32, v33
    v_cvt_pk_bf16_f32 v49, v34, v35
    v_mfma_f32_16x16x32_bf16 v[24:27], a[204:207], v[164:167], v[24:27]
    v_cvt_pk_bf16_f32 v50, v36, v37
    v_cvt_pk_bf16_f32 v51, v38, v39
    v_cvt_pk_bf16_f32 v52, v40, v41
    v_mfma_f32_16x16x32_bf16 v[28:31], a[204:207], v[180:183], v[28:31]
    v_cvt_pk_bf16_f32 v53, v42, v43
    v_cvt_pk_bf16_f32 v54, v44, v45
    v_cvt_pk_bf16_f32 v55, v46, v47
    s_waitcnt lgkmcnt(3)
    v_mfma_f32_16x16x32_bf16 v[0:3], a[208:211], v[136:139], v[0:3]
    v_accvgpr_write_b32 a176, v48
    v_accvgpr_write_b32 a177, v49
    v_accvgpr_write_b32 a178, v50
    v_accvgpr_write_b32 a179, v51
    v_mfma_f32_16x16x32_bf16 v[4:7], a[208:211], v[152:155], v[4:7]
    ds_read_b128 a[192:195], v196 offset:8448
    v_accvgpr_write_b32 a180, v52
    v_accvgpr_write_b32 a181, v53
    v_accvgpr_write_b32 a182, v54
    v_mfma_f32_16x16x32_bf16 v[8:11], a[208:211], v[168:171], v[8:11]
    v_accvgpr_write_b32 a183, v55
    v_accvgpr_read_b32 v64, a104
    v_accvgpr_read_b32 v65, a105
    v_mfma_f32_16x16x32_bf16 v[12:15], a[208:211], v[184:187], v[12:15]
    v_accvgpr_read_b32 v66, a106
    v_accvgpr_read_b32 v67, a107
    v_accvgpr_read_b32 v68, a120
    s_waitcnt lgkmcnt(3)
    v_mfma_f32_16x16x32_bf16 v[16:19], a[212:215], v[136:139], v[16:19]
    s_add_u32 m0, s41, 50688
    s_mov_b32 s59, 311296
    buffer_load_dwordx4 v198, s[12:15], s59 offen nt lds
    v_accvgpr_read_b32 v69, a121
    v_accvgpr_read_b32 v70, a122
    v_mfma_f32_16x16x32_bf16 v[20:23], a[212:215], v[152:155], v[20:23]
    ds_read_b128 a[196:199], v196 offset:8960
    v_accvgpr_read_b32 v71, a123
    v_accvgpr_read_b32 v72, a108
    v_accvgpr_read_b32 v73, a109
    v_mfma_f32_16x16x32_bf16 v[24:27], a[212:215], v[168:171], v[24:27]
    v_accvgpr_read_b32 v74, a110
    v_accvgpr_read_b32 v75, a111
    v_accvgpr_read_b32 v76, a124
    v_mfma_f32_16x16x32_bf16 v[28:31], a[212:215], v[184:187], v[28:31]
    v_accvgpr_read_b32 v77, a125
    v_accvgpr_read_b32 v78, a126
    v_accvgpr_read_b32 v79, a127
    s_waitcnt lgkmcnt(3)
    v_mfma_f32_16x16x32_bf16 v[0:3], a[216:219], v[140:143], v[0:3]
    v_pk_mul_f32 v[64:65], v[64:65], v[216:217] op_sel_hi:[1,0]
    v_pk_mul_f32 v[66:67], v[66:67], v[216:217] op_sel_hi:[1,0]
    v_pk_mul_f32 v[68:69], v[68:69], v[216:217] op_sel_hi:[1,0]
    v_mfma_f32_16x16x32_bf16 v[4:7], a[216:219], v[156:159], v[4:7]
    ds_read_b128 a[200:203], v196 offset:8512
    v_pk_mul_f32 v[70:71], v[70:71], v[216:217] op_sel_hi:[1,0]
    v_pk_mul_f32 v[72:73], v[72:73], v[218:219] op_sel_hi:[1,0]
    v_pk_mul_f32 v[74:75], v[74:75], v[218:219] op_sel_hi:[1,0]
    v_mfma_f32_16x16x32_bf16 v[8:11], a[216:219], v[172:175], v[8:11]
    v_pk_mul_f32 v[76:77], v[76:77], v[218:219] op_sel_hi:[1,0]
    v_pk_mul_f32 v[78:79], v[78:79], v[218:219] op_sel_hi:[1,0]
    v_cvt_pk_bf16_f32 v80, v64, v65
    v_mfma_f32_16x16x32_bf16 v[12:15], a[216:219], v[188:191], v[12:15]
    v_cvt_pk_bf16_f32 v81, v66, v67
    v_cvt_pk_bf16_f32 v82, v68, v69
    v_cvt_pk_bf16_f32 v83, v70, v71
    s_waitcnt lgkmcnt(3)
    v_mfma_f32_16x16x32_bf16 v[16:19], a[220:223], v[140:143], v[16:19]
    v_cvt_pk_bf16_f32 v84, v72, v73
    v_cvt_pk_bf16_f32 v85, v74, v75
    v_cvt_pk_bf16_f32 v86, v76, v77
    v_mfma_f32_16x16x32_bf16 v[20:23], a[220:223], v[156:159], v[20:23]
    ds_read_b128 a[204:207], v196 offset:9024
    v_cvt_pk_bf16_f32 v87, v78, v79
    v_accvgpr_write_b32 a184, v80
    v_accvgpr_write_b32 a185, v81
    v_mfma_f32_16x16x32_bf16 v[24:27], a[220:223], v[172:175], v[24:27]
    v_accvgpr_write_b32 a186, v82
    v_accvgpr_write_b32 a187, v83
    v_accvgpr_write_b32 a188, v84
    v_mfma_f32_16x16x32_bf16 v[28:31], a[220:223], v[188:191], v[28:31]
    v_accvgpr_write_b32 a189, v85
    v_accvgpr_write_b32 a190, v86
    v_accvgpr_write_b32 a191, v87
    s_nop 4
    s_getpc_b64 s[56:57]
K1_PF2:
    v_lshlrev_b32 v220, 7, v204
    v_add_u32 v220, s44, v220
    v_add_u32 v220, K1_TAIL-K1_PF2, v220
    v_min_u32 v220, K1_END-K1_PF2, v220
    global_load_dword v208, v220, s[56:57]
    s_add_u32 m0, s41, 51744
    s_mov_b32 s59, 311296
    buffer_load_dwordx4 v199, s[12:15], s59 offen nt lds
    v_max3_f32 v212, v0, v1, v248
    v_max3_f32 v212, v212, v2, v3
    v_max3_f32 v212, v212, v16, v17
    v_max3_f32 v212, v212, v18, v19
    v_max3_f32 v213, v4, v5, v249
    v_max3_f32 v213, v213, v6, v7
    v_max3_f32 v213, v213, v20, v21
    v_max3_f32 v213, v213, v22, v23
    v_max3_f32 v214, v8, v9, v250
    v_max3_f32 v214, v214, v10, v11
    v_max3_f32 v214, v214, v24, v25
    v_max3_f32 v214, v214, v26, v27
    v_max3_f32 v215, v12, v13, v251
    v_max3_f32 v215, v215, v14, v15
    v_max3_f32 v215, v215, v28, v29
    v_max3_f32 v215, v215, v30, v31
    v_mov_b32 v216, v212
    v_mov_b32 v217, v213
    v_mov_b32 v218, v214
    v_mov_b32 v219, v215
    v_permlane16_swap_b32 v212, v216
    v_permlane16_swap_b32 v213, v217
    v_permlane16_swap_b32 v214, v218
    v_permlane16_swap_b32 v215, v219
    v_max_f32 v212, v212, v216
    v_max_f32 v213, v213, v217
    v_max_f32 v214, v214, v218
    v_max_f32 v215, v215, v219
    v_mov_b32 v216, v212
    v_mov_b32 v217, v213
    v_mov_b32 v218, v214
    v_mov_b32 v219, v215
    v_permlane32_swap_b32 v212, v216
    v_permlane32_swap_b32 v213, v217
    v_permlane32_swap_b32 v214, v218
    v_permlane32_swap_b32 v215, v219
    v_max_f32 v212, v212, v216
    v_max_f32 v213, v213, v217
    v_max_f32 v214, v214, v218
    v_max_f32 v215, v215, v219
    v_sub_f32 v212, 0, v212
    v_sub_f32 v213, 0, v213
    v_sub_f32 v214, 0, v214
    v_sub_f32 v215, 0, v215
    v_mov_b32 v96, v212
    v_mov_b32 v97, v212
    v_mov_b32 v98, v212
    v_mov_b32 v99, v212
    v_mov_b32 v100, v213
    v_mov_b32 v101, v213
    v_mov_b32 v102, v213
    v_mov_b32 v103, v213
    v_mov_b32 v104, v214
    v_mov_b32 v105, v214
    v_mov_b32 v106, v214
    v_mov_b32 v107, v214
    v_mov_b32 v108, v215
    v_mov_b32 v109, v215
    v_mov_b32 v110, v215
    v_mov_b32 v111, v215
    s_add_u32 m0, s42, 33792
    s_mov_b32 s59, 294912
    buffer_load_dwordx4 v198, s[16:19], s59 offen nt lds
    v_add_f32 v0, v0, v212
    v_add_f32 v1, v1, v212
    v_add_f32 v2, v2, v212
    v_add_f32 v3, v3, v212
    v_add_f32 v16, v16, v212
    v_add_f32 v17, v17, v212
    v_add_f32 v18, v18, v212
    v_add_f32 v19, v19, v212
    v_add_f32 v4, v4, v213
    v_add_f32 v5, v5, v213
    v_add_f32 v6, v6, v213
    v_add_f32 v7, v7, v213
    v_add_f32 v20, v20, v213
    v_add_f32 v21, v21, v213
    v_add_f32 v22, v22, v213
    v_add_f32 v23, v23, v213
    v_add_f32 v8, v8, v214
    v_add_f32 v9, v9, v214
    v_add_f32 v10, v10, v214
    v_add_f32 v11, v11, v214
    v_add_f32 v24, v24, v214
    v_add_f32 v25, v25, v214
    v_add_f32 v26, v26, v214
    v_add_f32 v27, v27, v214
    v_add_f32 v12, v12, v215
    v_add_f32 v13, v13, v215
    v_add_f32 v14, v14, v215
    v_add_f32 v15, v15, v215
    v_add_f32 v28, v28, v215
    v_add_f32 v29, v29, v215
    v_add_f32 v30, v30, v215
    v_add_f32 v31, v31, v215
    s_waitcnt lgkmcnt(2)
    v_mfma_f32_16x16x32_bf16 v[32:35], a[192:195], v[128:131], v[96:99]
    v_exp_f32 v0, v0
    ds_read_b128 a[208:211], v196 offset:8576
    s_add_u32 m0, s42, 34848
    s_mov_b32 s59, 294912
    buffer_load_dwordx4 v199, s[16:19], s59 offen nt lds
    v_mfma_f32_16x16x32_bf16 v[36:39], a[192:195], v[144:147], v[100:103]
    v_exp_f32 v1, v1
    v_mfma_f32_16x16x32_bf16 v[40:43], a[192:195], v[160:163], v[104:107]
    v_exp_f32 v2, v2
    v_cvt_pk_bf16_f32 v64, v0, v1
    v_mfma_f32_16x16x32_bf16 v[44:47], a[192:195], v[176:179], v[108:111]
    v_exp_f32 v3, v3
    v_mfma_f32_16x16x32_bf16 v[48:51], a[196:199], v[128:131], v[96:99]
    v_exp_f32 v16, v16
    ds_read_b128 a[212:215], v196 offset:9088
    v_cvt_pk_bf16_f32 v65, v2, v3
    v_mfma_f32_16x16x32_bf16 v[52:55], a[196:199], v[144:147], v[100:103]
    v_exp_f32 v17, v17
    s_add_u32 m0, s41, 59136
    s_mov_b32 s59, 319488
    buffer_load_dwordx4 v198, s[12:15], s59 offen nt lds
    v_mfma_f32_16x16x32_bf16 v[56:59], a[196:199], v[160:163], v[104:107]
    v_exp_f32 v18, v18
    v_cvt_pk_bf16_f32 v66, v16, v17
    v_mfma_f32_16x16x32_bf16 v[60:63], a[196:199], v[176:179], v[108:111]
    v_exp_f32 v19, v19
    s_waitcnt lgkmcnt(2)
    v_mfma_f32_16x16x32_bf16 v[32:35], a[200:203], v[132:135], v[32:35]
    v_exp_f32 v4, v4
    ds_read_b128 a[216:219], v196 offset:8640
    v_cvt_pk_bf16_f32 v67, v18, v19
    v_mfma_f32_16x16x32_bf16 v[36:39], a[200:203], v[148:151], v[36:39]
    v_exp_f32 v5, v5
    v_mfma_f32_16x16x32_bf16 v[40:43], a[200:203], v[164:167], v[40:43]
    v_exp_f32 v6, v6
    v_cvt_pk_bf16_f32 v68, v4, v5
    s_add_u32 m0, s41, 60192
    s_mov_b32 s59, 319488
    buffer_load_dwordx4 v199, s[12:15], s59 offen nt lds
    v_mfma_f32_16x16x32_bf16 v[44:47], a[200:203], v[180:183], v[44:47]
    v_exp_f32 v7, v7
    v_mfma_f32_16x16x32_bf16 v[48:51], a[204:207], v[132:135], v[48:51]
    v_exp_f32 v20, v20
    ds_read_b128 a[220:223], v196 offset:9152
    v_cvt_pk_bf16_f32 v69, v6, v7
    v_mfma_f32_16x16x32_bf16 v[52:55], a[204:207], v[148:151], v[52:55]
    v_exp_f32 v21, v21
    v_mfma_f32_16x16x32_bf16 v[56:59], a[204:207], v[164:167], v[56:59]
    v_exp_f32 v22, v22
    v_cvt_pk_bf16_f32 v70, v20, v21
    v_mfma_f32_16x16x32_bf16 v[60:63], a[204:207], v[180:183], v[60:63]
    v_exp_f32 v23, v23
    s_add_u32 m0, s42, 42240
    s_mov_b32 s59, 303104
    buffer_load_dwordx4 v198, s[16:19], s59 offen nt lds
    s_waitcnt vmcnt(20) lgkmcnt(2)
    s_barrier
    v_mfma_f32_16x16x32_bf16 v[32:35], a[208:211], v[136:139], v[32:35]
    v_exp_f32 v8, v8
    ds_read_b128 a[192:195], v196 offset:16896
    v_cvt_pk_bf16_f32 v71, v22, v23
    s_add_u32 s53, s49, 4294705152
    buffer_store_dwordx4 a[128:131], v205, s[20:23], s53 offen offset:0 sc1
    v_mfma_f32_16x16x32_bf16 v[36:39], a[208:211], v[152:155], v[36:39]
    v_exp_f32 v9, v9
    ds_read_b64_tr_b16 a[224:225], v197 offset:0
    buffer_store_dwordx4 a[132:135], v205, s[20:23], s53 offen offset:1024 sc1
    v_mfma_f32_16x16x32_bf16 v[40:43], a[208:211], v[168:171], v[40:43]
    v_exp_f32 v10, v10
    v_cvt_pk_bf16_f32 v72, v8, v9
    ds_read_b64_tr_b16 a[226:227], v197 offset:512
    s_add_u32 m0, s41, 0
    v_mfma_f32_16x16x32_bf16 v[44:47], a[208:211], v[184:187], v[44:47]
    v_exp_f32 v11, v11
    buffer_load_dwordx4 v200, s[12:15], s46 offen nt lds
    v_mfma_f32_16x16x32_bf16 v[48:51], a[212:215], v[136:139], v[48:51]
    v_exp_f32 v24, v24
    ds_read_b128 a[196:199], v196 offset:17408
    v_cvt_pk_bf16_f32 v73, v10, v11
    v_mfma_f32_16x16x32_bf16 v[52:55], a[212:215], v[152:155], v[52:55]
    v_exp_f32 v25, v25
    ds_read_b64_tr_b16 a[228:229], v197 offset:32
    v_mfma_f32_16x16x32_bf16 v[56:59], a[212:215], v[168:171], v[56:59]
    v_exp_f32 v26, v26
    v_cvt_pk_bf16_f32 v74, v24, v25
    ds_read_b64_tr_b16 a[230:231], v197 offset:544
    v_mfma_f32_16x16x32_bf16 v[60:63], a[212:215], v[184:187], v[60:63]
    v_exp_f32 v27, v27
    s_waitcnt lgkmcnt(6)
    v_mfma_f32_16x16x32_bf16 v[32:35], a[216:219], v[140:143], v[32:35]
    v_exp_f32 v12, v12
    ds_read_b128 a[200:203], v196 offset:16960
    v_cvt_pk_bf16_f32 v75, v26, v27
    v_mfma_f32_16x16x32_bf16 v[36:39], a[216:219], v[156:159], v[36:39]
    v_exp_f32 v13, v13
    ds_read_b64_tr_b16 a[232:233], v197 offset:64
    v_mfma_f32_16x16x32_bf16 v[40:43], a[216:219], v[172:175], v[40:43]
    v_exp_f32 v14, v14
    v_cvt_pk_bf16_f32 v76, v12, v13
    ds_read_b64_tr_b16 a[234:235], v197 offset:576
    v_mfma_f32_16x16x32_bf16 v[44:47], a[216:219], v[188:191], v[44:47]
    v_exp_f32 v15, v15
    buffer_load_dwordx4 v201, s[12:15], s46 offen offset:1056 nt lds
    v_mfma_f32_16x16x32_bf16 v[48:51], a[220:223], v[140:143], v[48:51]
    v_exp_f32 v28, v28
    ds_read_b128 a[204:207], v196 offset:17472
    v_cvt_pk_bf16_f32 v77, v14, v15
    s_add_u32 m0, s42, 43296
    s_mov_b32 s59, 303104
    buffer_load_dwordx4 v199, s[16:19], s59 offen nt lds
    v_mfma_f32_16x16x32_bf16 v[52:55], a[220:223], v[156:159], v[52:55]
    v_exp_f32 v29, v29
    ds_read_b64_tr_b16 a[236:237], v197 offset:96
    v_mfma_f32_16x16x32_bf16 v[56:59], a[220:223], v[172:175], v[56:59]
    v_exp_f32 v30, v30
    v_cvt_pk_bf16_f32 v78, v28, v29
    ds_read_b64_tr_b16 a[238:239], v197 offset:608
    v_mfma_f32_16x16x32_bf16 v[60:63], a[220:223], v[188:191], v[60:63]
    v_exp_f32 v31, v31
    s_waitcnt lgkmcnt(6)
    v_mfma_f32_16x16x32_bf16 v[0:3], a[192:195], v[128:131], v[96:99]
    v_exp_f32 v32, v32
    v_mfma_f32_16x16x32_bf16 v[4:7], a[192:195], v[144:147], v[100:103]
    ds_read_b128 a[208:211], v196 offset:17024
    v_cvt_pk_bf16_f32 v79, v30, v31
    v_mfma_f32_16x16x32_bf16 v[8:11], a[192:195], v[160:163], v[104:107]
    v_exp_f32 v33, v33
    v_mfma_f32_16x16x32_bf16 v[12:15], a[192:195], v[176:179], v[108:111]
    ds_read_b64_tr_b16 a[240:241], v197 offset:128
    v_cvt_pk_bf16_f32 v80, v32, v33
    v_mfma_f32_16x16x32_bf16 a[0:3], a[224:227], v[64:67], 0
    v_exp_f32 v34, v34
    v_mfma_f32_16x16x32_bf16 a[4:7], a[224:227], v[68:71], 0
    ds_read_b64_tr_b16 a[242:243], v197 offset:640
    s_add_u32 m0, s42, 50688
    v_mfma_f32_16x16x32_bf16 a[8:11], a[224:227], v[72:75], 0
    v_exp_f32 v35, v35
    v_mfma_f32_16x16x32_bf16 a[12:15], a[224:227], v[76:79], 0
    buffer_load_dwordx4 v202, s[16:19], s46 offen nt lds
    v_mfma_f32_16x16x32_bf16 v[16:19], a[196:199], v[128:131], v[96:99]
    v_exp_f32 v48, v48
    v_mfma_f32_16x16x32_bf16 v[20:23], a[196:199], v[144:147], v[100:103]
    ds_read_b128 a[212:215], v196 offset:17536
    v_cvt_pk_bf16_f32 v81, v34, v35
    v_mfma_f32_16x16x32_bf16 v[24:27], a[196:199], v[160:163], v[104:107]
    v_exp_f32 v49, v49
    v_mfma_f32_16x16x32_bf16 v[28:31], a[196:199], v[176:179], v[108:111]
    ds_read_b64_tr_b16 a[244:245], v197 offset:160
    v_cvt_pk_bf16_f32 v82, v48, v49
    v_mfma_f32_16x16x32_bf16 a[16:19], a[228:231], v[64:67], 0
    v_exp_f32 v50, v50
    v_mfma_f32_16x16x32_bf16 a[20:23], a[228:231], v[68:71], 0
    ds_read_b64_tr_b16 a[246:247], v197 offset:672
    v_mfma_f32_16x16x32_bf16 a[24:27], a[228:231], v[72:75], 0
    v_exp_f32 v51, v51
    v_mfma_f32_16x16x32_bf16 a[28:31], a[228:231], v[76:79], 0
    v_mfma_f32_16x16x32_bf16 v[112:115], v[192:195], v[64:67], 0
    s_waitcnt lgkmcnt(6)
    v_mfma_f32_16x16x32_bf16 v[0:3], a[200:203], v[132:135], v[0:3]
    v_exp_f32 v36, v36
    v_mfma_f32_16x16x32_bf16 v[4:7], a[200:203], v[148:151], v[4:7]
    ds_read_b128 a[216:219], v196 offset:17088
    v_cvt_pk_bf16_f32 v83, v50, v51
    v_mfma_f32_16x16x32_bf16 v[8:11], a[200:203], v[164:167], v[8:11]
    v_exp_f32 v37, v37
    v_mfma_f32_16x16x32_bf16 v[12:15], a[200:203], v[180:183], v[12:15]
    ds_read_b64_tr_b16 a[248:249], v197 offset:192
    v_cvt_pk_bf16_f32 v84, v36, v37
    v_mfma_f32_16x16x32_bf16 a[32:35], a[232:235], v[64:67], 0
    v_exp_f32 v38, v38
    v_mfma_f32_16x16x32_bf16 a[36:39], a[232:235], v[68:71], 0
    ds_read_b64_tr_b16 a[250:251], v197 offset:704
    v_mfma_f32_16x16x32_bf16 a[40:43], a[232:235], v[72:75], 0
    v_exp_f32 v39, v39
    v_mfma_f32_16x16x32_bf16 a[44:47], a[232:235], v[76:79], 0
    buffer_load_dwordx4 v203, s[16:19], s46 offen offset:1056 nt lds
    v_mfma_f32_16x16x32_bf16 v[16:19], a[204:207], v[132:135], v[16:19]
    v_exp_f32 v52, v52
    v_mfma_f32_16x16x32_bf16 v[20:23], a[204:207], v[148:151], v[20:23]
    ds_read_b128 a[220:223], v196 offset:17600
    v_cvt_pk_bf16_f32 v85, v38, v39
    v_mfma_f32_16x16x32_bf16 v[24:27], a[204:207], v[164:167], v[24:27]
    v_exp_f32 v53, v53
    v_mfma_f32_16x16x32_bf16 v[28:31], a[204:207], v[180:183], v[28:31]
    ds_read_b64_tr_b16 a[252:253], v197 offset:224
    v_cvt_pk_bf16_f32 v86, v52, v53
    v_mfma_f32_16x16x32_bf16 a[48:51], a[236:239], v[64:67], 0
    v_exp_f32 v54, v54
    v_mfma_f32_16x16x32_bf16 a[52:55], a[236:239], v[68:71], 0
    ds_read_b64_tr_b16 a[254:255], v197 offset:736
    s_add_u32 s46, s46, 8192
    v_mfma_f32_16x16x32_bf16 a[56:59], a[236:239], v[72:75], 0
    v_exp_f32 v55, v55
    v_mfma_f32_16x16x32_bf16 a[60:63], a[236:239], v[76:79], 0
    v_mfma_f32_16x16x32_bf16 v[116:119], v[192:195], v[68:71], 0
    s_waitcnt vmcnt(23) lgkmcnt(6)
    s_barrier
    v_mfma_f32_16x16x32_bf16 v[0:3], a[208:211], v[136:139], v[0:3]
    v_exp_f32 v40, v40
    v_mfma_f32_16x16x32_bf16 v[4:7], a[208:211], v[152:155], v[4:7]
    ds_read_b128 a[192:195], v196 offset:25344
    v_cvt_pk_bf16_f32 v87, v54, v55
    buffer_store_dwordx4 a[136:139], v205, s[20:23], s53 offen offset:2048 sc1
    v_mfma_f32_16x16x32_bf16 v[8:11], a[208:211], v[168:171], v[8:11]
    v_exp_f32 v41, v41
    v_mfma_f32_16x16x32_bf16 v[12:15], a[208:211], v[184:187], v[12:15]
    ds_read_b64_tr_b16 a[224:225], v197 offset:8448
    v_cvt_pk_bf16_f32 v88, v40, v41
    buffer_store_dwordx4 a[140:143], v205, s[20:23], s53 offen offset:3072 sc1
    v_mfma_f32_16x16x32_bf16 a[64:67], a[240:243], v[64:67], 0
    v_exp_f32 v42, v42
    v_mfma_f32_16x16x32_bf16 a[68:71], a[240:243], v[68:71], 0
    ds_read_b64_tr_b16 a[226:227], v197 offset:8960
    s_add_u32 m0, s41, 8448
    v_mfma_f32_16x16x32_bf16 a[72:75], a[240:243], v[72:75], 0
    v_exp_f32 v43, v43
    v_mfma_f32_16x16x32_bf16 a[76:79], a[240:243], v[76:79], 0
    buffer_load_dwordx4 v200, s[12:15], s46 offen nt lds
    v_mfma_f32_16x16x32_bf16 v[16:19], a[212:215], v[136:139], v[16:19]
    v_exp_f32 v56, v56
    v_mfma_f32_16x16x32_bf16 v[20:23], a[212:215], v[152:155], v[20:23]
    ds_read_b128 a[196:199], v196 offset:25856
    v_cvt_pk_bf16_f32 v89, v42, v43
    v_mfma_f32_16x16x32_bf16 v[24:27], a[212:215], v[168:171], v[24:27]
    v_exp_f32 v57, v57
    v_mfma_f32_16x16x32_bf16 v[28:31], a[212:215], v[184:187], v[28:31]
    ds_read_b64_tr_b16 a[228:229], v197 offset:8480
    v_cvt_pk_bf16_f32 v90, v56, v57
    v_mfma_f32_16x16x32_bf16 a[80:83], a[244:247], v[64:67], 0
    v_exp_f32 v58, v58
    v_mfma_f32_16x16x32_bf16 a[84:87], a[244:247], v[68:71], 0
    ds_read_b64_tr_b16 a[230:231], v197 offset:8992
    v_mfma_f32_16x16x32_bf16 a[88:91], a[244:247], v[72:75], 0
    v_exp_f32 v59, v59
    v_mfma_f32_16x16x32_bf16 a[92:95], a[244:247], v[76:79], 0
    v_mfma_f32_16x16x32_bf16 v[120:123], v[192:195], v[72:75], 0
    s_waitcnt lgkmcnt(6)
    v_mfma_f32_16x16x32_bf16 v[0:3], a[216:219], v[140:143], v[0:3]
    v_exp_f32 v44, v44
    v_mfma_f32_16x16x32_bf16 v[4:7], a[216:219], v[156:159], v[4:7]
    ds_read_b128 a[200:203], v196 offset:25408
    v_cvt_pk_bf16_f32 v91, v58, v59
    v_mfma_f32_16x16x32_bf16 v[8:11], a[216:219], v[172:175], v[8:11]
    v_exp_f32 v45, v45
    v_mfma_f32_16x16x32_bf16 v[12:15], a[216:219], v[188:191], v[12:15]
    ds_read_b64_tr_b16 a[232:233], v197 offset:8512
    v_cvt_pk_bf16_f32 v92, v44, v45
    v_mfma_f32_16x16x32_bf16 a[96:99], a[248:251], v[64:67], 0
    v_exp_f32 v46, v46
    v_mfma_f32_16x16x32_bf16 a[100:103], a[248:251], v[68:71], 0
    ds_read_b64_tr_b16 a[234:235], v197 offset:9024
    v_mfma_f32_16x16x32_bf16 a[104:107], a[248:251], v[72:75], 0
    v_exp_f32 v47, v47
    v_mfma_f32_16x16x32_bf16 a[108:111], a[248:251], v[76:79], 0
    buffer_load_dwordx4 v201, s[12:15], s46 offen offset:1056 nt lds
    v_mfma_f32_16x16x32_bf16 v[16:19], a[220:223], v[140:143], v[16:19]
    v_exp_f32 v60, v60
    v_mfma_f32_16x16x32_bf16 v[20:23], a[220:223], v[156:159], v[20:23]
    ds_read_b128 a[204:207], v196 offset:25920
    v_cvt_pk_bf16_f32 v93, v46, v47
    v_mfma_f32_16x16x32_bf16 v[24:27], a[220:223], v[172:175], v[24:27]
    v_exp_f32 v61, v61
    v_mfma_f32_16x16x32_bf16 v[28:31], a[220:223], v[188:191], v[28:31]
    ds_read_b64_tr_b16 a[236:237], v197 offset:8544
    v_cvt_pk_bf16_f32 v94, v60, v61
    v_mfma_f32_16x16x32_bf16 a[112:115], a[252:255], v[64:67], 0
    v_exp_f32 v62, v62
    v_mfma_f32_16x16x32_bf16 a[116:119], a[252:255], v[68:71], 0
    ds_read_b64_tr_b16 a[238:239], v197 offset:9056
    v_mfma_f32_16x16x32_bf16 a[120:123], a[252:255], v[72:75], 0
    v_exp_f32 v63, v63
    v_mfma_f32_16x16x32_bf16 a[124:127], a[252:255], v[76:79], 0
    v_mfma_f32_16x16x32_bf16 v[124:127], v[192:195], v[76:79], 0
    s_waitcnt lgkmcnt(6)
    v_mfma_f32_16x16x32_bf16 v[32:35], a[192:195], v[128:131], v[96:99]
    v_exp_f32 v0, v0
    v_mfma_f32_16x16x32_bf16 v[36:39], a[192:195], v[144:147], v[100:103]
    ds_read_b128 a[208:211], v196 offset:25472
    v_cvt_pk_bf16_f32 v95, v62, v63
    v_mfma_f32_16x16x32_bf16 v[40:43], a[192:195], v[160:163], v[104:107]
    v_exp_f32 v1, v1
    v_mfma_f32_16x16x32_bf16 v[44:47], a[192:195], v[176:179], v[108:111]
    ds_read_b64_tr_b16 a[240:241], v197 offset:8576
    v_cvt_pk_bf16_f32 v64, v0, v1
    v_mfma_f32_16x16x32_bf16 a[0:3], a[224:227], v[80:83], a[0:3]
    v_exp_f32 v2, v2
    v_mfma_f32_16x16x32_bf16 a[4:7], a[224:227], v[84:87], a[4:7]
    ds_read_b64_tr_b16 a[242:243], v197 offset:9088
    s_add_u32 m0, s42, 59136
    v_mfma_f32_16x16x32_bf16 a[8:11], a[224:227], v[88:91], a[8:11]
    v_exp_f32 v3, v3
    v_mfma_f32_16x16x32_bf16 a[12:15], a[224:227], v[92:95], a[12:15]
    buffer_load_dwordx4 v202, s[16:19], s46 offen nt lds
    v_mfma_f32_16x16x32_bf16 v[48:51], a[196:199], v[128:131], v[96:99]
    v_exp_f32 v16, v16
    v_mfma_f32_16x16x32_bf16 v[52:55], a[196:199], v[144:147], v[100:103]
    ds_read_b128 a[212:215], v196 offset:25984
    v_cvt_pk_bf16_f32 v65, v2, v3
    v_mfma_f32_16x16x32_bf16 v[56:59], a[196:199], v[160:163], v[104:107]
    v_exp_f32 v17, v17
    v_mfma_f32_16x16x32_bf16 v[60:63], a[196:199], v[176:179], v[108:111]
    ds_read_b64_tr_b16 a[244:245], v197 offset:8608
    v_cvt_pk_bf16_f32 v66, v16, v17
    v_mfma_f32_16x16x32_bf16 a[16:19], a[228:231], v[80:83], a[16:19]
    v_exp_f32 v18, v18
    v_mfma_f32_16x16x32_bf16 a[20:23], a[228:231], v[84:87], a[20:23]
    ds_read_b64_tr_b16 a[246:247], v197 offset:9120
    v_mfma_f32_16x16x32_bf16 a[24:27], a[228:231], v[88:91], a[24:27]
    v_exp_f32 v19, v19
    v_mfma_f32_16x16x32_bf16 a[28:31], a[228:231], v[92:95], a[28:31]
    v_mfma_f32_16x16x32_bf16 v[112:115], v[192:195], v[80:83], v[112:115]
    s_waitcnt lgkmcnt(6)
    v_mfma_f32_16x16x32_bf16 v[32:35], a[200:203], v[132:135], v[32:35]
    v_exp_f32 v4, v4
    v_mfma_f32_16x16x32_bf16 v[36:39], a[200:203], v[148:151], v[36:39]
    ds_read_b128 a[216:219], v196 offset:25536
    v_cvt_pk_bf16_f32 v67, v18, v19
    v_mfma_f32_16x16x32_bf16 v[40:43], a[200:203], v[164:167], v[40:43]
    v_exp_f32 v5, v5
    v_mfma_f32_16x16x32_bf16 v[44:47], a[200:203], v[180:183], v[44:47]
    ds_read_b64_tr_b16 a[248:249], v197 offset:8640
    v_cvt_pk_bf16_f32 v68, v4, v5
    v_mfma_f32_16x16x32_bf16 a[32:35], a[232:235], v[80:83], a[32:35]
    v_exp_f32 v6, v6
    v_mfma_f32_16x16x32_bf16 a[36:39], a[232:235], v[84:87], a[36:39]
    ds_read_b64_tr_b16 a[250:251], v197 offset:9152
    v_mfma_f32_16x16x32_bf16 a[40:43], a[232:235], v[88:91], a[40:43]
    v_exp_f32 v7, v7
    v_mfma_f32_16x16x32_bf16 a[44:47], a[232:235], v[92:95], a[44:47]
    buffer_load_dwordx4 v203, s[16:19], s46 offen offset:1056 nt lds
    v_mfma_f32_16x16x32_bf16 v[48:51], a[204:207], v[132:135], v[48:51]
    v_exp_f32 v20, v20
    v_mfma_f32_16x16x32_bf16 v[52:55], a[204:207], v[148:151], v[52:55]
    ds_read_b128 a[220:223], v196 offset:26048
    v_cvt_pk_bf16_f32 v69, v6, v7
    v_mfma_f32_16x16x32_bf16 v[56:59], a[204:207], v[164:167], v[56:59]
    v_exp_f32 v21, v21
    v_mfma_f32_16x16x32_bf16 v[60:63], a[204:207], v[180:183], v[60:63]
    ds_read_b64_tr_b16 a[252:253], v197 offset:8672
    v_cvt_pk_bf16_f32 v70, v20, v21
    v_mfma_f32_16x16x32_bf16 a[48:51], a[236:239], v[80:83], a[48:51]
    v_exp_f32 v22, v22
    v_mfma_f32_16x16x32_bf16 a[52:55], a[236:239], v[84:87], a[52:55]
    ds_read_b64_tr_b16 a[254:255], v197 offset:9184
    s_add_u32 s46, s46, 8192
    v_mfma_f32_16x16x32_bf16 a[56:59], a[236:239], v[88:91], a[56:59]
    v_exp_f32 v23, v23
    v_mfma_f32_16x16x32_bf16 a[60:63], a[236:239], v[92:95], a[60:63]
    v_mfma_f32_16x16x32_bf16 v[116:119], v[192:195], v[84:87], v[116:119]
    s_waitcnt vmcnt(6) lgkmcnt(6)
    s_barrier
    v_mfma_f32_16x16x32_bf16 v[32:35], a[208:211], v[136:139], v[32:35]
    v_exp_f32 v8, v8
    s_add_u32 s53, s49, 4294709248
    v_mfma_f32_16x16x32_bf16 v[36:39], a[208:211], v[152:155], v[36:39]
    ds_read_b128 a[192:195], v196 offset:33792
    v_cvt_pk_bf16_f32 v71, v22, v23
    buffer_store_dwordx4 a[144:147], v205, s[20:23], s53 offen offset:0 sc1
    v_mfma_f32_16x16x32_bf16 v[40:43], a[208:211], v[168:171], v[40:43]
    v_exp_f32 v9, v9
    v_mfma_f32_16x16x32_bf16 v[44:47], a[208:211], v[184:187], v[44:47]
    ds_read_b64_tr_b16 a[224:225], v197 offset:16896
    v_cvt_pk_bf16_f32 v72, v8, v9
    buffer_store_dwordx4 a[148:151], v205, s[20:23], s53 offen offset:1024 sc1
    v_mfma_f32_16x16x32_bf16 a[64:67], a[240:243], v[80:83], a[64:67]
    v_exp_f32 v10, v10
    v_mfma_f32_16x16x32_bf16 a[68:71], a[240:243], v[84:87], a[68:71]
    ds_read_b64_tr_b16 a[226:227], v197 offset:17408
    s_add_u32 m0, s41, 16896
    v_mfma_f32_16x16x32_bf16 a[72:75], a[240:243], v[88:91], a[72:75]
    v_exp_f32 v11, v11
    v_mfma_f32_16x16x32_bf16 a[76:79], a[240:243], v[92:95], a[76:79]
    buffer_load_dwordx4 v200, s[12:15], s46 offen nt lds
    v_mfma_f32_16x16x32_bf16 v[48:51], a[212:215], v[136:139], v[48:51]
    v_exp_f32 v24, v24
    v_mfma_f32_16x16x32_bf16 v[52:55], a[212:215], v[152:155], v[52:55]
    ds_read_b128 a[196:199], v196 offset:34304
    v_cvt_pk_bf16_f32 v73, v10, v11
    v_mfma_f32_16x16x32_bf16 v[56:59], a[212:215], v[168:171], v[56:59]
    v_exp_f32 v25, v25
    v_mfma_f32_16x16x32_bf16 v[60:63], a[212:215], v[184:187], v[60:63]
    ds_read_b64_tr_b16 a[228:229], v197 offset:16928
    v_cvt_pk_bf16_f32 v74, v24, v25
    v_mfma_f32_16x16x32_bf16 a[80:83], a[244:247], v[80:83], a[80:83]
    v_exp_f32 v26, v26
    v_mfma_f32_16x16x32_bf16 a[84:87], a[244:247], v[84:87], a[84:87]
    ds_read_b64_tr_b16 a[230:231], v197 offset:17440
    v_mfma_f32_16x16x32_bf16 a[88:91], a[244:247], v[88:91], a[88:91]
    v_exp_f32 v27, v27
    v_mfma_f32_16x16x32_bf16 a[92:95], a[244:247], v[92:95], a[92:95]
    v_mfma_f32_16x16x32_bf16 v[120:123], v[192:195], v[88:91], v[120:123]
    s_waitcnt lgkmcnt(6)
    v_mfma_f32_16x16x32_bf16 v[32:35], a[216:219], v[140:143], v[32:35]
    v_exp_f32 v12, v12
    v_mfma_f32_16x16x32_bf16 v[36:39], a[216:219], v[156:159], v[36:39]
    ds_read_b128 a[200:203], v196 offset:33856
    v_cvt_pk_bf16_f32 v75, v26, v27
    v_mfma_f32_16x16x32_bf16 v[40:43], a[216:219], v[172:175], v[40:43]
    v_exp_f32 v13, v13
    v_mfma_f32_16x16x32_bf16 v[44:47], a[216:219], v[188:191], v[44:47]
    ds_read_b64_tr_b16 a[232:233], v197 offset:16960
    v_cvt_pk_bf16_f32 v76, v12, v13
    v_mfma_f32_16x16x32_bf16 a[96:99], a[248:251], v[80:83], a[96:99]
    v_exp_f32 v14, v14
    v_mfma_f32_16x16x32_bf16 a[100:103], a[248:251], v[84:87], a[100:103]
    ds_read_b64_tr_b16 a[234:235], v197 offset:17472
    v_mfma_f32_16x16x32_bf16 a[104:107], a[248:251], v[88:91], a[104:107]
    v_exp_f32 v15, v15
    v_mfma_f32_16x16x32_bf16 a[108:111], a[248:251], v[92:95], a[108:111]
    buffer_load_dwordx4 v201, s[12:15], s46 offen offset:1056 nt lds
    v_mfma_f32_16x16x32_bf16 v[48:51], a[220:223], v[140:143], v[48:51]
    v_exp_f32 v28, v28
    v_mfma_f32_16x16x32_bf16 v[52:55], a[220:223], v[156:159], v[52:55]
    ds_read_b128 a[204:207], v196 offset:34368
    v_cvt_pk_bf16_f32 v77, v14, v15
    v_mfma_f32_16x16x32_bf16 v[56:59], a[220:223], v[172:175], v[56:59]
    v_exp_f32 v29, v29
    v_mfma_f32_16x16x32_bf16 v[60:63], a[220:223], v[188:191], v[60:63]
    ds_read_b64_tr_b16 a[236:237], v197 offset:16992
    v_cvt_pk_bf16_f32 v78, v28, v29
    v_mfma_f32_16x16x32_bf16 a[112:115], a[252:255], v[80:83], a[112:115]
    v_exp_f32 v30, v30
    v_mfma_f32_16x16x32_bf16 a[116:119], a[252:255], v[84:87], a[116:119]
    ds_read_b64_tr_b16 a[238:239], v197 offset:17504
    v_mfma_f32_16x16x32_bf16 a[120:123], a[252:255], v[88:91], a[120:123]
    v_exp_f32 v31, v31
    v_mfma_f32_16x16x32_bf16 a[124:127], a[252:255], v[92:95], a[124:127]
    v_mfma_f32_16x16x32_bf16 v[124:127], v[192:195], v[92:95], v[124:127]
    s_waitcnt vmcnt(6)
    s_waitcnt lgkmcnt(6)
    v_mfma_f32_16x16x32_bf16 v[0:3], a[192:195], v[128:131], v[96:99]
    v_exp_f32 v32, v32
    v_mfma_f32_16x16x32_bf16 v[4:7], a[192:195], v[144:147], v[100:103]
    ds_read_b128 a[208:211], v196 offset:33920
    v_cvt_pk_bf16_f32 v79, v30, v31
    v_mfma_f32_16x16x32_bf16 v[8:11], a[192:195], v[160:163], v[104:107]
    v_exp_f32 v33, v33
    v_mfma_f32_16x16x32_bf16 v[12:15], a[192:195], v[176:179], v[108:111]
    ds_read_b64_tr_b16 a[240:241], v197 offset:17024
    v_cvt_pk_bf16_f32 v80, v32, v33
    v_mfma_f32_16x16x32_bf16 a[0:3], a[224:227], v[64:67], a[0:3]
    v_exp_f32 v34, v34
    v_mfma_f32_16x16x32_bf16 a[4:7], a[224:227], v[68:71], a[4:7]
    ds_read_b64_tr_b16 a[242:243], v197 offset:17536
    s_add_u32 m0, s42, 0
    v_mfma_f32_16x16x32_bf16 a[8:11], a[224:227], v[72:75], a[8:11]
    v_exp_f32 v35, v35
    v_mfma_f32_16x16x32_bf16 a[12:15], a[224:227], v[76:79], a[12:15]
    buffer_load_dwordx4 v202, s[16:19], s46 offen nt lds
    v_mfma_f32_16x16x32_bf16 v[16:19], a[196:199], v[128:131], v[96:99]
    v_exp_f32 v48, v48
    v_mfma_f32_16x16x32_bf16 v[20:23], a[196:199], v[144:147], v[100:103]
    ds_read_b128 a[212:215], v196 offset:34432
    v_cvt_pk_bf16_f32 v81, v34, v35
    v_mfma_f32_16x16x32_bf16 v[24:27], a[196:199], v[160:163], v[104:107]
    v_exp_f32 v49, v49
    v_mfma_f32_16x16x32_bf16 v[28:31], a[196:199], v[176:179], v[108:111]
    ds_read_b64_tr_b16 a[244:245], v197 offset:17056
    v_cvt_pk_bf16_f32 v82, v48, v49
    v_mfma_f32_16x16x32_bf16 a[16:19], a[228:231], v[64:67], a[16:19]
    v_exp_f32 v50, v50
    v_mfma_f32_16x16x32_bf16 a[20:23], a[228:231], v[68:71], a[20:23]
    ds_read_b64_tr_b16 a[246:247], v197 offset:17568
    v_mfma_f32_16x16x32_bf16 a[24:27], a[228:231], v[72:75], a[24:27]
    v_exp_f32 v51, v51
    v_mfma_f32_16x16x32_bf16 a[28:31], a[228:231], v[76:79], a[28:31]
    v_mfma_f32_16x16x32_bf16 v[112:115], v[192:195], v[64:67], v[112:115]
    s_waitcnt lgkmcnt(6)
    v_mfma_f32_16x16x32_bf16 v[0:3], a[200:203], v[132:135], v[0:3]
    v_exp_f32 v36, v36
    v_mfma_f32_16x16x32_bf16 v[4:7], a[200:203], v[148:151], v[4:7]
    ds_read_b128 a[216:219], v196 offset:33984
    v_cvt_pk_bf16_f32 v83, v50, v51
    v_mfma_f32_16x16x32_bf16 v[8:11], a[200:203], v[164:167], v[8:11]
    v_exp_f32 v37, v37
    v_mfma_f32_16x16x32_bf16 v[12:15], a[200:203], v[180:183], v[12:15]
    ds_read_b64_tr_b16 a[248:249], v197 offset:17088
    v_cvt_pk_bf16_f32 v84, v36, v37
    v_mfma_f32_16x16x32_bf16 a[32:35], a[232:235], v[64:67], a[32:35]
    v_exp_f32 v38, v38
    v_mfma_f32_16x16x32_bf16 a[36:39], a[232:235], v[68:71], a[36:39]
    ds_read_b64_tr_b16 a[250:251], v197 offset:17600
    v_mfma_f32_16x16x32_bf16 a[40:43], a[232:235], v[72:75], a[40:43]
    v_exp_f32 v39, v39
    v_mfma_f32_16x16x32_bf16 a[44:47], a[232:235], v[76:79], a[44:47]
    buffer_load_dwordx4 v203, s[16:19], s46 offen offset:1056 nt lds
    v_mfma_f32_16x16x32_bf16 v[16:19], a[204:207], v[132:135], v[16:19]
    v_exp_f32 v52, v52
    v_mfma_f32_16x16x32_bf16 v[20:23], a[204:207], v[148:151], v[20:23]
    ds_read_b128 a[220:223], v196 offset:34496
    v_cvt_pk_bf16_f32 v85, v38, v39
    v_mfma_f32_16x16x32_bf16 v[24:27], a[204:207], v[164:167], v[24:27]
    v_exp_f32 v53, v53
    v_mfma_f32_16x16x32_bf16 v[28:31], a[204:207], v[180:183], v[28:31]
    ds_read_b64_tr_b16 a[252:253], v197 offset:17120
    v_cvt_pk_bf16_f32 v86, v52, v53
    v_mfma_f32_16x16x32_bf16 a[48:51], a[236:239], v[64:67], a[48:51]
    v_exp_f32 v54, v54
    v_mfma_f32_16x16x32_bf16 a[52:55], a[236:239], v[68:71], a[52:55]
    ds_read_b64_tr_b16 a[254:255], v197 offset:17632
    s_add_u32 s46, s46, 8192
    v_mfma_f32_16x16x32_bf16 a[56:59], a[236:239], v[72:75], a[56:59]
    v_exp_f32 v55, v55
    v_mfma_f32_16x16x32_bf16 a[60:63], a[236:239], v[76:79], a[60:63]
    v_mfma_f32_16x16x32_bf16 v[116:119], v[192:195], v[68:71], v[116:119]
    s_waitcnt vmcnt(6) lgkmcnt(6)
    s_barrier
    v_mfma_f32_16x16x32_bf16 v[0:3], a[208:211], v[136:139], v[0:3]
    v_exp_f32 v40, v40
    v_mfma_f32_16x16x32_bf16 v[4:7], a[208:211], v[152:155], v[4:7]
    ds_read_b128 a[192:195], v196 offset:42240
    v_cvt_pk_bf16_f32 v87, v54, v55
    buffer_store_dwordx4 a[152:155], v205, s[20:23], s53 offen offset:2048 sc1
    v_mfma_f32_16x16x32_bf16 v[8:11], a[208:211], v[168:171], v[8:11]
    v_exp_f32 v41, v41
    v_mfma_f32_16x16x32_bf16 v[12:15], a[208:211], v[184:187], v[12:15]
    ds_read_b64_tr_b16 a[224:225], v197 offset:25344
    v_cvt_pk_bf16_f32 v88, v40, v41
    buffer_store_dwordx4 a[156:159], v205, s[20:23], s53 offen offset:3072 sc1
    v_mfma_f32_16x16x32_bf16 a[64:67], a[240:243], v[64:67], a[64:67]
    v_exp_f32 v42, v42
    v_mfma_f32_16x16x32_bf16 a[68:71], a[240:243], v[68:71], a[68:71]
    ds_read_b64_tr_b16 a[226:227], v197 offset:25856
    s_add_u32 m0, s41, 25344
    v_mfma_f32_16x16x32_bf16 a[72:75], a[240:243], v[72:75], a[72:75]
    v_exp_f32 v43, v43
    v_mfma_f32_16x16x32_bf16 a[76:79], a[240:243], v[76:79], a[76:79]
    buffer_load_dwordx4 v200, s[12:15], s46 offen nt lds
    v_mfma_f32_16x16x32_bf16 v[16:19], a[212:215], v[136:139], v[16:19]
    v_exp_f32 v56, v56
    v_mfma_f32_16x16x32_bf16 v[20:23], a[212:215], v[152:155], v[20:23]
    ds_read_b128 a[196:199], v196 offset:42752
    v_cvt_pk_bf16_f32 v89, v42, v43
    v_mfma_f32_16x16x32_bf16 v[24:27], a[212:215], v[168:171], v[24:27]
    v_exp_f32 v57, v57
    v_mfma_f32_16x16x32_bf16 v[28:31], a[212:215], v[184:187], v[28:31]
    ds_read_b64_tr_b16 a[228:229], v197 offset:25376
    v_cvt_pk_bf16_f32 v90, v56, v57
    v_mfma_f32_16x16x32_bf16 a[80:83], a[244:247], v[64:67], a[80:83]
    v_exp_f32 v58, v58
    v_mfma_f32_16x16x32_bf16 a[84:87], a[244:247], v[68:71], a[84:87]
    ds_read_b64_tr_b16 a[230:231], v197 offset:25888
    v_mfma_f32_16x16x32_bf16 a[88:91], a[244:247], v[72:75], a[88:91]
    v_exp_f32 v59, v59
    v_mfma_f32_16x16x32_bf16 a[92:95], a[244:247], v[76:79], a[92:95]
    v_mfma_f32_16x16x32_bf16 v[120:123], v[192:195], v[72:75], v[120:123]
    s_waitcnt lgkmcnt(6)
    v_mfma_f32_16x16x32_bf16 v[0:3], a[216:219], v[140:143], v[0:3]
    v_exp_f32 v44, v44
    v_mfma_f32_16x16x32_bf16 v[4:7], a[216:219], v[156:159], v[4:7]
    ds_read_b128 a[200:203], v196 offset:42304
    v_cvt_pk_bf16_f32 v91, v58, v59
    v_mfma_f32_16x16x32_bf16 v[8:11], a[216:219], v[172:175], v[8:11]
    v_exp_f32 v45, v45
    v_mfma_f32_16x16x32_bf16 v[12:15], a[216:219], v[188:191], v[12:15]
    ds_read_b64_tr_b16 a[232:233], v197 offset:25408
    v_cvt_pk_bf16_f32 v92, v44, v45
    v_mfma_f32_16x16x32_bf16 a[96:99], a[248:251], v[64:67], a[96:99]
    v_exp_f32 v46, v46
    v_mfma_f32_16x16x32_bf16 a[100:103], a[248:251], v[68:71], a[100:103]
    ds_read_b64_tr_b16 a[234:235], v197 offset:25920
    v_mfma_f32_16x16x32_bf16 a[104:107], a[248:251], v[72:75], a[104:107]
    v_exp_f32 v47, v47
    v_mfma_f32_16x16x32_bf16 a[108:111], a[248:251], v[76:79], a[108:111]
    buffer_load_dwordx4 v201, s[12:15], s46 offen offset:1056 nt lds
    v_mfma_f32_16x16x32_bf16 v[16:19], a[220:223], v[140:143], v[16:19]
    v_exp_f32 v60, v60
    v_mfma_f32_16x16x32_bf16 v[20:23], a[220:223], v[156:159], v[20:23]
    ds_read_b128 a[204:207], v196 offset:42816
    v_cvt_pk_bf16_f32 v93, v46, v47
    v_mfma_f32_16x16x32_bf16 v[24:27], a[220:223], v[172:175], v[24:27]
    v_exp_f32 v61, v61
    v_mfma_f32_16x16x32_bf16 v[28:31], a[220:223], v[188:191], v[28:31]
    ds_read_b64_tr_b16 a[236:237], v197 offset:25440
    v_cvt_pk_bf16_f32 v94, v60, v61
    v_mfma_f32_16x16x32_bf16 a[112:115], a[252:255], v[64:67], a[112:115]
    v_exp_f32 v62, v62
    v_mfma_f32_16x16x32_bf16 a[116:119], a[252:255], v[68:71], a[116:119]
    ds_read_b64_tr_b16 a[238:239], v197 offset:25952
    v_mfma_f32_16x16x32_bf16 a[120:123], a[252:255], v[72:75], a[120:123]
    v_exp_f32 v63, v63
    v_mfma_f32_16x16x32_bf16 a[124:127], a[252:255], v[76:79], a[124:127]
    v_mfma_f32_16x16x32_bf16 v[124:127], v[192:195], v[76:79], v[124:127]
    s_waitcnt vmcnt(6)
    s_waitcnt lgkmcnt(6)
    v_mfma_f32_16x16x32_bf16 v[32:35], a[192:195], v[128:131], v[96:99]
    v_exp_f32 v0, v0
    v_mfma_f32_16x16x32_bf16 v[36:39], a[192:195], v[144:147], v[100:103]
    ds_read_b128 a[208:211], v196 offset:42368
    v_cvt_pk_bf16_f32 v95, v62, v63
    v_mfma_f32_16x16x32_bf16 v[40:43], a[192:195], v[160:163], v[104:107]
    v_exp_f32 v1, v1
    v_mfma_f32_16x16x32_bf16 v[44:47], a[192:195], v[176:179], v[108:111]
    ds_read_b64_tr_b16 a[240:241], v197 offset:25472
    v_cvt_pk_bf16_f32 v64, v0, v1
    v_mfma_f32_16x16x32_bf16 a[0:3], a[224:227], v[80:83], a[0:3]
    v_exp_f32 v2, v2
    v_mfma_f32_16x16x32_bf16 a[4:7], a[224:227], v[84:87], a[4:7]
    ds_read_b64_tr_b16 a[242:243], v197 offset:25984
    s_add_u32 m0, s42, 8448
    v_mfma_f32_16x16x32_bf16 a[8:11], a[224:227], v[88:91], a[8:11]
    v_exp_f32 v3, v3
    v_mfma_f32_16x16x32_bf16 a[12:15], a[224:227], v[92:95], a[12:15]
    buffer_load_dwordx4 v202, s[16:19], s46 offen nt lds
    v_mfma_f32_16x16x32_bf16 v[48:51], a[196:199], v[128:131], v[96:99]
    v_exp_f32 v16, v16
    v_mfma_f32_16x16x32_bf16 v[52:55], a[196:199], v[144:147], v[100:103]
    ds_read_b128 a[212:215], v196 offset:42880
    v_cvt_pk_bf16_f32 v65, v2, v3
    v_mfma_f32_16x16x32_bf16 v[56:59], a[196:199], v[160:163], v[104:107]
    v_exp_f32 v17, v17
    v_mfma_f32_16x16x32_bf16 v[60:63], a[196:199], v[176:179], v[108:111]
    ds_read_b64_tr_b16 a[244:245], v197 offset:25504
    v_cvt_pk_bf16_f32 v66, v16, v17
    v_mfma_f32_16x16x32_bf16 a[16:19], a[228:231], v[80:83], a[16:19]
    v_exp_f32 v18, v18
    v_mfma_f32_16x16x32_bf16 a[20:23], a[228:231], v[84:87], a[20:23]
    ds_read_b64_tr_b16 a[246:247], v197 offset:26016
    v_mfma_f32_16x16x32_bf16 a[24:27], a[228:231], v[88:91], a[24:27]
    v_exp_f32 v19, v19
    v_mfma_f32_16x16x32_bf16 a[28:31], a[228:231], v[92:95], a[28:31]
    v_mfma_f32_16x16x32_bf16 v[112:115], v[192:195], v[80:83], v[112:115]
    s_waitcnt lgkmcnt(6)
    v_mfma_f32_16x16x32_bf16 v[32:35], a[200:203], v[132:135], v[32:35]
    v_exp_f32 v4, v4
    v_mfma_f32_16x16x32_bf16 v[36:39], a[200:203], v[148:151], v[36:39]
    ds_read_b128 a[216:219], v196 offset:42432
    v_cvt_pk_bf16_f32 v67, v18, v19
    v_mfma_f32_16x16x32_bf16 v[40:43], a[200:203], v[164:167], v[40:43]
    v_exp_f32 v5, v5
    v_mfma_f32_16x16x32_bf16 v[44:47], a[200:203], v[180:183], v[44:47]
    ds_read_b64_tr_b16 a[248:249], v197 offset:25536
    v_cvt_pk_bf16_f32 v68, v4, v5
    v_mfma_f32_16x16x32_bf16 a[32:35], a[232:235], v[80:83], a[32:35]
    v_exp_f32 v6, v6
    v_mfma_f32_16x16x32_bf16 a[36:39], a[232:235], v[84:87], a[36:39]
    ds_read_b64_tr_b16 a[250:251], v197 offset:26048
    v_mfma_f32_16x16x32_bf16 a[40:43], a[232:235], v[88:91], a[40:43]
    v_exp_f32 v7, v7
    v_mfma_f32_16x16x32_bf16 a[44:47], a[232:235], v[92:95], a[44:47]
    buffer_load_dwordx4 v203, s[16:19], s46 offen offset:1056 nt lds
    v_mfma_f32_16x16x32_bf16 v[48:51], a[204:207], v[132:135], v[48:51]
    v_exp_f32 v20, v20
    v_mfma_f32_16x16x32_bf16 v[52:55], a[204:207], v[148:151], v[52:55]
    ds_read_b128 a[220:223], v196 offset:42944
    v_cvt_pk_bf16_f32 v69, v6, v7
    v_mfma_f32_16x16x32_bf16 v[56:59], a[204:207], v[164:167], v[56:59]
    v_exp_f32 v21, v21
    v_mfma_f32_16x16x32_bf16 v[60:63], a[204:207], v[180:183], v[60:63]
    ds_read_b64_tr_b16 a[252:253], v197 offset:25568
    v_cvt_pk_bf16_f32 v70, v20, v21
    v_mfma_f32_16x16x32_bf16 a[48:51], a[236:239], v[80:83], a[48:51]
    v_exp_f32 v22, v22
    v_mfma_f32_16x16x32_bf16 a[52:55], a[236:239], v[84:87], a[52:55]
    ds_read_b64_tr_b16 a[254:255], v197 offset:26080
    s_add_u32 s46, s46, 8192
    v_mfma_f32_16x16x32_bf16 a[56:59], a[236:239], v[88:91], a[56:59]
    v_exp_f32 v23, v23
    v_mfma_f32_16x16x32_bf16 a[60:63], a[236:239], v[92:95], a[60:63]
    v_mfma_f32_16x16x32_bf16 v[116:119], v[192:195], v[84:87], v[116:119]
    s_waitcnt vmcnt(6) lgkmcnt(6)
    s_barrier
    v_mfma_f32_16x16x32_bf16 v[32:35], a[208:211], v[136:139], v[32:35]
    v_exp_f32 v8, v8
    s_add_u32 s53, s49, 4294721536
    v_mfma_f32_16x16x32_bf16 v[36:39], a[208:211], v[152:155], v[36:39]
    ds_read_b128 a[192:195], v196 offset:50688
    v_cvt_pk_bf16_f32 v71, v22, v23
    buffer_store_dwordx4 a[160:163], v205, s[20:23], s53 offen offset:0 sc1
    v_mfma_f32_16x16x32_bf16 v[40:43], a[208:211], v[168:171], v[40:43]
    v_exp_f32 v9, v9
    v_mfma_f32_16x16x32_bf16 v[44:47], a[208:211], v[184:187], v[44:47]
    ds_read_b64_tr_b16 a[224:225], v197 offset:33792
    v_cvt_pk_bf16_f32 v72, v8, v9
    buffer_store_dwordx4 a[164:167], v205, s[20:23], s53 offen offset:1024 sc1
    v_mfma_f32_16x16x32_bf16 a[64:67], a[240:243], v[80:83], a[64:67]
    v_exp_f32 v10, v10
    v_mfma_f32_16x16x32_bf16 a[68:71], a[240:243], v[84:87], a[68:71]
    ds_read_b64_tr_b16 a[226:227], v197 offset:34304
    s_add_u32 m0, s41, 33792
    v_mfma_f32_16x16x32_bf16 a[72:75], a[240:243], v[88:91], a[72:75]
    v_exp_f32 v11, v11
    v_mfma_f32_16x16x32_bf16 a[76:79], a[240:243], v[92:95], a[76:79]
    buffer_load_dwordx4 v200, s[12:15], s46 offen nt lds
    v_mfma_f32_16x16x32_bf16 v[48:51], a[212:215], v[136:139], v[48:51]
    v_exp_f32 v24, v24
    v_mfma_f32_16x16x32_bf16 v[52:55], a[212:215], v[152:155], v[52:55]
    ds_read_b128 a[196:199], v196 offset:51200
    v_cvt_pk_bf16_f32 v73, v10, v11
    v_mfma_f32_16x16x32_bf16 v[56:59], a[212:215], v[168:171], v[56:59]
    v_exp_f32 v25, v25
    v_mfma_f32_16x16x32_bf16 v[60:63], a[212:215], v[184:187], v[60:63]
    ds_read_b64_tr_b16 a[228:229], v197 offset:33824
    v_cvt_pk_bf16_f32 v74, v24, v25
    v_mfma_f32_16x16x32_bf16 a[80:83], a[244:247], v[80:83], a[80:83]
    v_exp_f32 v26, v26
    v_mfma_f32_16x16x32_bf16 a[84:87], a[244:247], v[84:87], a[84:87]
    ds_read_b64_tr_b16 a[230:231], v197 offset:34336
    v_mfma_f32_16x16x32_bf16 a[88:91], a[244:247], v[88:91], a[88:91]
    v_exp_f32 v27, v27
    v_mfma_f32_16x16x32_bf16 a[92:95], a[244:247], v[92:95], a[92:95]
    v_mfma_f32_16x16x32_bf16 v[120:123], v[192:195], v[88:91], v[120:123]
    s_waitcnt lgkmcnt(6)
    v_mfma_f32_16x16x32_bf16 v[32:35], a[216:219], v[140:143], v[32:35]
    v_exp_f32 v12, v12
    v_mfma_f32_16x16x32_bf16 v[36:39], a[216:219], v[156:159], v[36:39]
    ds_read_b128 a[200:203], v196 offset:50752
    v_cvt_pk_bf16_f32 v75, v26, v27
    v_mfma_f32_16x16x32_bf16 v[40:43], a[216:219], v[172:175], v[40:43]
    v_exp_f32 v13, v13
    v_mfma_f32_16x16x32_bf16 v[44:47], a[216:219], v[188:191], v[44:47]
    ds_read_b64_tr_b16 a[232:233], v197 offset:33856
    v_cvt_pk_bf16_f32 v76, v12, v13
    v_mfma_f32_16x16x32_bf16 a[96:99], a[248:251], v[80:83], a[96:99]
    v_exp_f32 v14, v14
    v_mfma_f32_16x16x32_bf16 a[100:103], a[248:251], v[84:87], a[100:103]
    ds_read_b64_tr_b16 a[234:235], v197 offset:34368
    v_mfma_f32_16x16x32_bf16 a[104:107], a[248:251], v[88:91], a[104:107]
    v_exp_f32 v15, v15
    v_mfma_f32_16x16x32_bf16 a[108:111], a[248:251], v[92:95], a[108:111]
    buffer_load_dwordx4 v201, s[12:15], s46 offen offset:1056 nt lds
    v_mfma_f32_16x16x32_bf16 v[48:51], a[220:223], v[140:143], v[48:51]
    v_exp_f32 v28, v28
    v_mfma_f32_16x16x32_bf16 v[52:55], a[220:223], v[156:159], v[52:55]
    ds_read_b128 a[204:207], v196 offset:51264
    v_cvt_pk_bf16_f32 v77, v14, v15
    v_mfma_f32_16x16x32_bf16 v[56:59], a[220:223], v[172:175], v[56:59]
    v_exp_f32 v29, v29
    v_mfma_f32_16x16x32_bf16 v[60:63], a[220:223], v[188:191], v[60:63]
    ds_read_b64_tr_b16 a[236:237], v197 offset:33888
    v_cvt_pk_bf16_f32 v78, v28, v29
    v_mfma_f32_16x16x32_bf16 a[112:115], a[252:255], v[80:83], a[112:115]
    v_exp_f32 v30, v30
    v_mfma_f32_16x16x32_bf16 a[116:119], a[252:255], v[84:87], a[116:119]
    ds_read_b64_tr_b16 a[238:239], v197 offset:34400
    v_mfma_f32_16x16x32_bf16 a[120:123], a[252:255], v[88:91], a[120:123]
    v_exp_f32 v31, v31
    v_mfma_f32_16x16x32_bf16 a[124:127], a[252:255], v[92:95], a[124:127]
    v_mfma_f32_16x16x32_bf16 v[124:127], v[192:195], v[92:95], v[124:127]
    s_waitcnt vmcnt(6)
    s_waitcnt lgkmcnt(6)
    v_mfma_f32_16x16x32_bf16 v[0:3], a[192:195], v[128:131], v[96:99]
    v_exp_f32 v32, v32
    v_mfma_f32_16x16x32_bf16 v[4:7], a[192:195], v[144:147], v[100:103]
    ds_read_b128 a[208:211], v196 offset:50816
    v_cvt_pk_bf16_f32 v79, v30, v31
    v_mfma_f32_16x16x32_bf16 v[8:11], a[192:195], v[160:163], v[104:107]
    v_exp_f32 v33, v33
    v_mfma_f32_16x16x32_bf16 v[12:15], a[192:195], v[176:179], v[108:111]
    ds_read_b64_tr_b16 a[240:241], v197 offset:33920
    v_cvt_pk_bf16_f32 v80, v32, v33
    v_mfma_f32_16x16x32_bf16 a[0:3], a[224:227], v[64:67], a[0:3]
    v_exp_f32 v34, v34
    v_mfma_f32_16x16x32_bf16 a[4:7], a[224:227], v[68:71], a[4:7]
    ds_read_b64_tr_b16 a[242:243], v197 offset:34432
    s_add_u32 m0, s42, 16896
    v_mfma_f32_16x16x32_bf16 a[8:11], a[224:227], v[72:75], a[8:11]
    v_exp_f32 v35, v35
    v_mfma_f32_16x16x32_bf16 a[12:15], a[224:227], v[76:79], a[12:15]
    buffer_load_dwordx4 v202, s[16:19], s46 offen nt lds
    v_mfma_f32_16x16x32_bf16 v[16:19], a[196:199], v[128:131], v[96:99]
    v_exp_f32 v48, v48
    v_mfma_f32_16x16x32_bf16 v[20:23], a[196:199], v[144:147], v[100:103]
    ds_read_b128 a[212:215], v196 offset:51328
    v_cvt_pk_bf16_f32 v81, v34, v35
    v_mfma_f32_16x16x32_bf16 v[24:27], a[196:199], v[160:163], v[104:107]
    v_exp_f32 v49, v49
    v_mfma_f32_16x16x32_bf16 v[28:31], a[196:199], v[176:179], v[108:111]
    ds_read_b64_tr_b16 a[244:245], v197 offset:33952
    v_cvt_pk_bf16_f32 v82, v48, v49
    v_mfma_f32_16x16x32_bf16 a[16:19], a[228:231], v[64:67], a[16:19]
    v_exp_f32 v50, v50
    v_mfma_f32_16x16x32_bf16 a[20:23], a[228:231], v[68:71], a[20:23]
    ds_read_b64_tr_b16 a[246:247], v197 offset:34464
    v_mfma_f32_16x16x32_bf16 a[24:27], a[228:231], v[72:75], a[24:27]
    v_exp_f32 v51, v51
    v_mfma_f32_16x16x32_bf16 a[28:31], a[228:231], v[76:79], a[28:31]
    v_mfma_f32_16x16x32_bf16 v[112:115], v[192:195], v[64:67], v[112:115]
    s_waitcnt lgkmcnt(6)
    v_mfma_f32_16x16x32_bf16 v[0:3], a[200:203], v[132:135], v[0:3]
    v_exp_f32 v36, v36
    v_mfma_f32_16x16x32_bf16 v[4:7], a[200:203], v[148:151], v[4:7]
    ds_read_b128 a[216:219], v196 offset:50880
    v_cvt_pk_bf16_f32 v83, v50, v51
    v_mfma_f32_16x16x32_bf16 v[8:11], a[200:203], v[164:167], v[8:11]
    v_exp_f32 v37, v37
    v_mfma_f32_16x16x32_bf16 v[12:15], a[200:203], v[180:183], v[12:15]
    ds_read_b64_tr_b16 a[248:249], v197 offset:33984
    v_cvt_pk_bf16_f32 v84, v36, v37
    v_mfma_f32_16x16x32_bf16 a[32:35], a[232:235], v[64:67], a[32:35]
    v_exp_f32 v38, v38
    v_mfma_f32_16x16x32_bf16 a[36:39], a[232:235], v[68:71], a[36:39]
    ds_read_b64_tr_b16 a[250:251], v197 offset:34496
    v_mfma_f32_16x16x32_bf16 a[40:43], a[232:235], v[72:75], a[40:43]
    v_exp_f32 v39, v39
    v_mfma_f32_16x16x32_bf16 a[44:47], a[232:235], v[76:79], a[44:47]
    buffer_load_dwordx4 v203, s[16:19], s46 offen offset:1056 nt lds
    v_mfma_f32_16x16x32_bf16 v[16:19], a[204:207], v[132:135], v[16:19]
    v_exp_f32 v52, v52
    v_mfma_f32_16x16x32_bf16 v[20:23], a[204:207], v[148:151], v[20:23]
    ds_read_b128 a[220:223], v196 offset:51392
    v_cvt_pk_bf16_f32 v85, v38, v39
    v_mfma_f32_16x16x32_bf16 v[24:27], a[204:207], v[164:167], v[24:27]
    v_exp_f32 v53, v53
    v_mfma_f32_16x16x32_bf16 v[28:31], a[204:207], v[180:183], v[28:31]
    ds_read_b64_tr_b16 a[252:253], v197 offset:34016
    v_cvt_pk_bf16_f32 v86, v52, v53
    v_mfma_f32_16x16x32_bf16 a[48:51], a[236:239], v[64:67], a[48:51]
    v_exp_f32 v54, v54
    v_mfma_f32_16x16x32_bf16 a[52:55], a[236:239], v[68:71], a[52:55]
    ds_read_b64_tr_b16 a[254:255], v197 offset:34528
    s_add_u32 s46, s46, 8192
    v_mfma_f32_16x16x32_bf16 a[56:59], a[236:239], v[72:75], a[56:59]
    v_exp_f32 v55, v55
    v_mfma_f32_16x16x32_bf16 a[60:63], a[236:239], v[76:79], a[60:63]
    v_mfma_f32_16x16x32_bf16 v[116:119], v[192:195], v[68:71], v[116:119]
    s_waitcnt vmcnt(6) lgkmcnt(6)
    s_barrier
    v_mfma_f32_16x16x32_bf16 v[0:3], a[208:211], v[136:139], v[0:3]
    v_exp_f32 v40, v40
    v_mfma_f32_16x16x32_bf16 v[4:7], a[208:211], v[152:155], v[4:7]
    ds_read_b128 a[192:195], v196 offset:59136
    v_cvt_pk_bf16_f32 v87, v54, v55
    buffer_store_dwordx4 a[168:171], v205, s[20:23], s53 offen offset:2048 sc1
    v_mfma_f32_16x16x32_bf16 v[8:11], a[208:211], v[168:171], v[8:11]
    v_exp_f32 v41, v41
    v_mfma_f32_16x16x32_bf16 v[12:15], a[208:211], v[184:187], v[12:15]
    ds_read_b64_tr_b16 a[224:225], v197 offset:42240
    v_cvt_pk_bf16_f32 v88, v40, v41
    buffer_store_dwordx4 a[172:175], v205, s[20:23], s53 offen offset:3072 sc1
    v_mfma_f32_16x16x32_bf16 a[64:67], a[240:243], v[64:67], a[64:67]
    v_exp_f32 v42, v42
    v_mfma_f32_16x16x32_bf16 a[68:71], a[240:243], v[68:71], a[68:71]
    ds_read_b64_tr_b16 a[226:227], v197 offset:42752
    s_add_u32 m0, s41, 42240
    v_mfma_f32_16x16x32_bf16 a[72:75], a[240:243], v[72:75], a[72:75]
    v_exp_f32 v43, v43
    v_mfma_f32_16x16x32_bf16 a[76:79], a[240:243], v[76:79], a[76:79]
    buffer_load_dwordx4 v200, s[12:15], s46 offen nt lds
    v_mfma_f32_16x16x32_bf16 v[16:19], a[212:215], v[136:139], v[16:19]
    v_exp_f32 v56, v56
    v_mfma_f32_16x16x32_bf16 v[20:23], a[212:215], v[152:155], v[20:23]
    ds_read_b128 a[196:199], v196 offset:59648
    v_cvt_pk_bf16_f32 v89, v42, v43
    v_mfma_f32_16x16x32_bf16 v[24:27], a[212:215], v[168:171], v[24:27]
    v_exp_f32 v57, v57
    v_mfma_f32_16x16x32_bf16 v[28:31], a[212:215], v[184:187], v[28:31]
    ds_read_b64_tr_b16 a[228:229], v197 offset:42272
    v_cvt_pk_bf16_f32 v90, v56, v57
    v_mfma_f32_16x16x32_bf16 a[80:83], a[244:247], v[64:67], a[80:83]
    v_exp_f32 v58, v58
    v_mfma_f32_16x16x32_bf16 a[84:87], a[244:247], v[68:71], a[84:87]
    ds_read_b64_tr_b16 a[230:231], v197 offset:42784
    v_mfma_f32_16x16x32_bf16 a[88:91], a[244:247], v[72:75], a[88:91]
    v_exp_f32 v59, v59
    v_mfma_f32_16x16x32_bf16 a[92:95], a[244:247], v[76:79], a[92:95]
    v_mfma_f32_16x16x32_bf16 v[120:123], v[192:195], v[72:75], v[120:123]
    s_waitcnt lgkmcnt(6)
    v_mfma_f32_16x16x32_bf16 v[0:3], a[216:219], v[140:143], v[0:3]
    v_exp_f32 v44, v44
    v_mfma_f32_16x16x32_bf16 v[4:7], a[216:219], v[156:159], v[4:7]
    ds_read_b128 a[200:203], v196 offset:59200
    v_cvt_pk_bf16_f32 v91, v58, v59
    v_mfma_f32_16x16x32_bf16 v[8:11], a[216:219], v[172:175], v[8:11]
    v_exp_f32 v45, v45
    v_mfma_f32_16x16x32_bf16 v[12:15], a[216:219], v[188:191], v[12:15]
    ds_read_b64_tr_b16 a[232:233], v197 offset:42304
    v_cvt_pk_bf16_f32 v92, v44, v45
    v_mfma_f32_16x16x32_bf16 a[96:99], a[248:251], v[64:67], a[96:99]
    v_exp_f32 v46, v46
    v_mfma_f32_16x16x32_bf16 a[100:103], a[248:251], v[68:71], a[100:103]
    ds_read_b64_tr_b16 a[234:235], v197 offset:42816
    v_mfma_f32_16x16x32_bf16 a[104:107], a[248:251], v[72:75], a[104:107]
    v_exp_f32 v47, v47
    v_mfma_f32_16x16x32_bf16 a[108:111], a[248:251], v[76:79], a[108:111]
    buffer_load_dwordx4 v201, s[12:15], s46 offen offset:1056 nt lds
    v_mfma_f32_16x16x32_bf16 v[16:19], a[220:223], v[140:143], v[16:19]
    v_exp_f32 v60, v60
    v_mfma_f32_16x16x32_bf16 v[20:23], a[220:223], v[156:159], v[20:23]
    ds_read_b128 a[204:207], v196 offset:59712
    v_cvt_pk_bf16_f32 v93, v46, v47
    v_mfma_f32_16x16x32_bf16 v[24:27], a[220:223], v[172:175], v[24:27]
    v_exp_f32 v61, v61
    v_mfma_f32_16x16x32_bf16 v[28:31], a[220:223], v[188:191], v[28:31]
    ds_read_b64_tr_b16 a[236:237], v197 offset:42336
    v_cvt_pk_bf16_f32 v94, v60, v61
    v_mfma_f32_16x16x32_bf16 a[112:115], a[252:255], v[64:67], a[112:115]
    v_exp_f32 v62, v62
    v_mfma_f32_16x16x32_bf16 a[116:119], a[252:255], v[68:71], a[116:119]
    ds_read_b64_tr_b16 a[238:239], v197 offset:42848
    v_mfma_f32_16x16x32_bf16 a[120:123], a[252:255], v[72:75], a[120:123]
    v_exp_f32 v63, v63
    v_mfma_f32_16x16x32_bf16 a[124:127], a[252:255], v[76:79], a[124:127]
    v_mfma_f32_16x16x32_bf16 v[124:127], v[192:195], v[76:79], v[124:127]
    s_waitcnt vmcnt(6)
    s_waitcnt lgkmcnt(6)
    v_mfma_f32_16x16x32_bf16 v[32:35], a[192:195], v[128:131], v[96:99]
    v_exp_f32 v0, v0
    v_mfma_f32_16x16x32_bf16 v[36:39], a[192:195], v[144:147], v[100:103]
    ds_read_b128 a[208:211], v196 offset:59264
    v_cvt_pk_bf16_f32 v95, v62, v63
    v_mfma_f32_16x16x32_bf16 v[40:43], a[192:195], v[160:163], v[104:107]
    v_exp_f32 v1, v1
    v_mfma_f32_16x16x32_bf16 v[44:47], a[192:195], v[176:179], v[108:111]
    ds_read_b64_tr_b16 a[240:241], v197 offset:42368
    v_cvt_pk_bf16_f32 v64, v0, v1
    v_mfma_f32_16x16x32_bf16 a[0:3], a[224:227], v[80:83], a[0:3]
    v_exp_f32 v2, v2
    v_mfma_f32_16x16x32_bf16 a[4:7], a[224:227], v[84:87], a[4:7]
    ds_read_b64_tr_b16 a[242:243], v197 offset:42880
    s_add_u32 m0, s42, 25344
    v_mfma_f32_16x16x32_bf16 a[8:11], a[224:227], v[88:91], a[8:11]
    v_exp_f32 v3, v3
    v_mfma_f32_16x16x32_bf16 a[12:15], a[224:227], v[92:95], a[12:15]
    buffer_load_dwordx4 v202, s[16:19], s46 offen nt lds
    v_mfma_f32_16x16x32_bf16 v[48:51], a[196:199], v[128:131], v[96:99]
    v_exp_f32 v16, v16
    v_mfma_f32_16x16x32_bf16 v[52:55], a[196:199], v[144:147], v[100:103]
    ds_read_b128 a[212:215], v196 offset:59776
    v_cvt_pk_bf16_f32 v65, v2, v3
    v_mfma_f32_16x16x32_bf16 v[56:59], a[196:199], v[160:163], v[104:107]
    v_exp_f32 v17, v17
    v_mfma_f32_16x16x32_bf16 v[60:63], a[196:199], v[176:179], v[108:111]
    ds_read_b64_tr_b16 a[244:245], v197 offset:42400
    v_cvt_pk_bf16_f32 v66, v16, v17
    v_mfma_f32_16x16x32_bf16 a[16:19], a[228:231], v[80:83], a[16:19]
    v_exp_f32 v18, v18
    v_mfma_f32_16x16x32_bf16 a[20:23], a[228:231], v[84:87], a[20:23]
    ds_read_b64_tr_b16 a[246:247], v197 offset:42912
    v_mfma_f32_16x16x32_bf16 a[24:27], a[228:231], v[88:91], a[24:27]
    v_exp_f32 v19, v19
    v_mfma_f32_16x16x32_bf16 a[28:31], a[228:231], v[92:95], a[28:31]
    v_mfma_f32_16x16x32_bf16 v[112:115], v[192:195], v[80:83], v[112:115]
    s_waitcnt lgkmcnt(6)
    v_mfma_f32_16x16x32_bf16 v[32:35], a[200:203], v[132:135], v[32:35]
    v_exp_f32 v4, v4
    v_mfma_f32_16x16x32_bf16 v[36:39], a[200:203], v[148:151], v[36:39]
    ds_read_b128 a[216:219], v196 offset:59328
    v_cvt_pk_bf16_f32 v67, v18, v19
    v_mfma_f32_16x16x32_bf16 v[40:43], a[200:203], v[164:167], v[40:43]
    v_exp_f32 v5, v5
    v_mfma_f32_16x16x32_bf16 v[44:47], a[200:203], v[180:183], v[44:47]
    ds_read_b64_tr_b16 a[248:249], v197 offset:42432
    v_cvt_pk_bf16_f32 v68, v4, v5
    v_mfma_f32_16x16x32_bf16 a[32:35], a[232:235], v[80:83], a[32:35]
    v_exp_f32 v6, v6
    v_mfma_f32_16x16x32_bf16 a[36:39], a[232:235], v[84:87], a[36:39]
    ds_read_b64_tr_b16 a[250:251], v197 offset:42944
    v_mfma_f32_16x16x32_bf16 a[40:43], a[232:235], v[88:91], a[40:43]
    v_exp_f32 v7, v7
    v_mfma_f32_16x16x32_bf16 a[44:47], a[232:235], v[92:95], a[44:47]
    buffer_load_dwordx4 v203, s[16:19], s46 offen offset:1056 nt lds
    v_mfma_f32_16x16x32_bf16 v[48:51], a[204:207], v[132:135], v[48:51]
    v_exp_f32 v20, v20
    v_mfma_f32_16x16x32_bf16 v[52:55], a[204:207], v[148:151], v[52:55]
    ds_read_b128 a[220:223], v196 offset:59840
    v_cvt_pk_bf16_f32 v69, v6, v7
    v_mfma_f32_16x16x32_bf16 v[56:59], a[204:207], v[164:167], v[56:59]
    v_exp_f32 v21, v21
    v_mfma_f32_16x16x32_bf16 v[60:63], a[204:207], v[180:183], v[60:63]
    ds_read_b64_tr_b16 a[252:253], v197 offset:42464
    v_cvt_pk_bf16_f32 v70, v20, v21
    v_mfma_f32_16x16x32_bf16 a[48:51], a[236:239], v[80:83], a[48:51]
    v_exp_f32 v22, v22
    v_mfma_f32_16x16x32_bf16 a[52:55], a[236:239], v[84:87], a[52:55]
    ds_read_b64_tr_b16 a[254:255], v197 offset:42976
    s_add_u32 s46, s46, 8192
    v_mfma_f32_16x16x32_bf16 a[56:59], a[236:239], v[88:91], a[56:59]
    v_exp_f32 v23, v23
    v_mfma_f32_16x16x32_bf16 a[60:63], a[236:239], v[92:95], a[60:63]
    v_mfma_f32_16x16x32_bf16 v[116:119], v[192:195], v[84:87], v[116:119]
    s_waitcnt vmcnt(6) lgkmcnt(6)
    s_barrier
    v_mfma_f32_16x16x32_bf16 v[32:35], a[208:211], v[136:139], v[32:35]
    v_exp_f32 v8, v8
    s_add_u32 s53, s49, 4294725632
    v_mfma_f32_16x16x32_bf16 v[36:39], a[208:211], v[152:155], v[36:39]
    ds_read_b128 a[192:195], v196 offset:0
    v_cvt_pk_bf16_f32 v71, v22, v23
    buffer_store_dwordx4 a[176:179], v205, s[20:23], s53 offen offset:0 sc1
    v_mfma_f32_16x16x32_bf16 v[40:43], a[208:211], v[168:171], v[40:43]
    v_exp_f32 v9, v9
    v_mfma_f32_16x16x32_bf16 v[44:47], a[208:211], v[184:187], v[44:47]
    ds_read_b64_tr_b16 a[224:225], v197 offset:50688
    v_cvt_pk_bf16_f32 v72, v8, v9
    buffer_store_dwordx4 a[180:183], v205, s[20:23], s53 offen offset:1024 sc1
    v_mfma_f32_16x16x32_bf16 a[64:67], a[240:243], v[80:83], a[64:67]
    v_exp_f32 v10, v10
    v_mfma_f32_16x16x32_bf16 a[68:71], a[240:243], v[84:87], a[68:71]
    ds_read_b64_tr_b16 a[226:227], v197 offset:51200
    s_add_u32 m0, s41, 50688
    v_mfma_f32_16x16x32_bf16 a[72:75], a[240:243], v[88:91], a[72:75]
    v_exp_f32 v11, v11
    v_mfma_f32_16x16x32_bf16 a[76:79], a[240:243], v[92:95], a[76:79]
    buffer_load_dwordx4 v200, s[12:15], s46 offen nt lds
    v_mfma_f32_16x16x32_bf16 v[48:51], a[212:215], v[136:139], v[48:51]
    v_exp_f32 v24, v24
    v_mfma_f32_16x16x32_bf16 v[52:55], a[212:215], v[152:155], v[52:55]
    ds_read_b128 a[196:199], v196 offset:512
    v_cvt_pk_bf16_f32 v73, v10, v11
    v_mfma_f32_16x16x32_bf16 v[56:59], a[212:215], v[168:171], v[56:59]
    v_exp_f32 v25, v25
    v_mfma_f32_16x16x32_bf16 v[60:63], a[212:215], v[184:187], v[60:63]
    ds_read_b64_tr_b16 a[228:229], v197 offset:50720
    v_cvt_pk_bf16_f32 v74, v24, v25
    v_mfma_f32_16x16x32_bf16 a[80:83], a[244:247], v[80:83], a[80:83]
    v_exp_f32 v26, v26
    v_mfma_f32_16x16x32_bf16 a[84:87], a[244:247], v[84:87], a[84:87]
    ds_read_b64_tr_b16 a[230:231], v197 offset:51232
    v_mfma_f32_16x16x32_bf16 a[88:91], a[244:247], v[88:91], a[88:91]
    v_exp_f32 v27, v27
    v_mfma_f32_16x16x32_bf16 a[92:95], a[244:247], v[92:95], a[92:95]
    v_mfma_f32_16x16x32_bf16 v[120:123], v[192:195], v[88:91], v[120:123]
    s_waitcnt lgkmcnt(6)
    v_mfma_f32_16x16x32_bf16 v[32:35], a[216:219], v[140:143], v[32:35]
    v_exp_f32 v12, v12
    v_mfma_f32_16x16x32_bf16 v[36:39], a[216:219], v[156:159], v[36:39]
    ds_read_b128 a[200:203], v196 offset:64
    v_cvt_pk_bf16_f32 v75, v26, v27
    v_mfma_f32_16x16x32_bf16 v[40:43], a[216:219], v[172:175], v[40:43]
    v_exp_f32 v13, v13
    v_mfma_f32_16x16x32_bf16 v[44:47], a[216:219], v[188:191], v[44:47]
    ds_read_b64_tr_b16 a[232:233], v197 offset:50752
    v_cvt_pk_bf16_f32 v76, v12, v13
    v_mfma_f32_16x16x32_bf16 a[96:99], a[248:251], v[80:83], a[96:99]
    v_exp_f32 v14, v14
    v_mfma_f32_16x16x32_bf16 a[100:103], a[248:251], v[84:87], a[100:103]
    ds_read_b64_tr_b16 a[234:235], v197 offset:51264
    v_mfma_f32_16x16x32_bf16 a[104:107], a[248:251], v[88:91], a[104:107]
    v_exp_f32 v15, v15
    v_mfma_f32_16x16x32_bf16 a[108:111], a[248:251], v[92:95], a[108:111]
    buffer_load_dwordx4 v201, s[12:15], s46 offen offset:1056 nt lds
    v_mfma_f32_16x16x32_bf16 v[48:51], a[220:223], v[140:143], v[48:51]
    v_exp_f32 v28, v28
    v_mfma_f32_16x16x32_bf16 v[52:55], a[220:223], v[156:159], v[52:55]
    ds_read_b128 a[204:207], v196 offset:576
    v_cvt_pk_bf16_f32 v77, v14, v15
    v_mfma_f32_16x16x32_bf16 v[56:59], a[220:223], v[172:175], v[56:59]
    v_exp_f32 v29, v29
    v_mfma_f32_16x16x32_bf16 v[60:63], a[220:223], v[188:191], v[60:63]
    ds_read_b64_tr_b16 a[236:237], v197 offset:50784
    v_cvt_pk_bf16_f32 v78, v28, v29
    v_mfma_f32_16x16x32_bf16 a[112:115], a[252:255], v[80:83], a[112:115]
    v_exp_f32 v30, v30
    v_mfma_f32_16x16x32_bf16 a[116:119], a[252:255], v[84:87], a[116:119]
    ds_read_b64_tr_b16 a[238:239], v197 offset:51296
    v_mfma_f32_16x16x32_bf16 a[120:123], a[252:255], v[88:91], a[120:123]
    v_exp_f32 v31, v31
    v_mfma_f32_16x16x32_bf16 a[124:127], a[252:255], v[92:95], a[124:127]
    v_mfma_f32_16x16x32_bf16 v[124:127], v[192:195], v[92:95], v[124:127]
    s_waitcnt vmcnt(6)
    s_waitcnt lgkmcnt(6)
    v_mfma_f32_16x16x32_bf16 v[0:3], a[192:195], v[128:131], v[96:99]
    v_exp_f32 v32, v32
    v_mfma_f32_16x16x32_bf16 v[4:7], a[192:195], v[144:147], v[100:103]
    ds_read_b128 a[208:211], v196 offset:128
    v_cvt_pk_bf16_f32 v79, v30, v31
    v_mfma_f32_16x16x32_bf16 v[8:11], a[192:195], v[160:163], v[104:107]
    v_exp_f32 v33, v33
    v_mfma_f32_16x16x32_bf16 v[12:15], a[192:195], v[176:179], v[108:111]
    ds_read_b64_tr_b16 a[240:241], v197 offset:50816
    v_cvt_pk_bf16_f32 v80, v32, v33
    v_mfma_f32_16x16x32_bf16 a[0:3], a[224:227], v[64:67], a[0:3]
    v_exp_f32 v34, v34
    v_mfma_f32_16x16x32_bf16 a[4:7], a[224:227], v[68:71], a[4:7]
    ds_read_b64_tr_b16 a[242:243], v197 offset:51328
    s_add_u32 m0, s42, 33792
    v_mfma_f32_16x16x32_bf16 a[8:11], a[224:227], v[72:75], a[8:11]
    v_exp_f32 v35, v35
    v_mfma_f32_16x16x32_bf16 a[12:15], a[224:227], v[76:79], a[12:15]
    buffer_load_dwordx4 v202, s[16:19], s46 offen nt lds
    v_mfma_f32_16x16x32_bf16 v[16:19], a[196:199], v[128:131], v[96:99]
    v_exp_f32 v48, v48
    v_mfma_f32_16x16x32_bf16 v[20:23], a[196:199], v[144:147], v[100:103]
    ds_read_b128 a[212:215], v196 offset:640
    v_cvt_pk_bf16_f32 v81, v34, v35
    v_mfma_f32_16x16x32_bf16 v[24:27], a[196:199], v[160:163], v[104:107]
    v_exp_f32 v49, v49
    v_mfma_f32_16x16x32_bf16 v[28:31], a[196:199], v[176:179], v[108:111]
    ds_read_b64_tr_b16 a[244:245], v197 offset:50848
    v_cvt_pk_bf16_f32 v82, v48, v49
    v_mfma_f32_16x16x32_bf16 a[16:19], a[228:231], v[64:67], a[16:19]
    v_exp_f32 v50, v50
    v_mfma_f32_16x16x32_bf16 a[20:23], a[228:231], v[68:71], a[20:23]
    ds_read_b64_tr_b16 a[246:247], v197 offset:51360
    v_mfma_f32_16x16x32_bf16 a[24:27], a[228:231], v[72:75], a[24:27]
    v_exp_f32 v51, v51
    v_mfma_f32_16x16x32_bf16 a[28:31], a[228:231], v[76:79], a[28:31]
    v_mfma_f32_16x16x32_bf16 v[112:115], v[192:195], v[64:67], v[112:115]
    s_waitcnt lgkmcnt(6)
    v_mfma_f32_16x16x32_bf16 v[0:3], a[200:203], v[132:135], v[0:3]
    v_exp_f32 v36, v36
    v_mfma_f32_16x16x32_bf16 v[4:7], a[200:203], v[148:151], v[4:7]
    ds_read_b128 a[216:219], v196 offset:192
    v_cvt_pk_bf16_f32 v83, v50, v51
    v_mfma_f32_16x16x32_bf16 v[8:11], a[200:203], v[164:167], v[8:11]
    v_exp_f32 v37, v37
    v_mfma_f32_16x16x32_bf16 v[12:15], a[200:203], v[180:183], v[12:15]
    ds_read_b64_tr_b16 a[248:249], v197 offset:50880
    v_cvt_pk_bf16_f32 v84, v36, v37
    v_mfma_f32_16x16x32_bf16 a[32:35], a[232:235], v[64:67], a[32:35]
    v_exp_f32 v38, v38
    v_mfma_f32_16x16x32_bf16 a[36:39], a[232:235], v[68:71], a[36:39]
    ds_read_b64_tr_b16 a[250:251], v197 offset:51392
    v_mfma_f32_16x16x32_bf16 a[40:43], a[232:235], v[72:75], a[40:43]
    v_exp_f32 v39, v39
    v_mfma_f32_16x16x32_bf16 a[44:47], a[232:235], v[76:79], a[44:47]
    buffer_load_dwordx4 v203, s[16:19], s46 offen offset:1056 nt lds
    v_mfma_f32_16x16x32_bf16 v[16:19], a[204:207], v[132:135], v[16:19]
    v_exp_f32 v52, v52
    v_mfma_f32_16x16x32_bf16 v[20:23], a[204:207], v[148:151], v[20:23]
    ds_read_b128 a[220:223], v196 offset:704
    v_cvt_pk_bf16_f32 v85, v38, v39
    v_mfma_f32_16x16x32_bf16 v[24:27], a[204:207], v[164:167], v[24:27]
    v_exp_f32 v53, v53
    v_mfma_f32_16x16x32_bf16 v[28:31], a[204:207], v[180:183], v[28:31]
    ds_read_b64_tr_b16 a[252:253], v197 offset:50912
    v_cvt_pk_bf16_f32 v86, v52, v53
    v_mfma_f32_16x16x32_bf16 a[48:51], a[236:239], v[64:67], a[48:51]
    v_exp_f32 v54, v54
    v_mfma_f32_16x16x32_bf16 a[52:55], a[236:239], v[68:71], a[52:55]
    ds_read_b64_tr_b16 a[254:255], v197 offset:51424
    s_add_u32 s46, s46, 8192
    v_mfma_f32_16x16x32_bf16 a[56:59], a[236:239], v[72:75], a[56:59]
    v_exp_f32 v55, v55
    v_mfma_f32_16x16x32_bf16 a[60:63], a[236:239], v[76:79], a[60:63]
    v_mfma_f32_16x16x32_bf16 v[116:119], v[192:195], v[68:71], v[116:119]
    s_waitcnt vmcnt(6) lgkmcnt(6)
    s_barrier
    v_mfma_f32_16x16x32_bf16 v[0:3], a[208:211], v[136:139], v[0:3]
    v_exp_f32 v40, v40
    v_mfma_f32_16x16x32_bf16 v[4:7], a[208:211], v[152:155], v[4:7]
    ds_read_b128 a[192:195], v196 offset:8448
    v_cvt_pk_bf16_f32 v87, v54, v55
    buffer_store_dwordx4 a[184:187], v205, s[20:23], s53 offen offset:2048 sc1
    v_mfma_f32_16x16x32_bf16 v[8:11], a[208:211], v[168:171], v[8:11]
    v_exp_f32 v41, v41
    v_mfma_f32_16x16x32_bf16 v[12:15], a[208:211], v[184:187], v[12:15]
    ds_read_b64_tr_b16 a[224:225], v197 offset:59136
    v_cvt_pk_bf16_f32 v88, v40, v41
    buffer_store_dwordx4 a[188:191], v205, s[20:23], s53 offen offset:3072 sc1
    v_mfma_f32_16x16x32_bf16 a[64:67], a[240:243], v[64:67], a[64:67]
    v_exp_f32 v42, v42
    v_mfma_f32_16x16x32_bf16 a[68:71], a[240:243], v[68:71], a[68:71]
    ds_read_b64_tr_b16 a[226:227], v197 offset:59648
    s_add_u32 m0, s41, 59136
    v_mfma_f32_16x16x32_bf16 a[72:75], a[240:243], v[72:75], a[72:75]
    v_exp_f32 v43, v43
    v_mfma_f32_16x16x32_bf16 a[76:79], a[240:243], v[76:79], a[76:79]
    buffer_load_dwordx4 v200, s[12:15], s46 offen nt lds
    v_mfma_f32_16x16x32_bf16 v[16:19], a[212:215], v[136:139], v[16:19]
    v_exp_f32 v56, v56
    v_mfma_f32_16x16x32_bf16 v[20:23], a[212:215], v[152:155], v[20:23]
    ds_read_b128 a[196:199], v196 offset:8960
    v_cvt_pk_bf16_f32 v89, v42, v43
    v_mfma_f32_16x16x32_bf16 v[24:27], a[212:215], v[168:171], v[24:27]
    v_exp_f32 v57, v57
    v_mfma_f32_16x16x32_bf16 v[28:31], a[212:215], v[184:187], v[28:31]
    ds_read_b64_tr_b16 a[228:229], v197 offset:59168
    v_cvt_pk_bf16_f32 v90, v56, v57
    v_mfma_f32_16x16x32_bf16 a[80:83], a[244:247], v[64:67], a[80:83]
    v_exp_f32 v58, v58
    v_mfma_f32_16x16x32_bf16 a[84:87], a[244:247], v[68:71], a[84:87]
    ds_read_b64_tr_b16 a[230:231], v197 offset:59680
    v_mfma_f32_16x16x32_bf16 a[88:91], a[244:247], v[72:75], a[88:91]
    v_exp_f32 v59, v59
    v_mfma_f32_16x16x32_bf16 a[92:95], a[244:247], v[76:79], a[92:95]
    v_mfma_f32_16x16x32_bf16 v[120:123], v[192:195], v[72:75], v[120:123]
    s_waitcnt lgkmcnt(6)
    v_mfma_f32_16x16x32_bf16 v[0:3], a[216:219], v[140:143], v[0:3]
    v_exp_f32 v44, v44
    v_mfma_f32_16x16x32_bf16 v[4:7], a[216:219], v[156:159], v[4:7]
    ds_read_b128 a[200:203], v196 offset:8512
    v_cvt_pk_bf16_f32 v91, v58, v59
    v_mfma_f32_16x16x32_bf16 v[8:11], a[216:219], v[172:175], v[8:11]
    v_exp_f32 v45, v45
    v_mfma_f32_16x16x32_bf16 v[12:15], a[216:219], v[188:191], v[12:15]
    ds_read_b64_tr_b16 a[232:233], v197 offset:59200
    v_cvt_pk_bf16_f32 v92, v44, v45
    v_mfma_f32_16x16x32_bf16 a[96:99], a[248:251], v[64:67], a[96:99]
    v_exp_f32 v46, v46
    v_mfma_f32_16x16x32_bf16 a[100:103], a[248:251], v[68:71], a[100:103]
    ds_read_b64_tr_b16 a[234:235], v197 offset:59712
    v_mfma_f32_16x16x32_bf16 a[104:107], a[248:251], v[72:75], a[104:107]
    v_exp_f32 v47, v47
    v_mfma_f32_16x16x32_bf16 a[108:111], a[248:251], v[76:79], a[108:111]
    buffer_load_dwordx4 v201, s[12:15], s46 offen offset:1056 nt lds
    v_mfma_f32_16x16x32_bf16 v[16:19], a[220:223], v[140:143], v[16:19]
    v_exp_f32 v60, v60
    v_mfma_f32_16x16x32_bf16 v[20:23], a[220:223], v[156:159], v[20:23]
    ds_read_b128 a[204:207], v196 offset:9024
    v_cvt_pk_bf16_f32 v93, v46, v47
    v_mfma_f32_16x16x32_bf16 v[24:27], a[220:223], v[172:175], v[24:27]
    v_exp_f32 v61, v61
    v_mfma_f32_16x16x32_bf16 v[28:31], a[220:223], v[188:191], v[28:31]
    ds_read_b64_tr_b16 a[236:237], v197 offset:59232
    v_cvt_pk_bf16_f32 v94, v60, v61
    v_mfma_f32_16x16x32_bf16 a[112:115], a[252:255], v[64:67], a[112:115]
    v_exp_f32 v62, v62
    v_mfma_f32_16x16x32_bf16 a[116:119], a[252:255], v[68:71], a[116:119]
    ds_read_b64_tr_b16 a[238:239], v197 offset:59744
    v_mfma_f32_16x16x32_bf16 a[120:123], a[252:255], v[72:75], a[120:123]
    v_exp_f32 v63, v63
    v_mfma_f32_16x16x32_bf16 a[124:127], a[252:255], v[76:79], a[124:127]
    v_mfma_f32_16x16x32_bf16 v[124:127], v[192:195], v[76:79], v[124:127]
    s_waitcnt vmcnt(6)
    s_waitcnt lgkmcnt(6)
    v_mfma_f32_16x16x32_bf16 v[32:35], a[192:195], v[128:131], v[96:99]
    v_exp_f32 v0, v0
    v_mfma_f32_16x16x32_bf16 v[36:39], a[192:195], v[144:147], v[100:103]
    ds_read_b128 a[208:211], v196 offset:8576
    v_cvt_pk_bf16_f32 v95, v62, v63
    v_mfma_f32_16x16x32_bf16 v[40:43], a[192:195], v[160:163], v[104:107]
    v_exp_f32 v1, v1
    v_mfma_f32_16x16x32_bf16 v[44:47], a[192:195], v[176:179], v[108:111]
    ds_read_b64_tr_b16 a[240:241], v197 offset:59264
    v_cvt_pk_bf16_f32 v64, v0, v1
    v_mfma_f32_16x16x32_bf16 a[0:3], a[224:227], v[80:83], a[0:3]
    v_exp_f32 v2, v2
    v_mfma_f32_16x16x32_bf16 a[4:7], a[224:227], v[84:87], a[4:7]
    ds_read_b64_tr_b16 a[242:243], v197 offset:59776
    s_add_u32 m0, s42, 42240
    v_mfma_f32_16x16x32_bf16 a[8:11], a[224:227], v[88:91], a[8:11]
    v_exp_f32 v3, v3
    v_mfma_f32_16x16x32_bf16 a[12:15], a[224:227], v[92:95], a[12:15]
    buffer_load_dwordx4 v202, s[16:19], s46 offen nt lds
    v_mfma_f32_16x16x32_bf16 v[48:51], a[196:199], v[128:131], v[96:99]
    v_exp_f32 v16, v16
    v_mfma_f32_16x16x32_bf16 v[52:55], a[196:199], v[144:147], v[100:103]
    ds_read_b128 a[212:215], v196 offset:9088
    v_cvt_pk_bf16_f32 v65, v2, v3
    v_mfma_f32_16x16x32_bf16 v[56:59], a[196:199], v[160:163], v[104:107]
    v_exp_f32 v17, v17
    v_mfma_f32_16x16x32_bf16 v[60:63], a[196:199], v[176:179], v[108:111]
    ds_read_b64_tr_b16 a[244:245], v197 offset:59296
    v_cvt_pk_bf16_f32 v66, v16, v17
    v_mfma_f32_16x16x32_bf16 a[16:19], a[228:231], v[80:83], a[16:19]
    v_exp_f32 v18, v18
    v_mfma_f32_16x16x32_bf16 a[20:23], a[228:231], v[84:87], a[20:23]
    ds_read_b64_tr_b16 a[246:247], v197 offset:59808
    v_mfma_f32_16x16x32_bf16 a[24:27], a[228:231], v[88:91], a[24:27]
    v_exp_f32 v19, v19
    v_mfma_f32_16x16x32_bf16 a[28:31], a[228:231], v[92:95], a[28:31]
    v_mfma_f32_16x16x32_bf16 v[112:115], v[192:195], v[80:83], v[112:115]
    s_waitcnt lgkmcnt(6)
    v_mfma_f32_16x16x32_bf16 v[32:35], a[200:203], v[132:135], v[32:35]
    v_exp_f32 v4, v4
    v_mfma_f32_16x16x32_bf16 v[36:39], a[200:203], v[148:151], v[36:39]
    ds_read_b128 a[216:219], v196 offset:8640
    v_cvt_pk_bf16_f32 v67, v18, v19
    v_mfma_f32_16x16x32_bf16 v[40:43], a[200:203], v[164:167], v[40:43]
    v_exp_f32 v5, v5
    v_mfma_f32_16x16x32_bf16 v[44:47], a[200:203], v[180:183], v[44:47]
    ds_read_b64_tr_b16 a[248:249], v197 offset:59328
    v_cvt_pk_bf16_f32 v68, v4, v5
    v_mfma_f32_16x16x32_bf16 a[32:35], a[232:235], v[80:83], a[32:35]
    v_exp_f32 v6, v6
    v_mfma_f32_16x16x32_bf16 a[36:39], a[232:235], v[84:87], a[36:39]
    ds_read_b64_tr_b16 a[250:251], v197 offset:59840
    v_mfma_f32_16x16x32_bf16 a[40:43], a[232:235], v[88:91], a[40:43]
    v_exp_f32 v7, v7
    v_mfma_f32_16x16x32_bf16 a[44:47], a[232:235], v[92:95], a[44:47]
    buffer_load_dwordx4 v203, s[16:19], s46 offen offset:1056 nt lds
    v_mfma_f32_16x16x32_bf16 v[48:51], a[204:207], v[132:135], v[48:51]
    v_exp_f32 v20, v20
    v_mfma_f32_16x16x32_bf16 v[52:55], a[204:207], v[148:151], v[52:55]
    ds_read_b128 a[220:223], v196 offset:9152
    v_cvt_pk_bf16_f32 v69, v6, v7
    v_mfma_f32_16x16x32_bf16 v[56:59], a[204:207], v[164:167], v[56:59]
    v_exp_f32 v21, v21
    v_mfma_f32_16x16x32_bf16 v[60:63], a[204:207], v[180:183], v[60:63]
    ds_read_b64_tr_b16 a[252:253], v197 offset:59360
    v_cvt_pk_bf16_f32 v70, v20, v21
    v_mfma_f32_16x16x32_bf16 a[48:51], a[236:239], v[80:83], a[48:51]
    v_exp_f32 v22, v22
    v_mfma_f32_16x16x32_bf16 a[52:55], a[236:239], v[84:87], a[52:55]
    ds_read_b64_tr_b16 a[254:255], v197 offset:59872
    s_add_u32 s46, s46, 8192
    v_mfma_f32_16x16x32_bf16 a[56:59], a[236:239], v[88:91], a[56:59]
    v_exp_f32 v23, v23
    v_mfma_f32_16x16x32_bf16 a[60:63], a[236:239], v[92:95], a[60:63]
    v_mfma_f32_16x16x32_bf16 v[116:119], v[192:195], v[84:87], v[116:119]
    s_waitcnt vmcnt(6) lgkmcnt(6)
    s_barrier
    v_mfma_f32_16x16x32_bf16 v[32:35], a[208:211], v[136:139], v[32:35]
    v_exp_f32 v8, v8
    v_mfma_f32_16x16x32_bf16 v[36:39], a[208:211], v[152:155], v[36:39]
    ds_read_b128 a[192:195], v196 offset:16896
    v_cvt_pk_bf16_f32 v71, v22, v23
    v_mfma_f32_16x16x32_bf16 v[40:43], a[208:211], v[168:171], v[40:43]
    v_exp_f32 v9, v9
    v_mfma_f32_16x16x32_bf16 v[44:47], a[208:211], v[184:187], v[44:47]
    ds_read_b64_tr_b16 a[224:225], v197 offset:0
    v_cvt_pk_bf16_f32 v72, v8, v9
    v_mfma_f32_16x16x32_bf16 a[64:67], a[240:243], v[80:83], a[64:67]
    v_exp_f32 v10, v10
    v_mfma_f32_16x16x32_bf16 a[68:71], a[240:243], v[84:87], a[68:71]
    ds_read_b64_tr_b16 a[226:227], v197 offset:512
    s_add_u32 m0, s41, 0
    v_mfma_f32_16x16x32_bf16 a[72:75], a[240:243], v[88:91], a[72:75]
    v_exp_f32 v11, v11
    v_mfma_f32_16x16x32_bf16 a[76:79], a[240:243], v[92:95], a[76:79]
    buffer_load_dwordx4 v200, s[12:15], s46 offen nt lds
    v_mfma_f32_16x16x32_bf16 v[48:51], a[212:215], v[136:139], v[48:51]
    v_exp_f32 v24, v24
    v_mfma_f32_16x16x32_bf16 v[52:55], a[212:215], v[152:155], v[52:55]
    ds_read_b128 a[196:199], v196 offset:17408
    v_cvt_pk_bf16_f32 v73, v10, v11
    v_mfma_f32_16x16x32_bf16 v[56:59], a[212:215], v[168:171], v[56:59]
    v_exp_f32 v25, v25
    v_mfma_f32_16x16x32_bf16 v[60:63], a[212:215], v[184:187], v[60:63]
    ds_read_b64_tr_b16 a[228:229], v197 offset:32
    v_cvt_pk_bf16_f32 v74, v24, v25
    v_mfma_f32_16x16x32_bf16 a[80:83], a[244:247], v[80:83], a[80:83]
    v_exp_f32 v26, v26
    v_mfma_f32_16x16x32_bf16 a[84:87], a[244:247], v[84:87], a[84:87]
    ds_read_b64_tr_b16 a[230:231], v197 offset:544
    v_mfma_f32_16x16x32_bf16 a[88:91], a[244:247], v[88:91], a[88:91]
    v_exp_f32 v27, v27
    v_mfma_f32_16x16x32_bf16 a[92:95], a[244:247], v[92:95], a[92:95]
    v_mfma_f32_16x16x32_bf16 v[120:123], v[192:195], v[88:91], v[120:123]
    s_waitcnt lgkmcnt(6)
    v_mfma_f32_16x16x32_bf16 v[32:35], a[216:219], v[140:143], v[32:35]
    v_exp_f32 v12, v12
    v_mfma_f32_16x16x32_bf16 v[36:39], a[216:219], v[156:159], v[36:39]
    ds_read_b128 a[200:203], v196 offset:16960
    v_cvt_pk_bf16_f32 v75, v26, v27
    v_mfma_f32_16x16x32_bf16 v[40:43], a[216:219], v[172:175], v[40:43]
    v_exp_f32 v13, v13
    v_mfma_f32_16x16x32_bf16 v[44:47], a[216:219], v[188:191], v[44:47]
    ds_read_b64_tr_b16 a[232:233], v197 offset:64
    v_cvt_pk_bf16_f32 v76, v12, v13
    v_mfma_f32_16x16x32_bf16 a[96:99], a[248:251], v[80:83], a[96:99]
    v_exp_f32 v14, v14
    v_mfma_f32_16x16x32_bf16 a[100:103], a[248:251], v[84:87], a[100:103]
    ds_read_b64_tr_b16 a[234:235], v197 offset:576
    v_mfma_f32_16x16x32_bf16 a[104:107], a[248:251], v[88:91], a[104:107]
    v_exp_f32 v15, v15
    v_mfma_f32_16x16x32_bf16 a[108:111], a[248:251], v[92:95], a[108:111]
    buffer_load_dwordx4 v201, s[12:15], s46 offen offset:1056 nt lds
    v_mfma_f32_16x16x32_bf16 v[48:51], a[220:223], v[140:143], v[48:51]
    v_exp_f32 v28, v28
    v_mfma_f32_16x16x32_bf16 v[52:55], a[220:223], v[156:159], v[52:55]
    ds_read_b128 a[204:207], v196 offset:17472
    v_cvt_pk_bf16_f32 v77, v14, v15
    v_mfma_f32_16x16x32_bf16 v[56:59], a[220:223], v[172:175], v[56:59]
    v_exp_f32 v29, v29
    v_mfma_f32_16x16x32_bf16 v[60:63], a[220:223], v[188:191], v[60:63]
    ds_read_b64_tr_b16 a[236:237], v197 offset:96
    v_cvt_pk_bf16_f32 v78, v28, v29
    v_mfma_f32_16x16x32_bf16 a[112:115], a[252:255], v[80:83], a[112:115]
    v_exp_f32 v30, v30
    v_mfma_f32_16x16x32_bf16 a[116:119], a[252:255], v[84:87], a[116:119]
    ds_read_b64_tr_b16 a[238:239], v197 offset:608
    v_mfma_f32_16x16x32_bf16 a[120:123], a[252:255], v[88:91], a[120:123]
    v_exp_f32 v31, v31
    v_mfma_f32_16x16x32_bf16 a[124:127], a[252:255], v[92:95], a[124:127]
    v_mfma_f32_16x16x32_bf16 v[124:127], v[192:195], v[92:95], v[124:127]
    s_waitcnt vmcnt(4)
    s_waitcnt lgkmcnt(6)
    v_mfma_f32_16x16x32_bf16 v[0:3], a[192:195], v[128:131], v[96:99]
    v_exp_f32 v32, v32
    v_mfma_f32_16x16x32_bf16 v[4:7], a[192:195], v[144:147], v[100:103]
    ds_read_b128 a[208:211], v196 offset:17024
    v_cvt_pk_bf16_f32 v79, v30, v31
    v_mfma_f32_16x16x32_bf16 v[8:11], a[192:195], v[160:163], v[104:107]
    v_exp_f32 v33, v33
    v_mfma_f32_16x16x32_bf16 v[12:15], a[192:195], v[176:179], v[108:111]
    ds_read_b64_tr_b16 a[240:241], v197 offset:128
    v_cvt_pk_bf16_f32 v80, v32, v33
    v_mfma_f32_16x16x32_bf16 a[0:3], a[224:227], v[64:67], a[0:3]
    v_exp_f32 v34, v34
    v_mfma_f32_16x16x32_bf16 a[4:7], a[224:227], v[68:71], a[4:7]
    ds_read_b64_tr_b16 a[242:243], v197 offset:640
    s_add_u32 m0, s42, 50688
    v_mfma_f32_16x16x32_bf16 a[8:11], a[224:227], v[72:75], a[8:11]
    v_exp_f32 v35, v35
    v_mfma_f32_16x16x32_bf16 a[12:15], a[224:227], v[76:79], a[12:15]
    buffer_load_dwordx4 v202, s[16:19], s46 offen nt lds
    v_mfma_f32_16x16x32_bf16 v[16:19], a[196:199], v[128:131], v[96:99]
    v_exp_f32 v48, v48
    v_mfma_f32_16x16x32_bf16 v[20:23], a[196:199], v[144:147], v[100:103]
    ds_read_b128 a[212:215], v196 offset:17536
    v_cvt_pk_bf16_f32 v81, v34, v35
    v_mfma_f32_16x16x32_bf16 v[24:27], a[196:199], v[160:163], v[104:107]
    v_exp_f32 v49, v49
    v_mfma_f32_16x16x32_bf16 v[28:31], a[196:199], v[176:179], v[108:111]
    ds_read_b64_tr_b16 a[244:245], v197 offset:160
    v_cvt_pk_bf16_f32 v82, v48, v49
    v_mfma_f32_16x16x32_bf16 a[16:19], a[228:231], v[64:67], a[16:19]
    v_exp_f32 v50, v50
    v_mfma_f32_16x16x32_bf16 a[20:23], a[228:231], v[68:71], a[20:23]
    ds_read_b64_tr_b16 a[246:247], v197 offset:672
    v_mfma_f32_16x16x32_bf16 a[24:27], a[228:231], v[72:75], a[24:27]
    v_exp_f32 v51, v51
    v_mfma_f32_16x16x32_bf16 a[28:31], a[228:231], v[76:79], a[28:31]
    v_mfma_f32_16x16x32_bf16 v[112:115], v[192:195], v[64:67], v[112:115]
    s_waitcnt lgkmcnt(6)
    v_mfma_f32_16x16x32_bf16 v[0:3], a[200:203], v[132:135], v[0:3]
    v_exp_f32 v36, v36
    v_mfma_f32_16x16x32_bf16 v[4:7], a[200:203], v[148:151], v[4:7]
    ds_read_b128 a[216:219], v196 offset:17088
    v_cvt_pk_bf16_f32 v83, v50, v51
    v_mfma_f32_16x16x32_bf16 v[8:11], a[200:203], v[164:167], v[8:11]
    v_exp_f32 v37, v37
    v_mfma_f32_16x16x32_bf16 v[12:15], a[200:203], v[180:183], v[12:15]
    ds_read_b64_tr_b16 a[248:249], v197 offset:192
    v_cvt_pk_bf16_f32 v84, v36, v37
    v_mfma_f32_16x16x32_bf16 a[32:35], a[232:235], v[64:67], a[32:35]
    v_exp_f32 v38, v38
    v_mfma_f32_16x16x32_bf16 a[36:39], a[232:235], v[68:71], a[36:39]
    ds_read_b64_tr_b16 a[250:251], v197 offset:704
    v_mfma_f32_16x16x32_bf16 a[40:43], a[232:235], v[72:75], a[40:43]
    v_exp_f32 v39, v39
    v_mfma_f32_16x16x32_bf16 a[44:47], a[232:235], v[76:79], a[44:47]
    buffer_load_dwordx4 v203, s[16:19], s46 offen offset:1056 nt lds
    v_mfma_f32_16x16x32_bf16 v[16:19], a[204:207], v[132:135], v[16:19]
    v_exp_f32 v52, v52
    v_mfma_f32_16x16x32_bf16 v[20:23], a[204:207], v[148:151], v[20:23]
    ds_read_b128 a[220:223], v196 offset:17600
    v_cvt_pk_bf16_f32 v85, v38, v39
    v_mfma_f32_16x16x32_bf16 v[24:27], a[204:207], v[164:167], v[24:27]
    v_exp_f32 v53, v53
    v_mfma_f32_16x16x32_bf16 v[28:31], a[204:207], v[180:183], v[28:31]
    ds_read_b64_tr_b16 a[252:253], v197 offset:224
    v_cvt_pk_bf16_f32 v86, v52, v53
    v_mfma_f32_16x16x32_bf16 a[48:51], a[236:239], v[64:67], a[48:51]
    v_exp_f32 v54, v54
    v_mfma_f32_16x16x32_bf16 a[52:55], a[236:239], v[68:71], a[52:55]
    ds_read_b64_tr_b16 a[254:255], v197 offset:736
    s_add_u32 s46, s46, 8192
    v_mfma_f32_16x16x32_bf16 a[56:59], a[236:239], v[72:75], a[56:59]
    v_exp_f32 v55, v55
    v_mfma_f32_16x16x32_bf16 a[60:63], a[236:239], v[76:79], a[60:63]
    v_mfma_f32_16x16x32_bf16 v[116:119], v[192:195], v[68:71], v[116:119]
    s_waitcnt vmcnt(4) lgkmcnt(6)
    s_barrier
    v_mfma_f32_16x16x32_bf16 v[0:3], a[208:211], v[136:139], v[0:3]
    v_exp_f32 v40, v40
    v_mfma_f32_16x16x32_bf16 v[4:7], a[208:211], v[152:155], v[4:7]
    ds_read_b128 a[192:195], v196 offset:25344
    v_cvt_pk_bf16_f32 v87, v54, v55
    s_add_u32 s56, s52, 0
    v_mov_b32 v222, s43
    v_mov_b32 v223, s56
    s_cmp_eq_u32 s40, 0
    s_cselect_b64 exec, 1, 0
    global_store_dword v222, v223, s[94:95] sc1
    s_mov_b64 exec, -1
    v_mfma_f32_16x16x32_bf16 v[8:11], a[208:211], v[168:171], v[8:11]
    v_exp_f32 v41, v41
    v_mfma_f32_16x16x32_bf16 v[12:15], a[208:211], v[184:187], v[12:15]
    ds_read_b64_tr_b16 a[224:225], v197 offset:8448
    v_cvt_pk_bf16_f32 v88, v40, v41
    v_mfma_f32_16x16x32_bf16 a[64:67], a[240:243], v[64:67], a[64:67]
    v_exp_f32 v42, v42
    v_mfma_f32_16x16x32_bf16 a[68:71], a[240:243], v[68:71], a[68:71]
    ds_read_b64_tr_b16 a[226:227], v197 offset:8960
    s_add_u32 m0, s41, 8448
    v_mfma_f32_16x16x32_bf16 a[72:75], a[240:243], v[72:75], a[72:75]
    v_exp_f32 v43, v43
    v_mfma_f32_16x16x32_bf16 a[76:79], a[240:243], v[76:79], a[76:79]
    buffer_load_dwordx4 v200, s[12:15], s46 offen nt lds
    v_mfma_f32_16x16x32_bf16 v[16:19], a[212:215], v[136:139], v[16:19]
    v_exp_f32 v56, v56
    v_mfma_f32_16x16x32_bf16 v[20:23], a[212:215], v[152:155], v[20:23]
    ds_read_b128 a[196:199], v196 offset:25856
    v_cvt_pk_bf16_f32 v89, v42, v43
    v_mfma_f32_16x16x32_bf16 v[24:27], a[212:215], v[168:171], v[24:27]
    v_exp_f32 v57, v57
    v_mfma_f32_16x16x32_bf16 v[28:31], a[212:215], v[184:187], v[28:31]
    ds_read_b64_tr_b16 a[228:229], v197 offset:8480
    v_cvt_pk_bf16_f32 v90, v56, v57
    v_mfma_f32_16x16x32_bf16 a[80:83], a[244:247], v[64:67], a[80:83]
    v_exp_f32 v58, v58
    v_mfma_f32_16x16x32_bf16 a[84:87], a[244:247], v[68:71], a[84:87]
    ds_read_b64_tr_b16 a[230:231], v197 offset:8992
    v_mfma_f32_16x16x32_bf16 a[88:91], a[244:247], v[72:75], a[88:91]
    v_exp_f32 v59, v59
    v_mfma_f32_16x16x32_bf16 a[92:95], a[244:247], v[76:79], a[92:95]
    v_mfma_f32_16x16x32_bf16 v[120:123], v[192:195], v[72:75], v[120:123]
    s_waitcnt lgkmcnt(6)
    v_mfma_f32_16x16x32_bf16 v[0:3], a[216:219], v[140:143], v[0:3]
    v_exp_f32 v44, v44
    v_mfma_f32_16x16x32_bf16 v[4:7], a[216:219], v[156:159], v[4:7]
    ds_read_b128 a[200:203], v196 offset:25408
    v_cvt_pk_bf16_f32 v91, v58, v59
    v_mfma_f32_16x16x32_bf16 v[8:11], a[216:219], v[172:175], v[8:11]
    v_exp_f32 v45, v45
    v_mfma_f32_16x16x32_bf16 v[12:15], a[216:219], v[188:191], v[12:15]
    ds_read_b64_tr_b16 a[232:233], v197 offset:8512
    v_cvt_pk_bf16_f32 v92, v44, v45
    v_mfma_f32_16x16x32_bf16 a[96:99], a[248:251], v[64:67], a[96:99]
    v_exp_f32 v46, v46
    v_mfma_f32_16x16x32_bf16 a[100:103], a[248:251], v[68:71], a[100:103]
    ds_read_b64_tr_b16 a[234:235], v197 offset:9024
    v_mfma_f32_16x16x32_bf16 a[104:107], a[248:251], v[72:75], a[104:107]
    v_exp_f32 v47, v47
    v_mfma_f32_16x16x32_bf16 a[108:111], a[248:251], v[76:79], a[108:111]
    buffer_load_dwordx4 v201, s[12:15], s46 offen offset:1056 nt lds
    v_mfma_f32_16x16x32_bf16 v[16:19], a[220:223], v[140:143], v[16:19]
    v_exp_f32 v60, v60
    v_mfma_f32_16x16x32_bf16 v[20:23], a[220:223], v[156:159], v[20:23]
    ds_read_b128 a[204:207], v196 offset:25920
    v_cvt_pk_bf16_f32 v93, v46, v47
    v_mfma_f32_16x16x32_bf16 v[24:27], a[220:223], v[172:175], v[24:27]
    v_exp_f32 v61, v61
    v_mfma_f32_16x16x32_bf16 v[28:31], a[220:223], v[188:191], v[28:31]
    ds_read_b64_tr_b16 a[236:237], v197 offset:8544
    v_cvt_pk_bf16_f32 v94, v60, v61
    v_mfma_f32_16x16x32_bf16 a[112:115], a[252:255], v[64:67], a[112:115]
    v_exp_f32 v62, v62
    v_mfma_f32_16x16x32_bf16 a[116:119], a[252:255], v[68:71], a[116:119]
    ds_read_b64_tr_b16 a[238:239], v197 offset:9056
    v_mfma_f32_16x16x32_bf16 a[120:123], a[252:255], v[72:75], a[120:123]
    v_exp_f32 v63, v63
    v_mfma_f32_16x16x32_bf16 a[124:127], a[252:255], v[76:79], a[124:127]
    v_mfma_f32_16x16x32_bf16 v[124:127], v[192:195], v[76:79], v[124:127]
    s_waitcnt vmcnt(4)
    s_waitcnt lgkmcnt(6)
    s_mov_b32 s45, 3
K1_BLOOP:
    v_mfma_f32_16x16x32_bf16 v[32:35], a[192:195], v[128:131], v[96:99]
    v_exp_f32 v0, v0
    v_mfma_f32_16x16x32_bf16 v[36:39], a[192:195], v[144:147], v[100:103]
    ds_read_b128 a[208:211], v196 offset:25472
    v_cvt_pk_bf16_f32 v95, v62, v63
    v_mfma_f32_16x16x32_bf16 v[40:43], a[192:195], v[160:163], v[104:107]
    v_exp_f32 v1, v1
    v_mfma_f32_16x16x32_bf16 v[44:47], a[192:195], v[176:179], v[108:111]
    ds_read_b64_tr_b16 a[240:241], v197 offset:8576
    v_cvt_pk_bf16_f32 v64, v0, v1
    v_mfma_f32_16x16x32_bf16 a[0:3], a[224:227], v[80:83], a[0:3]
    v_exp_f32 v2, v2
    v_mfma_f32_16x16x32_bf16 a[4:7], a[224:227], v[84:87], a[4:7]
    ds_read_b64_tr_b16 a[242:243], v197 offset:9088
    s_add_u32 m0, s38, 25344
    v_mfma_f32_16x16x32_bf16 a[8:11], a[224:227], v[88:91], a[8:11]
    v_exp_f32 v3, v3
    v_mfma_f32_16x16x32_bf16 a[12:15], a[224:227], v[92:95], a[12:15]
    buffer_load_dwordx4 v202, s[16:19], s46 offen nt lds
    v_mfma_f32_16x16x32_bf16 v[48:51], a[196:199], v[128:131], v[96:99]
    v_exp_f32 v16, v16
    v_mfma_f32_16x16x32_bf16 v[52:55], a[196:199], v[144:147], v[100:103]
    ds_read_b128 a[212:215], v196 offset:25984
    v_cvt_pk_bf16_f32 v65, v2, v3
    v_mfma_f32_16x16x32_bf16 v[56:59], a[196:199], v[160:163], v[104:107]
    v_exp_f32 v17, v17
    v_mfma_f32_16x16x32_bf16 v[60:63], a[196:199], v[176:179], v[108:111]
    ds_read_b64_tr_b16 a[244:245], v197 offset:8608
    v_cvt_pk_bf16_f32 v66, v16, v17
    v_mfma_f32_16x16x32_bf16 a[16:19], a[228:231], v[80:83], a[16:19]
    v_exp_f32 v18, v18
    v_mfma_f32_16x16x32_bf16 a[20:23], a[228:231], v[84:87], a[20:23]
    ds_read_b64_tr_b16 a[246:247], v197 offset:9120
    v_mfma_f32_16x16x32_bf16 a[24:27], a[228:231], v[88:91], a[24:27]
    v_exp_f32 v19, v19
    v_mfma_f32_16x16x32_bf16 a[28:31], a[228:231], v[92:95], a[28:31]
    v_mfma_f32_16x16x32_bf16 v[112:115], v[192:195], v[80:83], v[112:115]
    s_waitcnt lgkmcnt(6)
    v_mfma_f32_16x16x32_bf16 v[32:35], a[200:203], v[132:135], v[32:35]
    v_exp_f32 v4, v4
    v_mfma_f32_16x16x32_bf16 v[36:39], a[200:203], v[148:151], v[36:39]
    ds_read_b128 a[216:219], v196 offset:25536
    v_cvt_pk_bf16_f32 v67, v18, v19
    v_mfma_f32_16x16x32_bf16 v[40:43], a[200:203], v[164:167], v[40:43]
    v_exp_f32 v5, v5
    v_mfma_f32_16x16x32_bf16 v[44:47], a[200:203], v[180:183], v[44:47]
    ds_read_b64_tr_b16 a[248:249], v197 offset:8640
    v_cvt_pk_bf16_f32 v68, v4, v5
    v_mfma_f32_16x16x32_bf16 a[32:35], a[232:235], v[80:83], a[32:35]
    v_exp_f32 v6, v6
    v_mfma_f32_16x16x32_bf16 a[36:39], a[232:235], v[84:87], a[36:39]
    ds_read_b64_tr_b16 a[250:251], v197 offset:9152
    v_mfma_f32_16x16x32_bf16 a[40:43], a[232:235], v[88:91], a[40:43]
    v_exp_f32 v7, v7
    v_mfma_f32_16x16x32_bf16 a[44:47], a[232:235], v[92:95], a[44:47]
    buffer_load_dwordx4 v203, s[16:19], s46 offen offset:1056 nt lds
    v_mfma_f32_16x16x32_bf16 v[48:51], a[204:207], v[132:135], v[48:51]
    v_exp_f32 v20, v20
    v_mfma_f32_16x16x32_bf16 v[52:55], a[204:207], v[148:151], v[52:55]
    ds_read_b128 a[220:223], v196 offset:26048
    v_cvt_pk_bf16_f32 v69, v6, v7
    v_mfma_f32_16x16x32_bf16 v[56:59], a[204:207], v[164:167], v[56:59]
    v_exp_f32 v21, v21
    v_mfma_f32_16x16x32_bf16 v[60:63], a[204:207], v[180:183], v[60:63]
    ds_read_b64_tr_b16 a[252:253], v197 offset:8672
    v_cvt_pk_bf16_f32 v70, v20, v21
    v_mfma_f32_16x16x32_bf16 a[48:51], a[236:239], v[80:83], a[48:51]
    v_exp_f32 v22, v22
    v_mfma_f32_16x16x32_bf16 a[52:55], a[236:239], v[84:87], a[52:55]
    ds_read_b64_tr_b16 a[254:255], v197 offset:9184
    s_add_u32 s46, s46, 8192
    v_mfma_f32_16x16x32_bf16 a[56:59], a[236:239], v[88:91], a[56:59]
    v_exp_f32 v23, v23
    v_mfma_f32_16x16x32_bf16 a[60:63], a[236:239], v[92:95], a[60:63]
    v_mfma_f32_16x16x32_bf16 v[116:119], v[192:195], v[84:87], v[116:119]
    s_waitcnt vmcnt(4) lgkmcnt(6)
    s_barrier
    v_mfma_f32_16x16x32_bf16 v[32:35], a[208:211], v[136:139], v[32:35]
    v_exp_f32 v8, v8
    v_mfma_f32_16x16x32_bf16 v[36:39], a[208:211], v[152:155], v[36:39]
    ds_read_b128 a[192:195], v196 offset:33792
    v_cvt_pk_bf16_f32 v71, v22, v23
    v_mfma_f32_16x16x32_bf16 v[40:43], a[208:211], v[168:171], v[40:43]
    v_exp_f32 v9, v9
    v_mfma_f32_16x16x32_bf16 v[44:47], a[208:211], v[184:187], v[44:47]
    ds_read_b64_tr_b16 a[224:225], v197 offset:16896
    v_cvt_pk_bf16_f32 v72, v8, v9
    v_mfma_f32_16x16x32_bf16 a[64:67], a[240:243], v[80:83], a[64:67]
    v_exp_f32 v10, v10
    v_mfma_f32_16x16x32_bf16 a[68:71], a[240:243], v[84:87], a[68:71]
    ds_read_b64_tr_b16 a[226:227], v197 offset:17408
    s_add_u32 m0, s37, 50688
    v_mfma_f32_16x16x32_bf16 a[72:75], a[240:243], v[88:91], a[72:75]
    v_exp_f32 v11, v11
    v_mfma_f32_16x16x32_bf16 a[76:79], a[240:243], v[92:95], a[76:79]
    buffer_load_dwordx4 v200, s[12:15], s46 offen nt lds
    v_mfma_f32_16x16x32_bf16 v[48:51], a[212:215], v[136:139], v[48:51]
    v_exp_f32 v24, v24
    v_mfma_f32_16x16x32_bf16 v[52:55], a[212:215], v[152:155], v[52:55]
    ds_read_b128 a[196:199], v196 offset:34304
    v_cvt_pk_bf16_f32 v73, v10, v11
    v_mfma_f32_16x16x32_bf16 v[56:59], a[212:215], v[168:171], v[56:59]
    v_exp_f32 v25, v25
    v_mfma_f32_16x16x32_bf16 v[60:63], a[212:215], v[184:187], v[60:63]
    ds_read_b64_tr_b16 a[228:229], v197 offset:16928
    v_cvt_pk_bf16_f32 v74, v24, v25
    v_mfma_f32_16x16x32_bf16 a[80:83], a[244:247], v[80:83], a[80:83]
    v_exp_f32 v26, v26
    v_mfma_f32_16x16x32_bf16 a[84:87], a[244:247], v[84:87], a[84:87]
    ds_read_b64_tr_b16 a[230:231], v197 offset:17440
    v_mfma_f32_16x16x32_bf16 a[88:91], a[244:247], v[88:91], a[88:91]
    v_exp_f32 v27, v27
    v_mfma_f32_16x16x32_bf16 a[92:95], a[244:247], v[92:95], a[92:95]
    v_mfma_f32_16x16x32_bf16 v[120:123], v[192:195], v[88:91], v[120:123]
    s_waitcnt lgkmcnt(6)
    v_mfma_f32_16x16x32_bf16 v[32:35], a[216:219], v[140:143], v[32:35]
    v_exp_f32 v12, v12
    v_mfma_f32_16x16x32_bf16 v[36:39], a[216:219], v[156:159], v[36:39]
    ds_read_b128 a[200:203], v196 offset:33856
    v_cvt_pk_bf16_f32 v75, v26, v27
    v_mfma_f32_16x16x32_bf16 v[40:43], a[216:219], v[172:175], v[40:43]
    v_exp_f32 v13, v13
    v_mfma_f32_16x16x32_bf16 v[44:47], a[216:219], v[188:191], v[44:47]
    ds_read_b64_tr_b16 a[232:233], v197 offset:16960
    v_cvt_pk_bf16_f32 v76, v12, v13
    v_mfma_f32_16x16x32_bf16 a[96:99], a[248:251], v[80:83], a[96:99]
    v_exp_f32 v14, v14
    v_mfma_f32_16x16x32_bf16 a[100:103], a[248:251], v[84:87], a[100:103]
    ds_read_b64_tr_b16 a[234:235], v197 offset:17472
    v_mfma_f32_16x16x32_bf16 a[104:107], a[248:251], v[88:91], a[104:107]
    v_exp_f32 v15, v15
    v_mfma_f32_16x16x32_bf16 a[108:111], a[248:251], v[92:95], a[108:111]
    buffer_load_dwordx4 v201, s[12:15], s46 offen offset:1056 nt lds
    v_mfma_f32_16x16x32_bf16 v[48:51], a[220:223], v[140:143], v[48:51]
    v_exp_f32 v28, v28
    v_mfma_f32_16x16x32_bf16 v[52:55], a[220:223], v[156:159], v[52:55]
    ds_read_b128 a[204:207], v196 offset:34368
    v_cvt_pk_bf16_f32 v77, v14, v15
    v_mfma_f32_16x16x32_bf16 v[56:59], a[220:223], v[172:175], v[56:59]
    v_exp_f32 v29, v29
    v_mfma_f32_16x16x32_bf16 v[60:63], a[220:223], v[188:191], v[60:63]
    ds_read_b64_tr_b16 a[236:237], v197 offset:16992
    v_cvt_pk_bf16_f32 v78, v28, v29
    v_mfma_f32_16x16x32_bf16 a[112:115], a[252:255], v[80:83], a[112:115]
    v_exp_f32 v30, v30
    v_mfma_f32_16x16x32_bf16 a[116:119], a[252:255], v[84:87], a[116:119]
    ds_read_b64_tr_b16 a[238:239], v197 offset:17504
    v_mfma_f32_16x16x32_bf16 a[120:123], a[252:255], v[88:91], a[120:123]
    v_exp_f32 v31, v31
    v_mfma_f32_16x16x32_bf16 a[124:127], a[252:255], v[92:95], a[124:127]
    v_mfma_f32_16x16x32_bf16 v[124:127], v[192:195], v[92:95], v[124:127]
    s_waitcnt vmcnt(4)
    s_waitcnt lgkmcnt(6)
    v_mfma_f32_16x16x32_bf16 v[0:3], a[192:195], v[128:131], v[96:99]
    v_exp_f32 v32, v32
    v_mfma_f32_16x16x32_bf16 v[4:7], a[192:195], v[144:147], v[100:103]
    ds_read_b128 a[208:211], v196 offset:33920
    v_cvt_pk_bf16_f32 v79, v30, v31
    v_mfma_f32_16x16x32_bf16 v[8:11], a[192:195], v[160:163], v[104:107]
    v_exp_f32 v33, v33
    v_mfma_f32_16x16x32_bf16 v[12:15], a[192:195], v[176:179], v[108:111]
    ds_read_b64_tr_b16 a[240:241], v197 offset:17024
    v_cvt_pk_bf16_f32 v80, v32, v33
    v_mfma_f32_16x16x32_bf16 a[0:3], a[224:227], v[64:67], a[0:3]
    v_exp_f32 v34, v34
    v_mfma_f32_16x16x32_bf16 a[4:7], a[224:227], v[68:71], a[4:7]
    ds_read_b64_tr_b16 a[242:243], v197 offset:17536
    s_add_u32 m0, s39, 33792
    v_mfma_f32_16x16x32_bf16 a[8:11], a[224:227], v[72:75], a[8:11]
    v_exp_f32 v35, v35
    v_mfma_f32_16x16x32_bf16 a[12:15], a[224:227], v[76:79], a[12:15]
    buffer_load_dwordx4 v202, s[16:19], s46 offen nt lds
    v_mfma_f32_16x16x32_bf16 v[16:19], a[196:199], v[128:131], v[96:99]
    v_exp_f32 v48, v48
    v_mfma_f32_16x16x32_bf16 v[20:23], a[196:199], v[144:147], v[100:103]
    ds_read_b128 a[212:215], v196 offset:34432
    v_cvt_pk_bf16_f32 v81, v34, v35
    v_mfma_f32_16x16x32_bf16 v[24:27], a[196:199], v[160:163], v[104:107]
    v_exp_f32 v49, v49
    v_mfma_f32_16x16x32_bf16 v[28:31], a[196:199], v[176:179], v[108:111]
    ds_read_b64_tr_b16 a[244:245], v197 offset:17056
    v_cvt_pk_bf16_f32 v82, v48, v49
    v_mfma_f32_16x16x32_bf16 a[16:19], a[228:231], v[64:67], a[16:19]
    v_exp_f32 v50, v50
    v_mfma_f32_16x16x32_bf16 a[20:23], a[228:231], v[68:71], a[20:23]
    ds_read_b64_tr_b16 a[246:247], v197 offset:17568
    v_mfma_f32_16x16x32_bf16 a[24:27], a[228:231], v[72:75], a[24:27]
    v_exp_f32 v51, v51
    v_mfma_f32_16x16x32_bf16 a[28:31], a[228:231], v[76:79], a[28:31]
    v_mfma_f32_16x16x32_bf16 v[112:115], v[192:195], v[64:67], v[112:115]
    s_waitcnt lgkmcnt(6)
    v_mfma_f32_16x16x32_bf16 v[0:3], a[200:203], v[132:135], v[0:3]
    v_exp_f32 v36, v36
    v_mfma_f32_16x16x32_bf16 v[4:7], a[200:203], v[148:151], v[4:7]
    ds_read_b128 a[216:219], v196 offset:33984
    v_cvt_pk_bf16_f32 v83, v50, v51
    v_mfma_f32_16x16x32_bf16 v[8:11], a[200:203], v[164:167], v[8:11]
    v_exp_f32 v37, v37
    v_mfma_f32_16x16x32_bf16 v[12:15], a[200:203], v[180:183], v[12:15]
    ds_read_b64_tr_b16 a[248:249], v197 offset:17088
    v_cvt_pk_bf16_f32 v84, v36, v37
    v_mfma_f32_16x16x32_bf16 a[32:35], a[232:235], v[64:67], a[32:35]
    v_exp_f32 v38, v38
    v_mfma_f32_16x16x32_bf16 a[36:39], a[232:235], v[68:71], a[36:39]
    ds_read_b64_tr_b16 a[250:251], v197 offset:17600
    v_mfma_f32_16x16x32_bf16 a[40:43], a[232:235], v[72:75], a[40:43]
    v_exp_f32 v39, v39
    v_mfma_f32_16x16x32_bf16 a[44:47], a[232:235], v[76:79], a[44:47]
    buffer_load_dwordx4 v203, s[16:19], s46 offen offset:1056 nt lds
    v_mfma_f32_16x16x32_bf16 v[16:19], a[204:207], v[132:135], v[16:19]
    v_exp_f32 v52, v52
    v_mfma_f32_16x16x32_bf16 v[20:23], a[204:207], v[148:151], v[20:23]
    ds_read_b128 a[220:223], v196 offset:34496
    v_cvt_pk_bf16_f32 v85, v38, v39
    v_mfma_f32_16x16x32_bf16 v[24:27], a[204:207], v[164:167], v[24:27]
    v_exp_f32 v53, v53
    v_mfma_f32_16x16x32_bf16 v[28:31], a[204:207], v[180:183], v[28:31]
    ds_read_b64_tr_b16 a[252:253], v197 offset:17120
    v_cvt_pk_bf16_f32 v86, v52, v53
    v_mfma_f32_16x16x32_bf16 a[48:51], a[236:239], v[64:67], a[48:51]
    v_exp_f32 v54, v54
    v_mfma_f32_16x16x32_bf16 a[52:55], a[236:239], v[68:71], a[52:55]
    ds_read_b64_tr_b16 a[254:255], v197 offset:17632
    s_add_u32 s46, s46, 8192
    v_mfma_f32_16x16x32_bf16 a[56:59], a[236:239], v[72:75], a[56:59]
    v_exp_f32 v55, v55
    v_mfma_f32_16x16x32_bf16 a[60:63], a[236:239], v[76:79], a[60:63]
    v_mfma_f32_16x16x32_bf16 v[116:119], v[192:195], v[68:71], v[116:119]
    s_waitcnt vmcnt(4) lgkmcnt(6)
    s_barrier
    v_mfma_f32_16x16x32_bf16 v[0:3], a[208:211], v[136:139], v[0:3]
    v_exp_f32 v40, v40
    v_mfma_f32_16x16x32_bf16 v[4:7], a[208:211], v[152:155], v[4:7]
    ds_read_b128 a[192:195], v196 offset:42240
    v_cvt_pk_bf16_f32 v87, v54, v55
    v_mfma_f32_16x16x32_bf16 v[8:11], a[208:211], v[168:171], v[8:11]
    v_exp_f32 v41, v41
    v_mfma_f32_16x16x32_bf16 v[12:15], a[208:211], v[184:187], v[12:15]
    ds_read_b64_tr_b16 a[224:225], v197 offset:25344
    v_cvt_pk_bf16_f32 v88, v40, v41
    v_mfma_f32_16x16x32_bf16 a[64:67], a[240:243], v[64:67], a[64:67]
    v_exp_f32 v42, v42
    v_mfma_f32_16x16x32_bf16 a[68:71], a[240:243], v[68:71], a[68:71]
    ds_read_b64_tr_b16 a[226:227], v197 offset:25856
    s_add_u32 m0, s37, 59136
    v_mfma_f32_16x16x32_bf16 a[72:75], a[240:243], v[72:75], a[72:75]
    v_exp_f32 v43, v43
    v_mfma_f32_16x16x32_bf16 a[76:79], a[240:243], v[76:79], a[76:79]
    buffer_load_dwordx4 v200, s[12:15], s46 offen nt lds
    v_mfma_f32_16x16x32_bf16 v[16:19], a[212:215], v[136:139], v[16:19]
    v_exp_f32 v56, v56
    v_mfma_f32_16x16x32_bf16 v[20:23], a[212:215], v[152:155], v[20:23]
    ds_read_b128 a[196:199], v196 offset:42752
    v_cvt_pk_bf16_f32 v89, v42, v43
    v_mfma_f32_16x16x32_bf16 v[24:27], a[212:215], v[168:171], v[24:27]
    v_exp_f32 v57, v57
    v_mfma_f32_16x16x32_bf16 v[28:31], a[212:215], v[184:187], v[28:31]
    ds_read_b64_tr_b16 a[228:229], v197 offset:25376
    v_cvt_pk_bf16_f32 v90, v56, v57
    v_mfma_f32_16x16x32_bf16 a[80:83], a[244:247], v[64:67], a[80:83]
    v_exp_f32 v58, v58
    v_mfma_f32_16x16x32_bf16 a[84:87], a[244:247], v[68:71], a[84:87]
    ds_read_b64_tr_b16 a[230:231], v197 offset:25888
    v_mfma_f32_16x16x32_bf16 a[88:91], a[244:247], v[72:75], a[88:91]
    v_exp_f32 v59, v59
    v_mfma_f32_16x16x32_bf16 a[92:95], a[244:247], v[76:79], a[92:95]
    v_mfma_f32_16x16x32_bf16 v[120:123], v[192:195], v[72:75], v[120:123]
    s_waitcnt lgkmcnt(6)
    v_mfma_f32_16x16x32_bf16 v[0:3], a[216:219], v[140:143], v[0:3]
    v_exp_f32 v44, v44
    v_mfma_f32_16x16x32_bf16 v[4:7], a[216:219], v[156:159], v[4:7]
    ds_read_b128 a[200:203], v196 offset:42304
    v_cvt_pk_bf16_f32 v91, v58, v59
    v_mfma_f32_16x16x32_bf16 v[8:11], a[216:219], v[172:175], v[8:11]
    v_exp_f32 v45, v45
    v_mfma_f32_16x16x32_bf16 v[12:15], a[216:219], v[188:191], v[12:15]
    ds_read_b64_tr_b16 a[232:233], v197 offset:25408
    v_cvt_pk_bf16_f32 v92, v44, v45
    v_mfma_f32_16x16x32_bf16 a[96:99], a[248:251], v[64:67], a[96:99]
    v_exp_f32 v46, v46
    v_mfma_f32_16x16x32_bf16 a[100:103], a[248:251], v[68:71], a[100:103]
    ds_read_b64_tr_b16 a[234:235], v197 offset:25920
    v_mfma_f32_16x16x32_bf16 a[104:107], a[248:251], v[72:75], a[104:107]
    v_exp_f32 v47, v47
    v_mfma_f32_16x16x32_bf16 a[108:111], a[248:251], v[76:79], a[108:111]
    buffer_load_dwordx4 v201, s[12:15], s46 offen offset:1056 nt lds
    v_mfma_f32_16x16x32_bf16 v[16:19], a[220:223], v[140:143], v[16:19]
    v_exp_f32 v60, v60
    v_mfma_f32_16x16x32_bf16 v[20:23], a[220:223], v[156:159], v[20:23]
    ds_read_b128 a[204:207], v196 offset:42816
    v_cvt_pk_bf16_f32 v93, v46, v47
    v_mfma_f32_16x16x32_bf16 v[24:27], a[220:223], v[172:175], v[24:27]
    v_exp_f32 v61, v61
    v_mfma_f32_16x16x32_bf16 v[28:31], a[220:223], v[188:191], v[28:31]
    ds_read_b64_tr_b16 a[236:237], v197 offset:25440
    v_cvt_pk_bf16_f32 v94, v60, v61
    v_mfma_f32_16x16x32_bf16 a[112:115], a[252:255], v[64:67], a[112:115]
    v_exp_f32 v62, v62
    v_mfma_f32_16x16x32_bf16 a[116:119], a[252:255], v[68:71], a[116:119]
    ds_read_b64_tr_b16 a[238:239], v197 offset:25952
    v_mfma_f32_16x16x32_bf16 a[120:123], a[252:255], v[72:75], a[120:123]
    v_exp_f32 v63, v63
    v_mfma_f32_16x16x32_bf16 a[124:127], a[252:255], v[76:79], a[124:127]
    v_mfma_f32_16x16x32_bf16 v[124:127], v[192:195], v[76:79], v[124:127]
    s_waitcnt vmcnt(4)
    s_waitcnt lgkmcnt(6)
    v_mfma_f32_16x16x32_bf16 v[32:35], a[192:195], v[128:131], v[96:99]
    v_exp_f32 v0, v0
    v_mfma_f32_16x16x32_bf16 v[36:39], a[192:195], v[144:147], v[100:103]
    ds_read_b128 a[208:211], v196 offset:42368
    v_cvt_pk_bf16_f32 v95, v62, v63
    v_mfma_f32_16x16x32_bf16 v[40:43], a[192:195], v[160:163], v[104:107]
    v_exp_f32 v1, v1
    v_mfma_f32_16x16x32_bf16 v[44:47], a[192:195], v[176:179], v[108:111]
    ds_read_b64_tr_b16 a[240:241], v197 offset:25472
    v_cvt_pk_bf16_f32 v64, v0, v1
    v_mfma_f32_16x16x32_bf16 a[0:3], a[224:227], v[80:83], a[0:3]
    v_exp_f32 v2, v2
    v_mfma_f32_16x16x32_bf16 a[4:7], a[224:227], v[84:87], a[4:7]
    ds_read_b64_tr_b16 a[242:243], v197 offset:25984
    s_add_u32 m0, s39, 42240
    v_mfma_f32_16x16x32_bf16 a[8:11], a[224:227], v[88:91], a[8:11]
    v_exp_f32 v3, v3
    v_mfma_f32_16x16x32_bf16 a[12:15], a[224:227], v[92:95], a[12:15]
    buffer_load_dwordx4 v202, s[16:19], s46 offen nt lds
    v_mfma_f32_16x16x32_bf16 v[48:51], a[196:199], v[128:131], v[96:99]
    v_exp_f32 v16, v16
    v_mfma_f32_16x16x32_bf16 v[52:55], a[196:199], v[144:147], v[100:103]
    ds_read_b128 a[212:215], v196 offset:42880
    v_cvt_pk_bf16_f32 v65, v2, v3
    v_mfma_f32_16x16x32_bf16 v[56:59], a[196:199], v[160:163], v[104:107]
    v_exp_f32 v17, v17
    v_mfma_f32_16x16x32_bf16 v[60:63], a[196:199], v[176:179], v[108:111]
    ds_read_b64_tr_b16 a[244:245], v197 offset:25504
    v_cvt_pk_bf16_f32 v66, v16, v17
    v_mfma_f32_16x16x32_bf16 a[16:19], a[228:231], v[80:83], a[16:19]
    v_exp_f32 v18, v18
    v_mfma_f32_16x16x32_bf16 a[20:23], a[228:231], v[84:87], a[20:23]
    ds_read_b64_tr_b16 a[246:247], v197 offset:26016
    v_mfma_f32_16x16x32_bf16 a[24:27], a[228:231], v[88:91], a[24:27]
    v_exp_f32 v19, v19
    v_mfma_f32_16x16x32_bf16 a[28:31], a[228:231], v[92:95], a[28:31]
    v_mfma_f32_16x16x32_bf16 v[112:115], v[192:195], v[80:83], v[112:115]
    s_waitcnt lgkmcnt(6)
    v_mfma_f32_16x16x32_bf16 v[32:35], a[200:203], v[132:135], v[32:35]
    v_exp_f32 v4, v4
    v_mfma_f32_16x16x32_bf16 v[36:39], a[200:203], v[148:151], v[36:39]
    ds_read_b128 a[216:219], v196 offset:42432
    v_cvt_pk_bf16_f32 v67, v18, v19
    v_mfma_f32_16x16x32_bf16 v[40:43], a[200:203], v[164:167], v[40:43]
    v_exp_f32 v5, v5
    v_mfma_f32_16x16x32_bf16 v[44:47], a[200:203], v[180:183], v[44:47]
    ds_read_b64_tr_b16 a[248:249], v197 offset:25536
    v_cvt_pk_bf16_f32 v68, v4, v5
    v_mfma_f32_16x16x32_bf16 a[32:35], a[232:235], v[80:83], a[32:35]
    v_exp_f32 v6, v6
    v_mfma_f32_16x16x32_bf16 a[36:39], a[232:235], v[84:87], a[36:39]
    ds_read_b64_tr_b16 a[250:251], v197 offset:26048
    v_mfma_f32_16x16x32_bf16 a[40:43], a[232:235], v[88:91], a[40:43]
    v_exp_f32 v7, v7
    v_mfma_f32_16x16x32_bf16 a[44:47], a[232:235], v[92:95], a[44:47]
    buffer_load_dwordx4 v203, s[16:19], s46 offen offset:1056 nt lds
    v_mfma_f32_16x16x32_bf16 v[48:51], a[204:207], v[132:135], v[48:51]
    v_exp_f32 v20, v20
    v_mfma_f32_16x16x32_bf16 v[52:55], a[204:207], v[148:151], v[52:55]
    ds_read_b128 a[220:223], v196 offset:42944
    v_cvt_pk_bf16_f32 v69, v6, v7
    v_mfma_f32_16x16x32_bf16 v[56:59], a[204:207], v[164:167], v[56:59]
    v_exp_f32 v21, v21
    v_mfma_f32_16x16x32_bf16 v[60:63], a[204:207], v[180:183], v[60:63]
    ds_read_b64_tr_b16 a[252:253], v197 offset:25568
    v_cvt_pk_bf16_f32 v70, v20, v21
    v_mfma_f32_16x16x32_bf16 a[48:51], a[236:239], v[80:83], a[48:51]
    v_exp_f32 v22, v22
    v_mfma_f32_16x16x32_bf16 a[52:55], a[236:239], v[84:87], a[52:55]
    ds_read_b64_tr_b16 a[254:255], v197 offset:26080
    s_add_u32 s46, s46, 8192
    v_mfma_f32_16x16x32_bf16 a[56:59], a[236:239], v[88:91], a[56:59]
    v_exp_f32 v23, v23
    v_mfma_f32_16x16x32_bf16 a[60:63], a[236:239], v[92:95], a[60:63]
    v_mfma_f32_16x16x32_bf16 v[116:119], v[192:195], v[84:87], v[116:119]
    s_waitcnt vmcnt(4) lgkmcnt(6)
    s_barrier
    v_mfma_f32_16x16x32_bf16 v[32:35], a[208:211], v[136:139], v[32:35]
    v_exp_f32 v8, v8
    v_mfma_f32_16x16x32_bf16 v[36:39], a[208:211], v[152:155], v[36:39]
    ds_read_b128 a[192:195], v196 offset:50688
    v_cvt_pk_bf16_f32 v71, v22, v23
    v_mfma_f32_16x16x32_bf16 v[40:43], a[208:211], v[168:171], v[40:43]
    v_exp_f32 v9, v9
    v_mfma_f32_16x16x32_bf16 v[44:47], a[208:211], v[184:187], v[44:47]
    ds_read_b64_tr_b16 a[224:225], v197 offset:33792
    v_cvt_pk_bf16_f32 v72, v8, v9
    v_mfma_f32_16x16x32_bf16 a[64:67], a[240:243], v[80:83], a[64:67]
    v_exp_f32 v10, v10
    v_mfma_f32_16x16x32_bf16 a[68:71], a[240:243], v[84:87], a[68:71]
    ds_read_b64_tr_b16 a[226:227], v197 offset:34304
    s_add_u32 m0, s36, 0
    v_mfma_f32_16x16x32_bf16 a[72:75], a[240:243], v[88:91], a[72:75]
    v_exp_f32 v11, v11
    v_mfma_f32_16x16x32_bf16 a[76:79], a[240:243], v[92:95], a[76:79]
    buffer_load_dwordx4 v200, s[12:15], s46 offen nt lds
    v_mfma_f32_16x16x32_bf16 v[48:51], a[212:215], v[136:139], v[48:51]
    v_exp_f32 v24, v24
    v_mfma_f32_16x16x32_bf16 v[52:55], a[212:215], v[152:155], v[52:55]
    ds_read_b128 a[196:199], v196 offset:51200
    v_cvt_pk_bf16_f32 v73, v10, v11
    v_mfma_f32_16x16x32_bf16 v[56:59], a[212:215], v[168:171], v[56:59]
    v_exp_f32 v25, v25
    v_mfma_f32_16x16x32_bf16 v[60:63], a[212:215], v[184:187], v[60:63]
    ds_read_b64_tr_b16 a[228:229], v197 offset:33824
    v_cvt_pk_bf16_f32 v74, v24, v25
    v_mfma_f32_16x16x32_bf16 a[80:83], a[244:247], v[80:83], a[80:83]
    v_exp_f32 v26, v26
    v_mfma_f32_16x16x32_bf16 a[84:87], a[244:247], v[84:87], a[84:87]
    ds_read_b64_tr_b16 a[230:231], v197 offset:34336
    v_mfma_f32_16x16x32_bf16 a[88:91], a[244:247], v[88:91], a[88:91]
    v_exp_f32 v27, v27
    v_mfma_f32_16x16x32_bf16 a[92:95], a[244:247], v[92:95], a[92:95]
    v_mfma_f32_16x16x32_bf16 v[120:123], v[192:195], v[88:91], v[120:123]
    s_waitcnt lgkmcnt(6)
    v_mfma_f32_16x16x32_bf16 v[32:35], a[216:219], v[140:143], v[32:35]
    v_exp_f32 v12, v12
    v_mfma_f32_16x16x32_bf16 v[36:39], a[216:219], v[156:159], v[36:39]
    ds_read_b128 a[200:203], v196 offset:50752
    v_cvt_pk_bf16_f32 v75, v26, v27
    v_mfma_f32_16x16x32_bf16 v[40:43], a[216:219], v[172:175], v[40:43]
    v_exp_f32 v13, v13
    v_mfma_f32_16x16x32_bf16 v[44:47], a[216:219], v[188:191], v[44:47]
    ds_read_b64_tr_b16 a[232:233], v197 offset:33856
    v_cvt_pk_bf16_f32 v76, v12, v13
    v_mfma_f32_16x16x32_bf16 a[96:99], a[248:251], v[80:83], a[96:99]
    v_exp_f32 v14, v14
    v_mfma_f32_16x16x32_bf16 a[100:103], a[248:251], v[84:87], a[100:103]
    ds_read_b64_tr_b16 a[234:235], v197 offset:34368
    v_mfma_f32_16x16x32_bf16 a[104:107], a[248:251], v[88:91], a[104:107]
    v_exp_f32 v15, v15
    v_mfma_f32_16x16x32_bf16 a[108:111], a[248:251], v[92:95], a[108:111]
    buffer_load_dwordx4 v201, s[12:15], s46 offen offset:1056 nt lds
    v_mfma_f32_16x16x32_bf16 v[48:51], a[220:223], v[140:143], v[48:51]
    v_exp_f32 v28, v28
    v_mfma_f32_16x16x32_bf16 v[52:55], a[220:223], v[156:159], v[52:55]
    ds_read_b128 a[204:207], v196 offset:51264
    v_cvt_pk_bf16_f32 v77, v14, v15
    v_mfma_f32_16x16x32_bf16 v[56:59], a[220:223], v[172:175], v[56:59]
    v_exp_f32 v29, v29
    v_mfma_f32_16x16x32_bf16 v[60:63], a[220:223], v[188:191], v[60:63]
    ds_read_b64_tr_b16 a[236:237], v197 offset:33888
    v_cvt_pk_bf16_f32 v78, v28, v29
    v_mfma_f32_16x16x32_bf16 a[112:115], a[252:255], v[80:83], a[112:115]
    v_exp_f32 v30, v30
    v_mfma_f32_16x16x32_bf16 a[116:119], a[252:255], v[84:87], a[116:119]
    ds_read_b64_tr_b16 a[238:239], v197 offset:34400
    v_mfma_f32_16x16x32_bf16 a[120:123], a[252:255], v[88:91], a[120:123]
    v_exp_f32 v31, v31
    v_mfma_f32_16x16x32_bf16 a[124:127], a[252:255], v[92:95], a[124:127]
    v_mfma_f32_16x16x32_bf16 v[124:127], v[192:195], v[92:95], v[124:127]
    s_waitcnt vmcnt(4)
    s_waitcnt lgkmcnt(6)
    v_mfma_f32_16x16x32_bf16 v[0:3], a[192:195], v[128:131], v[96:99]
    v_exp_f32 v32, v32
    v_mfma_f32_16x16x32_bf16 v[4:7], a[192:195], v[144:147], v[100:103]
    ds_read_b128 a[208:211], v196 offset:50816
    v_cvt_pk_bf16_f32 v79, v30, v31
    v_mfma_f32_16x16x32_bf16 v[8:11], a[192:195], v[160:163], v[104:107]
    v_exp_f32 v33, v33
    v_mfma_f32_16x16x32_bf16 v[12:15], a[192:195], v[176:179], v[108:111]
    ds_read_b64_tr_b16 a[240:241], v197 offset:33920
    v_cvt_pk_bf16_f32 v80, v32, v33
    v_mfma_f32_16x16x32_bf16 a[0:3], a[224:227], v[64:67], a[0:3]
    v_exp_f32 v34, v34
    v_mfma_f32_16x16x32_bf16 a[4:7], a[224:227], v[68:71], a[4:7]
    ds_read_b64_tr_b16 a[242:243], v197 offset:34432
    s_add_u32 m0, s39, 50688
    v_mfma_f32_16x16x32_bf16 a[8:11], a[224:227], v[72:75], a[8:11]
    v_exp_f32 v35, v35
    v_mfma_f32_16x16x32_bf16 a[12:15], a[224:227], v[76:79], a[12:15]
    buffer_load_dwordx4 v202, s[16:19], s46 offen nt lds
    v_mfma_f32_16x16x32_bf16 v[16:19], a[196:199], v[128:131], v[96:99]
    v_exp_f32 v48, v48
    v_mfma_f32_16x16x32_bf16 v[20:23], a[196:199], v[144:147], v[100:103]
    ds_read_b128 a[212:215], v196 offset:51328
    v_cvt_pk_bf16_f32 v81, v34, v35
    v_mfma_f32_16x16x32_bf16 v[24:27], a[196:199], v[160:163], v[104:107]
    v_exp_f32 v49, v49
    v_mfma_f32_16x16x32_bf16 v[28:31], a[196:199], v[176:179], v[108:111]
    ds_read_b64_tr_b16 a[244:245], v197 offset:33952
    v_cvt_pk_bf16_f32 v82, v48, v49
    v_mfma_f32_16x16x32_bf16 a[16:19], a[228:231], v[64:67], a[16:19]
    v_exp_f32 v50, v50
    v_mfma_f32_16x16x32_bf16 a[20:23], a[228:231], v[68:71], a[20:23]
    ds_read_b64_tr_b16 a[246:247], v197 offset:34464
    v_mfma_f32_16x16x32_bf16 a[24:27], a[228:231], v[72:75], a[24:27]
    v_exp_f32 v51, v51
    v_mfma_f32_16x16x32_bf16 a[28:31], a[228:231], v[76:79], a[28:31]
    v_mfma_f32_16x16x32_bf16 v[112:115], v[192:195], v[64:67], v[112:115]
    s_waitcnt lgkmcnt(6)
    v_mfma_f32_16x16x32_bf16 v[0:3], a[200:203], v[132:135], v[0:3]
    v_exp_f32 v36, v36
    v_mfma_f32_16x16x32_bf16 v[4:7], a[200:203], v[148:151], v[4:7]
    ds_read_b128 a[216:219], v196 offset:50880
    v_cvt_pk_bf16_f32 v83, v50, v51
    v_mfma_f32_16x16x32_bf16 v[8:11], a[200:203], v[164:167], v[8:11]
    v_exp_f32 v37, v37
    v_mfma_f32_16x16x32_bf16 v[12:15], a[200:203], v[180:183], v[12:15]
    ds_read_b64_tr_b16 a[248:249], v197 offset:33984
    v_cvt_pk_bf16_f32 v84, v36, v37
    v_mfma_f32_16x16x32_bf16 a[32:35], a[232:235], v[64:67], a[32:35]
    v_exp_f32 v38, v38
    v_mfma_f32_16x16x32_bf16 a[36:39], a[232:235], v[68:71], a[36:39]
    ds_read_b64_tr_b16 a[250:251], v197 offset:34496
    v_mfma_f32_16x16x32_bf16 a[40:43], a[232:235], v[72:75], a[40:43]
    v_exp_f32 v39, v39
    v_mfma_f32_16x16x32_bf16 a[44:47], a[232:235], v[76:79], a[44:47]
    buffer_load_dwordx4 v203, s[16:19], s46 offen offset:1056 nt lds
    v_mfma_f32_16x16x32_bf16 v[16:19], a[204:207], v[132:135], v[16:19]
    v_exp_f32 v52, v52
    v_mfma_f32_16x16x32_bf16 v[20:23], a[204:207], v[148:151], v[20:23]
    ds_read_b128 a[220:223], v196 offset:51392
    v_cvt_pk_bf16_f32 v85, v38, v39
    v_mfma_f32_16x16x32_bf16 v[24:27], a[204:207], v[164:167], v[24:27]
    v_exp_f32 v53, v53
    v_mfma_f32_16x16x32_bf16 v[28:31], a[204:207], v[180:183], v[28:31]
    ds_read_b64_tr_b16 a[252:253], v197 offset:34016
    v_cvt_pk_bf16_f32 v86, v52, v53
    v_mfma_f32_16x16x32_bf16 a[48:51], a[236:239], v[64:67], a[48:51]
    v_exp_f32 v54, v54
    v_mfma_f32_16x16x32_bf16 a[52:55], a[236:239], v[68:71], a[52:55]
    ds_read_b64_tr_b16 a[254:255], v197 offset:34528
    s_add_u32 s46, s46, 8192
    v_mfma_f32_16x16x32_bf16 a[56:59], a[236:239], v[72:75], a[56:59]
    v_exp_f32 v55, v55
    v_mfma_f32_16x16x32_bf16 a[60:63], a[236:239], v[76:79], a[60:63]
    v_mfma_f32_16x16x32_bf16 v[116:119], v[192:195], v[68:71], v[116:119]
    s_waitcnt vmcnt(4) lgkmcnt(6)
    s_barrier
    v_mfma_f32_16x16x32_bf16 v[0:3], a[208:211], v[136:139], v[0:3]
    v_exp_f32 v40, v40
    v_mfma_f32_16x16x32_bf16 v[4:7], a[208:211], v[152:155], v[4:7]
    ds_read_b128 a[192:195], v196 offset:59136
    v_cvt_pk_bf16_f32 v87, v54, v55
    v_mfma_f32_16x16x32_bf16 v[8:11], a[208:211], v[168:171], v[8:11]
    v_exp_f32 v41, v41
    v_mfma_f32_16x16x32_bf16 v[12:15], a[208:211], v[184:187], v[12:15]
    ds_read_b64_tr_b16 a[224:225], v197 offset:42240
    v_cvt_pk_bf16_f32 v88, v40, v41
    v_mfma_f32_16x16x32_bf16 a[64:67], a[240:243], v[64:67], a[64:67]
    v_exp_f32 v42, v42
    v_mfma_f32_16x16x32_bf16 a[68:71], a[240:243], v[68:71], a[68:71]
    ds_read_b64_tr_b16 a[226:227], v197 offset:42752
    s_add_u32 m0, s36, 8448
    v_mfma_f32_16x16x32_bf16 a[72:75], a[240:243], v[72:75], a[72:75]
    v_exp_f32 v43, v43
    v_mfma_f32_16x16x32_bf16 a[76:79], a[240:243], v[76:79], a[76:79]
    buffer_load_dwordx4 v200, s[12:15], s46 offen nt lds
    v_mfma_f32_16x16x32_bf16 v[16:19], a[212:215], v[136:139], v[16:19]
    v_exp_f32 v56, v56
    v_mfma_f32_16x16x32_bf16 v[20:23], a[212:215], v[152:155], v[20:23]
    ds_read_b128 a[196:199], v196 offset:59648
    v_cvt_pk_bf16_f32 v89, v42, v43
    v_mfma_f32_16x16x32_bf16 v[24:27], a[212:215], v[168:171], v[24:27]
    v_exp_f32 v57, v57
    v_mfma_f32_16x16x32_bf16 v[28:31], a[212:215], v[184:187], v[28:31]
    ds_read_b64_tr_b16 a[228:229], v197 offset:42272
    v_cvt_pk_bf16_f32 v90, v56, v57
    v_mfma_f32_16x16x32_bf16 a[80:83], a[244:247], v[64:67], a[80:83]
    v_exp_f32 v58, v58
    v_mfma_f32_16x16x32_bf16 a[84:87], a[244:247], v[68:71], a[84:87]
    ds_read_b64_tr_b16 a[230:231], v197 offset:42784
    v_mfma_f32_16x16x32_bf16 a[88:91], a[244:247], v[72:75], a[88:91]
    v_exp_f32 v59, v59
    v_mfma_f32_16x16x32_bf16 a[92:95], a[244:247], v[76:79], a[92:95]
    v_mfma_f32_16x16x32_bf16 v[120:123], v[192:195], v[72:75], v[120:123]
    s_waitcnt lgkmcnt(6)
    v_mfma_f32_16x16x32_bf16 v[0:3], a[216:219], v[140:143], v[0:3]
    v_exp_f32 v44, v44
    v_mfma_f32_16x16x32_bf16 v[4:7], a[216:219], v[156:159], v[4:7]
    ds_read_b128 a[200:203], v196 offset:59200
    v_cvt_pk_bf16_f32 v91, v58, v59
    v_mfma_f32_16x16x32_bf16 v[8:11], a[216:219], v[172:175], v[8:11]
    v_exp_f32 v45, v45
    v_mfma_f32_16x16x32_bf16 v[12:15], a[216:219], v[188:191], v[12:15]
    ds_read_b64_tr_b16 a[232:233], v197 offset:42304
    v_cvt_pk_bf16_f32 v92, v44, v45
    v_mfma_f32_16x16x32_bf16 a[96:99], a[248:251], v[64:67], a[96:99]
    v_exp_f32 v46, v46
    v_mfma_f32_16x16x32_bf16 a[100:103], a[248:251], v[68:71], a[100:103]
    ds_read_b64_tr_b16 a[234:235], v197 offset:42816
    v_mfma_f32_16x16x32_bf16 a[104:107], a[248:251], v[72:75], a[104:107]
    v_exp_f32 v47, v47
    v_mfma_f32_16x16x32_bf16 a[108:111], a[248:251], v[76:79], a[108:111]
    buffer_load_dwordx4 v201, s[12:15], s46 offen offset:1056 nt lds
    v_mfma_f32_16x16x32_bf16 v[16:19], a[220:223], v[140:143], v[16:19]
    v_exp_f32 v60, v60
    v_mfma_f32_16x16x32_bf16 v[20:23], a[220:223], v[156:159], v[20:23]
    ds_read_b128 a[204:207], v196 offset:59712
    v_cvt_pk_bf16_f32 v93, v46, v47
    v_mfma_f32_16x16x32_bf16 v[24:27], a[220:223], v[172:175], v[24:27]
    v_exp_f32 v61, v61
    v_mfma_f32_16x16x32_bf16 v[28:31], a[220:223], v[188:191], v[28:31]
    ds_read_b64_tr_b16 a[236:237], v197 offset:42336
    v_cvt_pk_bf16_f32 v94, v60, v61
    v_mfma_f32_16x16x32_bf16 a[112:115], a[252:255], v[64:67], a[112:115]
    v_exp_f32 v62, v62
    v_mfma_f32_16x16x32_bf16 a[116:119], a[252:255], v[68:71], a[116:119]
    ds_read_b64_tr_b16 a[238:239], v197 offset:42848
    v_mfma_f32_16x16x32_bf16 a[120:123], a[252:255], v[72:75], a[120:123]
    v_exp_f32 v63, v63
    v_mfma_f32_16x16x32_bf16 a[124:127], a[252:255], v[76:79], a[124:127]
    v_mfma_f32_16x16x32_bf16 v[124:127], v[192:195], v[76:79], v[124:127]
    s_waitcnt vmcnt(4)
    s_sub_u32 s45, s45, 1
    s_waitcnt lgkmcnt(6)
    v_mfma_f32_16x16x32_bf16 v[32:35], a[192:195], v[128:131], v[96:99]
    v_exp_f32 v0, v0
    v_mfma_f32_16x16x32_bf16 v[36:39], a[192:195], v[144:147], v[100:103]
    ds_read_b128 a[208:211], v196 offset:59264
    v_cvt_pk_bf16_f32 v95, v62, v63
    v_mfma_f32_16x16x32_bf16 v[40:43], a[192:195], v[160:163], v[104:107]
    v_exp_f32 v1, v1
    v_mfma_f32_16x16x32_bf16 v[44:47], a[192:195], v[176:179], v[108:111]
    ds_read_b64_tr_b16 a[240:241], v197 offset:42368
    v_cvt_pk_bf16_f32 v64, v0, v1
    v_mfma_f32_16x16x32_bf16 a[0:3], a[224:227], v[80:83], a[0:3]
    v_exp_f32 v2, v2
    v_mfma_f32_16x16x32_bf16 a[4:7], a[224:227], v[84:87], a[4:7]
    ds_read_b64_tr_b16 a[242:243], v197 offset:42880
    s_add_u32 m0, s39, 59136
    v_mfma_f32_16x16x32_bf16 a[8:11], a[224:227], v[88:91], a[8:11]
    v_exp_f32 v3, v3
    v_mfma_f32_16x16x32_bf16 a[12:15], a[224:227], v[92:95], a[12:15]
    buffer_load_dwordx4 v202, s[16:19], s46 offen nt lds
    v_mfma_f32_16x16x32_bf16 v[48:51], a[196:199], v[128:131], v[96:99]
    v_exp_f32 v16, v16
    v_mfma_f32_16x16x32_bf16 v[52:55], a[196:199], v[144:147], v[100:103]
    ds_read_b128 a[212:215], v196 offset:59776
    v_cvt_pk_bf16_f32 v65, v2, v3
    v_mfma_f32_16x16x32_bf16 v[56:59], a[196:199], v[160:163], v[104:107]
    v_exp_f32 v17, v17
    v_mfma_f32_16x16x32_bf16 v[60:63], a[196:199], v[176:179], v[108:111]
    ds_read_b64_tr_b16 a[244:245], v197 offset:42400
    v_cvt_pk_bf16_f32 v66, v16, v17
    v_mfma_f32_16x16x32_bf16 a[16:19], a[228:231], v[80:83], a[16:19]
    v_exp_f32 v18, v18
    v_mfma_f32_16x16x32_bf16 a[20:23], a[228:231], v[84:87], a[20:23]
    ds_read_b64_tr_b16 a[246:247], v197 offset:42912
    v_mfma_f32_16x16x32_bf16 a[24:27], a[228:231], v[88:91], a[24:27]
    v_exp_f32 v19, v19
    v_mfma_f32_16x16x32_bf16 a[28:31], a[228:231], v[92:95], a[28:31]
    v_mfma_f32_16x16x32_bf16 v[112:115], v[192:195], v[80:83], v[112:115]
    s_waitcnt lgkmcnt(6)
    v_mfma_f32_16x16x32_bf16 v[32:35], a[200:203], v[132:135], v[32:35]
    v_exp_f32 v4, v4
    v_mfma_f32_16x16x32_bf16 v[36:39], a[200:203], v[148:151], v[36:39]
    ds_read_b128 a[216:219], v196 offset:59328
    v_cvt_pk_bf16_f32 v67, v18, v19
    v_mfma_f32_16x16x32_bf16 v[40:43], a[200:203], v[164:167], v[40:43]
    v_exp_f32 v5, v5
    v_mfma_f32_16x16x32_bf16 v[44:47], a[200:203], v[180:183], v[44:47]
    ds_read_b64_tr_b16 a[248:249], v197 offset:42432
    v_cvt_pk_bf16_f32 v68, v4, v5
    v_mfma_f32_16x16x32_bf16 a[32:35], a[232:235], v[80:83], a[32:35]
    v_exp_f32 v6, v6
    v_mfma_f32_16x16x32_bf16 a[36:39], a[232:235], v[84:87], a[36:39]
    ds_read_b64_tr_b16 a[250:251], v197 offset:42944
    v_mfma_f32_16x16x32_bf16 a[40:43], a[232:235], v[88:91], a[40:43]
    v_exp_f32 v7, v7
    v_mfma_f32_16x16x32_bf16 a[44:47], a[232:235], v[92:95], a[44:47]
    buffer_load_dwordx4 v203, s[16:19], s46 offen offset:1056 nt lds
    v_mfma_f32_16x16x32_bf16 v[48:51], a[204:207], v[132:135], v[48:51]
    v_exp_f32 v20, v20
    v_mfma_f32_16x16x32_bf16 v[52:55], a[204:207], v[148:151], v[52:55]
    ds_read_b128 a[220:223], v196 offset:59840
    v_cvt_pk_bf16_f32 v69, v6, v7
    v_mfma_f32_16x16x32_bf16 v[56:59], a[204:207], v[164:167], v[56:59]
    v_exp_f32 v21, v21
    v_mfma_f32_16x16x32_bf16 v[60:63], a[204:207], v[180:183], v[60:63]
    ds_read_b64_tr_b16 a[252:253], v197 offset:42464
    v_cvt_pk_bf16_f32 v70, v20, v21
    v_mfma_f32_16x16x32_bf16 a[48:51], a[236:239], v[80:83], a[48:51]
    v_exp_f32 v22, v22
    v_mfma_f32_16x16x32_bf16 a[52:55], a[236:239], v[84:87], a[52:55]
    ds_read_b64_tr_b16 a[254:255], v197 offset:42976
    s_add_u32 s46, s46, 8192
    v_mfma_f32_16x16x32_bf16 a[56:59], a[236:239], v[88:91], a[56:59]
    v_exp_f32 v23, v23
    v_mfma_f32_16x16x32_bf16 a[60:63], a[236:239], v[92:95], a[60:63]
    v_mfma_f32_16x16x32_bf16 v[116:119], v[192:195], v[84:87], v[116:119]
    s_waitcnt vmcnt(4) lgkmcnt(6)
    s_barrier
    v_mfma_f32_16x16x32_bf16 v[32:35], a[208:211], v[136:139], v[32:35]
    v_exp_f32 v8, v8
    v_mfma_f32_16x16x32_bf16 v[36:39], a[208:211], v[152:155], v[36:39]
    ds_read_b128 a[192:195], v196 offset:0
    v_cvt_pk_bf16_f32 v71, v22, v23
    v_mfma_f32_16x16x32_bf16 v[40:43], a[208:211], v[168:171], v[40:43]
    v_exp_f32 v9, v9
    v_mfma_f32_16x16x32_bf16 v[44:47], a[208:211], v[184:187], v[44:47]
    ds_read_b64_tr_b16 a[224:225], v197 offset:50688
    v_cvt_pk_bf16_f32 v72, v8, v9
    v_mfma_f32_16x16x32_bf16 a[64:67], a[240:243], v[80:83], a[64:67]
    v_exp_f32 v10, v10
    v_mfma_f32_16x16x32_bf16 a[68:71], a[240:243], v[84:87], a[68:71]
    ds_read_b64_tr_b16 a[226:227], v197 offset:51200
    s_add_u32 m0, s36, 16896
    v_mfma_f32_16x16x32_bf16 a[72:75], a[240:243], v[88:91], a[72:75]
    v_exp_f32 v11, v11
    v_mfma_f32_16x16x32_bf16 a[76:79], a[240:243], v[92:95], a[76:79]
    buffer_load_dwordx4 v200, s[12:15], s46 offen nt lds
    v_mfma_f32_16x16x32_bf16 v[48:51], a[212:215], v[136:139], v[48:51]
    v_exp_f32 v24, v24
    v_mfma_f32_16x16x32_bf16 v[52:55], a[212:215], v[152:155], v[52:55]
    ds_read_b128 a[196:199], v196 offset:512
    v_cvt_pk_bf16_f32 v73, v10, v11
    v_mfma_f32_16x16x32_bf16 v[56:59], a[212:215], v[168:171], v[56:59]
    v_exp_f32 v25, v25
    v_mfma_f32_16x16x32_bf16 v[60:63], a[212:215], v[184:187], v[60:63]
    ds_read_b64_tr_b16 a[228:229], v197 offset:50720
    v_cvt_pk_bf16_f32 v74, v24, v25
    v_mfma_f32_16x16x32_bf16 a[80:83], a[244:247], v[80:83], a[80:83]
    v_exp_f32 v26, v26
    v_mfma_f32_16x16x32_bf16 a[84:87], a[244:247], v[84:87], a[84:87]
    ds_read_b64_tr_b16 a[230:231], v197 offset:51232
    v_mfma_f32_16x16x32_bf16 a[88:91], a[244:247], v[88:91], a[88:91]
    v_exp_f32 v27, v27
    v_mfma_f32_16x16x32_bf16 a[92:95], a[244:247], v[92:95], a[92:95]
    v_mfma_f32_16x16x32_bf16 v[120:123], v[192:195], v[88:91], v[120:123]
    s_waitcnt lgkmcnt(6)
    v_mfma_f32_16x16x32_bf16 v[32:35], a[216:219], v[140:143], v[32:35]
    v_exp_f32 v12, v12
    v_mfma_f32_16x16x32_bf16 v[36:39], a[216:219], v[156:159], v[36:39]
    ds_read_b128 a[200:203], v196 offset:64
    v_cvt_pk_bf16_f32 v75, v26, v27
    v_mfma_f32_16x16x32_bf16 v[40:43], a[216:219], v[172:175], v[40:43]
    v_exp_f32 v13, v13
    v_mfma_f32_16x16x32_bf16 v[44:47], a[216:219], v[188:191], v[44:47]
    ds_read_b64_tr_b16 a[232:233], v197 offset:50752
    v_cvt_pk_bf16_f32 v76, v12, v13
    v_mfma_f32_16x16x32_bf16 a[96:99], a[248:251], v[80:83], a[96:99]
    v_exp_f32 v14, v14
    v_mfma_f32_16x16x32_bf16 a[100:103], a[248:251], v[84:87], a[100:103]
    ds_read_b64_tr_b16 a[234:235], v197 offset:51264
    v_mfma_f32_16x16x32_bf16 a[104:107], a[248:251], v[88:91], a[104:107]
    v_exp_f32 v15, v15
    v_mfma_f32_16x16x32_bf16 a[108:111], a[248:251], v[92:95], a[108:111]
    buffer_load_dwordx4 v201, s[12:15], s46 offen offset:1056 nt lds
    v_mfma_f32_16x16x32_bf16 v[48:51], a[220:223], v[140:143], v[48:51]
    v_exp_f32 v28, v28
    v_mfma_f32_16x16x32_bf16 v[52:55], a[220:223], v[156:159], v[52:55]
    ds_read_b128 a[204:207], v196 offset:576
    v_cvt_pk_bf16_f32 v77, v14, v15
    v_mfma_f32_16x16x32_bf16 v[56:59], a[220:223], v[172:175], v[56:59]
    v_exp_f32 v29, v29
    v_mfma_f32_16x16x32_bf16 v[60:63], a[220:223], v[188:191], v[60:63]
    ds_read_b64_tr_b16 a[236:237], v197 offset:50784
    v_cvt_pk_bf16_f32 v78, v28, v29
    v_mfma_f32_16x16x32_bf16 a[112:115], a[252:255], v[80:83], a[112:115]
    v_exp_f32 v30, v30
    v_mfma_f32_16x16x32_bf16 a[116:119], a[252:255], v[84:87], a[116:119]
    ds_read_b64_tr_b16 a[238:239], v197 offset:51296
    v_mfma_f32_16x16x32_bf16 a[120:123], a[252:255], v[88:91], a[120:123]
    v_exp_f32 v31, v31
    v_mfma_f32_16x16x32_bf16 a[124:127], a[252:255], v[92:95], a[124:127]
    v_mfma_f32_16x16x32_bf16 v[124:127], v[192:195], v[92:95], v[124:127]
    s_waitcnt vmcnt(4)
    s_cmp_eq_u32 s45, 0
    s_waitcnt lgkmcnt(6)
    s_cbranch_scc1 K1_AEXIT
    v_mfma_f32_16x16x32_bf16 v[0:3], a[192:195], v[128:131], v[96:99]
    v_exp_f32 v32, v32
    v_mfma_f32_16x16x32_bf16 v[4:7], a[192:195], v[144:147], v[100:103]
    ds_read_b128 a[208:211], v196 offset:128
    v_cvt_pk_bf16_f32 v79, v30, v31
    v_mfma_f32_16x16x32_bf16 v[8:11], a[192:195], v[160:163], v[104:107]
    v_exp_f32 v33, v33
    v_mfma_f32_16x16x32_bf16 v[12:15], a[192:195], v[176:179], v[108:111]
    ds_read_b64_tr_b16 a[240:241], v197 offset:50816
    v_cvt_pk_bf16_f32 v80, v32, v33
    v_mfma_f32_16x16x32_bf16 a[0:3], a[224:227], v[64:67], a[0:3]
    v_exp_f32 v34, v34
    v_mfma_f32_16x16x32_bf16 a[4:7], a[224:227], v[68:71], a[4:7]
    ds_read_b64_tr_b16 a[242:243], v197 offset:51328
    s_add_u32 m0, s38, 0
    v_mfma_f32_16x16x32_bf16 a[8:11], a[224:227], v[72:75], a[8:11]
    v_exp_f32 v35, v35
    v_mfma_f32_16x16x32_bf16 a[12:15], a[224:227], v[76:79], a[12:15]
    buffer_load_dwordx4 v202, s[16:19], s46 offen nt lds
    v_mfma_f32_16x16x32_bf16 v[16:19], a[196:199], v[128:131], v[96:99]
    v_exp_f32 v48, v48
    v_mfma_f32_16x16x32_bf16 v[20:23], a[196:199], v[144:147], v[100:103]
    ds_read_b128 a[212:215], v196 offset:640
    v_cvt_pk_bf16_f32 v81, v34, v35
    v_mfma_f32_16x16x32_bf16 v[24:27], a[196:199], v[160:163], v[104:107]
    v_exp_f32 v49, v49
    v_mfma_f32_16x16x32_bf16 v[28:31], a[196:199], v[176:179], v[108:111]
    ds_read_b64_tr_b16 a[244:245], v197 offset:50848
    v_cvt_pk_bf16_f32 v82, v48, v49
    v_mfma_f32_16x16x32_bf16 a[16:19], a[228:231], v[64:67], a[16:19]
    v_exp_f32 v50, v50
    v_mfma_f32_16x16x32_bf16 a[20:23], a[228:231], v[68:71], a[20:23]
    ds_read_b64_tr_b16 a[246:247], v197 offset:51360
    v_mfma_f32_16x16x32_bf16 a[24:27], a[228:231], v[72:75], a[24:27]
    v_exp_f32 v51, v51
    v_mfma_f32_16x16x32_bf16 a[28:31], a[228:231], v[76:79], a[28:31]
    v_mfma_f32_16x16x32_bf16 v[112:115], v[192:195], v[64:67], v[112:115]
    s_waitcnt lgkmcnt(6)
    v_mfma_f32_16x16x32_bf16 v[0:3], a[200:203], v[132:135], v[0:3]
    v_exp_f32 v36, v36
    v_mfma_f32_16x16x32_bf16 v[4:7], a[200:203], v[148:151], v[4:7]
    ds_read_b128 a[216:219], v196 offset:192
    v_cvt_pk_bf16_f32 v83, v50, v51
    v_mfma_f32_16x16x32_bf16 v[8:11], a[200:203], v[164:167], v[8:11]
    v_exp_f32 v37, v37
    v_mfma_f32_16x16x32_bf16 v[12:15], a[200:203], v[180:183], v[12:15]
    ds_read_b64_tr_b16 a[248:249], v197 offset:50880
    v_cvt_pk_bf16_f32 v84, v36, v37
    v_mfma_f32_16x16x32_bf16 a[32:35], a[232:235], v[64:67], a[32:35]
    v_exp_f32 v38, v38
    v_mfma_f32_16x16x32_bf16 a[36:39], a[232:235], v[68:71], a[36:39]
    ds_read_b64_tr_b16 a[250:251], v197 offset:51392
    v_mfma_f32_16x16x32_bf16 a[40:43], a[232:235], v[72:75], a[40:43]
    v_exp_f32 v39, v39
    v_mfma_f32_16x16x32_bf16 a[44:47], a[232:235], v[76:79], a[44:47]
    buffer_load_dwordx4 v203, s[16:19], s46 offen offset:1056 nt lds
    v_mfma_f32_16x16x32_bf16 v[16:19], a[204:207], v[132:135], v[16:19]
    v_exp_f32 v52, v52
    v_mfma_f32_16x16x32_bf16 v[20:23], a[204:207], v[148:151], v[20:23]
    ds_read_b128 a[220:223], v196 offset:704
    v_cvt_pk_bf16_f32 v85, v38, v39
    v_mfma_f32_16x16x32_bf16 v[24:27], a[204:207], v[164:167], v[24:27]
    v_exp_f32 v53, v53
    v_mfma_f32_16x16x32_bf16 v[28:31], a[204:207], v[180:183], v[28:31]
    ds_read_b64_tr_b16 a[252:253], v197 offset:50912
    v_cvt_pk_bf16_f32 v86, v52, v53
    v_mfma_f32_16x16x32_bf16 a[48:51], a[236:239], v[64:67], a[48:51]
    v_exp_f32 v54, v54
    v_mfma_f32_16x16x32_bf16 a[52:55], a[236:239], v[68:71], a[52:55]
    ds_read_b64_tr_b16 a[254:255], v197 offset:51424
    s_add_u32 s46, s46, 8192
    v_mfma_f32_16x16x32_bf16 a[56:59], a[236:239], v[72:75], a[56:59]
    v_exp_f32 v55, v55
    v_mfma_f32_16x16x32_bf16 a[60:63], a[236:239], v[76:79], a[60:63]
    v_mfma_f32_16x16x32_bf16 v[116:119], v[192:195], v[68:71], v[116:119]
    s_waitcnt vmcnt(4) lgkmcnt(6)
    s_barrier
    v_mfma_f32_16x16x32_bf16 v[0:3], a[208:211], v[136:139], v[0:3]
    v_exp_f32 v40, v40
    v_mfma_f32_16x16x32_bf16 v[4:7], a[208:211], v[152:155], v[4:7]
    ds_read_b128 a[192:195], v196 offset:8448
    v_cvt_pk_bf16_f32 v87, v54, v55
    v_mfma_f32_16x16x32_bf16 v[8:11], a[208:211], v[168:171], v[8:11]
    v_exp_f32 v41, v41
    v_mfma_f32_16x16x32_bf16 v[12:15], a[208:211], v[184:187], v[12:15]
    ds_read_b64_tr_b16 a[224:225], v197 offset:59136
    v_cvt_pk_bf16_f32 v88, v40, v41
    v_mfma_f32_16x16x32_bf16 a[64:67], a[240:243], v[64:67], a[64:67]
    v_exp_f32 v42, v42
    v_mfma_f32_16x16x32_bf16 a[68:71], a[240:243], v[68:71], a[68:71]
    ds_read_b64_tr_b16 a[226:227], v197 offset:59648
    s_add_u32 m0, s36, 25344
    v_mfma_f32_16x16x32_bf16 a[72:75], a[240:243], v[72:75], a[72:75]
    v_exp_f32 v43, v43
    v_mfma_f32_16x16x32_bf16 a[76:79], a[240:243], v[76:79], a[76:79]
    buffer_load_dwordx4 v200, s[12:15], s46 offen nt lds
    v_mfma_f32_16x16x32_bf16 v[16:19], a[212:215], v[136:139], v[16:19]
    v_exp_f32 v56, v56
    v_mfma_f32_16x16x32_bf16 v[20:23], a[212:215], v[152:155], v[20:23]
    ds_read_b128 a[196:199], v196 offset:8960
    v_cvt_pk_bf16_f32 v89, v42, v43
    v_mfma_f32_16x16x32_bf16 v[24:27], a[212:215], v[168:171], v[24:27]
    v_exp_f32 v57, v57
    v_mfma_f32_16x16x32_bf16 v[28:31], a[212:215], v[184:187], v[28:31]
    ds_read_b64_tr_b16 a[228:229], v197 offset:59168
    v_cvt_pk_bf16_f32 v90, v56, v57
    v_mfma_f32_16x16x32_bf16 a[80:83], a[244:247], v[64:67], a[80:83]
    v_exp_f32 v58, v58
    v_mfma_f32_16x16x32_bf16 a[84:87], a[244:247], v[68:71], a[84:87]
    ds_read_b64_tr_b16 a[230:231], v197 offset:59680
    v_mfma_f32_16x16x32_bf16 a[88:91], a[244:247], v[72:75], a[88:91]
    v_exp_f32 v59, v59
    v_mfma_f32_16x16x32_bf16 a[92:95], a[244:247], v[76:79], a[92:95]
    v_mfma_f32_16x16x32_bf16 v[120:123], v[192:195], v[72:75], v[120:123]
    s_waitcnt lgkmcnt(6)
    v_mfma_f32_16x16x32_bf16 v[0:3], a[216:219], v[140:143], v[0:3]
    v_exp_f32 v44, v44
    v_mfma_f32_16x16x32_bf16 v[4:7], a[216:219], v[156:159], v[4:7]
    ds_read_b128 a[200:203], v196 offset:8512
    v_cvt_pk_bf16_f32 v91, v58, v59
    v_mfma_f32_16x16x32_bf16 v[8:11], a[216:219], v[172:175], v[8:11]
    v_exp_f32 v45, v45
    v_mfma_f32_16x16x32_bf16 v[12:15], a[216:219], v[188:191], v[12:15]
    ds_read_b64_tr_b16 a[232:233], v197 offset:59200
    v_cvt_pk_bf16_f32 v92, v44, v45
    v_mfma_f32_16x16x32_bf16 a[96:99], a[248:251], v[64:67], a[96:99]
    v_exp_f32 v46, v46
    v_mfma_f32_16x16x32_bf16 a[100:103], a[248:251], v[68:71], a[100:103]
    ds_read_b64_tr_b16 a[234:235], v197 offset:59712
    v_mfma_f32_16x16x32_bf16 a[104:107], a[248:251], v[72:75], a[104:107]
    v_exp_f32 v47, v47
    v_mfma_f32_16x16x32_bf16 a[108:111], a[248:251], v[76:79], a[108:111]
    buffer_load_dwordx4 v201, s[12:15], s46 offen offset:1056 nt lds
    v_mfma_f32_16x16x32_bf16 v[16:19], a[220:223], v[140:143], v[16:19]
    v_exp_f32 v60, v60
    v_mfma_f32_16x16x32_bf16 v[20:23], a[220:223], v[156:159], v[20:23]
    ds_read_b128 a[204:207], v196 offset:9024
    v_cvt_pk_bf16_f32 v93, v46, v47
    v_mfma_f32_16x16x32_bf16 v[24:27], a[220:223], v[172:175], v[24:27]
    v_exp_f32 v61, v61
    v_mfma_f32_16x16x32_bf16 v[28:31], a[220:223], v[188:191], v[28:31]
    ds_read_b64_tr_b16 a[236:237], v197 offset:59232
    v_cvt_pk_bf16_f32 v94, v60, v61
    v_mfma_f32_16x16x32_bf16 a[112:115], a[252:255], v[64:67], a[112:115]
    v_exp_f32 v62, v62
    v_mfma_f32_16x16x32_bf16 a[116:119], a[252:255], v[68:71], a[116:119]
    ds_read_b64_tr_b16 a[238:239], v197 offset:59744
    v_mfma_f32_16x16x32_bf16 a[120:123], a[252:255], v[72:75], a[120:123]
    v_exp_f32 v63, v63
    v_mfma_f32_16x16x32_bf16 a[124:127], a[252:255], v[76:79], a[124:127]
    v_mfma_f32_16x16x32_bf16 v[124:127], v[192:195], v[76:79], v[124:127]
    s_waitcnt vmcnt(4)
    s_cmp_eq_u32 s45, s31
    s_waitcnt lgkmcnt(6)
    s_cbranch_scc1 K1_TAIL
    v_mfma_f32_16x16x32_bf16 v[32:35], a[192:195], v[128:131], v[96:99]
    v_exp_f32 v0, v0
    v_mfma_f32_16x16x32_bf16 v[36:39], a[192:195], v[144:147], v[100:103]
    ds_read_b128 a[208:211], v196 offset:8576
    v_cvt_pk_bf16_f32 v95, v62, v63
    v_mfma_f32_16x16x32_bf16 v[40:43], a[192:195], v[160:163], v[104:107]
    v_exp_f32 v1, v1
    v_mfma_f32_16x16x32_bf16 v[44:47], a[192:195], v[176:179], v[108:111]
    ds_read_b64_tr_b16 a[240:241], v197 offset:59264
    v_cvt_pk_bf16_f32 v64, v0, v1
    v_mfma_f32_16x16x32_bf16 a[0:3], a[224:227], v[80:83], a[0:3]
    v_exp_f32 v2, v2
    v_mfma_f32_16x16x32_bf16 a[4:7], a[224:227], v[84:87], a[4:7]
    ds_read_b64_tr_b16 a[242:243], v197 offset:59776
    s_add_u32 m0, s38, 8448
    v_mfma_f32_16x16x32_bf16 a[8:11], a[224:227], v[88:91], a[8:11]
    v_exp_f32 v3, v3
    v_mfma_f32_16x16x32_bf16 a[12:15], a[224:227], v[92:95], a[12:15]
    buffer_load_dwordx4 v202, s[16:19], s46 offen nt lds
    v_mfma_f32_16x16x32_bf16 v[48:51], a[196:199], v[128:131], v[96:99]
    v_exp_f32 v16, v16
    v_mfma_f32_16x16x32_bf16 v[52:55], a[196:199], v[144:147], v[100:103]
    ds_read_b128 a[212:215], v196 offset:9088
    v_cvt_pk_bf16_f32 v65, v2, v3
    v_mfma_f32_16x16x32_bf16 v[56:59], a[196:199], v[160:163], v[104:107]
    v_exp_f32 v17, v17
    v_mfma_f32_16x16x32_bf16 v[60:63], a[196:199], v[176:179], v[108:111]
    ds_read_b64_tr_b16 a[244:245], v197 offset:59296
    v_cvt_pk_bf16_f32 v66, v16, v17
    v_mfma_f32_16x16x32_bf16 a[16:19], a[228:231], v[80:83], a[16:19]
    v_exp_f32 v18, v18
    v_mfma_f32_16x16x32_bf16 a[20:23], a[228:231], v[84:87], a[20:23]
    ds_read_b64_tr_b16 a[246:247], v197 offset:59808
    v_mfma_f32_16x16x32_bf16 a[24:27], a[228:231], v[88:91], a[24:27]
    v_exp_f32 v19, v19
    v_mfma_f32_16x16x32_bf16 a[28:31], a[228:231], v[92:95], a[28:31]
    v_mfma_f32_16x16x32_bf16 v[112:115], v[192:195], v[80:83], v[112:115]
    s_waitcnt lgkmcnt(6)
    v_mfma_f32_16x16x32_bf16 v[32:35], a[200:203], v[132:135], v[32:35]
    v_exp_f32 v4, v4
    v_mfma_f32_16x16x32_bf16 v[36:39], a[200:203], v[148:151], v[36:39]
    ds_read_b128 a[216:219], v196 offset:8640
    v_cvt_pk_bf16_f32 v67, v18, v19
    v_mfma_f32_16x16x32_bf16 v[40:43], a[200:203], v[164:167], v[40:43]
    v_exp_f32 v5, v5
    v_mfma_f32_16x16x32_bf16 v[44:47], a[200:203], v[180:183], v[44:47]
    ds_read_b64_tr_b16 a[248:249], v197 offset:59328
    v_cvt_pk_bf16_f32 v68, v4, v5
    v_mfma_f32_16x16x32_bf16 a[32:35], a[232:235], v[80:83], a[32:35]
    v_exp_f32 v6, v6
    v_mfma_f32_16x16x32_bf16 a[36:39], a[232:235], v[84:87], a[36:39]
    ds_read_b64_tr_b16 a[250:251], v197 offset:59840
    v_mfma_f32_16x16x32_bf16 a[40:43], a[232:235], v[88:91], a[40:43]
    v_exp_f32 v7, v7
    v_mfma_f32_16x16x32_bf16 a[44:47], a[232:235], v[92:95], a[44:47]
    buffer_load_dwordx4 v203, s[16:19], s46 offen offset:1056 nt lds
    v_mfma_f32_16x16x32_bf16 v[48:51], a[204:207], v[132:135], v[48:51]
    v_exp_f32 v20, v20
    v_mfma_f32_16x16x32_bf16 v[52:55], a[204:207], v[148:151], v[52:55]
    ds_read_b128 a[220:223], v196 offset:9152
    v_cvt_pk_bf16_f32 v69, v6, v7
    v_mfma_f32_16x16x32_bf16 v[56:59], a[204:207], v[164:167], v[56:59]
    v_exp_f32 v21, v21
    v_mfma_f32_16x16x32_bf16 v[60:63], a[204:207], v[180:183], v[60:63]
    ds_read_b64_tr_b16 a[252:253], v197 offset:59360
    v_cvt_pk_bf16_f32 v70, v20, v21
    v_mfma_f32_16x16x32_bf16 a[48:51], a[236:239], v[80:83], a[48:51]
    v_exp_f32 v22, v22
    v_mfma_f32_16x16x32_bf16 a[52:55], a[236:239], v[84:87], a[52:55]
    ds_read_b64_tr_b16 a[254:255], v197 offset:59872
    s_add_u32 s46, s46, 8192
    v_mfma_f32_16x16x32_bf16 a[56:59], a[236:239], v[88:91], a[56:59]
    v_exp_f32 v23, v23
    v_mfma_f32_16x16x32_bf16 a[60:63], a[236:239], v[92:95], a[60:63]
    v_mfma_f32_16x16x32_bf16 v[116:119], v[192:195], v[84:87], v[116:119]
    s_waitcnt vmcnt(4) lgkmcnt(6)
    s_barrier
    v_mfma_f32_16x16x32_bf16 v[32:35], a[208:211], v[136:139], v[32:35]
    v_exp_f32 v8, v8
    v_mfma_f32_16x16x32_bf16 v[36:39], a[208:211], v[152:155], v[36:39]
    ds_read_b128 a[192:195], v196 offset:16896
    v_cvt_pk_bf16_f32 v71, v22, v23
    v_mfma_f32_16x16x32_bf16 v[40:43], a[208:211], v[168:171], v[40:43]
    v_exp_f32 v9, v9
    v_mfma_f32_16x16x32_bf16 v[44:47], a[208:211], v[184:187], v[44:47]
    ds_read_b64_tr_b16 a[224:225], v197 offset:0
    v_cvt_pk_bf16_f32 v72, v8, v9
    v_mfma_f32_16x16x32_bf16 a[64:67], a[240:243], v[80:83], a[64:67]
    v_exp_f32 v10, v10
    v_mfma_f32_16x16x32_bf16 a[68:71], a[240:243], v[84:87], a[68:71]
    ds_read_b64_tr_b16 a[226:227], v197 offset:512
    s_add_u32 m0, s37, 33792
    v_mfma_f32_16x16x32_bf16 a[72:75], a[240:243], v[88:91], a[72:75]
    v_exp_f32 v11, v11
    v_mfma_f32_16x16x32_bf16 a[76:79], a[240:243], v[92:95], a[76:79]
    buffer_load_dwordx4 v200, s[12:15], s46 offen nt lds
    v_mfma_f32_16x16x32_bf16 v[48:51], a[212:215], v[136:139], v[48:51]
    v_exp_f32 v24, v24
    v_mfma_f32_16x16x32_bf16 v[52:55], a[212:215], v[152:155], v[52:55]
    ds_read_b128 a[196:199], v196 offset:17408
    v_cvt_pk_bf16_f32 v73, v10, v11
    v_mfma_f32_16x16x32_bf16 v[56:59], a[212:215], v[168:171], v[56:59]
    v_exp_f32 v25, v25
    v_mfma_f32_16x16x32_bf16 v[60:63], a[212:215], v[184:187], v[60:63]
    ds_read_b64_tr_b16 a[228:229], v197 offset:32
    v_cvt_pk_bf16_f32 v74, v24, v25
    v_mfma_f32_16x16x32_bf16 a[80:83], a[244:247], v[80:83], a[80:83]
    v_exp_f32 v26, v26
    v_mfma_f32_16x16x32_bf16 a[84:87], a[244:247], v[84:87], a[84:87]
    ds_read_b64_tr_b16 a[230:231], v197 offset:544
    v_mfma_f32_16x16x32_bf16 a[88:91], a[244:247], v[88:91], a[88:91]
    v_exp_f32 v27, v27
    v_mfma_f32_16x16x32_bf16 a[92:95], a[244:247], v[92:95], a[92:95]
    v_mfma_f32_16x16x32_bf16 v[120:123], v[192:195], v[88:91], v[120:123]
    s_waitcnt lgkmcnt(6)
    v_mfma_f32_16x16x32_bf16 v[32:35], a[216:219], v[140:143], v[32:35]
    v_exp_f32 v12, v12
    v_mfma_f32_16x16x32_bf16 v[36:39], a[216:219], v[156:159], v[36:39]
    ds_read_b128 a[200:203], v196 offset:16960
    v_cvt_pk_bf16_f32 v75, v26, v27
    v_mfma_f32_16x16x32_bf16 v[40:43], a[216:219], v[172:175], v[40:43]
    v_exp_f32 v13, v13
    v_mfma_f32_16x16x32_bf16 v[44:47], a[216:219], v[188:191], v[44:47]
    ds_read_b64_tr_b16 a[232:233], v197 offset:64
    v_cvt_pk_bf16_f32 v76, v12, v13
    v_mfma_f32_16x16x32_bf16 a[96:99], a[248:251], v[80:83], a[96:99]
    v_exp_f32 v14, v14
    v_mfma_f32_16x16x32_bf16 a[100:103], a[248:251], v[84:87], a[100:103]
    ds_read_b64_tr_b16 a[234:235], v197 offset:576
    v_mfma_f32_16x16x32_bf16 a[104:107], a[248:251], v[88:91], a[104:107]
    v_exp_f32 v15, v15
    v_mfma_f32_16x16x32_bf16 a[108:111], a[248:251], v[92:95], a[108:111]
    buffer_load_dwordx4 v201, s[12:15], s46 offen offset:1056 nt lds
    v_mfma_f32_16x16x32_bf16 v[48:51], a[220:223], v[140:143], v[48:51]
    v_exp_f32 v28, v28
    v_mfma_f32_16x16x32_bf16 v[52:55], a[220:223], v[156:159], v[52:55]
    ds_read_b128 a[204:207], v196 offset:17472
    v_cvt_pk_bf16_f32 v77, v14, v15
    v_mfma_f32_16x16x32_bf16 v[56:59], a[220:223], v[172:175], v[56:59]
    v_exp_f32 v29, v29
    v_mfma_f32_16x16x32_bf16 v[60:63], a[220:223], v[188:191], v[60:63]
    ds_read_b64_tr_b16 a[236:237], v197 offset:96
    v_cvt_pk_bf16_f32 v78, v28, v29
    v_mfma_f32_16x16x32_bf16 a[112:115], a[252:255], v[80:83], a[112:115]
    v_exp_f32 v30, v30
    v_mfma_f32_16x16x32_bf16 a[116:119], a[252:255], v[84:87], a[116:119]
    ds_read_b64_tr_b16 a[238:239], v197 offset:608
    v_mfma_f32_16x16x32_bf16 a[120:123], a[252:255], v[88:91], a[120:123]
    v_exp_f32 v31, v31
    v_mfma_f32_16x16x32_bf16 a[124:127], a[252:255], v[92:95], a[124:127]
    v_mfma_f32_16x16x32_bf16 v[124:127], v[192:195], v[92:95], v[124:127]
    s_waitcnt vmcnt(4)
    s_waitcnt lgkmcnt(6)
    v_mfma_f32_16x16x32_bf16 v[0:3], a[192:195], v[128:131], v[96:99]
    v_exp_f32 v32, v32
    v_mfma_f32_16x16x32_bf16 v[4:7], a[192:195], v[144:147], v[100:103]
    ds_read_b128 a[208:211], v196 offset:17024
    v_cvt_pk_bf16_f32 v79, v30, v31
    v_mfma_f32_16x16x32_bf16 v[8:11], a[192:195], v[160:163], v[104:107]
    v_exp_f32 v33, v33
    v_mfma_f32_16x16x32_bf16 v[12:15], a[192:195], v[176:179], v[108:111]
    ds_read_b64_tr_b16 a[240:241], v197 offset:128
    v_cvt_pk_bf16_f32 v80, v32, v33
    v_mfma_f32_16x16x32_bf16 a[0:3], a[224:227], v[64:67], a[0:3]
    v_exp_f32 v34, v34
    v_mfma_f32_16x16x32_bf16 a[4:7], a[224:227], v[68:71], a[4:7]
    ds_read_b64_tr_b16 a[242:243], v197 offset:640
    s_add_u32 m0, s38, 16896
    v_mfma_f32_16x16x32_bf16 a[8:11], a[224:227], v[72:75], a[8:11]
    v_exp_f32 v35, v35
    v_mfma_f32_16x16x32_bf16 a[12:15], a[224:227], v[76:79], a[12:15]
    buffer_load_dwordx4 v202, s[16:19], s46 offen nt lds
    v_mfma_f32_16x16x32_bf16 v[16:19], a[196:199], v[128:131], v[96:99]
    v_exp_f32 v48, v48
    v_mfma_f32_16x16x32_bf16 v[20:23], a[196:199], v[144:147], v[100:103]
    ds_read_b128 a[212:215], v196 offset:17536
    v_cvt_pk_bf16_f32 v81, v34, v35
    v_mfma_f32_16x16x32_bf16 v[24:27], a[196:199], v[160:163], v[104:107]
    v_exp_f32 v49, v49
    v_mfma_f32_16x16x32_bf16 v[28:31], a[196:199], v[176:179], v[108:111]
    ds_read_b64_tr_b16 a[244:245], v197 offset:160
    v_cvt_pk_bf16_f32 v82, v48, v49
    v_mfma_f32_16x16x32_bf16 a[16:19], a[228:231], v[64:67], a[16:19]
    v_exp_f32 v50, v50
    v_mfma_f32_16x16x32_bf16 a[20:23], a[228:231], v[68:71], a[20:23]
    ds_read_b64_tr_b16 a[246:247], v197 offset:672
    v_mfma_f32_16x16x32_bf16 a[24:27], a[228:231], v[72:75], a[24:27]
    v_exp_f32 v51, v51
    v_mfma_f32_16x16x32_bf16 a[28:31], a[228:231], v[76:79], a[28:31]
    v_mfma_f32_16x16x32_bf16 v[112:115], v[192:195], v[64:67], v[112:115]
    s_waitcnt lgkmcnt(6)
    v_mfma_f32_16x16x32_bf16 v[0:3], a[200:203], v[132:135], v[0:3]
    v_exp_f32 v36, v36
    v_mfma_f32_16x16x32_bf16 v[4:7], a[200:203], v[148:151], v[4:7]
    ds_read_b128 a[216:219], v196 offset:17088
    v_cvt_pk_bf16_f32 v83, v50, v51
    v_mfma_f32_16x16x32_bf16 v[8:11], a[200:203], v[164:167], v[8:11]
    v_exp_f32 v37, v37
    v_mfma_f32_16x16x32_bf16 v[12:15], a[200:203], v[180:183], v[12:15]
    ds_read_b64_tr_b16 a[248:249], v197 offset:192
    v_cvt_pk_bf16_f32 v84, v36, v37
    v_mfma_f32_16x16x32_bf16 a[32:35], a[232:235], v[64:67], a[32:35]
    v_exp_f32 v38, v38
    v_mfma_f32_16x16x32_bf16 a[36:39], a[232:235], v[68:71], a[36:39]
    ds_read_b64_tr_b16 a[250:251], v197 offset:704
    v_mfma_f32_16x16x32_bf16 a[40:43], a[232:235], v[72:75], a[40:43]
    v_exp_f32 v39, v39
    v_mfma_f32_16x16x32_bf16 a[44:47], a[232:235], v[76:79], a[44:47]
    buffer_load_dwordx4 v203, s[16:19], s46 offen offset:1056 nt lds
    v_mfma_f32_16x16x32_bf16 v[16:19], a[204:207], v[132:135], v[16:19]
    v_exp_f32 v52, v52
    v_mfma_f32_16x16x32_bf16 v[20:23], a[204:207], v[148:151], v[20:23]
    ds_read_b128 a[220:223], v196 offset:17600
    v_cvt_pk_bf16_f32 v85, v38, v39
    v_mfma_f32_16x16x32_bf16 v[24:27], a[204:207], v[164:167], v[24:27]
    v_exp_f32 v53, v53
    v_mfma_f32_16x16x32_bf16 v[28:31], a[204:207], v[180:183], v[28:31]
    ds_read_b64_tr_b16 a[252:253], v197 offset:224
    v_cvt_pk_bf16_f32 v86, v52, v53
    v_mfma_f32_16x16x32_bf16 a[48:51], a[236:239], v[64:67], a[48:51]
    v_exp_f32 v54, v54
    v_mfma_f32_16x16x32_bf16 a[52:55], a[236:239], v[68:71], a[52:55]
    ds_read_b64_tr_b16 a[254:255], v197 offset:736
    s_add_u32 s46, s46, 8192
    v_mfma_f32_16x16x32_bf16 a[56:59], a[236:239], v[72:75], a[56:59]
    v_exp_f32 v55, v55
    v_mfma_f32_16x16x32_bf16 a[60:63], a[236:239], v[76:79], a[60:63]
    v_mfma_f32_16x16x32_bf16 v[116:119], v[192:195], v[68:71], v[116:119]
    s_waitcnt vmcnt(4) lgkmcnt(6)
    s_barrier
    v_mfma_f32_16x16x32_bf16 v[0:3], a[208:211], v[136:139], v[0:3]
    v_exp_f32 v40, v40
    v_mfma_f32_16x16x32_bf16 v[4:7], a[208:211], v[152:155], v[4:7]
    ds_read_b128 a[192:195], v196 offset:25344
    v_cvt_pk_bf16_f32 v87, v54, v55
    v_mfma_f32_16x16x32_bf16 v[8:11], a[208:211], v[168:171], v[8:11]
    v_exp_f32 v41, v41
    v_mfma_f32_16x16x32_bf16 v[12:15], a[208:211], v[184:187], v[12:15]
    ds_read_b64_tr_b16 a[224:225], v197 offset:8448
    v_cvt_pk_bf16_f32 v88, v40, v41
    v_mfma_f32_16x16x32_bf16 a[64:67], a[240:243], v[64:67], a[64:67]
    v_exp_f32 v42, v42
    v_mfma_f32_16x16x32_bf16 a[68:71], a[240:243], v[68:71], a[68:71]
    ds_read_b64_tr_b16 a[226:227], v197 offset:8960
    s_add_u32 m0, s37, 42240
    v_mfma_f32_16x16x32_bf16 a[72:75], a[240:243], v[72:75], a[72:75]
    v_exp_f32 v43, v43
    v_mfma_f32_16x16x32_bf16 a[76:79], a[240:243], v[76:79], a[76:79]
    buffer_load_dwordx4 v200, s[12:15], s46 offen nt lds
    v_mfma_f32_16x16x32_bf16 v[16:19], a[212:215], v[136:139], v[16:19]
    v_exp_f32 v56, v56
    v_mfma_f32_16x16x32_bf16 v[20:23], a[212:215], v[152:155], v[20:23]
    ds_read_b128 a[196:199], v196 offset:25856
    v_cvt_pk_bf16_f32 v89, v42, v43
    v_mfma_f32_16x16x32_bf16 v[24:27], a[212:215], v[168:171], v[24:27]
    v_exp_f32 v57, v57
    v_mfma_f32_16x16x32_bf16 v[28:31], a[212:215], v[184:187], v[28:31]
    ds_read_b64_tr_b16 a[228:229], v197 offset:8480
    v_cvt_pk_bf16_f32 v90, v56, v57
    v_mfma_f32_16x16x32_bf16 a[80:83], a[244:247], v[64:67], a[80:83]
    v_exp_f32 v58, v58
    v_mfma_f32_16x16x32_bf16 a[84:87], a[244:247], v[68:71], a[84:87]
    ds_read_b64_tr_b16 a[230:231], v197 offset:8992
    v_mfma_f32_16x16x32_bf16 a[88:91], a[244:247], v[72:75], a[88:91]
    v_exp_f32 v59, v59
    v_mfma_f32_16x16x32_bf16 a[92:95], a[244:247], v[76:79], a[92:95]
    v_mfma_f32_16x16x32_bf16 v[120:123], v[192:195], v[72:75], v[120:123]
    s_waitcnt lgkmcnt(6)
    v_mfma_f32_16x16x32_bf16 v[0:3], a[216:219], v[140:143], v[0:3]
    v_exp_f32 v44, v44
    v_mfma_f32_16x16x32_bf16 v[4:7], a[216:219], v[156:159], v[4:7]
    ds_read_b128 a[200:203], v196 offset:25408
    v_cvt_pk_bf16_f32 v91, v58, v59
    v_mfma_f32_16x16x32_bf16 v[8:11], a[216:219], v[172:175], v[8:11]
    v_exp_f32 v45, v45
    v_mfma_f32_16x16x32_bf16 v[12:15], a[216:219], v[188:191], v[12:15]
    ds_read_b64_tr_b16 a[232:233], v197 offset:8512
    v_cvt_pk_bf16_f32 v92, v44, v45
    v_mfma_f32_16x16x32_bf16 a[96:99], a[248:251], v[64:67], a[96:99]
    v_exp_f32 v46, v46
    v_mfma_f32_16x16x32_bf16 a[100:103], a[248:251], v[68:71], a[100:103]
    ds_read_b64_tr_b16 a[234:235], v197 offset:9024
    v_mfma_f32_16x16x32_bf16 a[104:107], a[248:251], v[72:75], a[104:107]
    v_exp_f32 v47, v47
    v_mfma_f32_16x16x32_bf16 a[108:111], a[248:251], v[76:79], a[108:111]
    buffer_load_dwordx4 v201, s[12:15], s46 offen offset:1056 nt lds
    v_mfma_f32_16x16x32_bf16 v[16:19], a[220:223], v[140:143], v[16:19]
    v_exp_f32 v60, v60
    v_mfma_f32_16x16x32_bf16 v[20:23], a[220:223], v[156:159], v[20:23]
    ds_read_b128 a[204:207], v196 offset:25920
    v_cvt_pk_bf16_f32 v93, v46, v47
    v_mfma_f32_16x16x32_bf16 v[24:27], a[220:223], v[172:175], v[24:27]
    v_exp_f32 v61, v61
    v_mfma_f32_16x16x32_bf16 v[28:31], a[220:223], v[188:191], v[28:31]
    ds_read_b64_tr_b16 a[236:237], v197 offset:8544
    v_cvt_pk_bf16_f32 v94, v60, v61
    v_mfma_f32_16x16x32_bf16 a[112:115], a[252:255], v[64:67], a[112:115]
    v_exp_f32 v62, v62
    v_mfma_f32_16x16x32_bf16 a[116:119], a[252:255], v[68:71], a[116:119]
    ds_read_b64_tr_b16 a[238:239], v197 offset:9056
    v_mfma_f32_16x16x32_bf16 a[120:123], a[252:255], v[72:75], a[120:123]
    v_exp_f32 v63, v63
    v_mfma_f32_16x16x32_bf16 a[124:127], a[252:255], v[76:79], a[124:127]
    v_mfma_f32_16x16x32_bf16 v[124:127], v[192:195], v[76:79], v[124:127]
    s_waitcnt vmcnt(4)
    s_waitcnt lgkmcnt(6)
    s_branch K1_BLOOP
K1_SPINE:
    s_mov_b32 s51, 20000
K1_SPINEL:
    global_load_dwordx2 v[210:211], v209, s[94:95] sc1
    s_waitcnt vmcnt(0)
    v_sub_u32 v222, v210, v254
    v_sub_u32 v223, v211, v255
    v_max_u32 v222, v222, v223
    v_cmp_lt_u32 vcc, 1, v222
    s_cmp_eq_u64 vcc, 0
    s_cbranch_scc1 K1_GATEER
    s_sub_u32 s51, s51, 1
    s_cmp_lg_u32 s51, 0
    s_cbranch_scc1 K1_SPINEL
    s_branch K1_GATEER
K1_SPINO:
    s_mov_b32 s51, 20000
K1_SPINOL:
    global_load_dwordx2 v[210:211], v209, s[94:95] sc1
    s_waitcnt vmcnt(0)
    v_sub_u32 v222, v210, v254
    v_sub_u32 v223, v211, v255
    v_xor_b32 v222, 1, v222
    v_xor_b32 v223, 1, v223
    v_or_b32 v222, v222, v223
    v_cmp_ne_u32 vcc, 0, v222
    s_and_b64 vcc, vcc, s[32:33]
    s_cmp_eq_u64 vcc, 0
    s_cbranch_scc1 K1_GATEOR
    s_sub_u32 s51, s51, 1
    s_cmp_lg_u32 s51, 0
    s_cbranch_scc1 K1_SPINOL
    s_branch K1_GATEOR
K1_FB:
    v_mov_b32 v248, 0xff800000
    v_mov_b32 v249, 0xff800000
    v_mov_b32 v250, 0xff800000
    v_mov_b32 v251, 0xff800000
    s_waitcnt vmcnt(0) lgkmcnt(0)
    s_barrier
    s_mov_b32 s45, 32
    s_mov_b32 s46, s29
K1_FBL:
    s_mov_b32 m0, s41
    s_nop 0
    buffer_load_dwordx4 v198, s[12:15], s46 offen lds
    s_add_u32 m0, s41, 1056
    s_nop 0
    buffer_load_dwordx4 v199, s[12:15], s46 offen lds
    s_waitcnt vmcnt(0)
    s_barrier
    ds_read_b128 a[192:195], v196 offset:0
    ds_read_b128 a[196:199], v196 offset:512
    ds_read_b128 a[200:203], v196 offset:64
    ds_read_b128 a[204:207], v196 offset:576
    ds_read_b128 a[208:211], v196 offset:128
    ds_read_b128 a[212:215], v196 offset:640
    ds_read_b128 a[216:219], v196 offset:192
    ds_read_b128 a[220:223], v196 offset:704
    s_waitcnt lgkmcnt(7)
    v_mfma_f32_16x16x32_bf16 v[0:3], a[192:195], v[128:131], 0
    v_mfma_f32_16x16x32_bf16 v[4:7], a[192:195], v[144:147], 0
    v_mfma_f32_16x16x32_bf16 v[8:11], a[192:195], v[160:163], 0
    v_mfma_f32_16x16x32_bf16 v[12:15], a[192:195], v[176:179], 0
    s_waitcnt lgkmcnt(6)
    v_mfma_f32_16x16x32_bf16 v[16:19], a[196:199], v[128:131], 0
    v_mfma_f32_16x16x32_bf16 v[20:23], a[196:199], v[144:147], 0
    v_mfma_f32_16x16x32_bf16 v[24:27], a[196:199], v[160:163], 0
    v_mfma_f32_16x16x32_bf16 v[28:31], a[196:199], v[176:179], 0
    s_waitcnt lgkmcnt(5)
    v_mfma_f32_16x16x32_bf16 v[0:3], a[200:203], v[132:135], v[0:3]
    v_mfma_f32_16x16x32_bf16 v[4:7], a[200:203], v[148:151], v[4:7]
    v_mfma_f32_16x16x32_bf16 v[8:11], a[200:203], v[164:167], v[8:11]
    v_mfma_f32_16x16x32_bf16 v[12:15], a[200:203], v[180:183], v[12:15]
    s_waitcnt lgkmcnt(4)
    v_mfma_f32_16x16x32_bf16 v[16:19], a[204:207], v[132:135], v[16:19]
    v_mfma_f32_16x16x32_bf16 v[20:23], a[204:207], v[148:151], v[20:23]
    v_mfma_f32_16x16x32_bf16 v[24:27], a[204:207], v[164:167], v[24:27]
    v_mfma_f32_16x16x32_bf16 v[28:31], a[204:207], v[180:183], v[28:31]
    s_waitcnt lgkmcnt(3)
    v_mfma_f32_16x16x32_bf16 v[0:3], a[208:211], v[136:139], v[0:3]
    v_mfma_f32_16x16x32_bf16 v[4:7], a[208:211], v[152:155], v[4:7]
    v_mfma_f32_16x16x32_bf16 v[8:11], a[208:211], v[168:171], v[8:11]
    v_mfma_f32_16x16x32_bf16 v[12:15], a[208:211], v[184:187], v[12:15]
    s_waitcnt lgkmcnt(2)
    v_mfma_f32_16x16x32_bf16 v[16:19], a[212:215], v[136:139], v[16:19]
    v_mfma_f32_16x16x32_bf16 v[20:23], a[212:215], v[152:155], v[20:23]
    v_mfma_f32_16x16x32_bf16 v[24:27], a[212:215], v[168:171], v[24:27]
    v_mfma_f32_16x16x32_bf16 v[28:31], a[212:215], v[184:187], v[28:31]
    s_waitcnt lgkmcnt(1)
    v_mfma_f32_16x16x32_bf16 v[0:3], a[216:219], v[140:143], v[0:3]
    v_mfma_f32_16x16x32_bf16 v[4:7], a[216:219], v[156:159], v[4:7]
    v_mfma_f32_16x16x32_bf16 v[8:11], a[216:219], v[172:175], v[8:11]
    v_mfma_f32_16x16x32_bf16 v[12:15], a[216:219], v[188:191], v[12:15]
    s_waitcnt lgkmcnt(0)
    v_mfma_f32_16x16x32_bf16 v[16:19], a[220:223], v[140:143], v[16:19]
    v_mfma_f32_16x16x32_bf16 v[20:23], a[220:223], v[156:159], v[20:23]
    v_mfma_f32_16x16x32_bf16 v[24:27], a[220:223], v[172:175], v[24:27]
    v_mfma_f32_16x16x32_bf16 v[28:31], a[220:223], v[188:191], v[28:31]
    s_nop 4
    s_barrier
    s_nop 4
    v_max3_f32 v248, v0, v1, v248
    v_max3_f32 v248, v248, v2, v3
    v_max3_f32 v248, v248, v16, v17
    v_max3_f32 v248, v248, v18, v19
    v_max3_f32 v249, v4, v5, v249
    v_max3_f32 v249, v249, v6, v7
    v_max3_f32 v249, v249, v20, v21
    v_max3_f32 v249, v249, v22, v23
    v_max3_f32 v250, v8, v9, v250
    v_max3_f32 v250, v250, v10, v11
    v_max3_f32 v250, v250, v24, v25
    v_max3_f32 v250, v250, v26, v27
    v_max3_f32 v251, v12, v13, v251
    v_max3_f32 v251, v251, v14, v15
    v_max3_f32 v251, v251, v28, v29
    v_max3_f32 v251, v251, v30, v31
    s_add_u32 s46, s46, 8192
    s_sub_u32 s45, s45, 1
    s_cmp_lg_u32 s45, 0
    s_cbranch_scc1 K1_FBL
    s_add_u32 m0, s41, 0
    s_add_u32 s59, s29, 0
    buffer_load_dwordx4 v198, s[12:15], s59 offen nt lds
    s_add_u32 m0, s41, 1056
    s_nop 0
    buffer_load_dwordx4 v199, s[12:15], s59 offen nt lds
    s_add_u32 m0, s41, 8448
    s_add_u32 s59, s29, 8192
    buffer_load_dwordx4 v198, s[12:15], s59 offen nt lds
    s_add_u32 m0, s41, 9504
    s_nop 0
    buffer_load_dwordx4 v199, s[12:15], s59 offen nt lds
    s_add_u32 m0, s41, 16896
    s_add_u32 s59, s29, 16384
    buffer_load_dwordx4 v198, s[12:15], s59 offen nt lds
    s_add_u32 m0, s41, 17952
    s_nop 0
    buffer_load_dwordx4 v199, s[12:15], s59 offen nt lds
    s_add_u32 m0, s41, 25344
    s_add_u32 s59, s29, 24576
    buffer_load_dwordx4 v198, s[12:15], s59 offen nt lds
    s_add_u32 m0, s41, 26400
    s_nop 0
    buffer_load_dwordx4 v199, s[12:15], s59 offen nt lds
    s_add_u32 m0, s41, 33792
    s_add_u32 s59, s29, 32768
    buffer_load_dwordx4 v198, s[12:15], s59 offen nt lds
    s_add_u32 m0, s41, 34848
    s_nop 0
    buffer_load_dwordx4 v199, s[12:15], s59 offen nt lds
    s_add_u32 m0, s42, 0
    s_add_u32 s59, s29, 0
    buffer_load_dwordx4 v198, s[16:19], s59 offen nt lds
    s_add_u32 m0, s42, 1056
    s_nop 0
    buffer_load_dwordx4 v199, s[16:19], s59 offen nt lds
    s_add_u32 m0, s41, 42240
    s_add_u32 s59, s29, 40960
    buffer_load_dwordx4 v198, s[12:15], s59 offen nt lds
    s_add_u32 m0, s41, 43296
    s_nop 0
    buffer_load_dwordx4 v199, s[12:15], s59 offen nt lds
    s_add_u32 m0, s42, 8448
    s_add_u32 s59, s29, 8192
    buffer_load_dwordx4 v198, s[16:19], s59 offen nt lds
    s_add_u32 m0, s42, 9504
    s_nop 0
    buffer_load_dwordx4 v199, s[16:19], s59 offen nt lds
    s_add_u32 m0, s41, 50688
    s_add_u32 s59, s29, 49152
    buffer_load_dwordx4 v198, s[12:15], s59 offen nt lds
    s_add_u32 m0, s41, 51744
    s_nop 0
    buffer_load_dwordx4 v199, s[12:15], s59 offen nt lds
    s_add_u32 m0, s42, 16896
    s_add_u32 s59, s29, 16384
    buffer_load_dwordx4 v198, s[16:19], s59 offen nt lds
    s_add_u32 m0, s42, 17952
    s_nop 0
    buffer_load_dwordx4 v199, s[16:19], s59 offen nt lds
    s_add_u32 m0, s41, 59136
    s_add_u32 s59, s29, 57344
    buffer_load_dwordx4 v198, s[12:15], s59 offen nt lds
    s_add_u32 m0, s41, 60192
    s_nop 0
    buffer_load_dwordx4 v199, s[12:15], s59 offen nt lds
    s_add_u32 m0, s42, 25344
    s_add_u32 s59, s29, 24576
    buffer_load_dwordx4 v198, s[16:19], s59 offen nt lds
    s_add_u32 m0, s42, 26400
    s_nop 0
    buffer_load_dwordx4 v199, s[16:19], s59 offen nt lds
    s_add_u32 m0, s42, 33792
    s_add_u32 s59, s29, 32768
    buffer_load_dwordx4 v198, s[16:19], s59 offen nt lds
    s_add_u32 m0, s42, 34848
    s_nop 0
    buffer_load_dwordx4 v199, s[16:19], s59 offen nt lds
    s_add_u32 m0, s42, 42240
    s_add_u32 s59, s29, 40960
    buffer_load_dwordx4 v198, s[16:19], s59 offen nt lds
    s_add_u32 m0, s42, 43296
    s_nop 0
    buffer_load_dwordx4 v199, s[16:19], s59 offen nt lds
    s_mul_i32 s46, s47, 294912
    s_add_u32 s46, s46, 8192
    s_mov_b32 s28, 1
    s_waitcnt vmcnt(0)
    s_barrier
K1_HEAD:
    ds_read_b128 a[192:195], v196 offset:0
    ds_read_b128 a[196:199], v196 offset:512
    ds_read_b128 a[200:203], v196 offset:64
    ds_read_b128 a[204:207], v196 offset:576
    ds_read_b128 a[208:211], v196 offset:128
    ds_read_b128 a[212:215], v196 offset:640
    ds_read_b128 a[216:219], v196 offset:192
    ds_read_b128 a[220:223], v196 offset:704
    s_waitcnt lgkmcnt(7)
    v_mfma_f32_16x16x32_bf16 v[0:3], a[192:195], v[128:131], 0
    v_mfma_f32_16x16x32_bf16 v[4:7], a[192:195], v[144:147], 0
    v_mfma_f32_16x16x32_bf16 v[8:11], a[192:195], v[160:163], 0
    v_mfma_f32_16x16x32_bf16 v[12:15], a[192:195], v[176:179], 0
    s_waitcnt lgkmcnt(6)
    v_mfma_f32_16x16x32_bf16 v[16:19], a[196:199], v[128:131], 0
    v_mfma_f32_16x16x32_bf16 v[20:23], a[196:199], v[144:147], 0
    v_mfma_f32_16x16x32_bf16 v[24:27], a[196:199], v[160:163], 0
    v_mfma_f32_16x16x32_bf16 v[28:31], a[196:199], v[176:179], 0
    s_waitcnt lgkmcnt(5)
    v_mfma_f32_16x16x32_bf16 v[0:3], a[200:203], v[132:135], v[0:3]
    v_mfma_f32_16x16x32_bf16 v[4:7], a[200:203], v[148:151], v[4:7]
    v_mfma_f32_16x16x32_bf16 v[8:11], a[200:203], v[164:167], v[8:11]
    v_mfma_f32_16x16x32_bf16 v[12:15], a[200:203], v[180:183], v[12:15]
    s_waitcnt lgkmcnt(4)
    v_mfma_f32_16x16x32_bf16 v[16:19], a[204:207], v[132:135], v[16:19]
    v_mfma_f32_16x16x32_bf16 v[20:23], a[204:207], v[148:151], v[20:23]
    v_mfma_f32_16x16x32_bf16 v[24:27], a[204:207], v[164:167], v[24:27]
    v_mfma_f32_16x16x32_bf16 v[28:31], a[204:207], v[180:183], v[28:31]
    s_waitcnt lgkmcnt(3)
    v_mfma_f32_16x16x32_bf16 v[0:3], a[208:211], v[136:139], v[0:3]
    v_mfma_f32_16x16x32_bf16 v[4:7], a[208:211], v[152:155], v[4:7]
    ds_read_b128 a[192:195], v196 offset:8448
    v_mfma_f32_16x16x32_bf16 v[8:11], a[208:211], v[168:171], v[8:11]
    v_mfma_f32_16x16x32_bf16 v[12:15], a[208:211], v[184:187], v[12:15]
    s_waitcnt lgkmcnt(3)
    v_mfma_f32_16x16x32_bf16 v[16:19], a[212:215], v[136:139], v[16:19]
    v_mfma_f32_16x16x32_bf16 v[20:23], a[212:215], v[152:155], v[20:23]
    ds_read_b128 a[196:199], v196 offset:8960
    v_mfma_f32_16x16x32_bf16 v[24:27], a[212:215], v[168:171], v[24:27]
    v_mfma_f32_16x16x32_bf16 v[28:31], a[212:215], v[184:187], v[28:31]
    s_waitcnt lgkmcnt(3)
    v_mfma_f32_16x16x32_bf16 v[0:3], a[216:219], v[140:143], v[0:3]
    v_mfma_f32_16x16x32_bf16 v[4:7], a[216:219], v[156:159], v[4:7]
    ds_read_b128 a[200:203], v196 offset:8512
    v_mfma_f32_16x16x32_bf16 v[8:11], a[216:219], v[172:175], v[8:11]
    v_mfma_f32_16x16x32_bf16 v[12:15], a[216:219], v[188:191], v[12:15]
    s_waitcnt lgkmcnt(3)
    v_mfma_f32_16x16x32_bf16 v[16:19], a[220:223], v[140:143], v[16:19]
    v_mfma_f32_16x16x32_bf16 v[20:23], a[220:223], v[156:159], v[20:23]
    ds_read_b128 a[204:207], v196 offset:9024
    v_mfma_f32_16x16x32_bf16 v[24:27], a[220:223], v[172:175], v[24:27]
    v_mfma_f32_16x16x32_bf16 v[28:31], a[220:223], v[188:191], v[28:31]
    s_nop 4
    s_branch K1_HM
K1_TAIL:
    v_mfma_f32_16x16x32_bf16 v[32:35], a[192:195], v[128:131], v[96:99]
    v_exp_f32 v0, v0
    v_mfma_f32_16x16x32_bf16 v[36:39], a[192:195], v[144:147], v[100:103]
    ds_read_b128 a[208:211], v196 offset:8576
    v_cvt_pk_bf16_f32 v95, v62, v63
    v_mfma_f32_16x16x32_bf16 v[40:43], a[192:195], v[160:163], v[104:107]
    v_exp_f32 v1, v1
    v_mfma_f32_16x16x32_bf16 v[44:47], a[192:195], v[176:179], v[108:111]
    ds_read_b64_tr_b16 a[240:241], v197 offset:59264
    v_cvt_pk_bf16_f32 v64, v0, v1
    v_mfma_f32_16x16x32_bf16 a[0:3], a[224:227], v[80:83], a[0:3]
    v_exp_f32 v2, v2
    v_mfma_f32_16x16x32_bf16 a[4:7], a[224:227], v[84:87], a[4:7]
    ds_read_b64_tr_b16 a[242:243], v197 offset:59776
    v_mfma_f32_16x16x32_bf16 a[8:11], a[224:227], v[88:91], a[8:11]
    v_exp_f32 v3, v3
    v_mfma_f32_16x16x32_bf16 a[12:15], a[224:227], v[92:95], a[12:15]
    global_load_dwordx2 v[210:211], v209, s[94:95] sc1
    s_add_u32 m0, s42, 42240
    v_mfma_f32_16x16x32_bf16 v[48:51], a[196:199], v[128:131], v[96:99]
    v_exp_f32 v16, v16
    v_mfma_f32_16x16x32_bf16 v[52:55], a[196:199], v[144:147], v[100:103]
    ds_read_b128 a[212:215], v196 offset:9088
    v_cvt_pk_bf16_f32 v65, v2, v3
    v_mfma_f32_16x16x32_bf16 v[56:59], a[196:199], v[160:163], v[104:107]
    v_exp_f32 v17, v17
    v_mfma_f32_16x16x32_bf16 v[60:63], a[196:199], v[176:179], v[108:111]
    ds_read_b64_tr_b16 a[244:245], v197 offset:59296
    v_cvt_pk_bf16_f32 v66, v16, v17
    v_mfma_f32_16x16x32_bf16 a[16:19], a[228:231], v[80:83], a[16:19]
    v_exp_f32 v18, v18
    v_mfma_f32_16x16x32_bf16 a[20:23], a[228:231], v[84:87], a[20:23]
    ds_read_b64_tr_b16 a[246:247], v197 offset:59808
    v_mfma_f32_16x16x32_bf16 a[24:27], a[228:231], v[88:91], a[24:27]
    v_exp_f32 v19, v19
    v_mfma_f32_16x16x32_bf16 a[28:31], a[228:231], v[92:95], a[28:31]
    buffer_load_dwordx4 v202, s[16:19], s46 offen nt lds
    v_mfma_f32_16x16x32_bf16 v[112:115], v[192:195], v[80:83], v[112:115]
    buffer_load_dwordx4 v203, s[16:19], s46 offen offset:1056 nt lds
    s_add_u32 s46, s46, 8192
    s_waitcnt lgkmcnt(6)
    v_mfma_f32_16x16x32_bf16 v[32:35], a[200:203], v[132:135], v[32:35]
    v_exp_f32 v4, v4
    v_mfma_f32_16x16x32_bf16 v[36:39], a[200:203], v[148:151], v[36:39]
    ds_read_b128 a[216:219], v196 offset:8640
    v_cvt_pk_bf16_f32 v67, v18, v19
    v_mfma_f32_16x16x32_bf16 v[40:43], a[200:203], v[164:167], v[40:43]
    v_exp_f32 v5, v5
    v_mfma_f32_16x16x32_bf16 v[44:47], a[200:203], v[180:183], v[44:47]
    ds_read_b64_tr_b16 a[248:249], v197 offset:59328
    v_cvt_pk_bf16_f32 v68, v4, v5
    v_mfma_f32_16x16x32_bf16 a[32:35], a[232:235], v[80:83], a[32:35]
    v_exp_f32 v6, v6
    v_mfma_f32_16x16x32_bf16 a[36:39], a[232:235], v[84:87], a[36:39]
    ds_read_b64_tr_b16 a[250:251], v197 offset:59840
    v_mfma_f32_16x16x32_bf16 a[40:43], a[232:235], v[88:91], a[40:43]
    v_exp_f32 v7, v7
    v_mfma_f32_16x16x32_bf16 a[44:47], a[232:235], v[92:95], a[44:47]
    v_mfma_f32_16x16x32_bf16 v[48:51], a[204:207], v[132:135], v[48:51]
    v_exp_f32 v20, v20
    v_mfma_f32_16x16x32_bf16 v[52:55], a[204:207], v[148:151], v[52:55]
    ds_read_b128 a[220:223], v196 offset:9152
    v_cvt_pk_bf16_f32 v69, v6, v7
    v_mfma_f32_16x16x32_bf16 v[56:59], a[204:207], v[164:167], v[56:59]
    v_exp_f32 v21, v21
    v_mfma_f32_16x16x32_bf16 v[60:63], a[204:207], v[180:183], v[60:63]
    ds_read_b64_tr_b16 a[252:253], v197 offset:59360
    v_cvt_pk_bf16_f32 v70, v20, v21
    v_mfma_f32_16x16x32_bf16 a[48:51], a[236:239], v[80:83], a[48:51]
    v_exp_f32 v22, v22
    v_mfma_f32_16x16x32_bf16 a[52:55], a[236:239], v[84:87], a[52:55]
    ds_read_b64_tr_b16 a[254:255], v197 offset:59872
    v_mfma_f32_16x16x32_bf16 a[56:59], a[236:239], v[88:91], a[56:59]
    v_exp_f32 v23, v23
    v_mfma_f32_16x16x32_bf16 a[60:63], a[236:239], v[92:95], a[60:63]
    v_mfma_f32_16x16x32_bf16 v[116:119], v[192:195], v[84:87], v[116:119]
    s_waitcnt vmcnt(21) lgkmcnt(6)
    s_barrier
    v_mfma_f32_16x16x32_bf16 v[32:35], a[208:211], v[136:139], v[32:35]
    v_exp_f32 v8, v8
    v_mfma_f32_16x16x32_bf16 v[36:39], a[208:211], v[152:155], v[36:39]
    ds_read_b128 a[192:195], v196 offset:16896
    v_cvt_pk_bf16_f32 v71, v22, v23
    v_mfma_f32_16x16x32_bf16 v[40:43], a[208:211], v[168:171], v[40:43]
    v_exp_f32 v9, v9
    v_mfma_f32_16x16x32_bf16 v[44:47], a[208:211], v[184:187], v[44:47]
    ds_read_b64_tr_b16 a[224:225], v197 offset:0
    v_cvt_pk_bf16_f32 v72, v8, v9
    v_mfma_f32_16x16x32_bf16 a[64:67], a[240:243], v[80:83], a[64:67]
    v_exp_f32 v10, v10
    v_mfma_f32_16x16x32_bf16 a[68:71], a[240:243], v[84:87], a[68:71]
    ds_read_b64_tr_b16 a[226:227], v197 offset:512
    v_mov_b32 v224, -1
    v_mfma_f32_16x16x32_bf16 a[72:75], a[240:243], v[88:91], a[72:75]
    v_exp_f32 v11, v11
    v_mfma_f32_16x16x32_bf16 a[76:79], a[240:243], v[92:95], a[76:79]
    v_mov_b32 v225, -1
    v_mov_b32 v226, -1
    v_mov_b32 v227, -1
    v_mfma_f32_16x16x32_bf16 v[48:51], a[212:215], v[136:139], v[48:51]
    v_exp_f32 v24, v24
    v_mfma_f32_16x16x32_bf16 v[52:55], a[212:215], v[152:155], v[52:55]
    ds_read_b128 a[196:199], v196 offset:17408
    v_cvt_pk_bf16_f32 v73, v10, v11
    v_mfma_f32_16x16x32_bf16 v[56:59], a[212:215], v[168:171], v[56:59]
    v_exp_f32 v25, v25
    v_mfma_f32_16x16x32_bf16 v[60:63], a[212:215], v[184:187], v[60:63]
    ds_read_b64_tr_b16 a[228:229], v197 offset:32
    v_cvt_pk_bf16_f32 v74, v24, v25
    v_mfma_f32_16x16x32_bf16 a[80:83], a[244:247], v[80:83], a[80:83]
    v_exp_f32 v26, v26
    v_mfma_f32_16x16x32_bf16 a[84:87], a[244:247], v[84:87], a[84:87]
    ds_read_b64_tr_b16 a[230:231], v197 offset:544
    v_mfma_f32_16x16x32_bf16 a[88:91], a[244:247], v[88:91], a[88:91]
    v_exp_f32 v27, v27
    v_mfma_f32_16x16x32_bf16 a[92:95], a[244:247], v[92:95], a[92:95]
    v_mfma_f32_16x16x32_bf16 v[120:123], v[192:195], v[88:91], v[120:123]
    s_waitcnt lgkmcnt(6)
    v_mfma_f32_16x16x32_bf16 v[32:35], a[216:219], v[140:143], v[32:35]
    v_exp_f32 v12, v12
    v_mfma_f32_16x16x32_bf16 v[36:39], a[216:219], v[156:159], v[36:39]
    ds_read_b128 a[200:203], v196 offset:16960
    v_cvt_pk_bf16_f32 v75, v26, v27
    v_mfma_f32_16x16x32_bf16 v[40:43], a[216:219], v[172:175], v[40:43]
    v_exp_f32 v13, v13
    v_mfma_f32_16x16x32_bf16 v[44:47], a[216:219], v[188:191], v[44:47]
    ds_read_b64_tr_b16 a[232:233], v197 offset:64
    v_cvt_pk_bf16_f32 v76, v12, v13
    v_mfma_f32_16x16x32_bf16 a[96:99], a[248:251], v[80:83], a[96:99]
    v_exp_f32 v14, v14
    v_mfma_f32_16x16x32_bf16 a[100:103], a[248:251], v[84:87], a[100:103]
    ds_read_b64_tr_b16 a[234:235], v197 offset:576
    v_mfma_f32_16x16x32_bf16 a[104:107], a[248:251], v[88:91], a[104:107]
    v_exp_f32 v15, v15
    v_mfma_f32_16x16x32_bf16 a[108:111], a[248:251], v[92:95], a[108:111]
    v_mfma_f32_16x16x32_bf16 v[48:51], a[220:223], v[140:143], v[48:51]
    v_exp_f32 v28, v28
    v_mfma_f32_16x16x32_bf16 v[52:55], a[220:223], v[156:159], v[52:55]
    ds_read_b128 a[204:207], v196 offset:17472
    v_cvt_pk_bf16_f32 v77, v14, v15
    v_mfma_f32_16x16x32_bf16 v[56:59], a[220:223], v[172:175], v[56:59]
    v_exp_f32 v29, v29
    v_mfma_f32_16x16x32_bf16 v[60:63], a[220:223], v[188:191], v[60:63]
    ds_read_b64_tr_b16 a[236:237], v197 offset:96
    v_cvt_pk_bf16_f32 v78, v28, v29
    v_mfma_f32_16x16x32_bf16 a[112:115], a[252:255], v[80:83], a[112:115]
    v_exp_f32 v30, v30
    v_mfma_f32_16x16x32_bf16 a[116:119], a[252:255], v[84:87], a[116:119]
    ds_read_b64_tr_b16 a[238:239], v197 offset:608
    v_mfma_f32_16x16x32_bf16 a[120:123], a[252:255], v[88:91], a[120:123]
    v_exp_f32 v31, v31
    v_mfma_f32_16x16x32_bf16 a[124:127], a[252:255], v[92:95], a[124:127]
    v_mfma_f32_16x16x32_bf16 v[124:127], v[192:195], v[92:95], v[124:127]
    s_waitcnt lgkmcnt(6)
    v_mfma_f32_16x16x32_bf16 v[0:3], a[192:195], v[128:131], v[96:99]
    v_exp_f32 v32, v32
    v_mfma_f32_16x16x32_bf16 v[4:7], a[192:195], v[144:147], v[100:103]
    ds_read_b128 a[208:211], v196 offset:17024
    v_cvt_pk_bf16_f32 v79, v30, v31
    v_mfma_f32_16x16x32_bf16 v[8:11], a[192:195], v[160:163], v[104:107]
    v_exp_f32 v33, v33
    v_mfma_f32_16x16x32_bf16 v[12:15], a[192:195], v[176:179], v[108:111]
    ds_read_b64_tr_b16 a[240:241], v197 offset:128
    v_cvt_pk_bf16_f32 v80, v32, v33
    v_mfma_f32_16x16x32_bf16 a[0:3], a[224:227], v[64:67], a[0:3]
    v_exp_f32 v34, v34
    v_mfma_f32_16x16x32_bf16 a[4:7], a[224:227], v[68:71], a[4:7]
    ds_read_b64_tr_b16 a[242:243], v197 offset:640
    s_add_u32 m0, s42, 50688
    v_mfma_f32_16x16x32_bf16 a[8:11], a[224:227], v[72:75], a[8:11]
    v_exp_f32 v35, v35
    v_mfma_f32_16x16x32_bf16 a[12:15], a[224:227], v[76:79], a[12:15]
    buffer_load_dwordx4 v202, s[16:19], s46 offen nt lds
    v_mfma_f32_16x16x32_bf16 v[16:19], a[196:199], v[128:131], v[96:99]
    v_exp_f32 v48, v48
    v_mfma_f32_16x16x32_bf16 v[20:23], a[196:199], v[144:147], v[100:103]
    ds_read_b128 a[212:215], v196 offset:17536
    v_cvt_pk_bf16_f32 v81, v34, v35
    v_mfma_f32_16x16x32_bf16 v[24:27], a[196:199], v[160:163], v[104:107]
    v_exp_f32 v49, v49
    v_mfma_f32_16x16x32_bf16 v[28:31], a[196:199], v[176:179], v[108:111]
    ds_read_b64_tr_b16 a[244:245], v197 offset:160
    v_cvt_pk_bf16_f32 v82, v48, v49
    v_mfma_f32_16x16x32_bf16 a[16:19], a[228:231], v[64:67], a[16:19]
    v_exp_f32 v50, v50
    v_mfma_f32_16x16x32_bf16 a[20:23], a[228:231], v[68:71], a[20:23]
    ds_read_b64_tr_b16 a[246:247], v197 offset:672
    v_mfma_f32_16x16x32_bf16 a[24:27], a[228:231], v[72:75], a[24:27]
    v_exp_f32 v51, v51
    v_mfma_f32_16x16x32_bf16 a[28:31], a[228:231], v[76:79], a[28:31]
    buffer_load_dwordx4 v203, s[16:19], s46 offen offset:1056 nt lds
    s_add_u32 s46, s46, 8192
    v_mfma_f32_16x16x32_bf16 v[112:115], v[192:195], v[64:67], v[112:115]
    s_waitcnt lgkmcnt(6)
    v_mfma_f32_16x16x32_bf16 v[0:3], a[200:203], v[132:135], v[0:3]
    v_exp_f32 v36, v36
    v_mfma_f32_16x16x32_bf16 v[4:7], a[200:203], v[148:151], v[4:7]
    ds_read_b128 a[216:219], v196 offset:17088
    v_cvt_pk_bf16_f32 v83, v50, v51
    v_mfma_f32_16x16x32_bf16 v[8:11], a[200:203], v[164:167], v[8:11]
    v_exp_f32 v37, v37
    v_mfma_f32_16x16x32_bf16 v[12:15], a[200:203], v[180:183], v[12:15]
    ds_read_b64_tr_b16 a[248:249], v197 offset:192
    v_cvt_pk_bf16_f32 v84, v36, v37
    v_mfma_f32_16x16x32_bf16 a[32:35], a[232:235], v[64:67], a[32:35]
    v_exp_f32 v38, v38
    v_mfma_f32_16x16x32_bf16 a[36:39], a[232:235], v[68:71], a[36:39]
    ds_read_b64_tr_b16 a[250:251], v197 offset:704
    v_mfma_f32_16x16x32_bf16 a[40:43], a[232:235], v[72:75], a[40:43]
    v_exp_f32 v39, v39
    v_mfma_f32_16x16x32_bf16 a[44:47], a[232:235], v[76:79], a[44:47]
    v_mfma_f32_16x16x32_bf16 v[16:19], a[204:207], v[132:135], v[16:19]
    v_exp_f32 v52, v52
    v_mfma_f32_16x16x32_bf16 v[20:23], a[204:207], v[148:151], v[20:23]
    ds_read_b128 a[220:223], v196 offset:17600
    v_cvt_pk_bf16_f32 v85, v38, v39
    v_mfma_f32_16x16x32_bf16 v[24:27], a[204:207], v[164:167], v[24:27]
    v_exp_f32 v53, v53
    v_mfma_f32_16x16x32_bf16 v[28:31], a[204:207], v[180:183], v[28:31]
    ds_read_b64_tr_b16 a[252:253], v197 offset:224
    v_cvt_pk_bf16_f32 v86, v52, v53
    v_mfma_f32_16x16x32_bf16 a[48:51], a[236:239], v[64:67], a[48:51]
    v_exp_f32 v54, v54
    v_mfma_f32_16x16x32_bf16 a[52:55], a[236:239], v[68:71], a[52:55]
    ds_read_b64_tr_b16 a[254:255], v197 offset:736
    v_mfma_f32_16x16x32_bf16 a[56:59], a[236:239], v[72:75], a[56:59]
    v_exp_f32 v55, v55
    v_mfma_f32_16x16x32_bf16 a[60:63], a[236:239], v[76:79], a[60:63]
    v_mfma_f32_16x16x32_bf16 v[116:119], v[192:195], v[68:71], v[116:119]
    s_waitcnt vmcnt(19) lgkmcnt(6)
    s_barrier
    v_mfma_f32_16x16x32_bf16 v[0:3], a[208:211], v[136:139], v[0:3]
    v_exp_f32 v40, v40
    v_mfma_f32_16x16x32_bf16 v[4:7], a[208:211], v[152:155], v[4:7]
    ds_read_b128 a[192:195], v196 offset:25344
    v_cvt_pk_bf16_f32 v87, v54, v55
    v_mfma_f32_16x16x32_bf16 v[8:11], a[208:211], v[168:171], v[8:11]
    v_exp_f32 v41, v41
    v_mfma_f32_16x16x32_bf16 v[12:15], a[208:211], v[184:187], v[12:15]
    ds_read_b64_tr_b16 a[224:225], v197 offset:8448
    v_cvt_pk_bf16_f32 v88, v40, v41
    v_mfma_f32_16x16x32_bf16 a[64:67], a[240:243], v[64:67], a[64:67]
    v_exp_f32 v42, v42
    v_mfma_f32_16x16x32_bf16 a[68:71], a[240:243], v[68:71], a[68:71]
    ds_read_b64_tr_b16 a[226:227], v197 offset:8960
    v_mfma_f32_16x16x32_bf16 a[72:75], a[240:243], v[72:75], a[72:75]
    v_exp_f32 v43, v43
    v_mfma_f32_16x16x32_bf16 a[76:79], a[240:243], v[76:79], a[76:79]
    v_mfma_f32_16x16x32_bf16 v[16:19], a[212:215], v[136:139], v[16:19]
    v_exp_f32 v56, v56
    v_mfma_f32_16x16x32_bf16 v[20:23], a[212:215], v[152:155], v[20:23]
    ds_read_b128 a[196:199], v196 offset:25856
    v_cvt_pk_bf16_f32 v89, v42, v43
    v_mfma_f32_16x16x32_bf16 v[24:27], a[212:215], v[168:171], v[24:27]
    v_exp_f32 v57, v57
    v_mfma_f32_16x16x32_bf16 v[28:31], a[212:215], v[184:187], v[28:31]
    ds_read_b64_tr_b16 a[228:229], v197 offset:8480
    v_cvt_pk_bf16_f32 v90, v56, v57
    v_mfma_f32_16x16x32_bf16 a[80:83], a[244:247], v[64:67], a[80:83]
    v_exp_f32 v58, v58
    v_mfma_f32_16x16x32_bf16 a[84:87], a[244:247], v[68:71], a[84:87]
    ds_read_b64_tr_b16 a[230:231], v197 offset:8992
    v_mfma_f32_16x16x32_bf16 a[88:91], a[244:247], v[72:75], a[88:91]
    v_exp_f32 v59, v59
    v_mfma_f32_16x16x32_bf16 a[92:95], a[244:247], v[76:79], a[92:95]
    v_mfma_f32_16x16x32_bf16 v[120:123], v[192:195], v[72:75], v[120:123]
    s_waitcnt lgkmcnt(6)
    v_mfma_f32_16x16x32_bf16 v[0:3], a[216:219], v[140:143], v[0:3]
    v_exp_f32 v44, v44
    v_mfma_f32_16x16x32_bf16 v[4:7], a[216:219], v[156:159], v[4:7]
    ds_read_b128 a[200:203], v196 offset:25408
    v_cvt_pk_bf16_f32 v91, v58, v59
    v_mfma_f32_16x16x32_bf16 v[8:11], a[216:219], v[172:175], v[8:11]
    v_exp_f32 v45, v45
    v_mfma_f32_16x16x32_bf16 v[12:15], a[216:219], v[188:191], v[12:15]
    ds_read_b64_tr_b16 a[232:233], v197 offset:8512
    v_cvt_pk_bf16_f32 v92, v44, v45
    v_mfma_f32_16x16x32_bf16 a[96:99], a[248:251], v[64:67], a[96:99]
    v_exp_f32 v46, v46
    v_mfma_f32_16x16x32_bf16 a[100:103], a[248:251], v[68:71], a[100:103]
    ds_read_b64_tr_b16 a[234:235], v197 offset:9024
    v_mfma_f32_16x16x32_bf16 a[104:107], a[248:251], v[72:75], a[104:107]
    v_exp_f32 v47, v47
    v_mfma_f32_16x16x32_bf16 a[108:111], a[248:251], v[76:79], a[108:111]
    v_mfma_f32_16x16x32_bf16 v[16:19], a[220:223], v[140:143], v[16:19]
    v_exp_f32 v60, v60
    v_mfma_f32_16x16x32_bf16 v[20:23], a[220:223], v[156:159], v[20:23]
    ds_read_b128 a[204:207], v196 offset:25920
    v_cvt_pk_bf16_f32 v93, v46, v47
    v_mfma_f32_16x16x32_bf16 v[24:27], a[220:223], v[172:175], v[24:27]
    v_exp_f32 v61, v61
    v_mfma_f32_16x16x32_bf16 v[28:31], a[220:223], v[188:191], v[28:31]
    ds_read_b64_tr_b16 a[236:237], v197 offset:8544
    v_cvt_pk_bf16_f32 v94, v60, v61
    v_mfma_f32_16x16x32_bf16 a[112:115], a[252:255], v[64:67], a[112:115]
    v_exp_f32 v62, v62
    v_mfma_f32_16x16x32_bf16 a[116:119], a[252:255], v[68:71], a[116:119]
    ds_read_b64_tr_b16 a[238:239], v197 offset:9056
    v_mfma_f32_16x16x32_bf16 a[120:123], a[252:255], v[72:75], a[120:123]
    v_exp_f32 v63, v63
    v_mfma_f32_16x16x32_bf16 a[124:127], a[252:255], v[76:79], a[124:127]
    v_mfma_f32_16x16x32_bf16 v[124:127], v[192:195], v[76:79], v[124:127]
    s_waitcnt lgkmcnt(6)
    v_mfma_f32_16x16x32_bf16 v[32:35], a[192:195], v[128:131], v[96:99]
    v_exp_f32 v0, v0
    v_mfma_f32_16x16x32_bf16 v[36:39], a[192:195], v[144:147], v[100:103]
    ds_read_b128 a[208:211], v196 offset:25472
    v_cvt_pk_bf16_f32 v95, v62, v63
    v_mfma_f32_16x16x32_bf16 v[40:43], a[192:195], v[160:163], v[104:107]
    v_exp_f32 v1, v1
    v_mfma_f32_16x16x32_bf16 v[44:47], a[192:195], v[176:179], v[108:111]
    ds_read_b64_tr_b16 a[240:241], v197 offset:8576
    v_cvt_pk_bf16_f32 v64, v0, v1
    v_mfma_f32_16x16x32_bf16 a[0:3], a[224:227], v[80:83], a[0:3]
    v_exp_f32 v2, v2
    v_mfma_f32_16x16x32_bf16 a[4:7], a[224:227], v[84:87], a[4:7]
    ds_read_b64_tr_b16 a[242:243], v197 offset:9088
    s_add_u32 m0, s42, 59136
    v_mfma_f32_16x16x32_bf16 a[8:11], a[224:227], v[88:91], a[8:11]
    v_exp_f32 v3, v3
    v_mfma_f32_16x16x32_bf16 a[12:15], a[224:227], v[92:95], a[12:15]
    buffer_load_dwordx4 v202, s[16:19], s46 offen nt lds
    v_mfma_f32_16x16x32_bf16 v[48:51], a[196:199], v[128:131], v[96:99]
    v_exp_f32 v16, v16
    v_mfma_f32_16x16x32_bf16 v[52:55], a[196:199], v[144:147], v[100:103]
    ds_read_b128 a[212:215], v196 offset:25984
    v_cvt_pk_bf16_f32 v65, v2, v3
    v_mfma_f32_16x16x32_bf16 v[56:59], a[196:199], v[160:163], v[104:107]
    v_exp_f32 v17, v17
    v_mfma_f32_16x16x32_bf16 v[60:63], a[196:199], v[176:179], v[108:111]
    ds_read_b64_tr_b16 a[244:245], v197 offset:8608
    v_cvt_pk_bf16_f32 v66, v16, v17
    v_mfma_f32_16x16x32_bf16 a[16:19], a[228:231], v[80:83], a[16:19]
    v_exp_f32 v18, v18
    v_mfma_f32_16x16x32_bf16 a[20:23], a[228:231], v[84:87], a[20:23]
    ds_read_b64_tr_b16 a[246:247], v197 offset:9120
    v_mfma_f32_16x16x32_bf16 a[24:27], a[228:231], v[88:91], a[24:27]
    v_exp_f32 v19, v19
    v_mfma_f32_16x16x32_bf16 a[28:31], a[228:231], v[92:95], a[28:31]
    buffer_load_dwordx4 v203, s[16:19], s46 offen offset:1056 nt lds
    s_add_u32 s46, s46, 8192
    v_mfma_f32_16x16x32_bf16 v[112:115], v[192:195], v[80:83], v[112:115]
    s_waitcnt lgkmcnt(6)
    v_mfma_f32_16x16x32_bf16 v[32:35], a[200:203], v[132:135], v[32:35]
    v_exp_f32 v4, v4
    v_mfma_f32_16x16x32_bf16 v[36:39], a[200:203], v[148:151], v[36:39]
    ds_read_b128 a[216:219], v196 offset:25536
    v_cvt_pk_bf16_f32 v67, v18, v19
    v_mfma_f32_16x16x32_bf16 v[40:43], a[200:203], v[164:167], v[40:43]
    v_exp_f32 v5, v5
    v_mfma_f32_16x16x32_bf16 v[44:47], a[200:203], v[180:183], v[44:47]
    ds_read_b64_tr_b16 a[248:249], v197 offset:8640
    v_cvt_pk_bf16_f32 v68, v4, v5
    v_mfma_f32_16x16x32_bf16 a[32:35], a[232:235], v[80:83], a[32:35]
    v_exp_f32 v6, v6
    v_mfma_f32_16x16x32_bf16 a[36:39], a[232:235], v[84:87], a[36:39]
    ds_read_b64_tr_b16 a[250:251], v197 offset:9152
    v_mfma_f32_16x16x32_bf16 a[40:43], a[232:235], v[88:91], a[40:43]
    v_exp_f32 v7, v7
    v_mfma_f32_16x16x32_bf16 a[44:47], a[232:235], v[92:95], a[44:47]
    v_mfma_f32_16x16x32_bf16 v[48:51], a[204:207], v[132:135], v[48:51]
    v_exp_f32 v20, v20
    v_mfma_f32_16x16x32_bf16 v[52:55], a[204:207], v[148:151], v[52:55]
    ds_read_b128 a[220:223], v196 offset:26048
    v_cvt_pk_bf16_f32 v69, v6, v7
    v_mfma_f32_16x16x32_bf16 v[56:59], a[204:207], v[164:167], v[56:59]
    v_exp_f32 v21, v21
    v_mfma_f32_16x16x32_bf16 v[60:63], a[204:207], v[180:183], v[60:63]
    ds_read_b64_tr_b16 a[252:253], v197 offset:8672
    v_cvt_pk_bf16_f32 v70, v20, v21
    v_mfma_f32_16x16x32_bf16 a[48:51], a[236:239], v[80:83], a[48:51]
    v_exp_f32 v22, v22
    v_mfma_f32_16x16x32_bf16 a[52:55], a[236:239], v[84:87], a[52:55]
    ds_read_b64_tr_b16 a[254:255], v197 offset:9184
    v_mfma_f32_16x16x32_bf16 a[56:59], a[236:239], v[88:91], a[56:59]
    v_exp_f32 v23, v23
    v_mfma_f32_16x16x32_bf16 a[60:63], a[236:239], v[92:95], a[60:63]
    v_mfma_f32_16x16x32_bf16 v[116:119], v[192:195], v[84:87], v[116:119]
    s_waitcnt vmcnt(6) lgkmcnt(6)
    s_barrier
    v_mfma_f32_16x16x32_bf16 v[32:35], a[208:211], v[136:139], v[32:35]
    v_exp_f32 v8, v8
    v_mfma_f32_16x16x32_bf16 v[36:39], a[208:211], v[152:155], v[36:39]
    ds_read_b128 a[192:195], v196 offset:33792
    v_cvt_pk_bf16_f32 v71, v22, v23
    v_mfma_f32_16x16x32_bf16 v[40:43], a[208:211], v[168:171], v[40:43]
    v_exp_f32 v9, v9
    v_mfma_f32_16x16x32_bf16 v[44:47], a[208:211], v[184:187], v[44:47]
    ds_read_b64_tr_b16 a[224:225], v197 offset:16896
    v_cvt_pk_bf16_f32 v72, v8, v9
    v_mfma_f32_16x16x32_bf16 a[64:67], a[240:243], v[80:83], a[64:67]
    v_exp_f32 v10, v10
    v_mfma_f32_16x16x32_bf16 a[68:71], a[240:243], v[84:87], a[68:71]
    ds_read_b64_tr_b16 a[226:227], v197 offset:17408
    v_sub_u32 v222, v210, v254
    v_mfma_f32_16x16x32_bf16 a[72:75], a[240:243], v[88:91], a[72:75]
    v_exp_f32 v11, v11
    v_mfma_f32_16x16x32_bf16 a[76:79], a[240:243], v[92:95], a[76:79]
    v_sub_u32 v223, v211, v255
    v_max_u32 v222, v222, v223
    v_cmp_lt_u32 vcc, 1, v222
    v_mfma_f32_16x16x32_bf16 v[48:51], a[212:215], v[136:139], v[48:51]
    v_exp_f32 v24, v24
    v_mfma_f32_16x16x32_bf16 v[52:55], a[212:215], v[152:155], v[52:55]
    ds_read_b128 a[196:199], v196 offset:34304
    v_cvt_pk_bf16_f32 v73, v10, v11
    v_mfma_f32_16x16x32_bf16 v[56:59], a[212:215], v[168:171], v[56:59]
    v_exp_f32 v25, v25
    v_mfma_f32_16x16x32_bf16 v[60:63], a[212:215], v[184:187], v[60:63]
    ds_read_b64_tr_b16 a[228:229], v197 offset:16928
    v_cvt_pk_bf16_f32 v74, v24, v25
    v_mfma_f32_16x16x32_bf16 a[80:83], a[244:247], v[80:83], a[80:83]
    v_exp_f32 v26, v26
    v_mfma_f32_16x16x32_bf16 a[84:87], a[244:247], v[84:87], a[84:87]
    ds_read_b64_tr_b16 a[230:231], v197 offset:17440
    s_cmp_eq_u64 vcc, 0
    v_mfma_f32_16x16x32_bf16 a[88:91], a[244:247], v[88:91], a[88:91]
    v_exp_f32 v27, v27
    v_mfma_f32_16x16x32_bf16 a[92:95], a[244:247], v[92:95], a[92:95]
    s_cbranch_scc0 K1_SPINE
K1_GATEER:
    s_add_u32 m0, s50, 143360
    s_mov_b32 s35, 0
    v_mfma_f32_16x16x32_bf16 v[120:123], v[192:195], v[88:91], v[120:123]
    buffer_load_dwordx4 v229, s[8:11], s35 offen offset:0 sc1 lds
    s_waitcnt lgkmcnt(6)
    v_mfma_f32_16x16x32_bf16 v[32:35], a[216:219], v[140:143], v[32:35]
    v_exp_f32 v12, v12
    v_mfma_f32_16x16x32_bf16 v[36:39], a[216:219], v[156:159], v[36:39]
    ds_read_b128 a[200:203], v196 offset:33856
    v_cvt_pk_bf16_f32 v75, v26, v27
    v_mfma_f32_16x16x32_bf16 v[40:43], a[216:219], v[172:175], v[40:43]
    v_exp_f32 v13, v13
    v_mfma_f32_16x16x32_bf16 v[44:47], a[216:219], v[188:191], v[44:47]
    ds_read_b64_tr_b16 a[232:233], v197 offset:16960
    v_cvt_pk_bf16_f32 v76, v12, v13
    v_mfma_f32_16x16x32_bf16 a[96:99], a[248:251], v[80:83], a[96:99]
    v_exp_f32 v14, v14
    v_mfma_f32_16x16x32_bf16 a[100:103], a[248:251], v[84:87], a[100:103]
    ds_read_b64_tr_b16 a[234:235], v197 offset:17472
    v_mfma_f32_16x16x32_bf16 a[104:107], a[248:251], v[88:91], a[104:107]
    v_exp_f32 v15, v15
    v_mfma_f32_16x16x32_bf16 a[108:111], a[248:251], v[92:95], a[108:111]
    buffer_load_dwordx4 v229, s[8:11], s35 offen offset:1024 sc1 lds
    v_mfma_f32_16x16x32_bf16 v[48:51], a[220:223], v[140:143], v[48:51]
    v_exp_f32 v28, v28
    v_mfma_f32_16x16x32_bf16 v[52:55], a[220:223], v[156:159], v[52:55]
    ds_read_b128 a[204:207], v196 offset:34368
    v_cvt_pk_bf16_f32 v77, v14, v15
    v_mfma_f32_16x16x32_bf16 v[56:59], a[220:223], v[172:175], v[56:59]
    v_exp_f32 v29, v29
    v_mfma_f32_16x16x32_bf16 v[60:63], a[220:223], v[188:191], v[60:63]
    ds_read_b64_tr_b16 a[236:237], v197 offset:16992
    v_cvt_pk_bf16_f32 v78, v28, v29
    v_mfma_f32_16x16x32_bf16 a[112:115], a[252:255], v[80:83], a[112:115]
    v_exp_f32 v30, v30
    v_mfma_f32_16x16x32_bf16 a[116:119], a[252:255], v[84:87], a[116:119]
    ds_read_b64_tr_b16 a[238:239], v197 offset:17504
    v_mfma_f32_16x16x32_bf16 a[120:123], a[252:255], v[88:91], a[120:123]
    v_exp_f32 v31, v31
    v_mfma_f32_16x16x32_bf16 a[124:127], a[252:255], v[92:95], a[124:127]
    buffer_load_dwordx4 v229, s[8:11], s35 offen offset:2048 sc1 lds
    v_mfma_f32_16x16x32_bf16 v[124:127], v[192:195], v[92:95], v[124:127]
    s_waitcnt lgkmcnt(6)
    v_mfma_f32_16x16x32_bf16 v[0:3], a[192:195], v[128:131], v[96:99]
    v_exp_f32 v32, v32
    v_mfma_f32_16x16x32_bf16 v[4:7], a[192:195], v[144:147], v[100:103]
    ds_read_b128 a[208:211], v196 offset:33920
    v_cvt_pk_bf16_f32 v79, v30, v31
    v_mfma_f32_16x16x32_bf16 v[8:11], a[192:195], v[160:163], v[104:107]
    v_exp_f32 v33, v33
    v_mfma_f32_16x16x32_bf16 v[12:15], a[192:195], v[176:179], v[108:111]
    ds_read_b64_tr_b16 a[240:241], v197 offset:17024
    v_cvt_pk_bf16_f32 v80, v32, v33
    v_mfma_f32_16x16x32_bf16 a[0:3], a[224:227], v[64:67], a[0:3]
    v_exp_f32 v34, v34
    v_mfma_f32_16x16x32_bf16 a[4:7], a[224:227], v[68:71], a[4:7]
    ds_read_b64_tr_b16 a[242:243], v197 offset:17536
    v_mfma_f32_16x16x32_bf16 a[8:11], a[224:227], v[72:75], a[8:11]
    v_exp_f32 v35, v35
    v_mfma_f32_16x16x32_bf16 a[12:15], a[224:227], v[76:79], a[12:15]
    buffer_load_dwordx4 v229, s[8:11], s35 offen offset:3072 sc1 lds
    s_add_u32 m0, s50, 147456
    v_mfma_f32_16x16x32_bf16 v[16:19], a[196:199], v[128:131], v[96:99]
    v_exp_f32 v48, v48
    v_mfma_f32_16x16x32_bf16 v[20:23], a[196:199], v[144:147], v[100:103]
    ds_read_b128 a[212:215], v196 offset:34432
    v_cvt_pk_bf16_f32 v81, v34, v35
    v_mfma_f32_16x16x32_bf16 v[24:27], a[196:199], v[160:163], v[104:107]
    v_exp_f32 v49, v49
    v_mfma_f32_16x16x32_bf16 v[28:31], a[196:199], v[176:179], v[108:111]
    ds_read_b64_tr_b16 a[244:245], v197 offset:17056
    v_cvt_pk_bf16_f32 v82, v48, v49
    v_mfma_f32_16x16x32_bf16 a[16:19], a[228:231], v[64:67], a[16:19]
    v_exp_f32 v50, v50
    v_mfma_f32_16x16x32_bf16 a[20:23], a[228:231], v[68:71], a[20:23]
    ds_read_b64_tr_b16 a[246:247], v197 offset:17568
    v_mfma_f32_16x16x32_bf16 a[24:27], a[228:231], v[72:75], a[24:27]
    v_exp_f32 v51, v51
    v_mfma_f32_16x16x32_bf16 a[28:31], a[228:231], v[76:79], a[28:31]
    buffer_load_dwordx4 v230, s[8:11], s35 offen sc1 lds
    s_mov_b32 s34, 0
    v_mfma_f32_16x16x32_bf16 v[112:115], v[192:195], v[64:67], v[112:115]
    buffer_load_dwordx4 a[128:131], v228, s[4:7], s34 offen offset:0 sc1
    s_waitcnt lgkmcnt(6)
    v_mfma_f32_16x16x32_bf16 v[0:3], a[200:203], v[132:135], v[0:3]
    v_exp_f32 v36, v36
    v_mfma_f32_16x16x32_bf16 v[4:7], a[200:203], v[148:151], v[4:7]
    ds_read_b128 a[216:219], v196 offset:33984
    v_cvt_pk_bf16_f32 v83, v50, v51
    v_mfma_f32_16x16x32_bf16 v[8:11], a[200:203], v[164:167], v[8:11]
    v_exp_f32 v37, v37
    v_mfma_f32_16x16x32_bf16 v[12:15], a[200:203], v[180:183], v[12:15]
    ds_read_b64_tr_b16 a[248:249], v197 offset:17088
    v_cvt_pk_bf16_f32 v84, v36, v37
    v_mfma_f32_16x16x32_bf16 a[32:35], a[232:235], v[64:67], a[32:35]
    v_exp_f32 v38, v38
    v_mfma_f32_16x16x32_bf16 a[36:39], a[232:235], v[68:71], a[36:39]
    ds_read_b64_tr_b16 a[250:251], v197 offset:17600
    v_mfma_f32_16x16x32_bf16 a[40:43], a[232:235], v[72:75], a[40:43]
    v_exp_f32 v39, v39
    v_mfma_f32_16x16x32_bf16 a[44:47], a[232:235], v[76:79], a[44:47]
    buffer_load_dwordx4 a[132:135], v228, s[4:7], s34 offen offset:1024 sc1
    v_mfma_f32_16x16x32_bf16 v[16:19], a[204:207], v[132:135], v[16:19]
    v_exp_f32 v52, v52
    v_mfma_f32_16x16x32_bf16 v[20:23], a[204:207], v[148:151], v[20:23]
    ds_read_b128 a[220:223], v196 offset:34496
    v_cvt_pk_bf16_f32 v85, v38, v39
    v_mfma_f32_16x16x32_bf16 v[24:27], a[204:207], v[164:167], v[24:27]
    v_exp_f32 v53, v53
    v_mfma_f32_16x16x32_bf16 v[28:31], a[204:207], v[180:183], v[28:31]
    ds_read_b64_tr_b16 a[252:253], v197 offset:17120
    v_cvt_pk_bf16_f32 v86, v52, v53
    v_mfma_f32_16x16x32_bf16 a[48:51], a[236:239], v[64:67], a[48:51]
    v_exp_f32 v54, v54
    v_mfma_f32_16x16x32_bf16 a[52:55], a[236:239], v[68:71], a[52:55]
    ds_read_b64_tr_b16 a[254:255], v197 offset:17632
    v_mfma_f32_16x16x32_bf16 a[56:59], a[236:239], v[72:75], a[56:59]
    v_exp_f32 v55, v55
    v_mfma_f32_16x16x32_bf16 a[60:63], a[236:239], v[76:79], a[60:63]
    buffer_load_dwordx4 a[136:139], v228, s[4:7], s34 offen offset:2048 sc1
    v_mfma_f32_16x16x32_bf16 v[116:119], v[192:195], v[68:71], v[116:119]
    s_waitcnt lgkmcnt(6)
    s_barrier
    v_mfma_f32_16x16x32_bf16 v[0:3], a[208:211], v[136:139], v[0:3]
    v_exp_f32 v40, v40
    v_mfma_f32_16x16x32_bf16 v[4:7], a[208:211], v[152:155], v[4:7]
    ds_read_b128 a[192:195], v196 offset:42240
    v_cvt_pk_bf16_f32 v87, v54, v55
    v_mfma_f32_16x16x32_bf16 v[8:11], a[208:211], v[168:171], v[8:11]
    v_exp_f32 v41, v41
    v_mfma_f32_16x16x32_bf16 v[12:15], a[208:211], v[184:187], v[12:15]
    ds_read_b64_tr_b16 a[224:225], v197 offset:25344
    v_cvt_pk_bf16_f32 v88, v40, v41
    v_mfma_f32_16x16x32_bf16 a[64:67], a[240:243], v[64:67], a[64:67]
    v_exp_f32 v42, v42
    v_mfma_f32_16x16x32_bf16 a[68:71], a[240:243], v[68:71], a[68:71]
    ds_read_b64_tr_b16 a[226:227], v197 offset:25856
    v_mfma_f32_16x16x32_bf16 a[72:75], a[240:243], v[72:75], a[72:75]
    v_exp_f32 v43, v43
    v_mfma_f32_16x16x32_bf16 a[76:79], a[240:243], v[76:79], a[76:79]
    global_store_dwordx4 v238, v[224:227], s[94:95] offset:-4096 sc1
    v_mfma_f32_16x16x32_bf16 v[16:19], a[212:215], v[136:139], v[16:19]
    v_exp_f32 v56, v56
    v_mfma_f32_16x16x32_bf16 v[20:23], a[212:215], v[152:155], v[20:23]
    ds_read_b128 a[196:199], v196 offset:42752
    v_cvt_pk_bf16_f32 v89, v42, v43
    v_mfma_f32_16x16x32_bf16 v[24:27], a[212:215], v[168:171], v[24:27]
    v_exp_f32 v57, v57
    v_mfma_f32_16x16x32_bf16 v[28:31], a[212:215], v[184:187], v[28:31]
    ds_read_b64_tr_b16 a[228:229], v197 offset:25376
    v_cvt_pk_bf16_f32 v90, v56, v57
    v_mfma_f32_16x16x32_bf16 a[80:83], a[244:247], v[64:67], a[80:83]
    v_exp_f32 v58, v58
    v_mfma_f32_16x16x32_bf16 a[84:87], a[244:247], v[68:71], a[84:87]
    ds_read_b64_tr_b16 a[230:231], v197 offset:25888
    v_mfma_f32_16x16x32_bf16 a[88:91], a[244:247], v[72:75], a[88:91]
    v_exp_f32 v59, v59
    v_mfma_f32_16x16x32_bf16 a[92:95], a[244:247], v[76:79], a[92:95]
    global_store_dwordx4 v238, v[224:227], s[94:95] offset:-3072 sc1
    v_mfma_f32_16x16x32_bf16 v[120:123], v[192:195], v[72:75], v[120:123]
    buffer_load_dwordx4 a[140:143], v228, s[4:7], s34 offen offset:3072 sc1
    s_add_u32 m0, s50, 0
    s_waitcnt lgkmcnt(6)
    v_mfma_f32_16x16x32_bf16 v[0:3], a[216:219], v[140:143], v[0:3]
    v_exp_f32 v44, v44
    v_mfma_f32_16x16x32_bf16 v[4:7], a[216:219], v[156:159], v[4:7]
    ds_read_b128 a[200:203], v196 offset:42304
    v_cvt_pk_bf16_f32 v91, v58, v59
    v_mfma_f32_16x16x32_bf16 v[8:11], a[216:219], v[172:175], v[8:11]
    v_exp_f32 v45, v45
    v_mfma_f32_16x16x32_bf16 v[12:15], a[216:219], v[188:191], v[12:15]
    ds_read_b64_tr_b16 a[232:233], v197 offset:25408
    v_cvt_pk_bf16_f32 v92, v44, v45
    v_mfma_f32_16x16x32_bf16 a[96:99], a[248:251], v[64:67], a[96:99]
    v_exp_f32 v46, v46
    v_mfma_f32_16x16x32_bf16 a[100:103], a[248:251], v[68:71], a[100:103]
    ds_read_b64_tr_b16 a[234:235], v197 offset:25920
    s_mov_b32 s35, 20480
    v_mfma_f32_16x16x32_bf16 a[104:107], a[248:251], v[72:75], a[104:107]
    v_exp_f32 v47, v47
    v_mfma_f32_16x16x32_bf16 a[108:111], a[248:251], v[76:79], a[108:111]
    buffer_load_dwordx4 v229, s[8:11], s35 offen offset:0 sc1 lds
    v_mfma_f32_16x16x32_bf16 v[16:19], a[220:223], v[140:143], v[16:19]
    v_exp_f32 v60, v60
    v_mfma_f32_16x16x32_bf16 v[20:23], a[220:223], v[156:159], v[20:23]
    ds_read_b128 a[204:207], v196 offset:42816
    v_cvt_pk_bf16_f32 v93, v46, v47
    v_mfma_f32_16x16x32_bf16 v[24:27], a[220:223], v[172:175], v[24:27]
    v_exp_f32 v61, v61
    v_mfma_f32_16x16x32_bf16 v[28:31], a[220:223], v[188:191], v[28:31]
    ds_read_b64_tr_b16 a[236:237], v197 offset:25440
    v_cvt_pk_bf16_f32 v94, v60, v61
    v_mfma_f32_16x16x32_bf16 a[112:115], a[252:255], v[64:67], a[112:115]
    v_exp_f32 v62, v62
    v_mfma_f32_16x16x32_bf16 a[116:119], a[252:255], v[68:71], a[116:119]
    ds_read_b64_tr_b16 a[238:239], v197 offset:25952
    v_mfma_f32_16x16x32_bf16 a[120:123], a[252:255], v[72:75], a[120:123]
    v_exp_f32 v63, v63
    v_mfma_f32_16x16x32_bf16 a[124:127], a[252:255], v[76:79], a[124:127]
    buffer_load_dwordx4 v229, s[8:11], s35 offen offset:1024 sc1 lds
    v_mfma_f32_16x16x32_bf16 v[124:127], v[192:195], v[76:79], v[124:127]
    s_waitcnt lgkmcnt(6)
    v_mfma_f32_16x16x32_bf16 v[32:35], a[192:195], v[128:131], v[96:99]
    v_exp_f32 v0, v0
    v_mfma_f32_16x16x32_bf16 v[36:39], a[192:195], v[144:147], v[100:103]
    ds_read_b128 a[208:211], v196 offset:42368
    v_cvt_pk_bf16_f32 v95, v62, v63
    v_mfma_f32_16x16x32_bf16 v[40:43], a[192:195], v[160:163], v[104:107]
    v_exp_f32 v1, v1
    v_mfma_f32_16x16x32_bf16 v[44:47], a[192:195], v[176:179], v[108:111]
    ds_read_b64_tr_b16 a[240:241], v197 offset:25472
    v_cvt_pk_bf16_f32 v64, v0, v1
    v_mfma_f32_16x16x32_bf16 a[0:3], a[224:227], v[80:83], a[0:3]
    v_exp_f32 v2, v2
    v_mfma_f32_16x16x32_bf16 a[4:7], a[224:227], v[84:87], a[4:7]
    ds_read_b64_tr_b16 a[242:243], v197 offset:25984
    v_mfma_f32_16x16x32_bf16 a[8:11], a[224:227], v[88:91], a[8:11]
    v_exp_f32 v3, v3
    v_mfma_f32_16x16x32_bf16 a[12:15], a[224:227], v[92:95], a[12:15]
    global_store_dwordx4 v238, v[224:227], s[94:95] offset:-2048 sc1
    v_mfma_f32_16x16x32_bf16 v[48:51], a[196:199], v[128:131], v[96:99]
    v_exp_f32 v16, v16
    v_mfma_f32_16x16x32_bf16 v[52:55], a[196:199], v[144:147], v[100:103]
    ds_read_b128 a[212:215], v196 offset:42880
    v_cvt_pk_bf16_f32 v65, v2, v3
    v_mfma_f32_16x16x32_bf16 v[56:59], a[196:199], v[160:163], v[104:107]
    v_exp_f32 v17, v17
    v_mfma_f32_16x16x32_bf16 v[60:63], a[196:199], v[176:179], v[108:111]
    ds_read_b64_tr_b16 a[244:245], v197 offset:25504
    v_cvt_pk_bf16_f32 v66, v16, v17
    v_mfma_f32_16x16x32_bf16 a[16:19], a[228:231], v[80:83], a[16:19]
    v_exp_f32 v18, v18
    v_mfma_f32_16x16x32_bf16 a[20:23], a[228:231], v[84:87], a[20:23]
    ds_read_b64_tr_b16 a[246:247], v197 offset:26016
    v_mfma_f32_16x16x32_bf16 a[24:27], a[228:231], v[88:91], a[24:27]
    v_exp_f32 v19, v19
    v_mfma_f32_16x16x32_bf16 a[28:31], a[228:231], v[92:95], a[28:31]
    global_store_dwordx4 v238, v[224:227], s[94:95] offset:-1024 sc1
    v_mfma_f32_16x16x32_bf16 v[112:115], v[192:195], v[80:83], v[112:115]
    buffer_load_dwordx4 v229, s[8:11], s35 offen offset:2048 sc1 lds
    s_waitcnt lgkmcnt(6)
    v_mfma_f32_16x16x32_bf16 v[32:35], a[200:203], v[132:135], v[32:35]
    v_exp_f32 v4, v4
    v_mfma_f32_16x16x32_bf16 v[36:39], a[200:203], v[148:151], v[36:39]
    ds_read_b128 a[216:219], v196 offset:42432
    v_cvt_pk_bf16_f32 v67, v18, v19
    v_mfma_f32_16x16x32_bf16 v[40:43], a[200:203], v[164:167], v[40:43]
    v_exp_f32 v5, v5
    v_mfma_f32_16x16x32_bf16 v[44:47], a[200:203], v[180:183], v[44:47]
    ds_read_b64_tr_b16 a[248:249], v197 offset:25536
    v_cvt_pk_bf16_f32 v68, v4, v5
    v_mfma_f32_16x16x32_bf16 a[32:35], a[232:235], v[80:83], a[32:35]
    v_exp_f32 v6, v6
    v_mfma_f32_16x16x32_bf16 a[36:39], a[232:235], v[84:87], a[36:39]
    ds_read_b64_tr_b16 a[250:251], v197 offset:26048
    v_mfma_f32_16x16x32_bf16 a[40:43], a[232:235], v[88:91], a[40:43]
    v_exp_f32 v7, v7
    v_mfma_f32_16x16x32_bf16 a[44:47], a[232:235], v[92:95], a[44:47]
    buffer_load_dwordx4 v229, s[8:11], s35 offen offset:3072 sc1 lds
    s_add_u32 m0, s50, 4096
    v_mfma_f32_16x16x32_bf16 v[48:51], a[204:207], v[132:135], v[48:51]
    v_exp_f32 v20, v20
    v_mfma_f32_16x16x32_bf16 v[52:55], a[204:207], v[148:151], v[52:55]
    ds_read_b128 a[220:223], v196 offset:42944
    v_cvt_pk_bf16_f32 v69, v6, v7
    v_mfma_f32_16x16x32_bf16 v[56:59], a[204:207], v[164:167], v[56:59]
    v_exp_f32 v21, v21
    v_mfma_f32_16x16x32_bf16 v[60:63], a[204:207], v[180:183], v[60:63]
    ds_read_b64_tr_b16 a[252:253], v197 offset:25568
    v_cvt_pk_bf16_f32 v70, v20, v21
    v_mfma_f32_16x16x32_bf16 a[48:51], a[236:239], v[80:83], a[48:51]
    v_exp_f32 v22, v22
    v_mfma_f32_16x16x32_bf16 a[52:55], a[236:239], v[84:87], a[52:55]
    ds_read_b64_tr_b16 a[254:255], v197 offset:26080
    v_mfma_f32_16x16x32_bf16 a[56:59], a[236:239], v[88:91], a[56:59]
    v_exp_f32 v23, v23
    v_mfma_f32_16x16x32_bf16 a[60:63], a[236:239], v[92:95], a[60:63]
    buffer_load_dwordx4 v230, s[8:11], s35 offen sc1 lds
    s_mov_b32 s34, 16384
    v_mfma_f32_16x16x32_bf16 v[116:119], v[192:195], v[84:87], v[116:119]
    s_waitcnt lgkmcnt(6)
    s_barrier
    v_mfma_f32_16x16x32_bf16 v[32:35], a[208:211], v[136:139], v[32:35]
    v_exp_f32 v8, v8
    v_mfma_f32_16x16x32_bf16 v[36:39], a[208:211], v[152:155], v[36:39]
    ds_read_b128 a[192:195], v196 offset:50688
    v_cvt_pk_bf16_f32 v71, v22, v23
    v_mfma_f32_16x16x32_bf16 v[40:43], a[208:211], v[168:171], v[40:43]
    v_exp_f32 v9, v9
    v_mfma_f32_16x16x32_bf16 v[44:47], a[208:211], v[184:187], v[44:47]
    ds_read_b64_tr_b16 a[224:225], v197 offset:33792
    v_cvt_pk_bf16_f32 v72, v8, v9
    v_mfma_f32_16x16x32_bf16 a[64:67], a[240:243], v[80:83], a[64:67]
    v_exp_f32 v10, v10
    v_mfma_f32_16x16x32_bf16 a[68:71], a[240:243], v[84:87], a[68:71]
    ds_read_b64_tr_b16 a[226:227], v197 offset:34304
    v_mfma_f32_16x16x32_bf16 a[72:75], a[240:243], v[88:91], a[72:75]
    v_exp_f32 v11, v11
    v_mfma_f32_16x16x32_bf16 a[76:79], a[240:243], v[92:95], a[76:79]
    global_store_dwordx4 v238, v[224:227], s[94:95] offset:0 sc1
    v_mfma_f32_16x16x32_bf16 v[48:51], a[212:215], v[136:139], v[48:51]
    v_exp_f32 v24, v24
    v_mfma_f32_16x16x32_bf16 v[52:55], a[212:215], v[152:155], v[52:55]
    ds_read_b128 a[196:199], v196 offset:51200
    v_cvt_pk_bf16_f32 v73, v10, v11
    v_mfma_f32_16x16x32_bf16 v[56:59], a[212:215], v[168:171], v[56:59]
    v_exp_f32 v25, v25
    v_mfma_f32_16x16x32_bf16 v[60:63], a[212:215], v[184:187], v[60:63]
    ds_read_b64_tr_b16 a[228:229], v197 offset:33824
    v_cvt_pk_bf16_f32 v74, v24, v25
    v_mfma_f32_16x16x32_bf16 a[80:83], a[244:247], v[80:83], a[80:83]
    v_exp_f32 v26, v26
    v_mfma_f32_16x16x32_bf16 a[84:87], a[244:247], v[84:87], a[84:87]
    ds_read_b64_tr_b16 a[230:231], v197 offset:34336
    v_mfma_f32_16x16x32_bf16 a[88:91], a[244:247], v[88:91], a[88:91]
    v_exp_f32 v27, v27
    v_mfma_f32_16x16x32_bf16 a[92:95], a[244:247], v[92:95], a[92:95]
    global_store_dwordx4 v238, v[224:227], s[94:95] offset:1024 sc1
    v_mfma_f32_16x16x32_bf16 v[120:123], v[192:195], v[88:91], v[120:123]
    buffer_load_dwordx4 a[144:147], v228, s[4:7], s34 offen offset:0 sc1
    s_waitcnt lgkmcnt(6)
    v_mfma_f32_16x16x32_bf16 v[32:35], a[216:219], v[140:143], v[32:35]
    v_exp_f32 v12, v12
    v_mfma_f32_16x16x32_bf16 v[36:39], a[216:219], v[156:159], v[36:39]
    ds_read_b128 a[200:203], v196 offset:50752
    v_cvt_pk_bf16_f32 v75, v26, v27
    v_mfma_f32_16x16x32_bf16 v[40:43], a[216:219], v[172:175], v[40:43]
    v_exp_f32 v13, v13
    v_mfma_f32_16x16x32_bf16 v[44:47], a[216:219], v[188:191], v[44:47]
    ds_read_b64_tr_b16 a[232:233], v197 offset:33856
    v_cvt_pk_bf16_f32 v76, v12, v13
    v_mfma_f32_16x16x32_bf16 a[96:99], a[248:251], v[80:83], a[96:99]
    v_exp_f32 v14, v14
    v_mfma_f32_16x16x32_bf16 a[100:103], a[248:251], v[84:87], a[100:103]
    ds_read_b64_tr_b16 a[234:235], v197 offset:34368
    v_mfma_f32_16x16x32_bf16 a[104:107], a[248:251], v[88:91], a[104:107]
    v_exp_f32 v15, v15
    v_mfma_f32_16x16x32_bf16 a[108:111], a[248:251], v[92:95], a[108:111]
    buffer_load_dwordx4 a[148:151], v228, s[4:7], s34 offen offset:1024 sc1
    v_mfma_f32_16x16x32_bf16 v[48:51], a[220:223], v[140:143], v[48:51]
    v_exp_f32 v28, v28
    v_mfma_f32_16x16x32_bf16 v[52:55], a[220:223], v[156:159], v[52:55]
    ds_read_b128 a[204:207], v196 offset:51264
    v_cvt_pk_bf16_f32 v77, v14, v15
    v_mfma_f32_16x16x32_bf16 v[56:59], a[220:223], v[172:175], v[56:59]
    v_exp_f32 v29, v29
    v_mfma_f32_16x16x32_bf16 v[60:63], a[220:223], v[188:191], v[60:63]
    ds_read_b64_tr_b16 a[236:237], v197 offset:33888
    v_cvt_pk_bf16_f32 v78, v28, v29
    v_mfma_f32_16x16x32_bf16 a[112:115], a[252:255], v[80:83], a[112:115]
    v_exp_f32 v30, v30
    v_mfma_f32_16x16x32_bf16 a[116:119], a[252:255], v[84:87], a[116:119]
    ds_read_b64_tr_b16 a[238:239], v197 offset:34400
    v_mfma_f32_16x16x32_bf16 a[120:123], a[252:255], v[88:91], a[120:123]
    v_exp_f32 v31, v31
    v_mfma_f32_16x16x32_bf16 a[124:127], a[252:255], v[92:95], a[124:127]
    buffer_load_dwordx4 a[152:155], v228, s[4:7], s34 offen offset:2048 sc1
    v_mfma_f32_16x16x32_bf16 v[124:127], v[192:195], v[92:95], v[124:127]
    s_waitcnt lgkmcnt(6)
    v_mfma_f32_16x16x32_bf16 v[0:3], a[192:195], v[128:131], v[96:99]
    v_exp_f32 v32, v32
    v_mfma_f32_16x16x32_bf16 v[4:7], a[192:195], v[144:147], v[100:103]
    ds_read_b128 a[208:211], v196 offset:50816
    v_cvt_pk_bf16_f32 v79, v30, v31
    v_mfma_f32_16x16x32_bf16 v[8:11], a[192:195], v[160:163], v[104:107]
    v_exp_f32 v33, v33
    v_mfma_f32_16x16x32_bf16 v[12:15], a[192:195], v[176:179], v[108:111]
    ds_read_b64_tr_b16 a[240:241], v197 offset:33920
    v_cvt_pk_bf16_f32 v80, v32, v33
    v_mfma_f32_16x16x32_bf16 a[0:3], a[224:227], v[64:67], a[0:3]
    v_exp_f32 v34, v34
    v_mfma_f32_16x16x32_bf16 a[4:7], a[224:227], v[68:71], a[4:7]
    ds_read_b64_tr_b16 a[242:243], v197 offset:34432
    v_mfma_f32_16x16x32_bf16 a[8:11], a[224:227], v[72:75], a[8:11]
    v_exp_f32 v35, v35
    v_mfma_f32_16x16x32_bf16 a[12:15], a[224:227], v[76:79], a[12:15]
    global_store_dwordx4 v238, v[224:227], s[94:95] offset:2048 sc1
    v_mfma_f32_16x16x32_bf16 v[16:19], a[196:199], v[128:131], v[96:99]
    v_exp_f32 v48, v48
    v_mfma_f32_16x16x32_bf16 v[20:23], a[196:199], v[144:147], v[100:103]
    ds_read_b128 a[212:215], v196 offset:51328
    v_cvt_pk_bf16_f32 v81, v34, v35
    v_mfma_f32_16x16x32_bf16 v[24:27], a[196:199], v[160:163], v[104:107]
    v_exp_f32 v49, v49
    v_mfma_f32_16x16x32_bf16 v[28:31], a[196:199], v[176:179], v[108:111]
    ds_read_b64_tr_b16 a[244:245], v197 offset:33952
    v_cvt_pk_bf16_f32 v82, v48, v49
    v_mfma_f32_16x16x32_bf16 a[16:19], a[228:231], v[64:67], a[16:19]
    v_exp_f32 v50, v50
    v_mfma_f32_16x16x32_bf16 a[20:23], a[228:231], v[68:71], a[20:23]
    ds_read_b64_tr_b16 a[246:247], v197 offset:34464
    v_mfma_f32_16x16x32_bf16 a[24:27], a[228:231], v[72:75], a[24:27]
    v_exp_f32 v51, v51
    v_mfma_f32_16x16x32_bf16 a[28:31], a[228:231], v[76:79], a[28:31]
    global_store_dwordx4 v238, v[224:227], s[94:95] offset:3072 sc1
    v_mfma_f32_16x16x32_bf16 v[112:115], v[192:195], v[64:67], v[112:115]
    buffer_load_dwordx4 a[156:159], v228, s[4:7], s34 offen offset:3072 sc1
    s_add_u32 m0, s50, 20480
    s_waitcnt lgkmcnt(6)
    v_mfma_f32_16x16x32_bf16 v[0:3], a[200:203], v[132:135], v[0:3]
    v_exp_f32 v36, v36
    v_mfma_f32_16x16x32_bf16 v[4:7], a[200:203], v[148:151], v[4:7]
    ds_read_b128 a[216:219], v196 offset:50880
    v_cvt_pk_bf16_f32 v83, v50, v51
    v_mfma_f32_16x16x32_bf16 v[8:11], a[200:203], v[164:167], v[8:11]
    v_exp_f32 v37, v37
    v_mfma_f32_16x16x32_bf16 v[12:15], a[200:203], v[180:183], v[12:15]
    ds_read_b64_tr_b16 a[248:249], v197 offset:33984
    v_cvt_pk_bf16_f32 v84, v36, v37
    v_mfma_f32_16x16x32_bf16 a[32:35], a[232:235], v[64:67], a[32:35]
    v_exp_f32 v38, v38
    v_mfma_f32_16x16x32_bf16 a[36:39], a[232:235], v[68:71], a[36:39]
    ds_read_b64_tr_b16 a[250:251], v197 offset:34496
    s_mov_b32 s35, 40960
    v_mfma_f32_16x16x32_bf16 a[40:43], a[232:235], v[72:75], a[40:43]
    v_exp_f32 v39, v39
    v_mfma_f32_16x16x32_bf16 a[44:47], a[232:235], v[76:79], a[44:47]
    buffer_load_dwordx4 v229, s[8:11], s35 offen offset:0 sc1 lds
    v_mfma_f32_16x16x32_bf16 v[16:19], a[204:207], v[132:135], v[16:19]
    v_exp_f32 v52, v52
    v_mfma_f32_16x16x32_bf16 v[20:23], a[204:207], v[148:151], v[20:23]
    ds_read_b128 a[220:223], v196 offset:51392
    v_cvt_pk_bf16_f32 v85, v38, v39
    v_mfma_f32_16x16x32_bf16 v[24:27], a[204:207], v[164:167], v[24:27]
    v_exp_f32 v53, v53
    v_mfma_f32_16x16x32_bf16 v[28:31], a[204:207], v[180:183], v[28:31]
    ds_read_b64_tr_b16 a[252:253], v197 offset:34016
    v_cvt_pk_bf16_f32 v86, v52, v53
    v_mfma_f32_16x16x32_bf16 a[48:51], a[236:239], v[64:67], a[48:51]
    v_exp_f32 v54, v54
    v_mfma_f32_16x16x32_bf16 a[52:55], a[236:239], v[68:71], a[52:55]
    ds_read_b64_tr_b16 a[254:255], v197 offset:34528
    v_mfma_f32_16x16x32_bf16 a[56:59], a[236:239], v[72:75], a[56:59]
    v_exp_f32 v55, v55
    v_mfma_f32_16x16x32_bf16 a[60:63], a[236:239], v[76:79], a[60:63]
    buffer_load_dwordx4 v229, s[8:11], s35 offen offset:1024 sc1 lds
    v_mfma_f32_16x16x32_bf16 v[116:119], v[192:195], v[68:71], v[116:119]
    s_waitcnt vmcnt(32) lgkmcnt(6)
    s_barrier
    v_mfma_f32_16x16x32_bf16 v[0:3], a[208:211], v[136:139], v[0:3]
    v_exp_f32 v40, v40
    v_mfma_f32_16x16x32_bf16 v[4:7], a[208:211], v[152:155], v[4:7]
    ds_read_b128 a[192:195], v196 offset:59136
    v_cvt_pk_bf16_f32 v87, v54, v55
    v_mfma_f32_16x16x32_bf16 v[8:11], a[208:211], v[168:171], v[8:11]
    v_exp_f32 v41, v41
    v_mfma_f32_16x16x32_bf16 v[12:15], a[208:211], v[184:187], v[12:15]
    ds_read_b64_tr_b16 a[224:225], v197 offset:42240
    v_cvt_pk_bf16_f32 v88, v40, v41
    v_mfma_f32_16x16x32_bf16 a[64:67], a[240:243], v[64:67], a[64:67]
    v_exp_f32 v42, v42
    v_mfma_f32_16x16x32_bf16 a[68:71], a[240:243], v[68:71], a[68:71]
    ds_read_b64_tr_b16 a[226:227], v197 offset:42752
    v_mfma_f32_16x16x32_bf16 a[72:75], a[240:243], v[72:75], a[72:75]
    v_exp_f32 v43, v43
    v_mfma_f32_16x16x32_bf16 a[76:79], a[240:243], v[76:79], a[76:79]
    global_store_dwordx4 v239, v[224:227], s[94:95] offset:-4096 sc1
    v_mfma_f32_16x16x32_bf16 v[16:19], a[212:215], v[136:139], v[16:19]
    v_exp_f32 v56, v56
    v_mfma_f32_16x16x32_bf16 v[20:23], a[212:215], v[152:155], v[20:23]
    ds_read_b128 a[196:199], v196 offset:59648
    v_cvt_pk_bf16_f32 v89, v42, v43
    v_mfma_f32_16x16x32_bf16 v[24:27], a[212:215], v[168:171], v[24:27]
    v_exp_f32 v57, v57
    v_mfma_f32_16x16x32_bf16 v[28:31], a[212:215], v[184:187], v[28:31]
    ds_read_b64_tr_b16 a[228:229], v197 offset:42272
    v_cvt_pk_bf16_f32 v90, v56, v57
    v_mfma_f32_16x16x32_bf16 a[80:83], a[244:247], v[64:67], a[80:83]
    v_exp_f32 v58, v58
    v_mfma_f32_16x16x32_bf16 a[84:87], a[244:247], v[68:71], a[84:87]
    ds_read_b64_tr_b16 a[230:231], v197 offset:42784
    v_mfma_f32_16x16x32_bf16 a[88:91], a[244:247], v[72:75], a[88:91]
    v_exp_f32 v59, v59
    v_mfma_f32_16x16x32_bf16 a[92:95], a[244:247], v[76:79], a[92:95]
    global_store_dwordx4 v239, v[224:227], s[94:95] offset:-3072 sc1
    v_mfma_f32_16x16x32_bf16 v[120:123], v[192:195], v[72:75], v[120:123]
    buffer_load_dwordx4 v229, s[8:11], s35 offen offset:2048 sc1 lds
    s_waitcnt lgkmcnt(6)
    v_mfma_f32_16x16x32_bf16 v[0:3], a[216:219], v[140:143], v[0:3]
    v_exp_f32 v44, v44
    v_mfma_f32_16x16x32_bf16 v[4:7], a[216:219], v[156:159], v[4:7]
    ds_read_b128 a[200:203], v196 offset:59200
    v_cvt_pk_bf16_f32 v91, v58, v59
    v_mfma_f32_16x16x32_bf16 v[8:11], a[216:219], v[172:175], v[8:11]
    v_exp_f32 v45, v45
    v_mfma_f32_16x16x32_bf16 v[12:15], a[216:219], v[188:191], v[12:15]
    ds_read_b64_tr_b16 a[232:233], v197 offset:42304
    v_cvt_pk_bf16_f32 v92, v44, v45
    v_mfma_f32_16x16x32_bf16 a[96:99], a[248:251], v[64:67], a[96:99]
    v_exp_f32 v46, v46
    v_mfma_f32_16x16x32_bf16 a[100:103], a[248:251], v[68:71], a[100:103]
    ds_read_b64_tr_b16 a[234:235], v197 offset:42816
    v_mfma_f32_16x16x32_bf16 a[104:107], a[248:251], v[72:75], a[104:107]
    v_exp_f32 v47, v47
    v_mfma_f32_16x16x32_bf16 a[108:111], a[248:251], v[76:79], a[108:111]
    buffer_load_dwordx4 v229, s[8:11], s35 offen offset:3072 sc1 lds
    s_add_u32 m0, s50, 24576
    v_mfma_f32_16x16x32_bf16 v[16:19], a[220:223], v[140:143], v[16:19]
    v_exp_f32 v60, v60
    v_mfma_f32_16x16x32_bf16 v[20:23], a[220:223], v[156:159], v[20:23]
    ds_read_b128 a[204:207], v196 offset:59712
    v_cvt_pk_bf16_f32 v93, v46, v47
    v_mfma_f32_16x16x32_bf16 v[24:27], a[220:223], v[172:175], v[24:27]
    v_exp_f32 v61, v61
    v_mfma_f32_16x16x32_bf16 v[28:31], a[220:223], v[188:191], v[28:31]
    ds_read_b64_tr_b16 a[236:237], v197 offset:42336
    v_cvt_pk_bf16_f32 v94, v60, v61
    v_mfma_f32_16x16x32_bf16 a[112:115], a[252:255], v[64:67], a[112:115]
    v_exp_f32 v62, v62
    v_mfma_f32_16x16x32_bf16 a[116:119], a[252:255], v[68:71], a[116:119]
    ds_read_b64_tr_b16 a[238:239], v197 offset:42848
    v_mfma_f32_16x16x32_bf16 a[120:123], a[252:255], v[72:75], a[120:123]
    v_exp_f32 v63, v63
    v_mfma_f32_16x16x32_bf16 a[124:127], a[252:255], v[76:79], a[124:127]
    buffer_load_dwordx4 v230, s[8:11], s35 offen sc1 lds
    s_mov_b32 s34, 32768
    v_mfma_f32_16x16x32_bf16 v[124:127], v[192:195], v[76:79], v[124:127]
    s_waitcnt lgkmcnt(6)
    v_mfma_f32_16x16x32_bf16 v[32:35], a[192:195], v[128:131], v[96:99]
    v_exp_f32 v0, v0
    v_mfma_f32_16x16x32_bf16 v[36:39], a[192:195], v[144:147], v[100:103]
    ds_read_b128 a[208:211], v196 offset:59264
    v_cvt_pk_bf16_f32 v95, v62, v63
    v_mfma_f32_16x16x32_bf16 v[40:43], a[192:195], v[160:163], v[104:107]
    v_exp_f32 v1, v1
    v_mfma_f32_16x16x32_bf16 v[44:47], a[192:195], v[176:179], v[108:111]
    ds_read_b64_tr_b16 a[240:241], v197 offset:42368
    v_cvt_pk_bf16_f32 v64, v0, v1
    v_mfma_f32_16x16x32_bf16 a[0:3], a[224:227], v[80:83], a[0:3]
    v_exp_f32 v2, v2
    v_mfma_f32_16x16x32_bf16 a[4:7], a[224:227], v[84:87], a[4:7]
    ds_read_b64_tr_b16 a[242:243], v197 offset:42880
    v_mfma_f32_16x16x32_bf16 a[8:11], a[224:227], v[88:91], a[8:11]
    v_exp_f32 v3, v3
    v_mfma_f32_16x16x32_bf16 a[12:15], a[224:227], v[92:95], a[12:15]
    buffer_load_dwordx4 a[160:163], v228, s[4:7], s34 offen offset:0 sc1
    v_mfma_f32_16x16x32_bf16 v[48:51], a[196:199], v[128:131], v[96:99]
    v_exp_f32 v16, v16
    v_mfma_f32_16x16x32_bf16 v[52:55], a[196:199], v[144:147], v[100:103]
    ds_read_b128 a[212:215], v196 offset:59776
    v_cvt_pk_bf16_f32 v65, v2, v3
    v_mfma_f32_16x16x32_bf16 v[56:59], a[196:199], v[160:163], v[104:107]
    v_exp_f32 v17, v17
    v_mfma_f32_16x16x32_bf16 v[60:63], a[196:199], v[176:179], v[108:111]
    ds_read_b64_tr_b16 a[244:245], v197 offset:42400
    v_cvt_pk_bf16_f32 v66, v16, v17
    v_mfma_f32_16x16x32_bf16 a[16:19], a[228:231], v[80:83], a[16:19]
    v_exp_f32 v18, v18
    v_mfma_f32_16x16x32_bf16 a[20:23], a[228:231], v[84:87], a[20:23]
    ds_read_b64_tr_b16 a[246:247], v197 offset:42912
    v_mfma_f32_16x16x32_bf16 a[24:27], a[228:231], v[88:91], a[24:27]
    v_exp_f32 v19, v19
    v_mfma_f32_16x16x32_bf16 a[28:31], a[228:231], v[92:95], a[28:31]
    buffer_load_dwordx4 a[164:167], v228, s[4:7], s34 offen offset:1024 sc1
    v_mfma_f32_16x16x32_bf16 v[112:115], v[192:195], v[80:83], v[112:115]
    buffer_load_dwordx4 a[168:171], v228, s[4:7], s34 offen offset:2048 sc1
    s_waitcnt lgkmcnt(6)
    v_mfma_f32_16x16x32_bf16 v[32:35], a[200:203], v[132:135], v[32:35]
    v_exp_f32 v4, v4
    v_mfma_f32_16x16x32_bf16 v[36:39], a[200:203], v[148:151], v[36:39]
    ds_read_b128 a[216:219], v196 offset:59328
    v_cvt_pk_bf16_f32 v67, v18, v19
    v_mfma_f32_16x16x32_bf16 v[40:43], a[200:203], v[164:167], v[40:43]
    v_exp_f32 v5, v5
    v_mfma_f32_16x16x32_bf16 v[44:47], a[200:203], v[180:183], v[44:47]
    ds_read_b64_tr_b16 a[248:249], v197 offset:42432
    v_cvt_pk_bf16_f32 v68, v4, v5
    v_mfma_f32_16x16x32_bf16 a[32:35], a[232:235], v[80:83], a[32:35]
    v_exp_f32 v6, v6
    v_mfma_f32_16x16x32_bf16 a[36:39], a[232:235], v[84:87], a[36:39]
    ds_read_b64_tr_b16 a[250:251], v197 offset:42944
    v_mfma_f32_16x16x32_bf16 a[40:43], a[232:235], v[88:91], a[40:43]
    v_exp_f32 v7, v7
    v_mfma_f32_16x16x32_bf16 a[44:47], a[232:235], v[92:95], a[44:47]
    buffer_load_dwordx4 a[172:175], v228, s[4:7], s34 offen offset:3072 sc1
    s_add_u32 m0, s50, 81920
    v_mfma_f32_16x16x32_bf16 v[48:51], a[204:207], v[132:135], v[48:51]
    v_exp_f32 v20, v20
    v_mfma_f32_16x16x32_bf16 v[52:55], a[204:207], v[148:151], v[52:55]
    ds_read_b128 a[220:223], v196 offset:59840
    v_cvt_pk_bf16_f32 v69, v6, v7
    v_mfma_f32_16x16x32_bf16 v[56:59], a[204:207], v[164:167], v[56:59]
    v_exp_f32 v21, v21
    v_mfma_f32_16x16x32_bf16 v[60:63], a[204:207], v[180:183], v[60:63]
    ds_read_b64_tr_b16 a[252:253], v197 offset:42464
    v_cvt_pk_bf16_f32 v70, v20, v21
    v_mfma_f32_16x16x32_bf16 a[48:51], a[236:239], v[80:83], a[48:51]
    v_exp_f32 v22, v22
    v_mfma_f32_16x16x32_bf16 a[52:55], a[236:239], v[84:87], a[52:55]
    ds_read_b64_tr_b16 a[254:255], v197 offset:42976
    s_mov_b32 s35, 61440
    v_mfma_f32_16x16x32_bf16 a[56:59], a[236:239], v[88:91], a[56:59]
    v_exp_f32 v23, v23
    v_mfma_f32_16x16x32_bf16 a[60:63], a[236:239], v[92:95], a[60:63]
    buffer_load_dwordx4 v229, s[8:11], s35 offen offset:0 sc1 lds
    v_mfma_f32_16x16x32_bf16 v[116:119], v[192:195], v[84:87], v[116:119]
    s_waitcnt vmcnt(40) lgkmcnt(6)
    s_barrier
    v_mfma_f32_16x16x32_bf16 v[32:35], a[208:211], v[136:139], v[32:35]
    v_exp_f32 v8, v8
    v_mfma_f32_16x16x32_bf16 v[36:39], a[208:211], v[152:155], v[36:39]
    v_cvt_pk_bf16_f32 v71, v22, v23
    v_mfma_f32_16x16x32_bf16 v[40:43], a[208:211], v[168:171], v[40:43]
    v_exp_f32 v9, v9
    v_mfma_f32_16x16x32_bf16 v[44:47], a[208:211], v[184:187], v[44:47]
    ds_read_b64_tr_b16 a[224:225], v197 offset:50688
    v_cvt_pk_bf16_f32 v72, v8, v9
    v_mfma_f32_16x16x32_bf16 a[64:67], a[240:243], v[80:83], a[64:67]
    v_exp_f32 v10, v10
    v_mfma_f32_16x16x32_bf16 a[68:71], a[240:243], v[84:87], a[68:71]
    ds_read_b64_tr_b16 a[226:227], v197 offset:51200
    v_mfma_f32_16x16x32_bf16 a[72:75], a[240:243], v[88:91], a[72:75]
    v_exp_f32 v11, v11
    v_mfma_f32_16x16x32_bf16 a[76:79], a[240:243], v[92:95], a[76:79]
    buffer_load_dwordx4 v229, s[8:11], s35 offen offset:1024 sc1 lds
    v_mfma_f32_16x16x32_bf16 v[48:51], a[212:215], v[136:139], v[48:51]
    v_exp_f32 v24, v24
    v_mfma_f32_16x16x32_bf16 v[52:55], a[212:215], v[152:155], v[52:55]
    v_cvt_pk_bf16_f32 v73, v10, v11
    v_mfma_f32_16x16x32_bf16 v[56:59], a[212:215], v[168:171], v[56:59]
    v_exp_f32 v25, v25
    v_mfma_f32_16x16x32_bf16 v[60:63], a[212:215], v[184:187], v[60:63]
    ds_read_b64_tr_b16 a[228:229], v197 offset:50720
    v_cvt_pk_bf16_f32 v74, v24, v25
    v_mfma_f32_16x16x32_bf16 a[80:83], a[244:247], v[80:83], a[80:83]
    v_exp_f32 v26, v26
    v_mfma_f32_16x16x32_bf16 a[84:87], a[244:247], v[84:87], a[84:87]
    ds_read_b64_tr_b16 a[230:231], v197 offset:51232
    v_mfma_f32_16x16x32_bf16 a[88:91], a[244:247], v[88:91], a[88:91]
    v_exp_f32 v27, v27
    v_mfma_f32_16x16x32_bf16 a[92:95], a[244:247], v[92:95], a[92:95]
    buffer_load_dwordx4 v229, s[8:11], s35 offen offset:2048 sc1 lds
    v_mfma_f32_16x16x32_bf16 v[120:123], v[192:195], v[88:91], v[120:123]
    buffer_load_dwordx4 v229, s[8:11], s35 offen offset:3072 sc1 lds
    s_add_u32 m0, s50, 86016
    s_waitcnt lgkmcnt(4)
    v_mfma_f32_16x16x32_bf16 v[32:35], a[216:219], v[140:143], v[32:35]
    v_exp_f32 v12, v12
    v_mfma_f32_16x16x32_bf16 v[36:39], a[216:219], v[156:159], v[36:39]
    v_cvt_pk_bf16_f32 v75, v26, v27
    v_mfma_f32_16x16x32_bf16 v[40:43], a[216:219], v[172:175], v[40:43]
    v_exp_f32 v13, v13
    v_mfma_f32_16x16x32_bf16 v[44:47], a[216:219], v[188:191], v[44:47]
    ds_read_b64_tr_b16 a[232:233], v197 offset:50752
    v_cvt_pk_bf16_f32 v76, v12, v13
    v_mfma_f32_16x16x32_bf16 a[96:99], a[248:251], v[80:83], a[96:99]
    v_exp_f32 v14, v14
    v_mfma_f32_16x16x32_bf16 a[100:103], a[248:251], v[84:87], a[100:103]
    ds_read_b64_tr_b16 a[234:235], v197 offset:51264
    v_mfma_f32_16x16x32_bf16 a[104:107], a[248:251], v[88:91], a[104:107]
    v_exp_f32 v15, v15
    v_mfma_f32_16x16x32_bf16 a[108:111], a[248:251], v[92:95], a[108:111]
    buffer_load_dwordx4 v230, s[8:11], s35 offen sc1 lds
    s_mov_b32 s34, 49152
    v_mfma_f32_16x16x32_bf16 v[48:51], a[220:223], v[140:143], v[48:51]
    v_exp_f32 v28, v28
    v_mfma_f32_16x16x32_bf16 v[52:55], a[220:223], v[156:159], v[52:55]
    v_cvt_pk_bf16_f32 v77, v14, v15
    v_mfma_f32_16x16x32_bf16 v[56:59], a[220:223], v[172:175], v[56:59]
    v_exp_f32 v29, v29
    v_mfma_f32_16x16x32_bf16 v[60:63], a[220:223], v[188:191], v[60:63]
    ds_read_b64_tr_b16 a[236:237], v197 offset:50784
    v_cvt_pk_bf16_f32 v78, v28, v29
    v_mfma_f32_16x16x32_bf16 a[112:115], a[252:255], v[80:83], a[112:115]
    v_exp_f32 v30, v30
    v_mfma_f32_16x16x32_bf16 a[116:119], a[252:255], v[84:87], a[116:119]
    ds_read_b64_tr_b16 a[238:239], v197 offset:51296
    v_mfma_f32_16x16x32_bf16 a[120:123], a[252:255], v[88:91], a[120:123]
    v_exp_f32 v31, v31
    v_mfma_f32_16x16x32_bf16 a[124:127], a[252:255], v[92:95], a[124:127]
    buffer_load_dwordx4 a[176:179], v228, s[4:7], s34 offen offset:0 sc1
    v_mfma_f32_16x16x32_bf16 v[124:127], v[192:195], v[92:95], v[124:127]
    s_waitcnt lgkmcnt(4)
    v_mfma_f32_16x16x32_bf16 a[0:3], a[224:227], v[64:67], a[0:3]
    v_exp_f32 v32, v32
    v_cvt_pk_bf16_f32 v79, v30, v31
    v_mfma_f32_16x16x32_bf16 a[4:7], a[224:227], v[68:71], a[4:7]
    v_exp_f32 v33, v33
    ds_read_b64_tr_b16 a[240:241], v197 offset:50816
    v_mfma_f32_16x16x32_bf16 a[8:11], a[224:227], v[72:75], a[8:11]
    v_exp_f32 v34, v34
    v_cvt_pk_bf16_f32 v80, v32, v33
    ds_read_b64_tr_b16 a[242:243], v197 offset:51328
    v_mfma_f32_16x16x32_bf16 a[12:15], a[224:227], v[76:79], a[12:15]
    v_exp_f32 v35, v35
    v_mfma_f32_16x16x32_bf16 a[16:19], a[228:231], v[64:67], a[16:19]
    v_exp_f32 v48, v48
    v_cvt_pk_bf16_f32 v81, v34, v35
    v_mfma_f32_16x16x32_bf16 a[20:23], a[228:231], v[68:71], a[20:23]
    v_exp_f32 v49, v49
    ds_read_b64_tr_b16 a[244:245], v197 offset:50848
    v_mfma_f32_16x16x32_bf16 a[24:27], a[228:231], v[72:75], a[24:27]
    v_exp_f32 v50, v50
    v_cvt_pk_bf16_f32 v82, v48, v49
    ds_read_b64_tr_b16 a[246:247], v197 offset:51360
    v_mfma_f32_16x16x32_bf16 a[28:31], a[228:231], v[76:79], a[28:31]
    v_exp_f32 v51, v51
    v_mfma_f32_16x16x32_bf16 v[112:115], v[192:195], v[64:67], v[112:115]
    buffer_load_dwordx4 a[180:183], v228, s[4:7], s34 offen offset:1024 sc1
    s_waitcnt lgkmcnt(4)
    v_mfma_f32_16x16x32_bf16 a[32:35], a[232:235], v[64:67], a[32:35]
    v_exp_f32 v36, v36
    v_cvt_pk_bf16_f32 v83, v50, v51
    v_mfma_f32_16x16x32_bf16 a[36:39], a[232:235], v[68:71], a[36:39]
    v_exp_f32 v37, v37
    ds_read_b64_tr_b16 a[248:249], v197 offset:50880
    v_mfma_f32_16x16x32_bf16 a[40:43], a[232:235], v[72:75], a[40:43]
    v_exp_f32 v38, v38
    v_cvt_pk_bf16_f32 v84, v36, v37
    ds_read_b64_tr_b16 a[250:251], v197 offset:51392
    v_mfma_f32_16x16x32_bf16 a[44:47], a[232:235], v[76:79], a[44:47]
    v_exp_f32 v39, v39
    v_mfma_f32_16x16x32_bf16 a[48:51], a[236:239], v[64:67], a[48:51]
    v_exp_f32 v52, v52
    v_cvt_pk_bf16_f32 v85, v38, v39
    v_mfma_f32_16x16x32_bf16 a[52:55], a[236:239], v[68:71], a[52:55]
    v_exp_f32 v53, v53
    ds_read_b64_tr_b16 a[252:253], v197 offset:50912
    v_mfma_f32_16x16x32_bf16 a[56:59], a[236:239], v[72:75], a[56:59]
    v_exp_f32 v54, v54
    v_cvt_pk_bf16_f32 v86, v52, v53
    ds_read_b64_tr_b16 a[254:255], v197 offset:51424
    v_mfma_f32_16x16x32_bf16 a[60:63], a[236:239], v[76:79], a[60:63]
    v_exp_f32 v55, v55
    v_mfma_f32_16x16x32_bf16 v[116:119], v[192:195], v[68:71], v[116:119]
    s_waitcnt vmcnt(39) lgkmcnt(4)
    s_barrier
    v_mfma_f32_16x16x32_bf16 a[64:67], a[240:243], v[64:67], a[64:67]
    v_exp_f32 v40, v40
    v_cvt_pk_bf16_f32 v87, v54, v55
    v_mfma_f32_16x16x32_bf16 a[68:71], a[240:243], v[68:71], a[68:71]
    v_exp_f32 v41, v41
    ds_read_b64_tr_b16 a[224:225], v197 offset:59136
    v_mfma_f32_16x16x32_bf16 a[72:75], a[240:243], v[72:75], a[72:75]
    v_exp_f32 v42, v42
    v_cvt_pk_bf16_f32 v88, v40, v41
    ds_read_b64_tr_b16 a[226:227], v197 offset:59648
    v_mfma_f32_16x16x32_bf16 a[76:79], a[240:243], v[76:79], a[76:79]
    v_exp_f32 v43, v43
    v_mfma_f32_16x16x32_bf16 a[80:83], a[244:247], v[64:67], a[80:83]
    v_exp_f32 v56, v56
    v_cvt_pk_bf16_f32 v89, v42, v43
    v_mfma_f32_16x16x32_bf16 a[84:87], a[244:247], v[68:71], a[84:87]
    v_exp_f32 v57, v57
    ds_read_b64_tr_b16 a[228:229], v197 offset:59168
    v_mfma_f32_16x16x32_bf16 a[88:91], a[244:247], v[72:75], a[88:91]
    v_exp_f32 v58, v58
    v_cvt_pk_bf16_f32 v90, v56, v57
    ds_read_b64_tr_b16 a[230:231], v197 offset:59680
    v_mfma_f32_16x16x32_bf16 a[92:95], a[244:247], v[76:79], a[92:95]
    v_exp_f32 v59, v59
    v_mfma_f32_16x16x32_bf16 v[120:123], v[192:195], v[72:75], v[120:123]
    buffer_load_dwordx4 a[184:187], v228, s[4:7], s34 offen offset:2048 sc1
    s_waitcnt lgkmcnt(4)
    v_mfma_f32_16x16x32_bf16 a[96:99], a[248:251], v[64:67], a[96:99]
    v_exp_f32 v44, v44
    v_cvt_pk_bf16_f32 v91, v58, v59
    v_mfma_f32_16x16x32_bf16 a[100:103], a[248:251], v[68:71], a[100:103]
    v_exp_f32 v45, v45
    ds_read_b64_tr_b16 a[232:233], v197 offset:59200
    v_mfma_f32_16x16x32_bf16 a[104:107], a[248:251], v[72:75], a[104:107]
    v_exp_f32 v46, v46
    v_cvt_pk_bf16_f32 v92, v44, v45
    ds_read_b64_tr_b16 a[234:235], v197 offset:59712
    v_mfma_f32_16x16x32_bf16 a[108:111], a[248:251], v[76:79], a[108:111]
    v_exp_f32 v47, v47
    v_mfma_f32_16x16x32_bf16 a[112:115], a[252:255], v[64:67], a[112:115]
    v_exp_f32 v60, v60
    v_cvt_pk_bf16_f32 v93, v46, v47
    v_mfma_f32_16x16x32_bf16 a[116:119], a[252:255], v[68:71], a[116:119]
    v_exp_f32 v61, v61
    ds_read_b64_tr_b16 a[236:237], v197 offset:59232
    v_mfma_f32_16x16x32_bf16 a[120:123], a[252:255], v[72:75], a[120:123]
    v_exp_f32 v62, v62
    v_cvt_pk_bf16_f32 v94, v60, v61
    ds_read_b64_tr_b16 a[238:239], v197 offset:59744
    v_mfma_f32_16x16x32_bf16 a[124:127], a[252:255], v[76:79], a[124:127]
    v_exp_f32 v63, v63
    v_mfma_f32_16x16x32_bf16 v[124:127], v[192:195], v[76:79], v[124:127]
    ds_read_b64_tr_b16 a[240:241], v197 offset:59264
    ds_read_b64_tr_b16 a[242:243], v197 offset:59776
    ds_read_b64_tr_b16 a[244:245], v197 offset:59296
    ds_read_b64_tr_b16 a[246:247], v197 offset:59808
    ds_read_b64_tr_b16 a[248:249], v197 offset:59328
    ds_read_b64_tr_b16 a[250:251], v197 offset:59840
    ds_read_b64_tr_b16 a[252:253], v197 offset:59360
    ds_read_b64_tr_b16 a[254:255], v197 offset:59872
    v_cvt_pk_bf16_f32 v95, v62, v63
    s_waitcnt lgkmcnt(14)
    v_mfma_f32_16x16x32_bf16 a[0:3], a[224:227], v[80:83], a[0:3]
    buffer_load_dwordx4 a[188:191], v228, s[4:7], s34 offen offset:3072 sc1
    v_mfma_f32_16x16x32_bf16 a[4:7], a[224:227], v[84:87], a[4:7]
    v_mfma_f32_16x16x32_bf16 a[8:11], a[224:227], v[88:91], a[8:11]
    ds_read_b128 a[192:195], v233 offset:20480
    v_mfma_f32_16x16x32_bf16 a[12:15], a[224:227], v[92:95], a[12:15]
    ds_read_b128 a[196:199], v233 offset:21504
    s_add_u32 m0, s50, 40960
    v_mfma_f32_16x16x32_bf16 v[112:115], v[192:195], v[80:83], v[112:115]
    ds_read_b128 a[200:203], v233 offset:22528
    s_mov_b32 s35, 81920
    v_mfma_f32_16x16x32_bf16 v[116:119], v[192:195], v[84:87], v[116:119]
    ds_read_b128 a[204:207], v233 offset:23552
    buffer_load_dwordx4 v229, s[8:11], s35 offen offset:0 sc1 lds
    v_mfma_f32_16x16x32_bf16 v[120:123], v[192:195], v[88:91], v[120:123]
    ds_read_b128 a[208:211], v233 offset:24576
    v_mfma_f32_16x16x32_bf16 v[124:127], v[192:195], v[92:95], v[124:127]
    ds_read_b128 a[212:215], v236 offset:20480
    s_waitcnt lgkmcnt(15)
    v_mfma_f32_16x16x32_bf16 a[16:19], a[228:231], v[80:83], a[16:19]
    ds_read_b128 a[216:219], v236 offset:21504
    buffer_load_dwordx4 v229, s[8:11], s35 offen offset:1024 sc1 lds
    v_mfma_f32_16x16x32_bf16 a[20:23], a[228:231], v[84:87], a[20:23]
    ds_read_b128 a[220:223], v236 offset:22528
    v_mfma_f32_16x16x32_bf16 a[24:27], a[228:231], v[88:91], a[24:27]
    v_mfma_f32_16x16x32_bf16 a[28:31], a[228:231], v[92:95], a[28:31]
    buffer_load_dwordx4 v229, s[8:11], s35 offen offset:2048 sc1 lds
    v_mfma_f32_16x16x32_bf16 a[32:35], a[232:235], v[80:83], a[32:35]
    s_mov_b32 s55, 1317011456
    s_mov_b64 s[56:57], -1
    v_mfma_f32_16x16x32_bf16 a[36:39], a[232:235], v[84:87], a[36:39]
    ds_read_b128 a[224:227], v236 offset:23552
    v_mfma_f32_16x16x32_bf16 a[40:43], a[232:235], v[88:91], a[40:43]
    ds_read_b128 a[228:231], v236 offset:24576
    buffer_load_dwordx4 v229, s[8:11], s35 offen offset:3072 sc1 lds
    v_mfma_f32_16x16x32_bf16 a[44:47], a[232:235], v[92:95], a[44:47]
    s_waitcnt lgkmcnt(15)
    v_mfma_f32_16x16x32_bf16 a[48:51], a[236:239], v[80:83], a[48:51]
    v_mfma_f32_16x16x32_bf16 a[52:55], a[236:239], v[84:87], a[52:55]
    v_cmp_gt_f32 vcc, s55, v112
    s_add_u32 m0, s50, 45056
    v_mfma_f32_16x16x32_bf16 a[56:59], a[236:239], v[88:91], a[56:59]
    s_and_b64 s[56:57], s[56:57], vcc
    buffer_load_dwordx4 v230, s[8:11], s35 offen sc1 lds
    v_mfma_f32_16x16x32_bf16 a[60:63], a[236:239], v[92:95], a[60:63]
    v_cmp_gt_f32 vcc, s55, v116
    v_mfma_f32_16x16x32_bf16 a[64:67], a[240:243], v[80:83], a[64:67]
    s_and_b64 s[56:57], s[56:57], vcc
    v_mfma_f32_16x16x32_bf16 a[68:71], a[240:243], v[84:87], a[68:71]
    v_cmp_gt_f32 vcc, s55, v120
    s_add_u32 m0, s50, 61440
    v_mfma_f32_16x16x32_bf16 a[72:75], a[240:243], v[88:91], a[72:75]
    s_and_b64 s[56:57], s[56:57], vcc
    s_mov_b32 s35, 102400
    v_mfma_f32_16x16x32_bf16 a[76:79], a[240:243], v[92:95], a[76:79]
    v_cmp_gt_f32 vcc, s55, v124
    buffer_load_dwordx4 v229, s[8:11], s35 offen offset:0 sc1 lds
    s_waitcnt lgkmcnt(14)
    v_mfma_f32_16x16x32_bf16 a[80:83], a[244:247], v[80:83], a[80:83]
    s_and_b64 s[56:57], s[56:57], vcc
    v_mfma_f32_16x16x32_bf16 a[84:87], a[244:247], v[84:87], a[84:87]
    s_cmp_eq_u64 s[56:57], -1
    v_mfma_f32_16x16x32_bf16 a[88:91], a[244:247], v[88:91], a[88:91]
    s_cselect_b32 s55, 0, 1
    buffer_load_dwordx4 v229, s[8:11], s35 offen offset:1024 sc1 lds
    v_mfma_f32_16x16x32_bf16 a[92:95], a[244:247], v[92:95], a[92:95]
    s_andn2_b32 s55, s55, s28
    s_waitcnt lgkmcnt(12)
    v_mfma_f32_16x16x32_bf16 a[96:99], a[248:251], v[80:83], a[96:99]
    v_mov_b32 v220, s55
    v_mfma_f32_16x16x32_bf16 a[100:103], a[248:251], v[84:87], a[100:103]
    ds_write_b32 v207, v220
    buffer_load_dwordx4 v229, s[8:11], s35 offen offset:2048 sc1 lds
    v_mfma_f32_16x16x32_bf16 a[104:107], a[248:251], v[88:91], a[104:107]
    v_mov_b32 v221, 135168
    v_mfma_f32_16x16x32_bf16 a[108:111], a[248:251], v[92:95], a[108:111]
    v_rcp_f32 v212, v112
    s_waitcnt lgkmcnt(11)
    v_mfma_f32_16x16x32_bf16 a[112:115], a[252:255], v[80:83], a[112:115]
    v_rcp_f32 v214, v116
    buffer_load_dwordx4 v229, s[8:11], s35 offen offset:3072 sc1 lds
    v_mfma_f32_16x16x32_bf16 a[116:119], a[252:255], v[84:87], a[116:119]
    v_rcp_f32 v216, v120
    v_mfma_f32_16x16x32_bf16 a[120:123], a[252:255], v[88:91], a[120:123]
    v_rcp_f32 v218, v124
    v_mfma_f32_16x16x32_bf16 a[124:127], a[252:255], v[92:95], a[124:127]
    s_waitcnt vmcnt(44) lgkmcnt(0)
    s_barrier
    v_mfma_f32_16x16x32_bf16 v[0:3], a[192:195], a[128:131], 0
    ds_read_b128 v[224:227], v221
    s_add_u32 m0, s50, 65536
    v_accvgpr_read_b32 v112, a0
    v_accvgpr_read_b32 v113, a1
    v_accvgpr_read_b32 v114, a2
    v_accvgpr_read_b32 v115, a3
    v_mfma_f32_16x16x32_bf16 v[4:7], a[192:195], a[132:135], 0
    ds_read_b128 a[232:235], v233 offset:30720
    v_accvgpr_read_b32 v116, a16
    v_accvgpr_read_b32 v117, a17
    v_accvgpr_read_b32 v118, a18
    v_accvgpr_read_b32 v119, a19
    v_accvgpr_read_b32 v120, a4
    v_mfma_f32_16x16x32_bf16 v[8:11], a[196:199], a[128:131], 0
    ds_read_b128 a[236:239], v233 offset:31744
    v_accvgpr_read_b32 v121, a5
    v_accvgpr_read_b32 v122, a6
    v_accvgpr_read_b32 v123, a7
    v_accvgpr_read_b32 v124, a20
    v_accvgpr_read_b32 v125, a21
    v_mfma_f32_16x16x32_bf16 v[12:15], a[196:199], a[132:135], 0
    ds_read_b128 a[240:243], v233 offset:32768
    v_accvgpr_read_b32 v126, a22
    v_accvgpr_read_b32 v127, a23
    v_mul_f32 v112, v112, v212
    v_mul_f32 v113, v113, v212
    v_mul_f32 v114, v114, v212
    v_mfma_f32_16x16x32_bf16 v[16:19], a[200:203], a[128:131], 0
    ds_read_b128 a[244:247], v233 offset:33792
    v_mul_f32 v115, v115, v212
    v_mul_f32 v116, v116, v212
    v_mul_f32 v117, v117, v212
    v_mul_f32 v118, v118, v212
    v_mul_f32 v119, v119, v212
    v_mfma_f32_16x16x32_bf16 v[20:23], a[200:203], a[132:135], 0
    ds_read_b128 a[248:251], v233 offset:34816
    v_mul_f32 v120, v120, v214
    v_mul_f32 v121, v121, v214
    v_mul_f32 v122, v122, v214
    v_mul_f32 v123, v123, v214
    v_mul_f32 v124, v124, v214
    v_mfma_f32_16x16x32_bf16 v[24:27], a[204:207], a[128:131], 0
    ds_read_b128 a[252:255], v236 offset:30720
    v_mul_f32 v125, v125, v214
    v_mul_f32 v126, v126, v214
    v_mul_f32 v127, v127, v214
    v_cvt_pk_bf16_f32 v80, v112, v113
    v_cvt_pk_bf16_f32 v81, v114, v115
    v_mfma_f32_16x16x32_bf16 v[28:31], a[204:207], a[132:135], 0
    ds_read_b128 v[96:99], v236 offset:31744
    v_cvt_pk_bf16_f32 v82, v116, v117
    v_cvt_pk_bf16_f32 v83, v118, v119
    v_cvt_pk_bf16_f32 v84, v120, v121
    v_cvt_pk_bf16_f32 v85, v122, v123
    v_cvt_pk_bf16_f32 v86, v124, v125
    v_mfma_f32_16x16x32_bf16 v[32:35], a[208:211], a[128:131], 0
    ds_read_b128 v[100:103], v236 offset:32768
    v_cvt_pk_bf16_f32 v87, v126, v127
    v_accvgpr_read_b32 v112, a32
    v_accvgpr_read_b32 v113, a33
    v_accvgpr_read_b32 v114, a34
    v_accvgpr_read_b32 v115, a35
    v_mfma_f32_16x16x32_bf16 v[36:39], a[208:211], a[132:135], 0
    ds_read_b128 v[104:107], v236 offset:33792
    s_add_u32 s55, s49, 0
    buffer_store_dwordx4 v[80:83], v205, s[20:23], s55 offen offset:0 sc1
    buffer_store_dwordx4 v[84:87], v205, s[20:23], s55 offen offset:1024 sc1
    v_mfma_f32_16x16x32_bf16 v[40:43], a[212:215], a[128:131], 0
    ds_read_b128 v[108:111], v236 offset:34816
    v_accvgpr_read_b32 v116, a48
    v_accvgpr_read_b32 v117, a49
    v_accvgpr_read_b32 v118, a50
    v_accvgpr_read_b32 v119, a51
    v_accvgpr_read_b32 v120, a36
    v_mfma_f32_16x16x32_bf16 v[44:47], a[212:215], a[132:135], 0
    buffer_load_dwordx4 v230, s[8:11], s35 offen sc1 lds
    v_accvgpr_read_b32 v121, a37
    v_accvgpr_read_b32 v122, a38
    v_accvgpr_read_b32 v123, a39
    v_accvgpr_read_b32 v124, a52
    v_mfma_f32_16x16x32_bf16 v[48:51], a[216:219], a[128:131], 0
    s_waitcnt lgkmcnt(10)
    s_add_u32 m0, s50, 102400
    v_mfma_f32_16x16x32_bf16 v[52:55], a[216:219], a[132:135], 0
    v_or3_b32 v224, v224, v225, v226
    s_mov_b32 s35, 122880
    v_mfma_f32_16x16x32_bf16 v[56:59], a[220:223], a[128:131], 0
    v_or_b32 v224, v224, v227
    v_mfma_f32_16x16x32_bf16 v[60:63], a[220:223], a[132:135], 0
    s_nop 0
    v_mfma_f32_16x16x32_bf16 v[64:67], a[224:227], a[128:131], 0
    v_readfirstlane_b32 s56, v224
    v_mfma_f32_16x16x32_bf16 v[68:71], a[224:227], a[132:135], 0
    s_cmp_lg_u32 s56, 0
    v_mfma_f32_16x16x32_bf16 v[72:75], a[228:231], a[128:131], 0
    s_cbranch_scc1 K1_FB
    v_mfma_f32_16x16x32_bf16 v[76:79], a[228:231], a[132:135], 0
    buffer_load_dwordx4 v229, s[8:11], s35 offen offset:0 sc1 lds
    s_waitcnt vmcnt(33) lgkmcnt(0)
    s_barrier
    v_mfma_f32_16x16x32_bf16 v[0:3], a[232:235], a[136:139], v[0:3]
    ds_read_b128 a[192:195], v231 offset:0
    v_accvgpr_read_b32 v125, a53
    v_accvgpr_read_b32 v126, a54
    v_accvgpr_read_b32 v127, a55
    v_mul_f32 v112, v112, v212
    v_mul_f32 v113, v113, v212
    v_mfma_f32_16x16x32_bf16 v[4:7], a[232:235], a[140:143], v[4:7]
    buffer_load_dwordx4 v229, s[8:11], s35 offen offset:1024 sc1 lds
    v_mul_f32 v114, v114, v212
    v_mul_f32 v115, v115, v212
    v_mul_f32 v116, v116, v212
    v_mul_f32 v117, v117, v212
    v_mfma_f32_16x16x32_bf16 v[8:11], a[236:239], a[136:139], v[8:11]
    ds_read_b128 a[196:199], v231 offset:1024
    v_mul_f32 v118, v118, v212
    v_mul_f32 v119, v119, v212
    v_mul_f32 v120, v120, v214
    v_mul_f32 v121, v121, v214
    v_mul_f32 v122, v122, v214
    v_mfma_f32_16x16x32_bf16 v[12:15], a[236:239], a[140:143], v[12:15]
    buffer_load_dwordx4 v229, s[8:11], s35 offen offset:2048 sc1 lds
    v_mul_f32 v123, v123, v214
    v_mul_f32 v124, v124, v214
    v_mul_f32 v125, v125, v214
    v_mul_f32 v126, v126, v214
    v_mfma_f32_16x16x32_bf16 v[16:19], a[240:243], a[136:139], v[16:19]
    ds_read_b128 a[200:203], v231 offset:2048
    v_mul_f32 v127, v127, v214
    v_cvt_pk_bf16_f32 v88, v112, v113
    v_cvt_pk_bf16_f32 v89, v114, v115
    v_cvt_pk_bf16_f32 v90, v116, v117
    v_cvt_pk_bf16_f32 v91, v118, v119
    v_mfma_f32_16x16x32_bf16 v[20:23], a[240:243], a[140:143], v[20:23]
    buffer_load_dwordx4 v229, s[8:11], s35 offen offset:3072 sc1 lds
    v_cvt_pk_bf16_f32 v92, v120, v121
    v_cvt_pk_bf16_f32 v93, v122, v123
    v_cvt_pk_bf16_f32 v94, v124, v125
    v_cvt_pk_bf16_f32 v95, v126, v127
    v_mfma_f32_16x16x32_bf16 v[24:27], a[244:247], a[136:139], v[24:27]
    ds_read_b128 a[204:207], v231 offset:3072
    s_add_u32 m0, s50, 106496
    buffer_store_dwordx4 v[88:91], v205, s[20:23], s55 offen offset:2048 sc1
    buffer_store_dwordx4 v[92:95], v205, s[20:23], s55 offen offset:3072 sc1
    v_mfma_f32_16x16x32_bf16 v[28:31], a[244:247], a[140:143], v[28:31]
    buffer_load_dwordx4 v230, s[8:11], s35 offen sc1 lds
    v_accvgpr_read_b32 v112, a8
    v_accvgpr_read_b32 v113, a9
    v_accvgpr_read_b32 v114, a10
    v_accvgpr_read_b32 v115, a11
    v_mfma_f32_16x16x32_bf16 v[32:35], a[248:251], a[136:139], v[32:35]
    ds_read_b128 a[208:211], v231 offset:4096
    v_accvgpr_read_b32 v116, a24
    v_accvgpr_read_b32 v117, a25
    v_accvgpr_read_b32 v118, a26
    v_accvgpr_read_b32 v119, a27
    v_accvgpr_read_b32 v120, a12
    v_mfma_f32_16x16x32_bf16 v[36:39], a[248:251], a[140:143], v[36:39]
    v_accvgpr_read_b32 v121, a13
    v_accvgpr_read_b32 v122, a14
    v_accvgpr_read_b32 v123, a15
    v_accvgpr_read_b32 v124, a28
    v_accvgpr_read_b32 v125, a29
    v_accvgpr_read_b32 v126, a30
    v_mfma_f32_16x16x32_bf16 v[40:43], a[252:255], a[136:139], v[40:43]
    ds_read_b128 a[212:215], v234 offset:0
    v_accvgpr_read_b32 v127, a31
    v_mul_f32 v112, v112, v216
    v_mul_f32 v113, v113, v216
    v_mul_f32 v114, v114, v216
    v_mul_f32 v115, v115, v216
    v_mfma_f32_16x16x32_bf16 v[44:47], a[252:255], a[140:143], v[44:47]
    v_mul_f32 v116, v116, v216
    v_mul_f32 v117, v117, v216
    v_mul_f32 v118, v118, v216
    v_mul_f32 v119, v119, v216
    v_mul_f32 v120, v120, v218
    v_mul_f32 v121, v121, v218
    v_mfma_f32_16x16x32_bf16 v[48:51], v[96:99], a[136:139], v[48:51]
    ds_read_b128 a[216:219], v234 offset:1024
    v_mul_f32 v122, v122, v218
    v_mul_f32 v123, v123, v218
    v_mul_f32 v124, v124, v218
    v_mul_f32 v125, v125, v218
    v_mul_f32 v126, v126, v218
    v_mfma_f32_16x16x32_bf16 v[52:55], v[96:99], a[140:143], v[52:55]
    v_mul_f32 v127, v127, v218
    v_cvt_pk_bf16_f32 v80, v112, v113
    v_cvt_pk_bf16_f32 v81, v114, v115
    v_cvt_pk_bf16_f32 v82, v116, v117
    v_cvt_pk_bf16_f32 v83, v118, v119
    v_cvt_pk_bf16_f32 v84, v120, v121
    v_mfma_f32_16x16x32_bf16 v[56:59], v[100:103], a[136:139], v[56:59]
    ds_read_b128 a[220:223], v234 offset:2048
    v_cvt_pk_bf16_f32 v85, v122, v123
    v_cvt_pk_bf16_f32 v86, v124, v125
    v_cvt_pk_bf16_f32 v87, v126, v127
    v_accvgpr_read_b32 v112, a40
    v_accvgpr_read_b32 v113, a41
    v_mfma_f32_16x16x32_bf16 v[60:63], v[100:103], a[140:143], v[60:63]
    s_add_u32 s55, s49, 4096
    buffer_store_dwordx4 v[80:83], v205, s[20:23], s55 offen offset:0 sc1
    buffer_store_dwordx4 v[84:87], v205, s[20:23], s55 offen offset:1024 sc1
    v_accvgpr_read_b32 v114, a42
    v_mfma_f32_16x16x32_bf16 v[64:67], v[104:107], a[136:139], v[64:67]
    ds_read_b128 a[224:227], v234 offset:3072
    v_accvgpr_read_b32 v115, a43
    v_accvgpr_read_b32 v116, a56
    v_accvgpr_read_b32 v117, a57
    v_accvgpr_read_b32 v118, a58
    v_accvgpr_read_b32 v119, a59
    v_mfma_f32_16x16x32_bf16 v[68:71], v[104:107], a[140:143], v[68:71]
    v_accvgpr_read_b32 v120, a44
    v_accvgpr_read_b32 v121, a45
    v_accvgpr_read_b32 v122, a46
    v_accvgpr_read_b32 v123, a47
    v_accvgpr_read_b32 v124, a60
    v_accvgpr_read_b32 v125, a61
    v_mfma_f32_16x16x32_bf16 v[72:75], v[108:111], a[136:139], v[72:75]
    ds_read_b128 a[228:231], v234 offset:4096
    v_accvgpr_read_b32 v126, a62
    v_accvgpr_read_b32 v127, a63
    v_mul_f32 v112, v112, v216
    v_mul_f32 v113, v113, v216
    v_mul_f32 v114, v114, v216
    v_mfma_f32_16x16x32_bf16 v[76:79], v[108:111], a[140:143], v[76:79]
    v_mul_f32 v115, v115, v216
    v_mul_f32 v116, v116, v216
    v_mul_f32 v117, v117, v216
    v_mul_f32 v118, v118, v216
    v_mul_f32 v119, v119, v216
    v_mul_f32 v120, v120, v218
    s_waitcnt lgkmcnt(6)
    v_mfma_f32_16x16x32_bf16 v[0:3], a[192:195], a[144:147], v[0:3]
    ds_read_b128 a[232:235], v231 offset:10240
    s_mov_b32 s34, 65536
    v_mul_f32 v121, v121, v218
    v_mul_f32 v122, v122, v218
    v_mul_f32 v123, v123, v218
    v_mul_f32 v124, v124, v218
    v_mfma_f32_16x16x32_bf16 v[4:7], a[192:195], a[148:151], v[4:7]
    buffer_load_dwordx4 v[128:131], v228, s[4:7], s34 offen offset:0 sc1
    v_mul_f32 v125, v125, v218
    v_mul_f32 v126, v126, v218
    v_mul_f32 v127, v127, v218
    v_cvt_pk_bf16_f32 v88, v112, v113
    v_mfma_f32_16x16x32_bf16 v[8:11], a[196:199], a[144:147], v[8:11]
    ds_read_b128 a[236:239], v231 offset:11264
    v_cvt_pk_bf16_f32 v89, v114, v115
    v_cvt_pk_bf16_f32 v90, v116, v117
    v_cvt_pk_bf16_f32 v91, v118, v119
    v_cvt_pk_bf16_f32 v92, v120, v121
    v_cvt_pk_bf16_f32 v93, v122, v123
    v_mfma_f32_16x16x32_bf16 v[12:15], a[196:199], a[148:151], v[12:15]
    buffer_load_dwordx4 v[132:135], v228, s[4:7], s34 offen offset:1024 sc1
    v_cvt_pk_bf16_f32 v94, v124, v125
    v_cvt_pk_bf16_f32 v95, v126, v127
    v_accvgpr_read_b32 v112, a64
    v_accvgpr_read_b32 v113, a65
    v_mfma_f32_16x16x32_bf16 v[16:19], a[200:203], a[144:147], v[16:19]
    ds_read_b128 a[240:243], v231 offset:12288
    buffer_store_dwordx4 v[88:91], v205, s[20:23], s55 offen offset:2048 sc1
    buffer_store_dwordx4 v[92:95], v205, s[20:23], s55 offen offset:3072 sc1
    v_accvgpr_read_b32 v114, a66
    v_mfma_f32_16x16x32_bf16 v[20:23], a[200:203], a[148:151], v[20:23]
    buffer_load_dwordx4 v[136:139], v228, s[4:7], s34 offen offset:2048 sc1
    v_accvgpr_read_b32 v115, a67
    v_accvgpr_read_b32 v116, a80
    v_accvgpr_read_b32 v117, a81
    v_accvgpr_read_b32 v118, a82
    v_mfma_f32_16x16x32_bf16 v[24:27], a[204:207], a[144:147], v[24:27]
    ds_read_b128 a[244:247], v231 offset:13312
    v_accvgpr_read_b32 v119, a83
    v_accvgpr_read_b32 v120, a68
    v_accvgpr_read_b32 v121, a69
    v_accvgpr_read_b32 v122, a70
    v_accvgpr_read_b32 v123, a71
    v_mfma_f32_16x16x32_bf16 v[28:31], a[204:207], a[148:151], v[28:31]
    buffer_load_dwordx4 v[140:143], v228, s[4:7], s34 offen offset:3072 sc1
    v_accvgpr_read_b32 v124, a84
    v_accvgpr_read_b32 v125, a85
    v_accvgpr_read_b32 v126, a86
    v_accvgpr_read_b32 v127, a87
    s_waitcnt lgkmcnt(7)
    v_mfma_f32_16x16x32_bf16 v[32:35], a[208:211], a[144:147], v[32:35]
    ds_read_b128 a[248:251], v231 offset:14336
    v_mul_f32 v112, v112, v212
    v_mul_f32 v113, v113, v212
    v_mul_f32 v114, v114, v212
    v_mul_f32 v115, v115, v212
    v_mul_f32 v116, v116, v212
    v_mfma_f32_16x16x32_bf16 v[36:39], a[208:211], a[148:151], v[36:39]
    v_mul_f32 v117, v117, v212
    v_mul_f32 v118, v118, v212
    v_mul_f32 v119, v119, v212
    v_mul_f32 v120, v120, v214
    v_mul_f32 v121, v121, v214
    v_mul_f32 v122, v122, v214
    v_mfma_f32_16x16x32_bf16 v[40:43], a[212:215], a[144:147], v[40:43]
    ds_read_b128 a[252:255], v234 offset:10240
    v_mul_f32 v123, v123, v214
    v_mul_f32 v124, v124, v214
    v_mul_f32 v125, v125, v214
    v_mul_f32 v126, v126, v214
    v_mul_f32 v127, v127, v214
    v_mfma_f32_16x16x32_bf16 v[44:47], a[212:215], a[148:151], v[44:47]
    v_cvt_pk_bf16_f32 v80, v112, v113
    v_cvt_pk_bf16_f32 v81, v114, v115
    v_cvt_pk_bf16_f32 v82, v116, v117
    v_cvt_pk_bf16_f32 v83, v118, v119
    v_cvt_pk_bf16_f32 v84, v120, v121
    v_cvt_pk_bf16_f32 v85, v122, v123
    v_mfma_f32_16x16x32_bf16 v[48:51], a[216:219], a[144:147], v[48:51]
    ds_read_b128 v[96:99], v234 offset:11264
    v_cvt_pk_bf16_f32 v86, v124, v125
    v_cvt_pk_bf16_f32 v87, v126, v127
    v_accvgpr_read_b32 v112, a96
    v_accvgpr_read_b32 v113, a97
    v_accvgpr_read_b32 v114, a98
    v_mfma_f32_16x16x32_bf16 v[52:55], a[216:219], a[148:151], v[52:55]
    s_add_u32 s55, s49, 16384
    buffer_store_dwordx4 v[80:83], v205, s[20:23], s55 offen offset:0 sc1
    buffer_store_dwordx4 v[84:87], v205, s[20:23], s55 offen offset:1024 sc1
    v_accvgpr_read_b32 v115, a99
    s_waitcnt lgkmcnt(7)
    v_mfma_f32_16x16x32_bf16 v[56:59], a[220:223], a[144:147], v[56:59]
    ds_read_b128 v[100:103], v234 offset:12288
    v_accvgpr_read_b32 v116, a112
    v_accvgpr_read_b32 v117, a113
    v_accvgpr_read_b32 v118, a114
    v_accvgpr_read_b32 v119, a115
    v_accvgpr_read_b32 v120, a100
    v_mfma_f32_16x16x32_bf16 v[60:63], a[220:223], a[148:151], v[60:63]
    v_accvgpr_read_b32 v121, a101
    v_accvgpr_read_b32 v122, a102
    v_accvgpr_read_b32 v123, a103
    v_accvgpr_read_b32 v124, a116
    v_accvgpr_read_b32 v125, a117
    v_accvgpr_read_b32 v126, a118
    v_mfma_f32_16x16x32_bf16 v[64:67], a[224:227], a[144:147], v[64:67]
    ds_read_b128 v[104:107], v234 offset:13312
    v_accvgpr_read_b32 v127, a119
    v_mul_f32 v112, v112, v212
    v_mul_f32 v113, v113, v212
    v_mul_f32 v114, v114, v212
    v_mul_f32 v115, v115, v212
    v_mfma_f32_16x16x32_bf16 v[68:71], a[224:227], a[148:151], v[68:71]
    v_mul_f32 v116, v116, v212
    v_mul_f32 v117, v117, v212
    v_mul_f32 v118, v118, v212
    v_mul_f32 v119, v119, v212
    v_mul_f32 v120, v120, v214
    v_mul_f32 v121, v121, v214
    v_mfma_f32_16x16x32_bf16 v[72:75], a[228:231], a[144:147], v[72:75]
    ds_read_b128 v[108:111], v234 offset:14336
    v_mul_f32 v122, v122, v214
    v_mul_f32 v123, v123, v214
    v_mul_f32 v124, v124, v214
    v_mul_f32 v125, v125, v214
    v_mul_f32 v126, v126, v214
    v_mfma_f32_16x16x32_bf16 v[76:79], a[228:231], a[148:151], v[76:79]
    v_mul_f32 v127, v127, v214
    v_cvt_pk_bf16_f32 v88, v112, v113
    v_cvt_pk_bf16_f32 v89, v114, v115
    v_cvt_pk_bf16_f32 v90, v116, v117
    v_cvt_pk_bf16_f32 v91, v118, v119
    v_cvt_pk_bf16_f32 v92, v120, v121
    s_waitcnt vmcnt(38) lgkmcnt(6)
    s_barrier
    v_mfma_f32_16x16x32_bf16 v[0:3], a[232:235], a[152:155], v[0:3]
    ds_read_b128 a[192:195], v231 offset:20480
    v_cvt_pk_bf16_f32 v93, v122, v123
    v_cvt_pk_bf16_f32 v94, v124, v125
    v_cvt_pk_bf16_f32 v95, v126, v127
    v_accvgpr_read_b32 v112, a72
    v_accvgpr_read_b32 v113, a73
    v_mfma_f32_16x16x32_bf16 v[4:7], a[232:235], a[156:159], v[4:7]
    buffer_store_dwordx4 v[88:91], v205, s[20:23], s55 offen offset:2048 sc1
    buffer_store_dwordx4 v[92:95], v205, s[20:23], s55 offen offset:3072 sc1
    v_accvgpr_read_b32 v114, a74
    v_accvgpr_read_b32 v115, a75
    v_mfma_f32_16x16x32_bf16 v[8:11], a[236:239], a[152:155], v[8:11]
    ds_read_b128 a[196:199], v231 offset:21504
    v_accvgpr_read_b32 v116, a88
    v_accvgpr_read_b32 v117, a89
    v_accvgpr_read_b32 v118, a90
    v_accvgpr_read_b32 v119, a91
    v_accvgpr_read_b32 v120, a76
    v_mfma_f32_16x16x32_bf16 v[12:15], a[236:239], a[156:159], v[12:15]
    v_accvgpr_read_b32 v121, a77
    v_accvgpr_read_b32 v122, a78
    v_accvgpr_read_b32 v123, a79
    v_accvgpr_read_b32 v124, a92
    v_accvgpr_read_b32 v125, a93
    v_accvgpr_read_b32 v126, a94
    v_mfma_f32_16x16x32_bf16 v[16:19], a[240:243], a[152:155], v[16:19]
    ds_read_b128 a[200:203], v231 offset:22528
    v_accvgpr_read_b32 v127, a95
    v_mul_f32 v112, v112, v216
    v_mul_f32 v113, v113, v216
    v_mul_f32 v114, v114, v216
    v_mul_f32 v115, v115, v216
    v_mfma_f32_16x16x32_bf16 v[20:23], a[240:243], a[156:159], v[20:23]
    v_mul_f32 v116, v116, v216
    v_mul_f32 v117, v117, v216
    v_mul_f32 v118, v118, v216
    v_mul_f32 v119, v119, v216
    v_mul_f32 v120, v120, v218
    v_mul_f32 v121, v121, v218
    v_mfma_f32_16x16x32_bf16 v[24:27], a[244:247], a[152:155], v[24:27]
    ds_read_b128 a[204:207], v231 offset:23552
    v_mul_f32 v122, v122, v218
    v_mul_f32 v123, v123, v218
    v_mul_f32 v124, v124, v218
    v_mul_f32 v125, v125, v218
    v_mul_f32 v126, v126, v218
    v_mfma_f32_16x16x32_bf16 v[28:31], a[244:247], a[156:159], v[28:31]
    v_mul_f32 v127, v127, v218
    v_cvt_pk_bf16_f32 v80, v112, v113
    v_cvt_pk_bf16_f32 v81, v114, v115
    v_cvt_pk_bf16_f32 v82, v116, v117
    v_cvt_pk_bf16_f32 v83, v118, v119
    v_cvt_pk_bf16_f32 v84, v120, v121
    s_waitcnt lgkmcnt(7)
    v_mfma_f32_16x16x32_bf16 v[32:35], a[248:251], a[152:155], v[32:35]
    ds_read_b128 a[208:211], v231 offset:24576
    v_cvt_pk_bf16_f32 v85, v122, v123
    v_cvt_pk_bf16_f32 v86, v124, v125
    v_cvt_pk_bf16_f32 v87, v126, v127
    v_accvgpr_read_b32 v112, a104
    v_accvgpr_read_b32 v113, a105
    v_mfma_f32_16x16x32_bf16 v[36:39], a[248:251], a[156:159], v[36:39]
    s_add_u32 s55, s49, 20480
    buffer_store_dwordx4 v[80:83], v205, s[20:23], s55 offen offset:0 sc1
    buffer_store_dwordx4 v[84:87], v205, s[20:23], s55 offen offset:1024 sc1
    v_accvgpr_read_b32 v114, a106
    v_mfma_f32_16x16x32_bf16 v[40:43], a[252:255], a[152:155], v[40:43]
    ds_read_b128 a[212:215], v234 offset:20480
    v_accvgpr_read_b32 v115, a107
    v_accvgpr_read_b32 v116, a120
    v_accvgpr_read_b32 v117, a121
    v_accvgpr_read_b32 v118, a122
    v_accvgpr_read_b32 v119, a123
    v_mfma_f32_16x16x32_bf16 v[44:47], a[252:255], a[156:159], v[44:47]
    v_accvgpr_read_b32 v120, a108
    v_accvgpr_read_b32 v121, a109
    v_accvgpr_read_b32 v122, a110
    v_accvgpr_read_b32 v123, a111
    v_accvgpr_read_b32 v124, a124
    v_accvgpr_read_b32 v125, a125
    v_mfma_f32_16x16x32_bf16 v[48:51], v[96:99], a[152:155], v[48:51]
    ds_read_b128 a[216:219], v234 offset:21504
    v_accvgpr_read_b32 v126, a126
    v_accvgpr_read_b32 v127, a127
    v_mul_f32 v112, v112, v216
    v_mul_f32 v113, v113, v216
    v_mul_f32 v114, v114, v216
    v_mfma_f32_16x16x32_bf16 v[52:55], v[96:99], a[156:159], v[52:55]
    v_mul_f32 v115, v115, v216
    v_mul_f32 v116, v116, v216
    v_mul_f32 v117, v117, v216
    v_mul_f32 v118, v118, v216
    v_mul_f32 v119, v119, v216
    v_mul_f32 v120, v120, v218
    s_waitcnt lgkmcnt(7)
    v_mfma_f32_16x16x32_bf16 v[56:59], v[100:103], a[152:155], v[56:59]
    ds_read_b128 a[220:223], v234 offset:22528
    v_mul_f32 v121, v121, v218
    v_mul_f32 v122, v122, v218
    v_mul_f32 v123, v123, v218
    v_mul_f32 v124, v124, v218
    v_mul_f32 v125, v125, v218
    v_mfma_f32_16x16x32_bf16 v[60:63], v[100:103], a[156:159], v[60:63]
    v_mul_f32 v126, v126, v218
    v_mul_f32 v127, v127, v218
    v_cvt_pk_bf16_f32 v88, v112, v113
    v_cvt_pk_bf16_f32 v89, v114, v115
    v_cvt_pk_bf16_f32 v90, v116, v117
    v_cvt_pk_bf16_f32 v91, v118, v119
    v_mfma_f32_16x16x32_bf16 v[64:67], v[104:107], a[152:155], v[64:67]
    ds_read_b128 a[224:227], v234 offset:23552
    v_cvt_pk_bf16_f32 v92, v120, v121
    v_cvt_pk_bf16_f32 v93, v122, v123
    v_cvt_pk_bf16_f32 v94, v124, v125
    v_cvt_pk_bf16_f32 v95, v126, v127
    v_mfma_f32_16x16x32_bf16 v[68:71], v[104:107], a[156:159], v[68:71]
    buffer_store_dwordx4 v[88:91], v205, s[20:23], s55 offen offset:2048 sc1
    buffer_store_dwordx4 v[92:95], v205, s[20:23], s55 offen offset:3072 sc1
    v_mfma_f32_16x16x32_bf16 v[72:75], v[108:111], a[152:155], v[72:75]
    ds_read_b128 a[228:231], v234 offset:24576
    v_mfma_f32_16x16x32_bf16 v[76:79], v[108:111], a[156:159], v[76:79]
    s_waitcnt lgkmcnt(6)
    v_mfma_f32_16x16x32_bf16 v[0:3], a[192:195], a[160:163], v[0:3]
    ds_read_b128 a[232:235], v231 offset:30720
    s_mov_b32 s34, 81920
    v_mfma_f32_16x16x32_bf16 v[4:7], a[192:195], a[164:167], v[4:7]
    buffer_load_dwordx4 v[144:147], v228, s[4:7], s34 offen offset:0 sc1
    v_mfma_f32_16x16x32_bf16 v[8:11], a[196:199], a[160:163], v[8:11]
    ds_read_b128 a[236:239], v231 offset:31744
    v_mfma_f32_16x16x32_bf16 v[12:15], a[196:199], a[164:167], v[12:15]
    buffer_load_dwordx4 v[148:151], v228, s[4:7], s34 offen offset:1024 sc1
    v_mfma_f32_16x16x32_bf16 v[16:19], a[200:203], a[160:163], v[16:19]
    ds_read_b128 a[240:243], v231 offset:32768
    v_mfma_f32_16x16x32_bf16 v[20:23], a[200:203], a[164:167], v[20:23]
    buffer_load_dwordx4 v[152:155], v228, s[4:7], s34 offen offset:2048 sc1
    v_mfma_f32_16x16x32_bf16 v[24:27], a[204:207], a[160:163], v[24:27]
    ds_read_b128 a[244:247], v231 offset:33792
    v_mfma_f32_16x16x32_bf16 v[28:31], a[204:207], a[164:167], v[28:31]
    buffer_load_dwordx4 v[156:159], v228, s[4:7], s34 offen offset:3072 sc1
    s_waitcnt lgkmcnt(7)
    v_mfma_f32_16x16x32_bf16 v[32:35], a[208:211], a[160:163], v[32:35]
    ds_read_b128 a[248:251], v231 offset:34816
    v_mfma_f32_16x16x32_bf16 v[36:39], a[208:211], a[164:167], v[36:39]
    v_mfma_f32_16x16x32_bf16 v[40:43], a[212:215], a[160:163], v[40:43]
    ds_read_b128 a[252:255], v234 offset:30720
    v_mfma_f32_16x16x32_bf16 v[44:47], a[212:215], a[164:167], v[44:47]
    v_mfma_f32_16x16x32_bf16 v[48:51], a[216:219], a[160:163], v[48:51]
    ds_read_b128 v[96:99], v234 offset:31744
    v_mfma_f32_16x16x32_bf16 v[52:55], a[216:219], a[164:167], v[52:55]
    s_waitcnt lgkmcnt(7)
    v_mfma_f32_16x16x32_bf16 v[56:59], a[220:223], a[160:163], v[56:59]
    ds_read_b128 v[100:103], v234 offset:32768
    v_mfma_f32_16x16x32_bf16 v[60:63], a[220:223], a[164:167], v[60:63]
    v_mfma_f32_16x16x32_bf16 v[64:67], a[224:227], a[160:163], v[64:67]
    ds_read_b128 v[104:107], v234 offset:33792
    v_mfma_f32_16x16x32_bf16 v[68:71], a[224:227], a[164:167], v[68:71]
    v_mfma_f32_16x16x32_bf16 v[72:75], a[228:231], a[160:163], v[72:75]
    ds_read_b128 v[108:111], v234 offset:34816
    v_mfma_f32_16x16x32_bf16 v[76:79], a[228:231], a[164:167], v[76:79]
    s_waitcnt vmcnt(4) lgkmcnt(6)
    s_barrier
    v_mfma_f32_16x16x32_bf16 v[0:3], a[232:235], a[168:171], v[0:3]
    ds_read_b128 a[192:195], v232 offset:20480
    v_mfma_f32_16x16x32_bf16 v[4:7], a[232:235], a[172:175], v[4:7]
    v_mfma_f32_16x16x32_bf16 v[8:11], a[236:239], a[168:171], v[8:11]
    ds_read_b128 a[196:199], v232 offset:21504
    v_mfma_f32_16x16x32_bf16 v[12:15], a[236:239], a[172:175], v[12:15]
    v_mfma_f32_16x16x32_bf16 v[16:19], a[240:243], a[168:171], v[16:19]
    ds_read_b128 a[200:203], v232 offset:22528
    v_mfma_f32_16x16x32_bf16 v[20:23], a[240:243], a[172:175], v[20:23]
    v_mfma_f32_16x16x32_bf16 v[24:27], a[244:247], a[168:171], v[24:27]
    ds_read_b128 a[204:207], v232 offset:23552
    v_mfma_f32_16x16x32_bf16 v[28:31], a[244:247], a[172:175], v[28:31]
    s_waitcnt lgkmcnt(7)
    v_mfma_f32_16x16x32_bf16 v[32:35], a[248:251], a[168:171], v[32:35]
    ds_read_b128 a[208:211], v232 offset:24576
    v_mfma_f32_16x16x32_bf16 v[36:39], a[248:251], a[172:175], v[36:39]
    v_mfma_f32_16x16x32_bf16 v[40:43], a[252:255], a[168:171], v[40:43]
    ds_read_b128 a[212:215], v235 offset:20480
    v_mfma_f32_16x16x32_bf16 v[44:47], a[252:255], a[172:175], v[44:47]
    v_mfma_f32_16x16x32_bf16 v[48:51], v[96:99], a[168:171], v[48:51]
    ds_read_b128 a[216:219], v235 offset:21504
    v_mfma_f32_16x16x32_bf16 v[52:55], v[96:99], a[172:175], v[52:55]
    s_waitcnt lgkmcnt(7)
    v_mfma_f32_16x16x32_bf16 v[56:59], v[100:103], a[168:171], v[56:59]
    ds_read_b128 a[220:223], v235 offset:22528
    v_mfma_f32_16x16x32_bf16 v[60:63], v[100:103], a[172:175], v[60:63]
    v_mfma_f32_16x16x32_bf16 v[64:67], v[104:107], a[168:171], v[64:67]
    ds_read_b128 a[224:227], v235 offset:23552
    v_mfma_f32_16x16x32_bf16 v[68:71], v[104:107], a[172:175], v[68:71]
    v_mfma_f32_16x16x32_bf16 v[72:75], v[108:111], a[168:171], v[72:75]
    ds_read_b128 a[228:231], v235 offset:24576
    v_mfma_f32_16x16x32_bf16 v[76:79], v[108:111], a[172:175], v[76:79]
    s_waitcnt lgkmcnt(6)
    v_mfma_f32_16x16x32_bf16 v[0:3], a[192:195], a[176:179], v[0:3]
    ds_read_b128 a[232:235], v232 offset:30720
    s_add_u32 s56, s52, 1
    v_mfma_f32_16x16x32_bf16 v[4:7], a[192:195], a[180:183], v[4:7]
    v_mov_b32 v222, s43
    s_mov_b32 s34, 98304
    v_mfma_f32_16x16x32_bf16 v[8:11], a[196:199], a[176:179], v[8:11]
    ds_read_b128 a[236:239], v232 offset:31744
    v_mov_b32 v223, s56
    v_mfma_f32_16x16x32_bf16 v[12:15], a[196:199], a[180:183], v[12:15]
    buffer_load_dwordx4 v[160:163], v228, s[4:7], s34 offen offset:0 sc1
    v_mfma_f32_16x16x32_bf16 v[16:19], a[200:203], a[176:179], v[16:19]
    ds_read_b128 a[240:243], v232 offset:32768
    v_mfma_f32_16x16x32_bf16 v[20:23], a[200:203], a[180:183], v[20:23]
    buffer_load_dwordx4 v[164:167], v228, s[4:7], s34 offen offset:1024 sc1
    v_mfma_f32_16x16x32_bf16 v[24:27], a[204:207], a[176:179], v[24:27]
    ds_read_b128 a[244:247], v232 offset:33792
    v_mfma_f32_16x16x32_bf16 v[28:31], a[204:207], a[180:183], v[28:31]
    buffer_load_dwordx4 v[168:171], v228, s[4:7], s34 offen offset:2048 sc1
    s_waitcnt lgkmcnt(7)
    v_mfma_f32_16x16x32_bf16 v[32:35], a[208:211], a[176:179], v[32:35]
    ds_read_b128 a[248:251], v232 offset:34816
    v_mfma_f32_16x16x32_bf16 v[36:39], a[208:211], a[180:183], v[36:39]
    buffer_load_dwordx4 v[172:175], v228, s[4:7], s34 offen offset:3072 sc1
    v_mfma_f32_16x16x32_bf16 v[40:43], a[212:215], a[176:179], v[40:43]
    ds_read_b128 a[252:255], v235 offset:30720
    v_mfma_f32_16x16x32_bf16 v[44:47], a[212:215], a[180:183], v[44:47]
    s_cmp_eq_u32 s40, 0
    s_cselect_b64 exec, 1, 0
    global_store_dword v222, v223, s[94:95] sc1
    s_mov_b64 exec, -1
    v_mfma_f32_16x16x32_bf16 v[48:51], a[216:219], a[176:179], v[48:51]
    ds_read_b128 v[96:99], v235 offset:31744
    v_mfma_f32_16x16x32_bf16 v[52:55], a[216:219], a[180:183], v[52:55]
    s_waitcnt lgkmcnt(7)
    v_mfma_f32_16x16x32_bf16 v[56:59], a[220:223], a[176:179], v[56:59]
    ds_read_b128 v[100:103], v235 offset:32768
    v_mfma_f32_16x16x32_bf16 v[60:63], a[220:223], a[180:183], v[60:63]
    v_mfma_f32_16x16x32_bf16 v[64:67], a[224:227], a[176:179], v[64:67]
    ds_read_b128 v[104:107], v235 offset:33792
    v_mfma_f32_16x16x32_bf16 v[68:71], a[224:227], a[180:183], v[68:71]
    v_mfma_f32_16x16x32_bf16 v[72:75], a[228:231], a[176:179], v[72:75]
    ds_read_b128 v[108:111], v235 offset:34816
    v_mfma_f32_16x16x32_bf16 v[76:79], a[228:231], a[180:183], v[76:79]
    s_waitcnt lgkmcnt(6)
    s_barrier
    v_mfma_f32_16x16x32_bf16 v[0:3], a[232:235], a[184:187], v[0:3]
    ds_read_b128 a[192:195], v231 offset:40960
    s_add_u32 m0, s50, 122880
    v_mfma_f32_16x16x32_bf16 v[4:7], a[232:235], a[188:191], v[4:7]
    s_mov_b32 s35, 143360
    v_mfma_f32_16x16x32_bf16 v[8:11], a[236:239], a[184:187], v[8:11]
    ds_read_b128 a[196:199], v231 offset:41984
    v_mfma_f32_16x16x32_bf16 v[12:15], a[236:239], a[188:191], v[12:15]
    buffer_load_dwordx4 v229, s[8:11], s35 offen offset:0 sc1 lds
    v_mfma_f32_16x16x32_bf16 v[16:19], a[240:243], a[184:187], v[16:19]
    ds_read_b128 a[200:203], v231 offset:43008
    v_mfma_f32_16x16x32_bf16 v[20:23], a[240:243], a[188:191], v[20:23]
    buffer_load_dwordx4 v229, s[8:11], s35 offen offset:1024 sc1 lds
    v_mfma_f32_16x16x32_bf16 v[24:27], a[244:247], a[184:187], v[24:27]
    ds_read_b128 a[204:207], v231 offset:44032
    v_mfma_f32_16x16x32_bf16 v[28:31], a[244:247], a[188:191], v[28:31]
    buffer_load_dwordx4 v229, s[8:11], s35 offen offset:2048 sc1 lds
    s_waitcnt lgkmcnt(7)
    v_mfma_f32_16x16x32_bf16 v[32:35], a[248:251], a[184:187], v[32:35]
    ds_read_b128 a[208:211], v231 offset:45056
    v_mfma_f32_16x16x32_bf16 v[36:39], a[248:251], a[188:191], v[36:39]
    buffer_load_dwordx4 v229, s[8:11], s35 offen offset:3072 sc1 lds
    v_mfma_f32_16x16x32_bf16 v[40:43], a[252:255], a[184:187], v[40:43]
    ds_read_b128 a[212:215], v234 offset:40960
    s_add_u32 m0, s50, 126976
    v_mfma_f32_16x16x32_bf16 v[44:47], a[252:255], a[188:191], v[44:47]
    buffer_load_dwordx4 v230, s[8:11], s35 offen sc1 lds
    v_mfma_f32_16x16x32_bf16 v[48:51], v[96:99], a[184:187], v[48:51]
    ds_read_b128 a[216:219], v234 offset:41984
    v_mfma_f32_16x16x32_bf16 v[52:55], v[96:99], a[188:191], v[52:55]
    s_waitcnt lgkmcnt(7)
    v_mfma_f32_16x16x32_bf16 v[56:59], v[100:103], a[184:187], v[56:59]
    ds_read_b128 a[220:223], v234 offset:43008
    v_mfma_f32_16x16x32_bf16 v[60:63], v[100:103], a[188:191], v[60:63]
    v_mfma_f32_16x16x32_bf16 v[64:67], v[104:107], a[184:187], v[64:67]
    ds_read_b128 a[224:227], v234 offset:44032
    v_mfma_f32_16x16x32_bf16 v[68:71], v[104:107], a[188:191], v[68:71]
    v_mfma_f32_16x16x32_bf16 v[72:75], v[108:111], a[184:187], v[72:75]
    ds_read_b128 a[228:231], v234 offset:45056
    v_mfma_f32_16x16x32_bf16 v[76:79], v[108:111], a[188:191], v[76:79]
    s_waitcnt lgkmcnt(6)
    v_mfma_f32_16x16x32_bf16 v[0:3], a[192:195], v[128:131], v[0:3]
    ds_read_b128 a[232:235], v231 offset:51200
    s_mov_b32 s34, 114688
    v_mfma_f32_16x16x32_bf16 v[4:7], a[192:195], v[132:135], v[4:7]
    buffer_load_dwordx4 v[176:179], v228, s[4:7], s34 offen offset:0 sc1
    v_mfma_f32_16x16x32_bf16 v[8:11], a[196:199], v[128:131], v[8:11]
    ds_read_b128 a[236:239], v231 offset:52224
    v_mfma_f32_16x16x32_bf16 v[12:15], a[196:199], v[132:135], v[12:15]
    buffer_load_dwordx4 v[180:183], v228, s[4:7], s34 offen offset:1024 sc1
    v_mfma_f32_16x16x32_bf16 v[16:19], a[200:203], v[128:131], v[16:19]
    ds_read_b128 a[240:243], v231 offset:53248
    v_mfma_f32_16x16x32_bf16 v[20:23], a[200:203], v[132:135], v[20:23]
    buffer_load_dwordx4 v[184:187], v228, s[4:7], s34 offen offset:2048 sc1
    v_mfma_f32_16x16x32_bf16 v[24:27], a[204:207], v[128:131], v[24:27]
    ds_read_b128 a[244:247], v231 offset:54272
    v_mfma_f32_16x16x32_bf16 v[28:31], a[204:207], v[132:135], v[28:31]
    buffer_load_dwordx4 v[188:191], v228, s[4:7], s34 offen offset:3072 sc1
    s_waitcnt lgkmcnt(7)
    v_mfma_f32_16x16x32_bf16 v[32:35], a[208:211], v[128:131], v[32:35]
    ds_read_b128 a[248:251], v231 offset:55296
    v_mfma_f32_16x16x32_bf16 v[36:39], a[208:211], v[132:135], v[36:39]
    v_mfma_f32_16x16x32_bf16 v[40:43], a[212:215], v[128:131], v[40:43]
    ds_read_b128 a[252:255], v234 offset:51200
    v_mfma_f32_16x16x32_bf16 v[44:47], a[212:215], v[132:135], v[44:47]
    v_mfma_f32_16x16x32_bf16 v[48:51], a[216:219], v[128:131], v[48:51]
    ds_read_b128 v[96:99], v234 offset:52224
    v_mfma_f32_16x16x32_bf16 v[52:55], a[216:219], v[132:135], v[52:55]
    s_waitcnt lgkmcnt(7)
    v_mfma_f32_16x16x32_bf16 v[56:59], a[220:223], v[128:131], v[56:59]
    ds_read_b128 v[100:103], v234 offset:53248
    v_mfma_f32_16x16x32_bf16 v[60:63], a[220:223], v[132:135], v[60:63]
    v_mfma_f32_16x16x32_bf16 v[64:67], a[224:227], v[128:131], v[64:67]
    ds_read_b128 v[104:107], v234 offset:54272
    v_mfma_f32_16x16x32_bf16 v[68:71], a[224:227], v[132:135], v[68:71]
    v_mfma_f32_16x16x32_bf16 v[72:75], a[228:231], v[128:131], v[72:75]
    ds_read_b128 v[108:111], v234 offset:55296
    v_mfma_f32_16x16x32_bf16 v[76:79], a[228:231], v[132:135], v[76:79]
    s_waitcnt vmcnt(13) lgkmcnt(6)
    s_barrier
    v_mfma_f32_16x16x32_bf16 v[0:3], a[232:235], v[136:139], v[0:3]
    ds_read_b128 a[192:195], v232 offset:0
    s_add_u32 m0, s50, 143360
    v_mfma_f32_16x16x32_bf16 v[4:7], a[232:235], v[140:143], v[4:7]
    s_mov_b32 s35, 163840
    v_mfma_f32_16x16x32_bf16 v[8:11], a[236:239], v[136:139], v[8:11]
    ds_read_b128 a[196:199], v232 offset:1024
    v_mfma_f32_16x16x32_bf16 v[12:15], a[236:239], v[140:143], v[12:15]
    buffer_load_dwordx4 v229, s[8:11], s35 offen offset:0 sc1 lds
    v_mfma_f32_16x16x32_bf16 v[16:19], a[240:243], v[136:139], v[16:19]
    ds_read_b128 a[200:203], v232 offset:2048
    v_mfma_f32_16x16x32_bf16 v[20:23], a[240:243], v[140:143], v[20:23]
    buffer_load_dwordx4 v229, s[8:11], s35 offen offset:1024 sc1 lds
    v_mfma_f32_16x16x32_bf16 v[24:27], a[244:247], v[136:139], v[24:27]
    ds_read_b128 a[204:207], v232 offset:3072
    v_mfma_f32_16x16x32_bf16 v[28:31], a[244:247], v[140:143], v[28:31]
    buffer_load_dwordx4 v229, s[8:11], s35 offen offset:2048 sc1 lds
    s_waitcnt lgkmcnt(7)
    v_mfma_f32_16x16x32_bf16 v[32:35], a[248:251], v[136:139], v[32:35]
    ds_read_b128 a[208:211], v232 offset:4096
    v_mfma_f32_16x16x32_bf16 v[36:39], a[248:251], v[140:143], v[36:39]
    buffer_load_dwordx4 v229, s[8:11], s35 offen offset:3072 sc1 lds
    v_mfma_f32_16x16x32_bf16 v[40:43], a[252:255], v[136:139], v[40:43]
    ds_read_b128 a[212:215], v235 offset:0
    s_add_u32 m0, s50, 147456
    v_mfma_f32_16x16x32_bf16 v[44:47], a[252:255], v[140:143], v[44:47]
    buffer_load_dwordx4 v230, s[8:11], s35 offen sc1 lds
    v_mfma_f32_16x16x32_bf16 v[48:51], v[96:99], v[136:139], v[48:51]
    ds_read_b128 a[216:219], v235 offset:1024
    v_mfma_f32_16x16x32_bf16 v[52:55], v[96:99], v[140:143], v[52:55]
    s_waitcnt lgkmcnt(7)
    v_mfma_f32_16x16x32_bf16 v[56:59], v[100:103], v[136:139], v[56:59]
    ds_read_b128 a[220:223], v235 offset:2048
    v_mfma_f32_16x16x32_bf16 v[60:63], v[100:103], v[140:143], v[60:63]
    v_mfma_f32_16x16x32_bf16 v[64:67], v[104:107], v[136:139], v[64:67]
    ds_read_b128 a[224:227], v235 offset:3072
    v_mfma_f32_16x16x32_bf16 v[68:71], v[104:107], v[140:143], v[68:71]
    v_mfma_f32_16x16x32_bf16 v[72:75], v[108:111], v[136:139], v[72:75]
    ds_read_b128 a[228:231], v235 offset:4096
    v_mfma_f32_16x16x32_bf16 v[76:79], v[108:111], v[140:143], v[76:79]
    s_waitcnt lgkmcnt(6)
    v_mfma_f32_16x16x32_bf16 v[0:3], a[192:195], v[144:147], v[0:3]
    ds_read_b128 a[232:235], v232 offset:10240
    s_mov_b32 s34, 131072
    v_mfma_f32_16x16x32_bf16 v[4:7], a[192:195], v[148:151], v[4:7]
    buffer_load_dwordx4 a[128:131], v228, s[4:7], s34 offen offset:0 sc1
    v_mfma_f32_16x16x32_bf16 v[8:11], a[196:199], v[144:147], v[8:11]
    ds_read_b128 a[236:239], v232 offset:11264
    v_mfma_f32_16x16x32_bf16 v[12:15], a[196:199], v[148:151], v[12:15]
    buffer_load_dwordx4 a[132:135], v228, s[4:7], s34 offen offset:1024 sc1
    v_mfma_f32_16x16x32_bf16 v[16:19], a[200:203], v[144:147], v[16:19]
    ds_read_b128 a[240:243], v232 offset:12288
    v_mfma_f32_16x16x32_bf16 v[20:23], a[200:203], v[148:151], v[20:23]
    buffer_load_dwordx4 a[136:139], v228, s[4:7], s34 offen offset:2048 sc1
    v_mfma_f32_16x16x32_bf16 v[24:27], a[204:207], v[144:147], v[24:27]
    ds_read_b128 a[244:247], v232 offset:13312
    v_mfma_f32_16x16x32_bf16 v[28:31], a[204:207], v[148:151], v[28:31]
    buffer_load_dwordx4 a[140:143], v228, s[4:7], s34 offen offset:3072 sc1
    s_waitcnt lgkmcnt(7)
    v_mfma_f32_16x16x32_bf16 v[32:35], a[208:211], v[144:147], v[32:35]
    ds_read_b128 a[248:251], v232 offset:14336
    v_mfma_f32_16x16x32_bf16 v[36:39], a[208:211], v[148:151], v[36:39]
    v_mfma_f32_16x16x32_bf16 v[40:43], a[212:215], v[144:147], v[40:43]
    ds_read_b128 a[252:255], v235 offset:10240
    v_mfma_f32_16x16x32_bf16 v[44:47], a[212:215], v[148:151], v[44:47]
    v_mfma_f32_16x16x32_bf16 v[48:51], a[216:219], v[144:147], v[48:51]
    ds_read_b128 v[96:99], v235 offset:11264
    v_mfma_f32_16x16x32_bf16 v[52:55], a[216:219], v[148:151], v[52:55]
    s_waitcnt lgkmcnt(7)
    v_mfma_f32_16x16x32_bf16 v[56:59], a[220:223], v[144:147], v[56:59]
    ds_read_b128 v[100:103], v235 offset:12288
    v_mfma_f32_16x16x32_bf16 v[60:63], a[220:223], v[148:151], v[60:63]
    v_mfma_f32_16x16x32_bf16 v[64:67], a[224:227], v[144:147], v[64:67]
    ds_read_b128 v[104:107], v235 offset:13312
    v_mfma_f32_16x16x32_bf16 v[68:71], a[224:227], v[148:151], v[68:71]
    v_mfma_f32_16x16x32_bf16 v[72:75], a[228:231], v[144:147], v[72:75]
    ds_read_b128 v[108:111], v235 offset:14336
    v_mfma_f32_16x16x32_bf16 v[76:79], a[228:231], v[148:151], v[76:79]
    s_waitcnt vmcnt(18) lgkmcnt(6)
    s_barrier
    v_mfma_f32_16x16x32_bf16 v[0:3], a[232:235], v[152:155], v[0:3]
    ds_read_b128 a[192:195], v232 offset:40960
    s_add_u32 m0, s50, 0
    v_mfma_f32_16x16x32_bf16 v[4:7], a[232:235], v[156:159], v[4:7]
    s_mov_b32 s35, 184320
    v_mfma_f32_16x16x32_bf16 v[8:11], a[236:239], v[152:155], v[8:11]
    ds_read_b128 a[196:199], v232 offset:41984
    v_mfma_f32_16x16x32_bf16 v[12:15], a[236:239], v[156:159], v[12:15]
    buffer_load_dwordx4 v229, s[8:11], s35 offen offset:0 sc1 lds
    v_mfma_f32_16x16x32_bf16 v[16:19], a[240:243], v[152:155], v[16:19]
    ds_read_b128 a[200:203], v232 offset:43008
    v_mfma_f32_16x16x32_bf16 v[20:23], a[240:243], v[156:159], v[20:23]
    buffer_load_dwordx4 v229, s[8:11], s35 offen offset:1024 sc1 lds
    v_mfma_f32_16x16x32_bf16 v[24:27], a[244:247], v[152:155], v[24:27]
    ds_read_b128 a[204:207], v232 offset:44032
    v_mfma_f32_16x16x32_bf16 v[28:31], a[244:247], v[156:159], v[28:31]
    buffer_load_dwordx4 v229, s[8:11], s35 offen offset:2048 sc1 lds
    s_waitcnt lgkmcnt(7)
    v_mfma_f32_16x16x32_bf16 v[32:35], a[248:251], v[152:155], v[32:35]
    ds_read_b128 a[208:211], v232 offset:45056
    v_mfma_f32_16x16x32_bf16 v[36:39], a[248:251], v[156:159], v[36:39]
    buffer_load_dwordx4 v229, s[8:11], s35 offen offset:3072 sc1 lds
    v_mfma_f32_16x16x32_bf16 v[40:43], a[252:255], v[152:155], v[40:43]
    ds_read_b128 a[212:215], v235 offset:40960
    s_add_u32 m0, s50, 4096
    v_mfma_f32_16x16x32_bf16 v[44:47], a[252:255], v[156:159], v[44:47]
    buffer_load_dwordx4 v230, s[8:11], s35 offen sc1 lds
    v_mfma_f32_16x16x32_bf16 v[48:51], v[96:99], v[152:155], v[48:51]
    ds_read_b128 a[216:219], v235 offset:41984
    v_mfma_f32_16x16x32_bf16 v[52:55], v[96:99], v[156:159], v[52:55]
    s_waitcnt lgkmcnt(7)
    v_mfma_f32_16x16x32_bf16 v[56:59], v[100:103], v[152:155], v[56:59]
    ds_read_b128 a[220:223], v235 offset:43008
    v_mfma_f32_16x16x32_bf16 v[60:63], v[100:103], v[156:159], v[60:63]
    v_mfma_f32_16x16x32_bf16 v[64:67], v[104:107], v[152:155], v[64:67]
    ds_read_b128 a[224:227], v235 offset:44032
    v_mfma_f32_16x16x32_bf16 v[68:71], v[104:107], v[156:159], v[68:71]
    v_mfma_f32_16x16x32_bf16 v[72:75], v[108:111], v[152:155], v[72:75]
    ds_read_b128 a[228:231], v235 offset:45056
    v_mfma_f32_16x16x32_bf16 v[76:79], v[108:111], v[156:159], v[76:79]
    s_waitcnt lgkmcnt(6)
    v_mfma_f32_16x16x32_bf16 v[0:3], a[192:195], v[160:163], v[0:3]
    ds_read_b128 a[232:235], v232 offset:51200
    s_mov_b32 s34, 147456
    v_mfma_f32_16x16x32_bf16 v[4:7], a[192:195], v[164:167], v[4:7]
    buffer_load_dwordx4 a[144:147], v228, s[4:7], s34 offen offset:0 sc1
    v_mfma_f32_16x16x32_bf16 v[8:11], a[196:199], v[160:163], v[8:11]
    ds_read_b128 a[236:239], v232 offset:52224
    v_mfma_f32_16x16x32_bf16 v[12:15], a[196:199], v[164:167], v[12:15]
    buffer_load_dwordx4 a[148:151], v228, s[4:7], s34 offen offset:1024 sc1
    v_mfma_f32_16x16x32_bf16 v[16:19], a[200:203], v[160:163], v[16:19]
    ds_read_b128 a[240:243], v232 offset:53248
    v_mfma_f32_16x16x32_bf16 v[20:23], a[200:203], v[164:167], v[20:23]
    buffer_load_dwordx4 a[152:155], v228, s[4:7], s34 offen offset:2048 sc1
    v_mfma_f32_16x16x32_bf16 v[24:27], a[204:207], v[160:163], v[24:27]
    ds_read_b128 a[244:247], v232 offset:54272
    v_mfma_f32_16x16x32_bf16 v[28:31], a[204:207], v[164:167], v[28:31]
    buffer_load_dwordx4 a[156:159], v228, s[4:7], s34 offen offset:3072 sc1
    s_waitcnt lgkmcnt(7)
    v_mfma_f32_16x16x32_bf16 v[32:35], a[208:211], v[160:163], v[32:35]
    ds_read_b128 a[248:251], v232 offset:55296
    v_mfma_f32_16x16x32_bf16 v[36:39], a[208:211], v[164:167], v[36:39]
    v_mfma_f32_16x16x32_bf16 v[40:43], a[212:215], v[160:163], v[40:43]
    ds_read_b128 a[252:255], v235 offset:51200
    v_mfma_f32_16x16x32_bf16 v[44:47], a[212:215], v[164:167], v[44:47]
    v_mfma_f32_16x16x32_bf16 v[48:51], a[216:219], v[160:163], v[48:51]
    ds_read_b128 v[96:99], v235 offset:52224
    v_mfma_f32_16x16x32_bf16 v[52:55], a[216:219], v[164:167], v[52:55]
    s_waitcnt lgkmcnt(7)
    v_mfma_f32_16x16x32_bf16 v[56:59], a[220:223], v[160:163], v[56:59]
    ds_read_b128 v[100:103], v235 offset:53248
    v_mfma_f32_16x16x32_bf16 v[60:63], a[220:223], v[164:167], v[60:63]
    v_mfma_f32_16x16x32_bf16 v[64:67], a[224:227], v[160:163], v[64:67]
    ds_read_b128 v[104:107], v235 offset:54272
    v_mfma_f32_16x16x32_bf16 v[68:71], a[224:227], v[164:167], v[68:71]
    v_mfma_f32_16x16x32_bf16 v[72:75], a[228:231], v[160:163], v[72:75]
    ds_read_b128 v[108:111], v235 offset:55296
    v_mfma_f32_16x16x32_bf16 v[76:79], a[228:231], v[164:167], v[76:79]
    s_waitcnt vmcnt(18) lgkmcnt(6)
    s_barrier
    v_mfma_f32_16x16x32_bf16 v[0:3], a[232:235], v[168:171], v[0:3]
    ds_read_b128 a[192:195], v233 offset:0
    s_add_u32 m0, s50, 20480
    v_mfma_f32_16x16x32_bf16 v[4:7], a[232:235], v[172:175], v[4:7]
    s_mov_b32 s35, 204800
    v_mfma_f32_16x16x32_bf16 v[8:11], a[236:239], v[168:171], v[8:11]
    ds_read_b128 a[196:199], v233 offset:1024
    v_mfma_f32_16x16x32_bf16 v[12:15], a[236:239], v[172:175], v[12:15]
    buffer_load_dwordx4 v229, s[8:11], s35 offen offset:0 sc1 lds
    v_mfma_f32_16x16x32_bf16 v[16:19], a[240:243], v[168:171], v[16:19]
    ds_read_b128 a[200:203], v233 offset:2048
    v_mfma_f32_16x16x32_bf16 v[20:23], a[240:243], v[172:175], v[20:23]
    buffer_load_dwordx4 v229, s[8:11], s35 offen offset:1024 sc1 lds
    v_mfma_f32_16x16x32_bf16 v[24:27], a[244:247], v[168:171], v[24:27]
    ds_read_b128 a[204:207], v233 offset:3072
    v_mfma_f32_16x16x32_bf16 v[28:31], a[244:247], v[172:175], v[28:31]
    buffer_load_dwordx4 v229, s[8:11], s35 offen offset:2048 sc1 lds
    s_waitcnt lgkmcnt(7)
    v_mfma_f32_16x16x32_bf16 v[32:35], a[248:251], v[168:171], v[32:35]
    ds_read_b128 a[208:211], v233 offset:4096
    v_mfma_f32_16x16x32_bf16 v[36:39], a[248:251], v[172:175], v[36:39]
    buffer_load_dwordx4 v229, s[8:11], s35 offen offset:3072 sc1 lds
    v_mfma_f32_16x16x32_bf16 v[40:43], a[252:255], v[168:171], v[40:43]
    ds_read_b128 a[212:215], v236 offset:0
    s_add_u32 m0, s50, 24576
    v_mfma_f32_16x16x32_bf16 v[44:47], a[252:255], v[172:175], v[44:47]
    buffer_load_dwordx4 v230, s[8:11], s35 offen sc1 lds
    v_mfma_f32_16x16x32_bf16 v[48:51], v[96:99], v[168:171], v[48:51]
    ds_read_b128 a[216:219], v236 offset:1024
    v_mfma_f32_16x16x32_bf16 v[52:55], v[96:99], v[172:175], v[52:55]
    s_waitcnt lgkmcnt(7)
    v_mfma_f32_16x16x32_bf16 v[56:59], v[100:103], v[168:171], v[56:59]
    ds_read_b128 a[220:223], v236 offset:2048
    v_mfma_f32_16x16x32_bf16 v[60:63], v[100:103], v[172:175], v[60:63]
    v_mfma_f32_16x16x32_bf16 v[64:67], v[104:107], v[168:171], v[64:67]
    ds_read_b128 a[224:227], v236 offset:3072
    v_mfma_f32_16x16x32_bf16 v[68:71], v[104:107], v[172:175], v[68:71]
    v_mfma_f32_16x16x32_bf16 v[72:75], v[108:111], v[168:171], v[72:75]
    ds_read_b128 a[228:231], v236 offset:4096
    v_mfma_f32_16x16x32_bf16 v[76:79], v[108:111], v[172:175], v[76:79]
    s_waitcnt lgkmcnt(6)
    v_mfma_f32_16x16x32_bf16 v[0:3], a[192:195], v[176:179], v[0:3]
    ds_read_b128 a[232:235], v233 offset:10240
    s_mov_b32 s34, 163840
    v_mfma_f32_16x16x32_bf16 v[4:7], a[192:195], v[180:183], v[4:7]
    buffer_load_dwordx4 a[160:163], v228, s[4:7], s34 offen offset:0 sc1
    v_mfma_f32_16x16x32_bf16 v[8:11], a[196:199], v[176:179], v[8:11]
    ds_read_b128 a[236:239], v233 offset:11264
    v_mfma_f32_16x16x32_bf16 v[12:15], a[196:199], v[180:183], v[12:15]
    buffer_load_dwordx4 a[164:167], v228, s[4:7], s34 offen offset:1024 sc1
    v_mfma_f32_16x16x32_bf16 v[16:19], a[200:203], v[176:179], v[16:19]
    ds_read_b128 a[240:243], v233 offset:12288
    v_mfma_f32_16x16x32_bf16 v[20:23], a[200:203], v[180:183], v[20:23]
    buffer_load_dwordx4 a[168:171], v228, s[4:7], s34 offen offset:2048 sc1
    v_mfma_f32_16x16x32_bf16 v[24:27], a[204:207], v[176:179], v[24:27]
    ds_read_b128 a[244:247], v233 offset:13312
    v_mfma_f32_16x16x32_bf16 v[28:31], a[204:207], v[180:183], v[28:31]
    buffer_load_dwordx4 a[172:175], v228, s[4:7], s34 offen offset:3072 sc1
    s_waitcnt lgkmcnt(7)
    v_mfma_f32_16x16x32_bf16 v[32:35], a[208:211], v[176:179], v[32:35]
    ds_read_b128 a[248:251], v233 offset:14336
    v_mfma_f32_16x16x32_bf16 v[36:39], a[208:211], v[180:183], v[36:39]
    v_mfma_f32_16x16x32_bf16 v[40:43], a[212:215], v[176:179], v[40:43]
    ds_read_b128 a[252:255], v236 offset:10240
    v_mfma_f32_16x16x32_bf16 v[44:47], a[212:215], v[180:183], v[44:47]
    v_mfma_f32_16x16x32_bf16 v[48:51], a[216:219], v[176:179], v[48:51]
    ds_read_b128 v[96:99], v236 offset:11264
    v_mfma_f32_16x16x32_bf16 v[52:55], a[216:219], v[180:183], v[52:55]
    s_waitcnt lgkmcnt(7)
    v_mfma_f32_16x16x32_bf16 v[56:59], a[220:223], v[176:179], v[56:59]
    ds_read_b128 v[100:103], v236 offset:12288
    v_mfma_f32_16x16x32_bf16 v[60:63], a[220:223], v[180:183], v[60:63]
    v_mfma_f32_16x16x32_bf16 v[64:67], a[224:227], v[176:179], v[64:67]
    ds_read_b128 v[104:107], v236 offset:13312
    v_mfma_f32_16x16x32_bf16 v[68:71], a[224:227], v[180:183], v[68:71]
    v_mfma_f32_16x16x32_bf16 v[72:75], a[228:231], v[176:179], v[72:75]
    ds_read_b128 v[108:111], v236 offset:14336
    v_mfma_f32_16x16x32_bf16 v[76:79], a[228:231], v[180:183], v[76:79]
    s_waitcnt vmcnt(18) lgkmcnt(6)
    s_barrier
    v_mfma_f32_16x16x32_bf16 v[0:3], a[232:235], v[184:187], v[0:3]
    ds_read_b128 a[192:195], v233 offset:20480
    s_add_u32 m0, s50, 81920
    v_mfma_f32_16x16x32_bf16 v[4:7], a[232:235], v[188:191], v[4:7]
    s_mov_b32 s35, 225280
    v_mfma_f32_16x16x32_bf16 v[8:11], a[236:239], v[184:187], v[8:11]
    ds_read_b128 a[196:199], v233 offset:21504
    v_mfma_f32_16x16x32_bf16 v[12:15], a[236:239], v[188:191], v[12:15]
    buffer_load_dwordx4 v229, s[8:11], s35 offen offset:0 sc1 lds
    v_mfma_f32_16x16x32_bf16 v[16:19], a[240:243], v[184:187], v[16:19]
    ds_read_b128 a[200:203], v233 offset:22528
    v_mfma_f32_16x16x32_bf16 v[20:23], a[240:243], v[188:191], v[20:23]
    buffer_load_dwordx4 v229, s[8:11], s35 offen offset:1024 sc1 lds
    v_mfma_f32_16x16x32_bf16 v[24:27], a[244:247], v[184:187], v[24:27]
    ds_read_b128 a[204:207], v233 offset:23552
    v_mfma_f32_16x16x32_bf16 v[28:31], a[244:247], v[188:191], v[28:31]
    buffer_load_dwordx4 v229, s[8:11], s35 offen offset:2048 sc1 lds
    s_waitcnt lgkmcnt(7)
    v_mfma_f32_16x16x32_bf16 v[32:35], a[248:251], v[184:187], v[32:35]
    ds_read_b128 a[208:211], v233 offset:24576
    v_mfma_f32_16x16x32_bf16 v[36:39], a[248:251], v[188:191], v[36:39]
    buffer_load_dwordx4 v229, s[8:11], s35 offen offset:3072 sc1 lds
    v_mfma_f32_16x16x32_bf16 v[40:43], a[252:255], v[184:187], v[40:43]
    ds_read_b128 a[212:215], v236 offset:20480
    s_add_u32 m0, s50, 86016
    v_mfma_f32_16x16x32_bf16 v[44:47], a[252:255], v[188:191], v[44:47]
    buffer_load_dwordx4 v230, s[8:11], s35 offen sc1 lds
    v_mfma_f32_16x16x32_bf16 v[48:51], v[96:99], v[184:187], v[48:51]
    ds_read_b128 a[216:219], v236 offset:21504
    v_mfma_f32_16x16x32_bf16 v[52:55], v[96:99], v[188:191], v[52:55]
    s_waitcnt lgkmcnt(7)
    v_mfma_f32_16x16x32_bf16 v[56:59], v[100:103], v[184:187], v[56:59]
    ds_read_b128 a[220:223], v236 offset:22528
    v_mfma_f32_16x16x32_bf16 v[60:63], v[100:103], v[188:191], v[60:63]
    v_mfma_f32_16x16x32_bf16 v[64:67], v[104:107], v[184:187], v[64:67]
    ds_read_b128 a[224:227], v236 offset:23552
    v_mfma_f32_16x16x32_bf16 v[68:71], v[104:107], v[188:191], v[68:71]
    v_mfma_f32_16x16x32_bf16 v[72:75], v[108:111], v[184:187], v[72:75]
    ds_read_b128 a[228:231], v236 offset:24576
    v_mfma_f32_16x16x32_bf16 v[76:79], v[108:111], v[188:191], v[76:79]
    s_waitcnt lgkmcnt(6)
    v_mfma_f32_16x16x32_bf16 v[0:3], a[192:195], a[128:131], v[0:3]
    ds_read_b128 a[232:235], v233 offset:30720
    s_mov_b32 s34, 180224
    v_mfma_f32_16x16x32_bf16 v[4:7], a[192:195], a[132:135], v[4:7]
    buffer_load_dwordx4 a[176:179], v228, s[4:7], s34 offen offset:0 sc1
    v_mfma_f32_16x16x32_bf16 v[8:11], a[196:199], a[128:131], v[8:11]
    ds_read_b128 a[236:239], v233 offset:31744
    v_mfma_f32_16x16x32_bf16 v[12:15], a[196:199], a[132:135], v[12:15]
    buffer_load_dwordx4 a[180:183], v228, s[4:7], s34 offen offset:1024 sc1
    v_mfma_f32_16x16x32_bf16 v[16:19], a[200:203], a[128:131], v[16:19]
    ds_read_b128 a[240:243], v233 offset:32768
    v_mfma_f32_16x16x32_bf16 v[20:23], a[200:203], a[132:135], v[20:23]
    buffer_load_dwordx4 a[184:187], v228, s[4:7], s34 offen offset:2048 sc1
    v_mfma_f32_16x16x32_bf16 v[24:27], a[204:207], a[128:131], v[24:27]
    ds_read_b128 a[244:247], v233 offset:33792
    v_mfma_f32_16x16x32_bf16 v[28:31], a[204:207], a[132:135], v[28:31]
    buffer_load_dwordx4 a[188:191], v228, s[4:7], s34 offen offset:3072 sc1
    s_waitcnt lgkmcnt(7)
    v_mfma_f32_16x16x32_bf16 v[32:35], a[208:211], a[128:131], v[32:35]
    ds_read_b128 a[248:251], v233 offset:34816
    v_mfma_f32_16x16x32_bf16 v[36:39], a[208:211], a[132:135], v[36:39]
    v_mfma_f32_16x16x32_bf16 v[40:43], a[212:215], a[128:131], v[40:43]
    ds_read_b128 a[252:255], v236 offset:30720
    v_mfma_f32_16x16x32_bf16 v[44:47], a[212:215], a[132:135], v[44:47]
    v_mfma_f32_16x16x32_bf16 v[48:51], a[216:219], a[128:131], v[48:51]
    ds_read_b128 v[96:99], v236 offset:31744
    v_mfma_f32_16x16x32_bf16 v[52:55], a[216:219], a[132:135], v[52:55]
    s_waitcnt lgkmcnt(7)
    v_mfma_f32_16x16x32_bf16 v[56:59], a[220:223], a[128:131], v[56:59]
    ds_read_b128 v[100:103], v236 offset:32768
    v_mfma_f32_16x16x32_bf16 v[60:63], a[220:223], a[132:135], v[60:63]
    v_mfma_f32_16x16x32_bf16 v[64:67], a[224:227], a[128:131], v[64:67]
    ds_read_b128 v[104:107], v236 offset:33792
    v_mfma_f32_16x16x32_bf16 v[68:71], a[224:227], a[132:135], v[68:71]
    v_mfma_f32_16x16x32_bf16 v[72:75], a[228:231], a[128:131], v[72:75]
    ds_read_b128 v[108:111], v236 offset:34816
    v_mfma_f32_16x16x32_bf16 v[76:79], a[228:231], a[132:135], v[76:79]
    s_waitcnt vmcnt(18) lgkmcnt(6)
    s_barrier
    v_mfma_f32_16x16x32_bf16 v[0:3], a[232:235], a[136:139], v[0:3]
    ds_read_b128 a[192:195], v231 offset:0
    s_add_u32 m0, s50, 40960
    v_mfma_f32_16x16x32_bf16 v[4:7], a[232:235], a[140:143], v[4:7]
    s_mov_b32 s35, 245760
    v_mfma_f32_16x16x32_bf16 v[8:11], a[236:239], a[136:139], v[8:11]
    ds_read_b128 a[196:199], v231 offset:1024
    v_mfma_f32_16x16x32_bf16 v[12:15], a[236:239], a[140:143], v[12:15]
    buffer_load_dwordx4 v229, s[8:11], s35 offen offset:0 sc1 lds
    v_mfma_f32_16x16x32_bf16 v[16:19], a[240:243], a[136:139], v[16:19]
    ds_read_b128 a[200:203], v231 offset:2048
    v_mfma_f32_16x16x32_bf16 v[20:23], a[240:243], a[140:143], v[20:23]
    buffer_load_dwordx4 v229, s[8:11], s35 offen offset:1024 sc1 lds
    v_mfma_f32_16x16x32_bf16 v[24:27], a[244:247], a[136:139], v[24:27]
    ds_read_b128 a[204:207], v231 offset:3072
    v_mfma_f32_16x16x32_bf16 v[28:31], a[244:247], a[140:143], v[28:31]
    buffer_load_dwordx4 v229, s[8:11], s35 offen offset:2048 sc1 lds
    s_waitcnt lgkmcnt(7)
    v_mfma_f32_16x16x32_bf16 v[32:35], a[248:251], a[136:139], v[32:35]
    ds_read_b128 a[208:211], v231 offset:4096
    v_mfma_f32_16x16x32_bf16 v[36:39], a[248:251], a[140:143], v[36:39]
    buffer_load_dwordx4 v229, s[8:11], s35 offen offset:3072 sc1 lds
    v_mfma_f32_16x16x32_bf16 v[40:43], a[252:255], a[136:139], v[40:43]
    ds_read_b128 a[212:215], v234 offset:0
    s_add_u32 m0, s50, 45056
    v_mfma_f32_16x16x32_bf16 v[44:47], a[252:255], a[140:143], v[44:47]
    buffer_load_dwordx4 v230, s[8:11], s35 offen sc1 lds
    v_mfma_f32_16x16x32_bf16 v[48:51], v[96:99], a[136:139], v[48:51]
    ds_read_b128 a[216:219], v234 offset:1024
    v_mfma_f32_16x16x32_bf16 v[52:55], v[96:99], a[140:143], v[52:55]
    s_waitcnt lgkmcnt(7)
    v_mfma_f32_16x16x32_bf16 v[56:59], v[100:103], a[136:139], v[56:59]
    ds_read_b128 a[220:223], v234 offset:2048
    v_mfma_f32_16x16x32_bf16 v[60:63], v[100:103], a[140:143], v[60:63]
    v_mfma_f32_16x16x32_bf16 v[64:67], v[104:107], a[136:139], v[64:67]
    ds_read_b128 a[224:227], v234 offset:3072
    v_mfma_f32_16x16x32_bf16 v[68:71], v[104:107], a[140:143], v[68:71]
    v_mfma_f32_16x16x32_bf16 v[72:75], v[108:111], a[136:139], v[72:75]
    ds_read_b128 a[228:231], v234 offset:4096
    v_mfma_f32_16x16x32_bf16 v[76:79], v[108:111], a[140:143], v[76:79]
    s_waitcnt lgkmcnt(6)
    v_mfma_f32_16x16x32_bf16 v[0:3], a[192:195], a[144:147], v[0:3]
    ds_read_b128 a[232:235], v231 offset:10240
    s_mov_b32 s34, 196608
    v_mfma_f32_16x16x32_bf16 v[4:7], a[192:195], a[148:151], v[4:7]
    buffer_load_dwordx4 v[128:131], v228, s[4:7], s34 offen offset:0 sc1
    v_mfma_f32_16x16x32_bf16 v[8:11], a[196:199], a[144:147], v[8:11]
    ds_read_b128 a[236:239], v231 offset:11264
    v_mfma_f32_16x16x32_bf16 v[12:15], a[196:199], a[148:151], v[12:15]
    buffer_load_dwordx4 v[132:135], v228, s[4:7], s34 offen offset:1024 sc1
    v_mfma_f32_16x16x32_bf16 v[16:19], a[200:203], a[144:147], v[16:19]
    ds_read_b128 a[240:243], v231 offset:12288
    v_mfma_f32_16x16x32_bf16 v[20:23], a[200:203], a[148:151], v[20:23]
    buffer_load_dwordx4 v[136:139], v228, s[4:7], s34 offen offset:2048 sc1
    v_mfma_f32_16x16x32_bf16 v[24:27], a[204:207], a[144:147], v[24:27]
    ds_read_b128 a[244:247], v231 offset:13312
    v_mfma_f32_16x16x32_bf16 v[28:31], a[204:207], a[148:151], v[28:31]
    buffer_load_dwordx4 v[140:143], v228, s[4:7], s34 offen offset:3072 sc1
    s_waitcnt lgkmcnt(7)
    v_mfma_f32_16x16x32_bf16 v[32:35], a[208:211], a[144:147], v[32:35]
    ds_read_b128 a[248:251], v231 offset:14336
    v_mfma_f32_16x16x32_bf16 v[36:39], a[208:211], a[148:151], v[36:39]
    v_mfma_f32_16x16x32_bf16 v[40:43], a[212:215], a[144:147], v[40:43]
    ds_read_b128 a[252:255], v234 offset:10240
    v_mfma_f32_16x16x32_bf16 v[44:47], a[212:215], a[148:151], v[44:47]
    v_mfma_f32_16x16x32_bf16 v[48:51], a[216:219], a[144:147], v[48:51]
    ds_read_b128 v[96:99], v234 offset:11264
    v_mfma_f32_16x16x32_bf16 v[52:55], a[216:219], a[148:151], v[52:55]
    s_waitcnt lgkmcnt(7)
    v_mfma_f32_16x16x32_bf16 v[56:59], a[220:223], a[144:147], v[56:59]
    ds_read_b128 v[100:103], v234 offset:12288
    v_mfma_f32_16x16x32_bf16 v[60:63], a[220:223], a[148:151], v[60:63]
    v_mfma_f32_16x16x32_bf16 v[64:67], a[224:227], a[144:147], v[64:67]
    ds_read_b128 v[104:107], v234 offset:13312
    v_mfma_f32_16x16x32_bf16 v[68:71], a[224:227], a[148:151], v[68:71]
    v_mfma_f32_16x16x32_bf16 v[72:75], a[228:231], a[144:147], v[72:75]
    ds_read_b128 v[108:111], v234 offset:14336
    v_mfma_f32_16x16x32_bf16 v[76:79], a[228:231], a[148:151], v[76:79]
    s_waitcnt vmcnt(18) lgkmcnt(6)
    s_barrier
    v_mfma_f32_16x16x32_bf16 v[0:3], a[232:235], a[152:155], v[0:3]
    ds_read_b128 a[192:195], v231 offset:20480
    s_add_u32 m0, s50, 61440
    v_mfma_f32_16x16x32_bf16 v[4:7], a[232:235], a[156:159], v[4:7]
    s_mov_b32 s35, 266240
    v_mfma_f32_16x16x32_bf16 v[8:11], a[236:239], a[152:155], v[8:11]
    ds_read_b128 a[196:199], v231 offset:21504
    v_mfma_f32_16x16x32_bf16 v[12:15], a[236:239], a[156:159], v[12:15]
    buffer_load_dwordx4 v229, s[8:11], s35 offen offset:0 sc1 lds
    v_mfma_f32_16x16x32_bf16 v[16:19], a[240:243], a[152:155], v[16:19]
    ds_read_b128 a[200:203], v231 offset:22528
    v_mfma_f32_16x16x32_bf16 v[20:23], a[240:243], a[156:159], v[20:23]
    buffer_load_dwordx4 v229, s[8:11], s35 offen offset:1024 sc1 lds
    v_mfma_f32_16x16x32_bf16 v[24:27], a[244:247], a[152:155], v[24:27]
    ds_read_b128 a[204:207], v231 offset:23552
    v_mfma_f32_16x16x32_bf16 v[28:31], a[244:247], a[156:159], v[28:31]
    buffer_load_dwordx4 v229, s[8:11], s35 offen offset:2048 sc1 lds
    s_waitcnt lgkmcnt(7)
    v_mfma_f32_16x16x32_bf16 v[32:35], a[248:251], a[152:155], v[32:35]
    ds_read_b128 a[208:211], v231 offset:24576
    v_mfma_f32_16x16x32_bf16 v[36:39], a[248:251], a[156:159], v[36:39]
    buffer_load_dwordx4 v229, s[8:11], s35 offen offset:3072 sc1 lds
    v_mfma_f32_16x16x32_bf16 v[40:43], a[252:255], a[152:155], v[40:43]
    ds_read_b128 a[212:215], v234 offset:20480
    s_add_u32 m0, s50, 65536
    v_mfma_f32_16x16x32_bf16 v[44:47], a[252:255], a[156:159], v[44:47]
    buffer_load_dwordx4 v230, s[8:11], s35 offen sc1 lds
    v_mfma_f32_16x16x32_bf16 v[48:51], v[96:99], a[152:155], v[48:51]
    ds_read_b128 a[216:219], v234 offset:21504
    v_mfma_f32_16x16x32_bf16 v[52:55], v[96:99], a[156:159], v[52:55]
    s_waitcnt lgkmcnt(7)
    v_mfma_f32_16x16x32_bf16 v[56:59], v[100:103], a[152:155], v[56:59]
    ds_read_b128 a[220:223], v234 offset:22528
    v_mfma_f32_16x16x32_bf16 v[60:63], v[100:103], a[156:159], v[60:63]
    v_mfma_f32_16x16x32_bf16 v[64:67], v[104:107], a[152:155], v[64:67]
    ds_read_b128 a[224:227], v234 offset:23552
    v_mfma_f32_16x16x32_bf16 v[68:71], v[104:107], a[156:159], v[68:71]
    v_mfma_f32_16x16x32_bf16 v[72:75], v[108:111], a[152:155], v[72:75]
    ds_read_b128 a[228:231], v234 offset:24576
    v_mfma_f32_16x16x32_bf16 v[76:79], v[108:111], a[156:159], v[76:79]
    s_waitcnt lgkmcnt(6)
    v_mfma_f32_16x16x32_bf16 v[0:3], a[192:195], a[160:163], v[0:3]
    ds_read_b128 a[232:235], v231 offset:30720
    s_mov_b32 s34, 212992
    v_mfma_f32_16x16x32_bf16 v[4:7], a[192:195], a[164:167], v[4:7]
    buffer_load_dwordx4 v[144:147], v228, s[4:7], s34 offen offset:0 sc1
    v_mfma_f32_16x16x32_bf16 v[8:11], a[196:199], a[160:163], v[8:11]
    ds_read_b128 a[236:239], v231 offset:31744
    v_mfma_f32_16x16x32_bf16 v[12:15], a[196:199], a[164:167], v[12:15]
    buffer_load_dwordx4 v[148:151], v228, s[4:7], s34 offen offset:1024 sc1
    v_mfma_f32_16x16x32_bf16 v[16:19], a[200:203], a[160:163], v[16:19]
    ds_read_b128 a[240:243], v231 offset:32768
    v_mfma_f32_16x16x32_bf16 v[20:23], a[200:203], a[164:167], v[20:23]
    buffer_load_dwordx4 v[152:155], v228, s[4:7], s34 offen offset:2048 sc1
    v_mfma_f32_16x16x32_bf16 v[24:27], a[204:207], a[160:163], v[24:27]
    ds_read_b128 a[244:247], v231 offset:33792
    v_mfma_f32_16x16x32_bf16 v[28:31], a[204:207], a[164:167], v[28:31]
    buffer_load_dwordx4 v[156:159], v228, s[4:7], s34 offen offset:3072 sc1
    s_waitcnt lgkmcnt(7)
    v_mfma_f32_16x16x32_bf16 v[32:35], a[208:211], a[160:163], v[32:35]
    ds_read_b128 a[248:251], v231 offset:34816
    v_mfma_f32_16x16x32_bf16 v[36:39], a[208:211], a[164:167], v[36:39]
    v_mfma_f32_16x16x32_bf16 v[40:43], a[212:215], a[160:163], v[40:43]
    ds_read_b128 a[252:255], v234 offset:30720
    v_mfma_f32_16x16x32_bf16 v[44:47], a[212:215], a[164:167], v[44:47]
    global_load_dwordx2 v[210:211], v209, s[94:95] sc1
    v_mfma_f32_16x16x32_bf16 v[48:51], a[216:219], a[160:163], v[48:51]
    ds_read_b128 v[96:99], v234 offset:31744
    v_mfma_f32_16x16x32_bf16 v[52:55], a[216:219], a[164:167], v[52:55]
    s_waitcnt lgkmcnt(7)
    v_mfma_f32_16x16x32_bf16 v[56:59], a[220:223], a[160:163], v[56:59]
    ds_read_b128 v[100:103], v234 offset:32768
    v_mfma_f32_16x16x32_bf16 v[60:63], a[220:223], a[164:167], v[60:63]
    v_mfma_f32_16x16x32_bf16 v[64:67], a[224:227], a[160:163], v[64:67]
    ds_read_b128 v[104:107], v234 offset:33792
    v_mfma_f32_16x16x32_bf16 v[68:71], a[224:227], a[164:167], v[68:71]
    v_mfma_f32_16x16x32_bf16 v[72:75], a[228:231], a[160:163], v[72:75]
    ds_read_b128 v[108:111], v234 offset:34816
    v_mfma_f32_16x16x32_bf16 v[76:79], a[228:231], a[164:167], v[76:79]
    s_waitcnt vmcnt(19) lgkmcnt(6)
    s_barrier
    v_mfma_f32_16x16x32_bf16 v[0:3], a[232:235], a[168:171], v[0:3]
    ds_read_b128 a[192:195], v232 offset:20480
    s_add_u32 m0, s50, 102400
    v_mfma_f32_16x16x32_bf16 v[4:7], a[232:235], a[172:175], v[4:7]
    s_mov_b32 s35, 286720
    v_mfma_f32_16x16x32_bf16 v[8:11], a[236:239], a[168:171], v[8:11]
    ds_read_b128 a[196:199], v232 offset:21504
    v_mfma_f32_16x16x32_bf16 v[12:15], a[236:239], a[172:175], v[12:15]
    buffer_load_dwordx4 v229, s[8:11], s35 offen offset:0 sc1 lds
    v_mfma_f32_16x16x32_bf16 v[16:19], a[240:243], a[168:171], v[16:19]
    ds_read_b128 a[200:203], v232 offset:22528
    v_mfma_f32_16x16x32_bf16 v[20:23], a[240:243], a[172:175], v[20:23]
    buffer_load_dwordx4 v229, s[8:11], s35 offen offset:1024 sc1 lds
    v_mfma_f32_16x16x32_bf16 v[24:27], a[244:247], a[168:171], v[24:27]
    ds_read_b128 a[204:207], v232 offset:23552
    v_mfma_f32_16x16x32_bf16 v[28:31], a[244:247], a[172:175], v[28:31]
    buffer_load_dwordx4 v229, s[8:11], s35 offen offset:2048 sc1 lds
    s_waitcnt lgkmcnt(7)
    v_mfma_f32_16x16x32_bf16 v[32:35], a[248:251], a[168:171], v[32:35]
    ds_read_b128 a[208:211], v232 offset:24576
    v_mfma_f32_16x16x32_bf16 v[36:39], a[248:251], a[172:175], v[36:39]
    buffer_load_dwordx4 v229, s[8:11], s35 offen offset:3072 sc1 lds
    v_mfma_f32_16x16x32_bf16 v[40:43], a[252:255], a[168:171], v[40:43]
    ds_read_b128 a[212:215], v235 offset:20480
    s_add_u32 m0, s50, 106496
    v_mfma_f32_16x16x32_bf16 v[44:47], a[252:255], a[172:175], v[44:47]
    buffer_load_dwordx4 v230, s[8:11], s35 offen sc1 lds
    v_mfma_f32_16x16x32_bf16 v[48:51], v[96:99], a[168:171], v[48:51]
    ds_read_b128 a[216:219], v235 offset:21504
    v_mfma_f32_16x16x32_bf16 v[52:55], v[96:99], a[172:175], v[52:55]
    s_waitcnt lgkmcnt(7)
    v_mfma_f32_16x16x32_bf16 v[56:59], v[100:103], a[168:171], v[56:59]
    ds_read_b128 a[220:223], v235 offset:22528
    v_mfma_f32_16x16x32_bf16 v[60:63], v[100:103], a[172:175], v[60:63]
    v_mfma_f32_16x16x32_bf16 v[64:67], v[104:107], a[168:171], v[64:67]
    ds_read_b128 a[224:227], v235 offset:23552
    v_mfma_f32_16x16x32_bf16 v[68:71], v[104:107], a[172:175], v[68:71]
    v_mfma_f32_16x16x32_bf16 v[72:75], v[108:111], a[168:171], v[72:75]
    ds_read_b128 a[228:231], v235 offset:24576
    v_mfma_f32_16x16x32_bf16 v[76:79], v[108:111], a[172:175], v[76:79]
    s_waitcnt lgkmcnt(6)
    v_mfma_f32_16x16x32_bf16 v[0:3], a[192:195], a[176:179], v[0:3]
    ds_read_b128 a[232:235], v232 offset:30720
    s_mov_b32 s34, 229376
    v_mfma_f32_16x16x32_bf16 v[4:7], a[192:195], a[180:183], v[4:7]
    buffer_load_dwordx4 v[160:163], v228, s[4:7], s34 offen offset:0 sc1
    v_mfma_f32_16x16x32_bf16 v[8:11], a[196:199], a[176:179], v[8:11]
    ds_read_b128 a[236:239], v232 offset:31744
    v_mfma_f32_16x16x32_bf16 v[12:15], a[196:199], a[180:183], v[12:15]
    buffer_load_dwordx4 v[164:167], v228, s[4:7], s34 offen offset:1024 sc1
    v_mfma_f32_16x16x32_bf16 v[16:19], a[200:203], a[176:179], v[16:19]
    ds_read_b128 a[240:243], v232 offset:32768
    v_mfma_f32_16x16x32_bf16 v[20:23], a[200:203], a[180:183], v[20:23]
    buffer_load_dwordx4 v[168:171], v228, s[4:7], s34 offen offset:2048 sc1
    v_mfma_f32_16x16x32_bf16 v[24:27], a[204:207], a[176:179], v[24:27]
    ds_read_b128 a[244:247], v232 offset:33792
    v_mfma_f32_16x16x32_bf16 v[28:31], a[204:207], a[180:183], v[28:31]
    buffer_load_dwordx4 v[172:175], v228, s[4:7], s34 offen offset:3072 sc1
    s_waitcnt lgkmcnt(7)
    v_mfma_f32_16x16x32_bf16 v[32:35], a[208:211], a[176:179], v[32:35]
    ds_read_b128 a[248:251], v232 offset:34816
    v_mfma_f32_16x16x32_bf16 v[36:39], a[208:211], a[180:183], v[36:39]
    v_mfma_f32_16x16x32_bf16 v[40:43], a[212:215], a[176:179], v[40:43]
    ds_read_b128 a[252:255], v235 offset:30720
    v_mfma_f32_16x16x32_bf16 v[44:47], a[212:215], a[180:183], v[44:47]
    v_mfma_f32_16x16x32_bf16 v[48:51], a[216:219], a[176:179], v[48:51]
    ds_read_b128 v[96:99], v235 offset:31744
    v_mfma_f32_16x16x32_bf16 v[52:55], a[216:219], a[180:183], v[52:55]
    s_waitcnt lgkmcnt(7)
    v_mfma_f32_16x16x32_bf16 v[56:59], a[220:223], a[176:179], v[56:59]
    ds_read_b128 v[100:103], v235 offset:32768
    v_mfma_f32_16x16x32_bf16 v[60:63], a[220:223], a[180:183], v[60:63]
    v_mfma_f32_16x16x32_bf16 v[64:67], a[224:227], a[176:179], v[64:67]
    ds_read_b128 v[104:107], v235 offset:33792
    v_mfma_f32_16x16x32_bf16 v[68:71], a[224:227], a[180:183], v[68:71]
    v_mfma_f32_16x16x32_bf16 v[72:75], a[228:231], a[176:179], v[72:75]
    ds_read_b128 v[108:111], v235 offset:34816
    v_mfma_f32_16x16x32_bf16 v[76:79], a[228:231], a[180:183], v[76:79]
    s_waitcnt vmcnt(19) lgkmcnt(6)
    s_barrier
    v_mfma_f32_16x16x32_bf16 v[0:3], a[232:235], a[184:187], v[0:3]
    ds_read_b128 a[192:195], v231 offset:40960
    s_add_u32 m0, s50, 122880
    v_mfma_f32_16x16x32_bf16 v[4:7], a[232:235], a[188:191], v[4:7]
    s_mov_b32 s35, 307200
    v_mfma_f32_16x16x32_bf16 v[8:11], a[236:239], a[184:187], v[8:11]
    ds_read_b128 a[196:199], v231 offset:41984
    v_mfma_f32_16x16x32_bf16 v[12:15], a[236:239], a[188:191], v[12:15]
    buffer_load_dwordx4 v229, s[8:11], s35 offen offset:0 sc1 lds
    v_mfma_f32_16x16x32_bf16 v[16:19], a[240:243], a[184:187], v[16:19]
    ds_read_b128 a[200:203], v231 offset:43008
    v_mfma_f32_16x16x32_bf16 v[20:23], a[240:243], a[188:191], v[20:23]
    buffer_load_dwordx4 v229, s[8:11], s35 offen offset:1024 sc1 lds
    v_mfma_f32_16x16x32_bf16 v[24:27], a[244:247], a[184:187], v[24:27]
    ds_read_b128 a[204:207], v231 offset:44032
    v_mfma_f32_16x16x32_bf16 v[28:31], a[244:247], a[188:191], v[28:31]
    buffer_load_dwordx4 v229, s[8:11], s35 offen offset:2048 sc1 lds
    s_waitcnt lgkmcnt(7)
    v_mfma_f32_16x16x32_bf16 v[32:35], a[248:251], a[184:187], v[32:35]
    ds_read_b128 a[208:211], v231 offset:45056
    v_mfma_f32_16x16x32_bf16 v[36:39], a[248:251], a[188:191], v[36:39]
    buffer_load_dwordx4 v229, s[8:11], s35 offen offset:3072 sc1 lds
    v_mfma_f32_16x16x32_bf16 v[40:43], a[252:255], a[184:187], v[40:43]
    ds_read_b128 a[212:215], v234 offset:40960
    s_waitcnt vmcnt(13)
    v_mfma_f32_16x16x32_bf16 v[44:47], a[252:255], a[188:191], v[44:47]
    v_sub_u32 v222, v210, v254
    s_add_u32 m0, s50, 126976
    v_mfma_f32_16x16x32_bf16 v[48:51], v[96:99], a[184:187], v[48:51]
    ds_read_b128 a[216:219], v234 offset:41984
    v_sub_u32 v223, v211, v255
    v_mfma_f32_16x16x32_bf16 v[52:55], v[96:99], a[188:191], v[52:55]
    v_xor_b32 v222, 1, v222
    s_waitcnt lgkmcnt(7)
    v_mfma_f32_16x16x32_bf16 v[56:59], v[100:103], a[184:187], v[56:59]
    ds_read_b128 a[220:223], v234 offset:43008
    v_xor_b32 v223, 1, v223
    v_mfma_f32_16x16x32_bf16 v[60:63], v[100:103], a[188:191], v[60:63]
    v_or_b32 v222, v222, v223
    v_mfma_f32_16x16x32_bf16 v[64:67], v[104:107], a[184:187], v[64:67]
    ds_read_b128 a[224:227], v234 offset:44032
    v_cmp_ne_u32 vcc, 0, v222
    v_mfma_f32_16x16x32_bf16 v[68:71], v[104:107], a[188:191], v[68:71]
    s_and_b64 vcc, vcc, s[32:33]
    s_cmp_eq_u64 vcc, 0
    v_mfma_f32_16x16x32_bf16 v[72:75], v[108:111], a[184:187], v[72:75]
    ds_read_b128 a[228:231], v234 offset:45056
    s_cbranch_scc0 K1_SPINO
K1_GATEOR:
    v_mfma_f32_16x16x32_bf16 v[76:79], v[108:111], a[188:191], v[76:79]
    buffer_load_dwordx4 v230, s[8:11], s35 offen sc1 lds
    s_waitcnt lgkmcnt(6)
    v_mfma_f32_16x16x32_bf16 v[0:3], a[192:195], v[128:131], v[0:3]
    ds_read_b128 a[232:235], v231 offset:51200
    s_mov_b32 s34, 245760
    v_mfma_f32_16x16x32_bf16 v[4:7], a[192:195], v[132:135], v[4:7]
    buffer_load_dwordx4 v[176:179], v228, s[4:7], s34 offen offset:0 sc1
    v_mfma_f32_16x16x32_bf16 v[8:11], a[196:199], v[128:131], v[8:11]
    ds_read_b128 a[236:239], v231 offset:52224
    v_mfma_f32_16x16x32_bf16 v[12:15], a[196:199], v[132:135], v[12:15]
    buffer_load_dwordx4 v[180:183], v228, s[4:7], s34 offen offset:1024 sc1
    v_mfma_f32_16x16x32_bf16 v[16:19], a[200:203], v[128:131], v[16:19]
    ds_read_b128 a[240:243], v231 offset:53248
    v_mfma_f32_16x16x32_bf16 v[20:23], a[200:203], v[132:135], v[20:23]
    buffer_load_dwordx4 v[184:187], v228, s[4:7], s34 offen offset:2048 sc1
    v_mfma_f32_16x16x32_bf16 v[24:27], a[204:207], v[128:131], v[24:27]
    ds_read_b128 a[244:247], v231 offset:54272
    v_mfma_f32_16x16x32_bf16 v[28:31], a[204:207], v[132:135], v[28:31]
    buffer_load_dwordx4 v[188:191], v228, s[4:7], s34 offen offset:3072 sc1
    s_waitcnt lgkmcnt(7)
    v_mfma_f32_16x16x32_bf16 v[32:35], a[208:211], v[128:131], v[32:35]
    ds_read_b128 a[248:251], v231 offset:55296
    v_mfma_f32_16x16x32_bf16 v[36:39], a[208:211], v[132:135], v[36:39]
    v_mfma_f32_16x16x32_bf16 v[40:43], a[212:215], v[128:131], v[40:43]
    ds_read_b128 a[252:255], v234 offset:51200
    v_mfma_f32_16x16x32_bf16 v[44:47], a[212:215], v[132:135], v[44:47]
    v_mfma_f32_16x16x32_bf16 v[48:51], a[216:219], v[128:131], v[48:51]
    ds_read_b128 v[96:99], v234 offset:52224
    v_mfma_f32_16x16x32_bf16 v[52:55], a[216:219], v[132:135], v[52:55]
    s_waitcnt lgkmcnt(7)
    v_mfma_f32_16x16x32_bf16 v[56:59], a[220:223], v[128:131], v[56:59]
    ds_read_b128 v[100:103], v234 offset:53248
    v_mfma_f32_16x16x32_bf16 v[60:63], a[220:223], v[132:135], v[60:63]
    v_mfma_f32_16x16x32_bf16 v[64:67], a[224:227], v[128:131], v[64:67]
    ds_read_b128 v[104:107], v234 offset:54272
    v_mfma_f32_16x16x32_bf16 v[68:71], a[224:227], v[132:135], v[68:71]
    v_mfma_f32_16x16x32_bf16 v[72:75], a[228:231], v[128:131], v[72:75]
    ds_read_b128 v[108:111], v234 offset:55296
    v_mfma_f32_16x16x32_bf16 v[76:79], a[228:231], v[132:135], v[76:79]
    s_waitcnt lgkmcnt(6)
    s_barrier
    v_mfma_f32_16x16x32_bf16 v[0:3], a[232:235], v[136:139], v[0:3]
    ds_read_b128 a[192:195], v232 offset:0
    s_add_u32 m0, s50, 143360
    v_mfma_f32_16x16x32_bf16 v[4:7], a[232:235], v[140:143], v[4:7]
    s_mov_b32 s35, 327680
    v_mfma_f32_16x16x32_bf16 v[8:11], a[236:239], v[136:139], v[8:11]
    ds_read_b128 a[196:199], v232 offset:1024
    v_mfma_f32_16x16x32_bf16 v[12:15], a[236:239], v[140:143], v[12:15]
    buffer_load_dwordx4 v229, s[8:11], s35 offen offset:0 sc1 lds
    v_mfma_f32_16x16x32_bf16 v[16:19], a[240:243], v[136:139], v[16:19]
    ds_read_b128 a[200:203], v232 offset:2048
    v_mfma_f32_16x16x32_bf16 v[20:23], a[240:243], v[140:143], v[20:23]
    buffer_load_dwordx4 v229, s[8:11], s35 offen offset:1024 sc1 lds
    v_mfma_f32_16x16x32_bf16 v[24:27], a[244:247], v[136:139], v[24:27]
    ds_read_b128 a[204:207], v232 offset:3072
    v_mfma_f32_16x16x32_bf16 v[28:31], a[244:247], v[140:143], v[28:31]
    buffer_load_dwordx4 v229, s[8:11], s35 offen offset:2048 sc1 lds
    s_waitcnt lgkmcnt(7)
    v_mfma_f32_16x16x32_bf16 v[32:35], a[248:251], v[136:139], v[32:35]
    ds_read_b128 a[208:211], v232 offset:4096
    v_mfma_f32_16x16x32_bf16 v[36:39], a[248:251], v[140:143], v[36:39]
    buffer_load_dwordx4 v229, s[8:11], s35 offen offset:3072 sc1 lds
    v_mfma_f32_16x16x32_bf16 v[40:43], a[252:255], v[136:139], v[40:43]
    ds_read_b128 a[212:215], v235 offset:0
    s_add_u32 m0, s50, 147456
    v_mfma_f32_16x16x32_bf16 v[44:47], a[252:255], v[140:143], v[44:47]
    buffer_load_dwordx4 v230, s[8:11], s35 offen sc1 lds
    v_mfma_f32_16x16x32_bf16 v[48:51], v[96:99], v[136:139], v[48:51]
    ds_read_b128 a[216:219], v235 offset:1024
    v_mfma_f32_16x16x32_bf16 v[52:55], v[96:99], v[140:143], v[52:55]
    s_waitcnt lgkmcnt(7)
    v_mfma_f32_16x16x32_bf16 v[56:59], v[100:103], v[136:139], v[56:59]
    ds_read_b128 a[220:223], v235 offset:2048
    v_mfma_f32_16x16x32_bf16 v[60:63], v[100:103], v[140:143], v[60:63]
    v_mfma_f32_16x16x32_bf16 v[64:67], v[104:107], v[136:139], v[64:67]
    ds_read_b128 a[224:227], v235 offset:3072
    v_mfma_f32_16x16x32_bf16 v[68:71], v[104:107], v[140:143], v[68:71]
    v_mfma_f32_16x16x32_bf16 v[72:75], v[108:111], v[136:139], v[72:75]
    ds_read_b128 a[228:231], v235 offset:4096
    v_mfma_f32_16x16x32_bf16 v[76:79], v[108:111], v[140:143], v[76:79]
    s_waitcnt lgkmcnt(6)
    v_mfma_f32_16x16x32_bf16 v[0:3], a[192:195], v[144:147], v[0:3]
    ds_read_b128 a[232:235], v232 offset:10240
    s_mov_b32 s34, 262144
    v_mfma_f32_16x16x32_bf16 v[4:7], a[192:195], v[148:151], v[4:7]
    buffer_load_dwordx4 a[128:131], v228, s[4:7], s34 offen offset:0 sc1
    v_mfma_f32_16x16x32_bf16 v[8:11], a[196:199], v[144:147], v[8:11]
    ds_read_b128 a[236:239], v232 offset:11264
    v_mfma_f32_16x16x32_bf16 v[12:15], a[196:199], v[148:151], v[12:15]
    buffer_load_dwordx4 a[132:135], v228, s[4:7], s34 offen offset:1024 sc1
    v_mfma_f32_16x16x32_bf16 v[16:19], a[200:203], v[144:147], v[16:19]
    ds_read_b128 a[240:243], v232 offset:12288
    v_mfma_f32_16x16x32_bf16 v[20:23], a[200:203], v[148:151], v[20:23]
    buffer_load_dwordx4 a[136:139], v228, s[4:7], s34 offen offset:2048 sc1
    v_mfma_f32_16x16x32_bf16 v[24:27], a[204:207], v[144:147], v[24:27]
    ds_read_b128 a[244:247], v232 offset:13312
    v_mfma_f32_16x16x32_bf16 v[28:31], a[204:207], v[148:151], v[28:31]
    buffer_load_dwordx4 a[140:143], v228, s[4:7], s34 offen offset:3072 sc1
    s_waitcnt lgkmcnt(7)
    v_mfma_f32_16x16x32_bf16 v[32:35], a[208:211], v[144:147], v[32:35]
    ds_read_b128 a[248:251], v232 offset:14336
    v_mfma_f32_16x16x32_bf16 v[36:39], a[208:211], v[148:151], v[36:39]
    v_mfma_f32_16x16x32_bf16 v[40:43], a[212:215], v[144:147], v[40:43]
    ds_read_b128 a[252:255], v235 offset:10240
    v_mfma_f32_16x16x32_bf16 v[44:47], a[212:215], v[148:151], v[44:47]
    v_mfma_f32_16x16x32_bf16 v[48:51], a[216:219], v[144:147], v[48:51]
    ds_read_b128 v[96:99], v235 offset:11264
    v_mfma_f32_16x16x32_bf16 v[52:55], a[216:219], v[148:151], v[52:55]
    s_waitcnt lgkmcnt(7)
    v_mfma_f32_16x16x32_bf16 v[56:59], a[220:223], v[144:147], v[56:59]
    ds_read_b128 v[100:103], v235 offset:12288
    v_mfma_f32_16x16x32_bf16 v[60:63], a[220:223], v[148:151], v[60:63]
    v_mfma_f32_16x16x32_bf16 v[64:67], a[224:227], v[144:147], v[64:67]
    ds_read_b128 v[104:107], v235 offset:13312
    v_mfma_f32_16x16x32_bf16 v[68:71], a[224:227], v[148:151], v[68:71]
    v_mfma_f32_16x16x32_bf16 v[72:75], a[228:231], v[144:147], v[72:75]
    ds_read_b128 v[108:111], v235 offset:14336
    v_mfma_f32_16x16x32_bf16 v[76:79], a[228:231], v[148:151], v[76:79]
    s_waitcnt vmcnt(18) lgkmcnt(6)
    s_barrier
    v_mfma_f32_16x16x32_bf16 v[0:3], a[232:235], v[152:155], v[0:3]
    ds_read_b128 a[192:195], v232 offset:40960
    s_add_u32 m0, s50, 0
    v_mfma_f32_16x16x32_bf16 v[4:7], a[232:235], v[156:159], v[4:7]
    s_mov_b32 s35, 348160
    v_mfma_f32_16x16x32_bf16 v[8:11], a[236:239], v[152:155], v[8:11]
    ds_read_b128 a[196:199], v232 offset:41984
    v_mfma_f32_16x16x32_bf16 v[12:15], a[236:239], v[156:159], v[12:15]
    buffer_load_dwordx4 v229, s[8:11], s35 offen offset:0 sc1 lds
    v_mfma_f32_16x16x32_bf16 v[16:19], a[240:243], v[152:155], v[16:19]
    ds_read_b128 a[200:203], v232 offset:43008
    v_mfma_f32_16x16x32_bf16 v[20:23], a[240:243], v[156:159], v[20:23]
    buffer_load_dwordx4 v229, s[8:11], s35 offen offset:1024 sc1 lds
    v_mfma_f32_16x16x32_bf16 v[24:27], a[244:247], v[152:155], v[24:27]
    ds_read_b128 a[204:207], v232 offset:44032
    v_mfma_f32_16x16x32_bf16 v[28:31], a[244:247], v[156:159], v[28:31]
    buffer_load_dwordx4 v229, s[8:11], s35 offen offset:2048 sc1 lds
    s_waitcnt lgkmcnt(7)
    v_mfma_f32_16x16x32_bf16 v[32:35], a[248:251], v[152:155], v[32:35]
    ds_read_b128 a[208:211], v232 offset:45056
    v_mfma_f32_16x16x32_bf16 v[36:39], a[248:251], v[156:159], v[36:39]
    buffer_load_dwordx4 v229, s[8:11], s35 offen offset:3072 sc1 lds
    v_mfma_f32_16x16x32_bf16 v[40:43], a[252:255], v[152:155], v[40:43]
    ds_read_b128 a[212:215], v235 offset:40960
    s_add_u32 m0, s50, 4096
    v_mfma_f32_16x16x32_bf16 v[44:47], a[252:255], v[156:159], v[44:47]
    buffer_load_dwordx4 v230, s[8:11], s35 offen sc1 lds
    v_mfma_f32_16x16x32_bf16 v[48:51], v[96:99], v[152:155], v[48:51]
    ds_read_b128 a[216:219], v235 offset:41984
    v_mfma_f32_16x16x32_bf16 v[52:55], v[96:99], v[156:159], v[52:55]
    s_waitcnt lgkmcnt(7)
    v_mfma_f32_16x16x32_bf16 v[56:59], v[100:103], v[152:155], v[56:59]
    ds_read_b128 a[220:223], v235 offset:43008
    v_mfma_f32_16x16x32_bf16 v[60:63], v[100:103], v[156:159], v[60:63]
    v_mfma_f32_16x16x32_bf16 v[64:67], v[104:107], v[152:155], v[64:67]
    ds_read_b128 a[224:227], v235 offset:44032
    v_mfma_f32_16x16x32_bf16 v[68:71], v[104:107], v[156:159], v[68:71]
    v_mfma_f32_16x16x32_bf16 v[72:75], v[108:111], v[152:155], v[72:75]
    ds_read_b128 a[228:231], v235 offset:45056
    v_mfma_f32_16x16x32_bf16 v[76:79], v[108:111], v[156:159], v[76:79]
    s_waitcnt lgkmcnt(6)
    v_mfma_f32_16x16x32_bf16 v[0:3], a[192:195], v[160:163], v[0:3]
    ds_read_b128 a[232:235], v232 offset:51200
    s_mov_b32 s34, 278528
    v_mfma_f32_16x16x32_bf16 v[4:7], a[192:195], v[164:167], v[4:7]
    buffer_load_dwordx4 a[144:147], v228, s[4:7], s34 offen offset:0 sc1
    v_mfma_f32_16x16x32_bf16 v[8:11], a[196:199], v[160:163], v[8:11]
    ds_read_b128 a[236:239], v232 offset:52224
    v_mfma_f32_16x16x32_bf16 v[12:15], a[196:199], v[164:167], v[12:15]
    buffer_load_dwordx4 a[148:151], v228, s[4:7], s34 offen offset:1024 sc1
    v_mfma_f32_16x16x32_bf16 v[16:19], a[200:203], v[160:163], v[16:19]
    ds_read_b128 a[240:243], v232 offset:53248
    v_mfma_f32_16x16x32_bf16 v[20:23], a[200:203], v[164:167], v[20:23]
    buffer_load_dwordx4 a[152:155], v228, s[4:7], s34 offen offset:2048 sc1
    v_mfma_f32_16x16x32_bf16 v[24:27], a[204:207], v[160:163], v[24:27]
    ds_read_b128 a[244:247], v232 offset:54272
    v_mfma_f32_16x16x32_bf16 v[28:31], a[204:207], v[164:167], v[28:31]
    buffer_load_dwordx4 a[156:159], v228, s[4:7], s34 offen offset:3072 sc1
    s_waitcnt lgkmcnt(7)
    v_mfma_f32_16x16x32_bf16 v[32:35], a[208:211], v[160:163], v[32:35]
    ds_read_b128 a[248:251], v232 offset:55296
    v_mfma_f32_16x16x32_bf16 v[36:39], a[208:211], v[164:167], v[36:39]
    v_mfma_f32_16x16x32_bf16 v[40:43], a[212:215], v[160:163], v[40:43]
    ds_read_b128 a[252:255], v235 offset:51200
    v_mfma_f32_16x16x32_bf16 v[44:47], a[212:215], v[164:167], v[44:47]
    v_mfma_f32_16x16x32_bf16 v[48:51], a[216:219], v[160:163], v[48:51]
    ds_read_b128 v[96:99], v235 offset:52224
    v_mfma_f32_16x16x32_bf16 v[52:55], a[216:219], v[164:167], v[52:55]
    s_waitcnt lgkmcnt(7)
    v_mfma_f32_16x16x32_bf16 v[56:59], a[220:223], v[160:163], v[56:59]
    ds_read_b128 v[100:103], v235 offset:53248
    v_mfma_f32_16x16x32_bf16 v[60:63], a[220:223], v[164:167], v[60:63]
    v_mfma_f32_16x16x32_bf16 v[64:67], a[224:227], v[160:163], v[64:67]
    ds_read_b128 v[104:107], v235 offset:54272
    v_mfma_f32_16x16x32_bf16 v[68:71], a[224:227], v[164:167], v[68:71]
    v_mfma_f32_16x16x32_bf16 v[72:75], a[228:231], v[160:163], v[72:75]
    ds_read_b128 v[108:111], v235 offset:55296
    v_mfma_f32_16x16x32_bf16 v[76:79], a[228:231], v[164:167], v[76:79]
    s_waitcnt vmcnt(18) lgkmcnt(6)
    s_barrier
    v_mfma_f32_16x16x32_bf16 v[0:3], a[232:235], v[168:171], v[0:3]
    ds_read_b128 a[192:195], v233 offset:0
    s_add_u32 m0, s50, 20480
    v_mfma_f32_16x16x32_bf16 v[4:7], a[232:235], v[172:175], v[4:7]
    s_mov_b32 s35, 368640
    v_mfma_f32_16x16x32_bf16 v[8:11], a[236:239], v[168:171], v[8:11]
    ds_read_b128 a[196:199], v233 offset:1024
    v_mfma_f32_16x16x32_bf16 v[12:15], a[236:239], v[172:175], v[12:15]
    buffer_load_dwordx4 v229, s[8:11], s35 offen offset:0 sc1 lds
    v_mfma_f32_16x16x32_bf16 v[16:19], a[240:243], v[168:171], v[16:19]
    ds_read_b128 a[200:203], v233 offset:2048
    v_mfma_f32_16x16x32_bf16 v[20:23], a[240:243], v[172:175], v[20:23]
    buffer_load_dwordx4 v229, s[8:11], s35 offen offset:1024 sc1 lds
    v_mfma_f32_16x16x32_bf16 v[24:27], a[244:247], v[168:171], v[24:27]
    ds_read_b128 a[204:207], v233 offset:3072
    v_mfma_f32_16x16x32_bf16 v[28:31], a[244:247], v[172:175], v[28:31]
    buffer_load_dwordx4 v229, s[8:11], s35 offen offset:2048 sc1 lds
    s_waitcnt lgkmcnt(7)
    v_mfma_f32_16x16x32_bf16 v[32:35], a[248:251], v[168:171], v[32:35]
    ds_read_b128 a[208:211], v233 offset:4096
    v_mfma_f32_16x16x32_bf16 v[36:39], a[248:251], v[172:175], v[36:39]
    buffer_load_dwordx4 v229, s[8:11], s35 offen offset:3072 sc1 lds
    v_mfma_f32_16x16x32_bf16 v[40:43], a[252:255], v[168:171], v[40:43]
    ds_read_b128 a[212:215], v236 offset:0
    s_add_u32 m0, s50, 24576
    v_mfma_f32_16x16x32_bf16 v[44:47], a[252:255], v[172:175], v[44:47]
    buffer_load_dwordx4 v230, s[8:11], s35 offen sc1 lds
    v_mfma_f32_16x16x32_bf16 v[48:51], v[96:99], v[168:171], v[48:51]
    ds_read_b128 a[216:219], v236 offset:1024
    v_mfma_f32_16x16x32_bf16 v[52:55], v[96:99], v[172:175], v[52:55]
    s_waitcnt lgkmcnt(7)
    v_mfma_f32_16x16x32_bf16 v[56:59], v[100:103], v[168:171], v[56:59]
    ds_read_b128 a[220:223], v236 offset:2048
    v_mfma_f32_16x16x32_bf16 v[60:63], v[100:103], v[172:175], v[60:63]
    v_mfma_f32_16x16x32_bf16 v[64:67], v[104:107], v[168:171], v[64:67]
    ds_read_b128 a[224:227], v236 offset:3072
    v_mfma_f32_16x16x32_bf16 v[68:71], v[104:107], v[172:175], v[68:71]
    v_mfma_f32_16x16x32_bf16 v[72:75], v[108:111], v[168:171], v[72:75]
    ds_read_b128 a[228:231], v236 offset:4096
    v_mfma_f32_16x16x32_bf16 v[76:79], v[108:111], v[172:175], v[76:79]
    s_waitcnt lgkmcnt(6)
    v_mfma_f32_16x16x32_bf16 v[0:3], a[192:195], v[176:179], v[0:3]
    ds_read_b128 a[232:235], v233 offset:10240
    s_mov_b32 s34, 294912
    v_mfma_f32_16x16x32_bf16 v[4:7], a[192:195], v[180:183], v[4:7]
    buffer_load_dwordx4 a[160:163], v228, s[4:7], s34 offen offset:0 sc1
    v_mfma_f32_16x16x32_bf16 v[8:11], a[196:199], v[176:179], v[8:11]
    ds_read_b128 a[236:239], v233 offset:11264
    v_mfma_f32_16x16x32_bf16 v[12:15], a[196:199], v[180:183], v[12:15]
    buffer_load_dwordx4 a[164:167], v228, s[4:7], s34 offen offset:1024 sc1
    v_mfma_f32_16x16x32_bf16 v[16:19], a[200:203], v[176:179], v[16:19]
    ds_read_b128 a[240:243], v233 offset:12288
    v_mfma_f32_16x16x32_bf16 v[20:23], a[200:203], v[180:183], v[20:23]
    buffer_load_dwordx4 a[168:171], v228, s[4:7], s34 offen offset:2048 sc1
    v_mfma_f32_16x16x32_bf16 v[24:27], a[204:207], v[176:179], v[24:27]
    ds_read_b128 a[244:247], v233 offset:13312
    v_mfma_f32_16x16x32_bf16 v[28:31], a[204:207], v[180:183], v[28:31]
    buffer_load_dwordx4 a[172:175], v228, s[4:7], s34 offen offset:3072 sc1
    s_waitcnt lgkmcnt(7)
    v_mfma_f32_16x16x32_bf16 v[32:35], a[208:211], v[176:179], v[32:35]
    ds_read_b128 a[248:251], v233 offset:14336
    v_mfma_f32_16x16x32_bf16 v[36:39], a[208:211], v[180:183], v[36:39]
    v_mfma_f32_16x16x32_bf16 v[40:43], a[212:215], v[176:179], v[40:43]
    ds_read_b128 a[252:255], v236 offset:10240
    v_mfma_f32_16x16x32_bf16 v[44:47], a[212:215], v[180:183], v[44:47]
    v_mfma_f32_16x16x32_bf16 v[48:51], a[216:219], v[176:179], v[48:51]
    ds_read_b128 v[96:99], v236 offset:11264
    v_mfma_f32_16x16x32_bf16 v[52:55], a[216:219], v[180:183], v[52:55]
    s_waitcnt lgkmcnt(7)
    v_mfma_f32_16x16x32_bf16 v[56:59], a[220:223], v[176:179], v[56:59]
    ds_read_b128 v[100:103], v236 offset:12288
    v_mfma_f32_16x16x32_bf16 v[60:63], a[220:223], v[180:183], v[60:63]
    v_mfma_f32_16x16x32_bf16 v[64:67], a[224:227], v[176:179], v[64:67]
    ds_read_b128 v[104:107], v236 offset:13312
    v_mfma_f32_16x16x32_bf16 v[68:71], a[224:227], v[180:183], v[68:71]
    v_mfma_f32_16x16x32_bf16 v[72:75], a[228:231], v[176:179], v[72:75]
    ds_read_b128 v[108:111], v236 offset:14336
    v_mfma_f32_16x16x32_bf16 v[76:79], a[228:231], v[180:183], v[76:79]
    s_waitcnt vmcnt(18) lgkmcnt(6)
    s_barrier
    v_mfma_f32_16x16x32_bf16 v[0:3], a[232:235], v[184:187], v[0:3]
    ds_read_b128 a[192:195], v233 offset:20480
    s_add_u32 m0, s50, 81920
    v_mfma_f32_16x16x32_bf16 v[4:7], a[232:235], v[188:191], v[4:7]
    s_mov_b32 s35, 389120
    v_mfma_f32_16x16x32_bf16 v[8:11], a[236:239], v[184:187], v[8:11]
    ds_read_b128 a[196:199], v233 offset:21504
    v_mfma_f32_16x16x32_bf16 v[12:15], a[236:239], v[188:191], v[12:15]
    buffer_load_dwordx4 v229, s[8:11], s35 offen offset:0 sc1 lds
    v_mfma_f32_16x16x32_bf16 v[16:19], a[240:243], v[184:187], v[16:19]
    ds_read_b128 a[200:203], v233 offset:22528
    v_mfma_f32_16x16x32_bf16 v[20:23], a[240:243], v[188:191], v[20:23]
    buffer_load_dwordx4 v229, s[8:11], s35 offen offset:1024 sc1 lds
    v_mfma_f32_16x16x32_bf16 v[24:27], a[244:247], v[184:187], v[24:27]
    ds_read_b128 a[204:207], v233 offset:23552
    v_mfma_f32_16x16x32_bf16 v[28:31], a[244:247], v[188:191], v[28:31]
    buffer_load_dwordx4 v229, s[8:11], s35 offen offset:2048 sc1 lds
    s_waitcnt lgkmcnt(7)
    v_mfma_f32_16x16x32_bf16 v[32:35], a[248:251], v[184:187], v[32:35]
    ds_read_b128 a[208:211], v233 offset:24576
    v_mfma_f32_16x16x32_bf16 v[36:39], a[248:251], v[188:191], v[36:39]
    buffer_load_dwordx4 v229, s[8:11], s35 offen offset:3072 sc1 lds
    v_mfma_f32_16x16x32_bf16 v[40:43], a[252:255], v[184:187], v[40:43]
    ds_read_b128 a[212:215], v236 offset:20480
    s_add_u32 m0, s50, 86016
    v_mfma_f32_16x16x32_bf16 v[44:47], a[252:255], v[188:191], v[44:47]
    buffer_load_dwordx4 v230, s[8:11], s35 offen sc1 lds
    v_mfma_f32_16x16x32_bf16 v[48:51], v[96:99], v[184:187], v[48:51]
    ds_read_b128 a[216:219], v236 offset:21504
    v_mfma_f32_16x16x32_bf16 v[52:55], v[96:99], v[188:191], v[52:55]
    s_waitcnt lgkmcnt(7)
    v_mfma_f32_16x16x32_bf16 v[56:59], v[100:103], v[184:187], v[56:59]
    ds_read_b128 a[220:223], v236 offset:22528
    v_mfma_f32_16x16x32_bf16 v[60:63], v[100:103], v[188:191], v[60:63]
    v_mfma_f32_16x16x32_bf16 v[64:67], v[104:107], v[184:187], v[64:67]
    ds_read_b128 a[224:227], v236 offset:23552
    v_mfma_f32_16x16x32_bf16 v[68:71], v[104:107], v[188:191], v[68:71]
    v_mfma_f32_16x16x32_bf16 v[72:75], v[108:111], v[184:187], v[72:75]
    ds_read_b128 a[228:231], v236 offset:24576
    v_mfma_f32_16x16x32_bf16 v[76:79], v[108:111], v[188:191], v[76:79]
    s_waitcnt lgkmcnt(6)
    v_mfma_f32_16x16x32_bf16 v[0:3], a[192:195], a[128:131], v[0:3]
    ds_read_b128 a[232:235], v233 offset:30720
    s_mov_b32 s34, 311296
    v_mfma_f32_16x16x32_bf16 v[4:7], a[192:195], a[132:135], v[4:7]
    buffer_load_dwordx4 a[176:179], v228, s[4:7], s34 offen offset:0 sc1
    v_mfma_f32_16x16x32_bf16 v[8:11], a[196:199], a[128:131], v[8:11]
    ds_read_b128 a[236:239], v233 offset:31744
    v_mfma_f32_16x16x32_bf16 v[12:15], a[196:199], a[132:135], v[12:15]
    buffer_load_dwordx4 a[180:183], v228, s[4:7], s34 offen offset:1024 sc1
    v_mfma_f32_16x16x32_bf16 v[16:19], a[200:203], a[128:131], v[16:19]
    ds_read_b128 a[240:243], v233 offset:32768
    v_mfma_f32_16x16x32_bf16 v[20:23], a[200:203], a[132:135], v[20:23]
    buffer_load_dwordx4 a[184:187], v228, s[4:7], s34 offen offset:2048 sc1
    v_mfma_f32_16x16x32_bf16 v[24:27], a[204:207], a[128:131], v[24:27]
    ds_read_b128 a[244:247], v233 offset:33792
    v_mfma_f32_16x16x32_bf16 v[28:31], a[204:207], a[132:135], v[28:31]
    buffer_load_dwordx4 a[188:191], v228, s[4:7], s34 offen offset:3072 sc1
    s_waitcnt lgkmcnt(7)
    v_mfma_f32_16x16x32_bf16 v[32:35], a[208:211], a[128:131], v[32:35]
    ds_read_b128 a[248:251], v233 offset:34816
    v_mfma_f32_16x16x32_bf16 v[36:39], a[208:211], a[132:135], v[36:39]
    v_mfma_f32_16x16x32_bf16 v[40:43], a[212:215], a[128:131], v[40:43]
    ds_read_b128 a[252:255], v236 offset:30720
    v_mfma_f32_16x16x32_bf16 v[44:47], a[212:215], a[132:135], v[44:47]
    v_mfma_f32_16x16x32_bf16 v[48:51], a[216:219], a[128:131], v[48:51]
    ds_read_b128 v[96:99], v236 offset:31744
    v_mfma_f32_16x16x32_bf16 v[52:55], a[216:219], a[132:135], v[52:55]
    s_waitcnt lgkmcnt(7)
    v_mfma_f32_16x16x32_bf16 v[56:59], a[220:223], a[128:131], v[56:59]
    ds_read_b128 v[100:103], v236 offset:32768
    v_mfma_f32_16x16x32_bf16 v[60:63], a[220:223], a[132:135], v[60:63]
    v_mfma_f32_16x16x32_bf16 v[64:67], a[224:227], a[128:131], v[64:67]
    ds_read_b128 v[104:107], v236 offset:33792
    v_mfma_f32_16x16x32_bf16 v[68:71], a[224:227], a[132:135], v[68:71]
    v_mfma_f32_16x16x32_bf16 v[72:75], a[228:231], a[128:131], v[72:75]
    ds_read_b128 v[108:111], v236 offset:34816
    v_mfma_f32_16x16x32_bf16 v[76:79], a[228:231], a[132:135], v[76:79]
    s_waitcnt vmcnt(18) lgkmcnt(6)
    s_barrier
    v_mfma_f32_16x16x32_bf16 v[0:3], a[232:235], a[136:139], v[0:3]
    ds_read_b128 a[192:195], v231 offset:0
    s_add_u32 m0, s50, 40960
    v_mfma_f32_16x16x32_bf16 v[4:7], a[232:235], a[140:143], v[4:7]
    s_mov_b32 s35, 409600
    v_mfma_f32_16x16x32_bf16 v[8:11], a[236:239], a[136:139], v[8:11]
    ds_read_b128 a[196:199], v231 offset:1024
    v_mfma_f32_16x16x32_bf16 v[12:15], a[236:239], a[140:143], v[12:15]
    buffer_load_dwordx4 v229, s[8:11], s35 offen offset:0 sc1 lds
    v_mfma_f32_16x16x32_bf16 v[16:19], a[240:243], a[136:139], v[16:19]
    ds_read_b128 a[200:203], v231 offset:2048
    v_mfma_f32_16x16x32_bf16 v[20:23], a[240:243], a[140:143], v[20:23]
    buffer_load_dwordx4 v229, s[8:11], s35 offen offset:1024 sc1 lds
    v_mfma_f32_16x16x32_bf16 v[24:27], a[244:247], a[136:139], v[24:27]
    ds_read_b128 a[204:207], v231 offset:3072
    v_mfma_f32_16x16x32_bf16 v[28:31], a[244:247], a[140:143], v[28:31]
    buffer_load_dwordx4 v229, s[8:11], s35 offen offset:2048 sc1 lds
    s_waitcnt lgkmcnt(7)
    v_mfma_f32_16x16x32_bf16 v[32:35], a[248:251], a[136:139], v[32:35]
    ds_read_b128 a[208:211], v231 offset:4096
    v_mfma_f32_16x16x32_bf16 v[36:39], a[248:251], a[140:143], v[36:39]
    buffer_load_dwordx4 v229, s[8:11], s35 offen offset:3072 sc1 lds
    v_mfma_f32_16x16x32_bf16 v[40:43], a[252:255], a[136:139], v[40:43]
    ds_read_b128 a[212:215], v234 offset:0
    s_add_u32 m0, s50, 45056
    v_mfma_f32_16x16x32_bf16 v[44:47], a[252:255], a[140:143], v[44:47]
    buffer_load_dwordx4 v230, s[8:11], s35 offen sc1 lds
    v_mfma_f32_16x16x32_bf16 v[48:51], v[96:99], a[136:139], v[48:51]
    ds_read_b128 a[216:219], v234 offset:1024
    v_mfma_f32_16x16x32_bf16 v[52:55], v[96:99], a[140:143], v[52:55]
    s_waitcnt lgkmcnt(7)
    v_mfma_f32_16x16x32_bf16 v[56:59], v[100:103], a[136:139], v[56:59]
    ds_read_b128 a[220:223], v234 offset:2048
    v_mfma_f32_16x16x32_bf16 v[60:63], v[100:103], a[140:143], v[60:63]
    v_mfma_f32_16x16x32_bf16 v[64:67], v[104:107], a[136:139], v[64:67]
    ds_read_b128 a[224:227], v234 offset:3072
    v_mfma_f32_16x16x32_bf16 v[68:71], v[104:107], a[140:143], v[68:71]
    v_mfma_f32_16x16x32_bf16 v[72:75], v[108:111], a[136:139], v[72:75]
    ds_read_b128 a[228:231], v234 offset:4096
    v_mfma_f32_16x16x32_bf16 v[76:79], v[108:111], a[140:143], v[76:79]
    s_waitcnt lgkmcnt(6)
    v_mfma_f32_16x16x32_bf16 v[0:3], a[192:195], a[144:147], v[0:3]
    ds_read_b128 a[232:235], v231 offset:10240
    s_mov_b32 s34, 327680
    v_mfma_f32_16x16x32_bf16 v[4:7], a[192:195], a[148:151], v[4:7]
    buffer_load_dwordx4 v[128:131], v228, s[4:7], s34 offen offset:0 sc1
    v_mfma_f32_16x16x32_bf16 v[8:11], a[196:199], a[144:147], v[8:11]
    ds_read_b128 a[236:239], v231 offset:11264
    v_mfma_f32_16x16x32_bf16 v[12:15], a[196:199], a[148:151], v[12:15]
    buffer_load_dwordx4 v[132:135], v228, s[4:7], s34 offen offset:1024 sc1
    v_mfma_f32_16x16x32_bf16 v[16:19], a[200:203], a[144:147], v[16:19]
    ds_read_b128 a[240:243], v231 offset:12288
    v_mfma_f32_16x16x32_bf16 v[20:23], a[200:203], a[148:151], v[20:23]
    buffer_load_dwordx4 v[136:139], v228, s[4:7], s34 offen offset:2048 sc1
    v_mfma_f32_16x16x32_bf16 v[24:27], a[204:207], a[144:147], v[24:27]
    ds_read_b128 a[244:247], v231 offset:13312
    v_mfma_f32_16x16x32_bf16 v[28:31], a[204:207], a[148:151], v[28:31]
    buffer_load_dwordx4 v[140:143], v228, s[4:7], s34 offen offset:3072 sc1
    s_waitcnt lgkmcnt(7)
    v_mfma_f32_16x16x32_bf16 v[32:35], a[208:211], a[144:147], v[32:35]
    ds_read_b128 a[248:251], v231 offset:14336
    v_mfma_f32_16x16x32_bf16 v[36:39], a[208:211], a[148:151], v[36:39]
    v_mfma_f32_16x16x32_bf16 v[40:43], a[212:215], a[144:147], v[40:43]
    ds_read_b128 a[252:255], v234 offset:10240
    v_mfma_f32_16x16x32_bf16 v[44:47], a[212:215], a[148:151], v[44:47]
    v_mfma_f32_16x16x32_bf16 v[48:51], a[216:219], a[144:147], v[48:51]
    ds_read_b128 v[96:99], v234 offset:11264
    v_mfma_f32_16x16x32_bf16 v[52:55], a[216:219], a[148:151], v[52:55]
    s_waitcnt lgkmcnt(7)
    v_mfma_f32_16x16x32_bf16 v[56:59], a[220:223], a[144:147], v[56:59]
    ds_read_b128 v[100:103], v234 offset:12288
    v_mfma_f32_16x16x32_bf16 v[60:63], a[220:223], a[148:151], v[60:63]
    v_mfma_f32_16x16x32_bf16 v[64:67], a[224:227], a[144:147], v[64:67]
    ds_read_b128 v[104:107], v234 offset:13312
    v_mfma_f32_16x16x32_bf16 v[68:71], a[224:227], a[148:151], v[68:71]
    v_mfma_f32_16x16x32_bf16 v[72:75], a[228:231], a[144:147], v[72:75]
    ds_read_b128 v[108:111], v234 offset:14336
    v_mfma_f32_16x16x32_bf16 v[76:79], a[228:231], a[148:151], v[76:79]
    s_waitcnt vmcnt(18) lgkmcnt(6)
    s_barrier
    v_mfma_f32_16x16x32_bf16 v[0:3], a[232:235], a[152:155], v[0:3]
    ds_read_b128 a[192:195], v231 offset:20480
    s_add_u32 m0, s50, 61440
    v_mfma_f32_16x16x32_bf16 v[4:7], a[232:235], a[156:159], v[4:7]
    s_mov_b32 s35, 430080
    v_mfma_f32_16x16x32_bf16 v[8:11], a[236:239], a[152:155], v[8:11]
    ds_read_b128 a[196:199], v231 offset:21504
    v_mfma_f32_16x16x32_bf16 v[12:15], a[236:239], a[156:159], v[12:15]
    buffer_load_dwordx4 v229, s[8:11], s35 offen offset:0 sc1 lds
    v_mfma_f32_16x16x32_bf16 v[16:19], a[240:243], a[152:155], v[16:19]
    ds_read_b128 a[200:203], v231 offset:22528
    v_mfma_f32_16x16x32_bf16 v[20:23], a[240:243], a[156:159], v[20:23]
    buffer_load_dwordx4 v229, s[8:11], s35 offen offset:1024 sc1 lds
    v_mfma_f32_16x16x32_bf16 v[24:27], a[244:247], a[152:155], v[24:27]
    ds_read_b128 a[204:207], v231 offset:23552
    v_mfma_f32_16x16x32_bf16 v[28:31], a[244:247], a[156:159], v[28:31]
    buffer_load_dwordx4 v229, s[8:11], s35 offen offset:2048 sc1 lds
    s_waitcnt lgkmcnt(7)
    v_mfma_f32_16x16x32_bf16 v[32:35], a[248:251], a[152:155], v[32:35]
    ds_read_b128 a[208:211], v231 offset:24576
    v_mfma_f32_16x16x32_bf16 v[36:39], a[248:251], a[156:159], v[36:39]
    buffer_load_dwordx4 v229, s[8:11], s35 offen offset:3072 sc1 lds
    v_mfma_f32_16x16x32_bf16 v[40:43], a[252:255], a[152:155], v[40:43]
    ds_read_b128 a[212:215], v234 offset:20480
    s_add_u32 m0, s50, 65536
    v_mfma_f32_16x16x32_bf16 v[44:47], a[252:255], a[156:159], v[44:47]
    buffer_load_dwordx4 v230, s[8:11], s35 offen sc1 lds
    v_mfma_f32_16x16x32_bf16 v[48:51], v[96:99], a[152:155], v[48:51]
    ds_read_b128 a[216:219], v234 offset:21504
    v_mfma_f32_16x16x32_bf16 v[52:55], v[96:99], a[156:159], v[52:55]
    s_waitcnt lgkmcnt(7)
    v_mfma_f32_16x16x32_bf16 v[56:59], v[100:103], a[152:155], v[56:59]
    ds_read_b128 a[220:223], v234 offset:22528
    v_mfma_f32_16x16x32_bf16 v[60:63], v[100:103], a[156:159], v[60:63]
    v_mfma_f32_16x16x32_bf16 v[64:67], v[104:107], a[152:155], v[64:67]
    ds_read_b128 a[224:227], v234 offset:23552
    v_mfma_f32_16x16x32_bf16 v[68:71], v[104:107], a[156:159], v[68:71]
    v_mfma_f32_16x16x32_bf16 v[72:75], v[108:111], a[152:155], v[72:75]
    ds_read_b128 a[228:231], v234 offset:24576
    v_mfma_f32_16x16x32_bf16 v[76:79], v[108:111], a[156:159], v[76:79]
    s_waitcnt lgkmcnt(6)
    v_mfma_f32_16x16x32_bf16 v[0:3], a[192:195], a[160:163], v[0:3]
    ds_read_b128 a[232:235], v231 offset:30720
    s_mov_b32 s34, 344064
    v_mfma_f32_16x16x32_bf16 v[4:7], a[192:195], a[164:167], v[4:7]
    buffer_load_dwordx4 v[144:147], v228, s[4:7], s34 offen offset:0 sc1
    v_mfma_f32_16x16x32_bf16 v[8:11], a[196:199], a[160:163], v[8:11]
    ds_read_b128 a[236:239], v231 offset:31744
    v_mfma_f32_16x16x32_bf16 v[12:15], a[196:199], a[164:167], v[12:15]
    buffer_load_dwordx4 v[148:151], v228, s[4:7], s34 offen offset:1024 sc1
    v_mfma_f32_16x16x32_bf16 v[16:19], a[200:203], a[160:163], v[16:19]
    ds_read_b128 a[240:243], v231 offset:32768
    v_mfma_f32_16x16x32_bf16 v[20:23], a[200:203], a[164:167], v[20:23]
    buffer_load_dwordx4 v[152:155], v228, s[4:7], s34 offen offset:2048 sc1
    v_mfma_f32_16x16x32_bf16 v[24:27], a[204:207], a[160:163], v[24:27]
    ds_read_b128 a[244:247], v231 offset:33792
    v_mfma_f32_16x16x32_bf16 v[28:31], a[204:207], a[164:167], v[28:31]
    buffer_load_dwordx4 v[156:159], v228, s[4:7], s34 offen offset:3072 sc1
    s_waitcnt lgkmcnt(7)
    v_mfma_f32_16x16x32_bf16 v[32:35], a[208:211], a[160:163], v[32:35]
    ds_read_b128 a[248:251], v231 offset:34816
    v_mfma_f32_16x16x32_bf16 v[36:39], a[208:211], a[164:167], v[36:39]
    v_mfma_f32_16x16x32_bf16 v[40:43], a[212:215], a[160:163], v[40:43]
    ds_read_b128 a[252:255], v234 offset:30720
    v_mfma_f32_16x16x32_bf16 v[44:47], a[212:215], a[164:167], v[44:47]
    v_mfma_f32_16x16x32_bf16 v[48:51], a[216:219], a[160:163], v[48:51]
    ds_read_b128 v[96:99], v234 offset:31744
    v_mfma_f32_16x16x32_bf16 v[52:55], a[216:219], a[164:167], v[52:55]
    s_waitcnt lgkmcnt(7)
    v_mfma_f32_16x16x32_bf16 v[56:59], a[220:223], a[160:163], v[56:59]
    ds_read_b128 v[100:103], v234 offset:32768
    v_mfma_f32_16x16x32_bf16 v[60:63], a[220:223], a[164:167], v[60:63]
    v_mfma_f32_16x16x32_bf16 v[64:67], a[224:227], a[160:163], v[64:67]
    ds_read_b128 v[104:107], v234 offset:33792
    v_mfma_f32_16x16x32_bf16 v[68:71], a[224:227], a[164:167], v[68:71]
    v_mfma_f32_16x16x32_bf16 v[72:75], a[228:231], a[160:163], v[72:75]
    ds_read_b128 v[108:111], v234 offset:34816
    v_mfma_f32_16x16x32_bf16 v[76:79], a[228:231], a[164:167], v[76:79]
    s_waitcnt vmcnt(18) lgkmcnt(6)
    s_barrier
    v_mfma_f32_16x16x32_bf16 v[0:3], a[232:235], a[168:171], v[0:3]
    ds_read_b128 a[192:195], v232 offset:20480
    s_add_u32 m0, s50, 102400
    v_mfma_f32_16x16x32_bf16 v[4:7], a[232:235], a[172:175], v[4:7]
    s_mov_b32 s35, 450560
    v_mfma_f32_16x16x32_bf16 v[8:11], a[236:239], a[168:171], v[8:11]
    ds_read_b128 a[196:199], v232 offset:21504
    v_mfma_f32_16x16x32_bf16 v[12:15], a[236:239], a[172:175], v[12:15]
    buffer_load_dwordx4 v229, s[8:11], s35 offen offset:0 sc1 lds
    v_mfma_f32_16x16x32_bf16 v[16:19], a[240:243], a[168:171], v[16:19]
    ds_read_b128 a[200:203], v232 offset:22528
    v_mfma_f32_16x16x32_bf16 v[20:23], a[240:243], a[172:175], v[20:23]
    buffer_load_dwordx4 v229, s[8:11], s35 offen offset:1024 sc1 lds
    v_mfma_f32_16x16x32_bf16 v[24:27], a[244:247], a[168:171], v[24:27]
    ds_read_b128 a[204:207], v232 offset:23552
    v_mfma_f32_16x16x32_bf16 v[28:31], a[244:247], a[172:175], v[28:31]
    buffer_load_dwordx4 v229, s[8:11], s35 offen offset:2048 sc1 lds
    s_waitcnt lgkmcnt(7)
    v_mfma_f32_16x16x32_bf16 v[32:35], a[248:251], a[168:171], v[32:35]
    ds_read_b128 a[208:211], v232 offset:24576
    v_mfma_f32_16x16x32_bf16 v[36:39], a[248:251], a[172:175], v[36:39]
    buffer_load_dwordx4 v229, s[8:11], s35 offen offset:3072 sc1 lds
    v_mfma_f32_16x16x32_bf16 v[40:43], a[252:255], a[168:171], v[40:43]
    ds_read_b128 a[212:215], v235 offset:20480
    s_add_u32 m0, s50, 106496
    v_mfma_f32_16x16x32_bf16 v[44:47], a[252:255], a[172:175], v[44:47]
    buffer_load_dwordx4 v230, s[8:11], s35 offen sc1 lds
    v_mfma_f32_16x16x32_bf16 v[48:51], v[96:99], a[168:171], v[48:51]
    ds_read_b128 a[216:219], v235 offset:21504
    v_mfma_f32_16x16x32_bf16 v[52:55], v[96:99], a[172:175], v[52:55]
    s_waitcnt lgkmcnt(7)
    v_mfma_f32_16x16x32_bf16 v[56:59], v[100:103], a[168:171], v[56:59]
    ds_read_b128 a[220:223], v235 offset:22528
    v_mfma_f32_16x16x32_bf16 v[60:63], v[100:103], a[172:175], v[60:63]
    v_mfma_f32_16x16x32_bf16 v[64:67], v[104:107], a[168:171], v[64:67]
    ds_read_b128 a[224:227], v235 offset:23552
    v_mfma_f32_16x16x32_bf16 v[68:71], v[104:107], a[172:175], v[68:71]
    v_mfma_f32_16x16x32_bf16 v[72:75], v[108:111], a[168:171], v[72:75]
    ds_read_b128 a[228:231], v235 offset:24576
    v_mfma_f32_16x16x32_bf16 v[76:79], v[108:111], a[172:175], v[76:79]
    s_waitcnt lgkmcnt(6)
    v_mfma_f32_16x16x32_bf16 v[0:3], a[192:195], a[176:179], v[0:3]
    ds_read_b128 a[232:235], v232 offset:30720
    s_mov_b32 s34, 360448
    v_mfma_f32_16x16x32_bf16 v[4:7], a[192:195], a[180:183], v[4:7]
    buffer_load_dwordx4 v[160:163], v228, s[4:7], s34 offen offset:0 sc1
    v_mfma_f32_16x16x32_bf16 v[8:11], a[196:199], a[176:179], v[8:11]
    ds_read_b128 a[236:239], v232 offset:31744
    v_mfma_f32_16x16x32_bf16 v[12:15], a[196:199], a[180:183], v[12:15]
    buffer_load_dwordx4 v[164:167], v228, s[4:7], s34 offen offset:1024 sc1
    v_mfma_f32_16x16x32_bf16 v[16:19], a[200:203], a[176:179], v[16:19]
    ds_read_b128 a[240:243], v232 offset:32768
    v_mfma_f32_16x16x32_bf16 v[20:23], a[200:203], a[180:183], v[20:23]
    buffer_load_dwordx4 v[168:171], v228, s[4:7], s34 offen offset:2048 sc1
    v_mfma_f32_16x16x32_bf16 v[24:27], a[204:207], a[176:179], v[24:27]
    ds_read_b128 a[244:247], v232 offset:33792
    v_mfma_f32_16x16x32_bf16 v[28:31], a[204:207], a[180:183], v[28:31]
    buffer_load_dwordx4 v[172:175], v228, s[4:7], s34 offen offset:3072 sc1
    s_waitcnt lgkmcnt(7)
    v_mfma_f32_16x16x32_bf16 v[32:35], a[208:211], a[176:179], v[32:35]
    ds_read_b128 a[248:251], v232 offset:34816
    v_mfma_f32_16x16x32_bf16 v[36:39], a[208:211], a[180:183], v[36:39]
    v_mfma_f32_16x16x32_bf16 v[40:43], a[212:215], a[176:179], v[40:43]
    ds_read_b128 a[252:255], v235 offset:30720
    v_mfma_f32_16x16x32_bf16 v[44:47], a[212:215], a[180:183], v[44:47]
    v_mfma_f32_16x16x32_bf16 v[48:51], a[216:219], a[176:179], v[48:51]
    ds_read_b128 v[96:99], v235 offset:31744
    v_mfma_f32_16x16x32_bf16 v[52:55], a[216:219], a[180:183], v[52:55]
    s_waitcnt lgkmcnt(7)
    v_mfma_f32_16x16x32_bf16 v[56:59], a[220:223], a[176:179], v[56:59]
    ds_read_b128 v[100:103], v235 offset:32768
    v_mfma_f32_16x16x32_bf16 v[60:63], a[220:223], a[180:183], v[60:63]
    v_mfma_f32_16x16x32_bf16 v[64:67], a[224:227], a[176:179], v[64:67]
    ds_read_b128 v[104:107], v235 offset:33792
    v_mfma_f32_16x16x32_bf16 v[68:71], a[224:227], a[180:183], v[68:71]
    v_mfma_f32_16x16x32_bf16 v[72:75], a[228:231], a[176:179], v[72:75]
    ds_read_b128 v[108:111], v235 offset:34816
    v_mfma_f32_16x16x32_bf16 v[76:79], a[228:231], a[180:183], v[76:79]
    s_waitcnt vmcnt(18) lgkmcnt(6)
    s_barrier
    v_mfma_f32_16x16x32_bf16 v[0:3], a[232:235], a[184:187], v[0:3]
    ds_read_b128 a[192:195], v231 offset:40960
    s_add_u32 m0, s50, 122880
    v_mfma_f32_16x16x32_bf16 v[4:7], a[232:235], a[188:191], v[4:7]
    s_mov_b32 s35, 471040
    v_mfma_f32_16x16x32_bf16 v[8:11], a[236:239], a[184:187], v[8:11]
    ds_read_b128 a[196:199], v231 offset:41984
    v_mfma_f32_16x16x32_bf16 v[12:15], a[236:239], a[188:191], v[12:15]
    buffer_load_dwordx4 v229, s[8:11], s35 offen offset:0 sc1 lds
    v_mfma_f32_16x16x32_bf16 v[16:19], a[240:243], a[184:187], v[16:19]
    ds_read_b128 a[200:203], v231 offset:43008
    v_mfma_f32_16x16x32_bf16 v[20:23], a[240:243], a[188:191], v[20:23]
    buffer_load_dwordx4 v229, s[8:11], s35 offen offset:1024 sc1 lds
    v_mfma_f32_16x16x32_bf16 v[24:27], a[244:247], a[184:187], v[24:27]
    ds_read_b128 a[204:207], v231 offset:44032
    v_mfma_f32_16x16x32_bf16 v[28:31], a[244:247], a[188:191], v[28:31]
    buffer_load_dwordx4 v229, s[8:11], s35 offen offset:2048 sc1 lds
    s_waitcnt lgkmcnt(7)
    v_mfma_f32_16x16x32_bf16 v[32:35], a[248:251], a[184:187], v[32:35]
    ds_read_b128 a[208:211], v231 offset:45056
    v_mfma_f32_16x16x32_bf16 v[36:39], a[248:251], a[188:191], v[36:39]
    buffer_load_dwordx4 v229, s[8:11], s35 offen offset:3072 sc1 lds
    v_mfma_f32_16x16x32_bf16 v[40:43], a[252:255], a[184:187], v[40:43]
    ds_read_b128 a[212:215], v234 offset:40960
    s_add_u32 m0, s50, 126976
    v_mfma_f32_16x16x32_bf16 v[44:47], a[252:255], a[188:191], v[44:47]
    buffer_load_dwordx4 v230, s[8:11], s35 offen sc1 lds
    v_mfma_f32_16x16x32_bf16 v[48:51], v[96:99], a[184:187], v[48:51]
    ds_read_b128 a[216:219], v234 offset:41984
    v_mfma_f32_16x16x32_bf16 v[52:55], v[96:99], a[188:191], v[52:55]
    s_waitcnt lgkmcnt(7)
    v_mfma_f32_16x16x32_bf16 v[56:59], v[100:103], a[184:187], v[56:59]
    ds_read_b128 a[220:223], v234 offset:43008
    v_mfma_f32_16x16x32_bf16 v[60:63], v[100:103], a[188:191], v[60:63]
    v_mfma_f32_16x16x32_bf16 v[64:67], v[104:107], a[184:187], v[64:67]
    ds_read_b128 a[224:227], v234 offset:44032
    v_mfma_f32_16x16x32_bf16 v[68:71], v[104:107], a[188:191], v[68:71]
    v_mfma_f32_16x16x32_bf16 v[72:75], v[108:111], a[184:187], v[72:75]
    ds_read_b128 a[228:231], v234 offset:45056
    v_mfma_f32_16x16x32_bf16 v[76:79], v[108:111], a[188:191], v[76:79]
    s_waitcnt lgkmcnt(6)
    v_mfma_f32_16x16x32_bf16 v[0:3], a[192:195], v[128:131], v[0:3]
    ds_read_b128 a[232:235], v231 offset:51200
    s_mov_b32 s34, 376832
    v_mfma_f32_16x16x32_bf16 v[4:7], a[192:195], v[132:135], v[4:7]
    s_bitcmp1_b32 s96, 1
    s_mov_b32 s101, 327680
    s_cselect_b32 s101, s101, 4294639616
    v_mfma_f32_16x16x32_bf16 v[8:11], a[196:199], v[128:131], v[8:11]
    ds_read_b128 a[236:239], v231 offset:52224
    v_mfma_f32_16x16x32_bf16 v[12:15], a[196:199], v[132:135], v[12:15]
    v_add_u32 v212, s101, v238
    v_mfma_f32_16x16x32_bf16 v[16:19], a[200:203], v[128:131], v[16:19]
    ds_read_b128 a[240:243], v231 offset:53248
    v_mfma_f32_16x16x32_bf16 v[20:23], a[200:203], v[132:135], v[20:23]
    v_add_u32 v213, s101, v239
    v_mfma_f32_16x16x32_bf16 v[24:27], a[204:207], v[128:131], v[24:27]
    ds_read_b128 a[244:247], v231 offset:54272
    v_mfma_f32_16x16x32_bf16 v[28:31], a[204:207], v[132:135], v[28:31]
    s_mov_b32 s51, 20000
    s_waitcnt lgkmcnt(7)
    v_mfma_f32_16x16x32_bf16 v[32:35], a[208:211], v[128:131], v[32:35]
    ds_read_b128 a[248:251], v231 offset:55296
    v_mfma_f32_16x16x32_bf16 v[36:39], a[208:211], v[132:135], v[36:39]
    buffer_load_dwordx4 v[176:179], v228, s[4:7], s34 offen offset:0 sc1
    v_mfma_f32_16x16x32_bf16 v[40:43], a[212:215], v[128:131], v[40:43]
    ds_read_b128 a[252:255], v234 offset:51200
    v_mfma_f32_16x16x32_bf16 v[44:47], a[212:215], v[132:135], v[44:47]
    buffer_load_dwordx4 v[180:183], v228, s[4:7], s34 offen offset:1024 sc1
    v_mfma_f32_16x16x32_bf16 v[48:51], a[216:219], v[128:131], v[48:51]
    ds_read_b128 v[96:99], v234 offset:52224
    v_mfma_f32_16x16x32_bf16 v[52:55], a[216:219], v[132:135], v[52:55]
    buffer_load_dwordx4 v[184:187], v228, s[4:7], s34 offen offset:2048 sc1
    s_waitcnt lgkmcnt(7)
    v_mfma_f32_16x16x32_bf16 v[56:59], a[220:223], v[128:131], v[56:59]
    ds_read_b128 v[100:103], v234 offset:53248
    v_mfma_f32_16x16x32_bf16 v[60:63], a[220:223], v[132:135], v[60:63]
    buffer_load_dwordx4 v[188:191], v228, s[4:7], s34 offen offset:3072 sc1
    v_mfma_f32_16x16x32_bf16 v[64:67], a[224:227], v[128:131], v[64:67]
    ds_read_b128 v[104:107], v234 offset:54272
    v_mfma_f32_16x16x32_bf16 v[68:71], a[224:227], v[132:135], v[68:71]
    v_mfma_f32_16x16x32_bf16 v[72:75], a[228:231], v[128:131], v[72:75]
    ds_read_b128 v[108:111], v234 offset:55296
    v_mfma_f32_16x16x32_bf16 v[76:79], a[228:231], v[132:135], v[76:79]
    s_waitcnt vmcnt(18) lgkmcnt(6)
    s_barrier
    v_mfma_f32_16x16x32_bf16 v[0:3], a[232:235], v[136:139], v[0:3]
    ds_read_b128 a[192:195], v232 offset:0
    s_add_u32 m0, s50, 143360
    v_mfma_f32_16x16x32_bf16 v[4:7], a[232:235], v[140:143], v[4:7]
    s_mov_b32 s35, 491520
    v_mfma_f32_16x16x32_bf16 v[8:11], a[236:239], v[136:139], v[8:11]
    ds_read_b128 a[196:199], v232 offset:1024
    v_mfma_f32_16x16x32_bf16 v[12:15], a[236:239], v[140:143], v[12:15]
    buffer_load_dwordx4 v229, s[8:11], s35 offen offset:0 sc1 lds
    v_mfma_f32_16x16x32_bf16 v[16:19], a[240:243], v[136:139], v[16:19]
    ds_read_b128 a[200:203], v232 offset:2048
    v_mfma_f32_16x16x32_bf16 v[20:23], a[240:243], v[140:143], v[20:23]
    buffer_load_dwordx4 v229, s[8:11], s35 offen offset:1024 sc1 lds
    v_mfma_f32_16x16x32_bf16 v[24:27], a[244:247], v[136:139], v[24:27]
    ds_read_b128 a[204:207], v232 offset:3072
    v_mfma_f32_16x16x32_bf16 v[28:31], a[244:247], v[140:143], v[28:31]
    buffer_load_dwordx4 v229, s[8:11], s35 offen offset:2048 sc1 lds
    s_waitcnt lgkmcnt(7)
    v_mfma_f32_16x16x32_bf16 v[32:35], a[248:251], v[136:139], v[32:35]
    ds_read_b128 a[208:211], v232 offset:4096
    v_mfma_f32_16x16x32_bf16 v[36:39], a[248:251], v[140:143], v[36:39]
    buffer_load_dwordx4 v229, s[8:11], s35 offen offset:3072 sc1 lds
    v_mfma_f32_16x16x32_bf16 v[40:43], a[252:255], v[136:139], v[40:43]
    ds_read_b128 a[212:215], v235 offset:0
    s_add_u32 m0, s50, 147456
    v_mfma_f32_16x16x32_bf16 v[44:47], a[252:255], v[140:143], v[44:47]
    buffer_load_dwordx4 v230, s[8:11], s35 offen sc1 lds
    v_mfma_f32_16x16x32_bf16 v[48:51], v[96:99], v[136:139], v[48:51]
    ds_read_b128 a[216:219], v235 offset:1024
    v_mfma_f32_16x16x32_bf16 v[52:55], v[96:99], v[140:143], v[52:55]
    s_waitcnt lgkmcnt(7)
    v_mfma_f32_16x16x32_bf16 v[56:59], v[100:103], v[136:139], v[56:59]
    ds_read_b128 a[220:223], v235 offset:2048
    v_mfma_f32_16x16x32_bf16 v[60:63], v[100:103], v[140:143], v[60:63]
    v_mfma_f32_16x16x32_bf16 v[64:67], v[104:107], v[136:139], v[64:67]
    ds_read_b128 a[224:227], v235 offset:3072
    v_mfma_f32_16x16x32_bf16 v[68:71], v[104:107], v[140:143], v[68:71]
    v_mfma_f32_16x16x32_bf16 v[72:75], v[108:111], v[136:139], v[72:75]
    ds_read_b128 a[228:231], v235 offset:4096
    v_mfma_f32_16x16x32_bf16 v[76:79], v[108:111], v[140:143], v[76:79]
    s_waitcnt lgkmcnt(6)
    v_mfma_f32_16x16x32_bf16 v[0:3], a[192:195], v[144:147], v[0:3]
    ds_read_b128 a[232:235], v232 offset:10240
    s_mov_b32 s34, 393216
    v_mfma_f32_16x16x32_bf16 v[4:7], a[192:195], v[148:151], v[4:7]
    buffer_load_dwordx4 a[128:131], v228, s[4:7], s34 offen offset:0 sc1
    v_mfma_f32_16x16x32_bf16 v[8:11], a[196:199], v[144:147], v[8:11]
    ds_read_b128 a[236:239], v232 offset:11264
    v_mfma_f32_16x16x32_bf16 v[12:15], a[196:199], v[148:151], v[12:15]
    buffer_load_dwordx4 a[132:135], v228, s[4:7], s34 offen offset:1024 sc1
    v_mfma_f32_16x16x32_bf16 v[16:19], a[200:203], v[144:147], v[16:19]
    ds_read_b128 a[240:243], v232 offset:12288
    v_mfma_f32_16x16x32_bf16 v[20:23], a[200:203], v[148:151], v[20:23]
    buffer_load_dwordx4 a[136:139], v228, s[4:7], s34 offen offset:2048 sc1
    v_mfma_f32_16x16x32_bf16 v[24:27], a[204:207], v[144:147], v[24:27]
    ds_read_b128 a[244:247], v232 offset:13312
    v_mfma_f32_16x16x32_bf16 v[28:31], a[204:207], v[148:151], v[28:31]
    buffer_load_dwordx4 a[140:143], v228, s[4:7], s34 offen offset:3072 sc1
    s_waitcnt lgkmcnt(7)
    v_mfma_f32_16x16x32_bf16 v[32:35], a[208:211], v[144:147], v[32:35]
    ds_read_b128 a[248:251], v232 offset:14336
    s_add_u32 m0, s50, 0
    v_mfma_f32_16x16x32_bf16 v[36:39], a[208:211], v[148:151], v[36:39]
    s_mov_b32 s35, 512000
    v_mfma_f32_16x16x32_bf16 v[40:43], a[212:215], v[144:147], v[40:43]
    ds_read_b128 a[252:255], v235 offset:10240
    v_mfma_f32_16x16x32_bf16 v[44:47], a[212:215], v[148:151], v[44:47]
    buffer_load_dwordx4 v229, s[8:11], s35 offen offset:0 sc1 lds
    v_mfma_f32_16x16x32_bf16 v[48:51], a[216:219], v[144:147], v[48:51]
    ds_read_b128 v[96:99], v235 offset:11264
    v_mfma_f32_16x16x32_bf16 v[52:55], a[216:219], v[148:151], v[52:55]
    buffer_load_dwordx4 v229, s[8:11], s35 offen offset:1024 sc1 lds
    s_waitcnt lgkmcnt(7)
    v_mfma_f32_16x16x32_bf16 v[56:59], a[220:223], v[144:147], v[56:59]
    ds_read_b128 v[100:103], v235 offset:12288
    v_mfma_f32_16x16x32_bf16 v[60:63], a[220:223], v[148:151], v[60:63]
    v_mfma_f32_16x16x32_bf16 v[64:67], a[224:227], v[144:147], v[64:67]
    ds_read_b128 v[104:107], v235 offset:13312
    v_mfma_f32_16x16x32_bf16 v[68:71], a[224:227], v[148:151], v[68:71]
    v_mfma_f32_16x16x32_bf16 v[72:75], a[228:231], v[144:147], v[72:75]
    ds_read_b128 v[108:111], v235 offset:14336
    v_mfma_f32_16x16x32_bf16 v[76:79], a[228:231], v[148:151], v[76:79]
    s_waitcnt vmcnt(20) lgkmcnt(6)
    s_barrier
    v_mfma_f32_16x16x32_bf16 v[0:3], a[232:235], v[152:155], v[0:3]
    ds_read_b128 a[192:195], v232 offset:40960
    v_mfma_f32_16x16x32_bf16 v[4:7], a[232:235], v[156:159], v[4:7]
    buffer_load_dwordx4 v229, s[8:11], s35 offen offset:2048 sc1 lds
    v_mfma_f32_16x16x32_bf16 v[8:11], a[236:239], v[152:155], v[8:11]
    ds_read_b128 a[196:199], v232 offset:41984
    v_mfma_f32_16x16x32_bf16 v[12:15], a[236:239], v[156:159], v[12:15]
    buffer_load_dwordx4 v229, s[8:11], s35 offen offset:3072 sc1 lds
    v_mfma_f32_16x16x32_bf16 v[16:19], a[240:243], v[152:155], v[16:19]
    ds_read_b128 a[200:203], v232 offset:43008
    s_add_u32 m0, s50, 4096
    v_mfma_f32_16x16x32_bf16 v[20:23], a[240:243], v[156:159], v[20:23]
    buffer_load_dwordx4 v230, s[8:11], s35 offen sc1 lds
    v_mfma_f32_16x16x32_bf16 v[24:27], a[244:247], v[152:155], v[24:27]
    ds_read_b128 a[204:207], v232 offset:44032
    s_mov_b32 s34, 409600
    v_mfma_f32_16x16x32_bf16 v[28:31], a[244:247], v[156:159], v[28:31]
    buffer_load_dwordx4 a[144:147], v228, s[4:7], s34 offen offset:0 sc1
    s_waitcnt lgkmcnt(7)
    v_mfma_f32_16x16x32_bf16 v[32:35], a[248:251], v[152:155], v[32:35]
    ds_read_b128 a[208:211], v232 offset:45056
    v_mfma_f32_16x16x32_bf16 v[36:39], a[248:251], v[156:159], v[36:39]
    buffer_load_dwordx4 a[148:151], v228, s[4:7], s34 offen offset:1024 sc1
    v_mfma_f32_16x16x32_bf16 v[40:43], a[252:255], v[152:155], v[40:43]
    ds_read_b128 a[212:215], v235 offset:40960
    v_mfma_f32_16x16x32_bf16 v[44:47], a[252:255], v[156:159], v[44:47]
    buffer_load_dwordx4 a[152:155], v228, s[4:7], s34 offen offset:2048 sc1
    v_mfma_f32_16x16x32_bf16 v[48:51], v[96:99], v[152:155], v[48:51]
    ds_read_b128 a[216:219], v235 offset:41984
    v_mfma_f32_16x16x32_bf16 v[52:55], v[96:99], v[156:159], v[52:55]
    s_waitcnt lgkmcnt(7)
    v_mfma_f32_16x16x32_bf16 v[56:59], v[100:103], v[152:155], v[56:59]
    ds_read_b128 a[220:223], v235 offset:43008
    v_mfma_f32_16x16x32_bf16 v[60:63], v[100:103], v[156:159], v[60:63]
    v_mfma_f32_16x16x32_bf16 v[64:67], v[104:107], v[152:155], v[64:67]
    ds_read_b128 a[224:227], v235 offset:44032
    v_mfma_f32_16x16x32_bf16 v[68:71], v[104:107], v[156:159], v[68:71]
    v_mfma_f32_16x16x32_bf16 v[72:75], v[108:111], v[152:155], v[72:75]
    ds_read_b128 a[228:231], v235 offset:45056
    v_mfma_f32_16x16x32_bf16 v[76:79], v[108:111], v[156:159], v[76:79]
    s_waitcnt lgkmcnt(6)
    v_mfma_f32_16x16x32_bf16 v[0:3], a[192:195], v[160:163], v[0:3]
    ds_read_b128 a[232:235], v232 offset:51200
    v_mfma_f32_16x16x32_bf16 v[4:7], a[192:195], v[164:167], v[4:7]
    buffer_load_dwordx4 a[156:159], v228, s[4:7], s34 offen offset:3072 sc1
    v_mfma_f32_16x16x32_bf16 v[8:11], a[196:199], v[160:163], v[8:11]
    ds_read_b128 a[236:239], v232 offset:52224
    s_add_u32 m0, s50, 20480
    v_mfma_f32_16x16x32_bf16 v[12:15], a[196:199], v[164:167], v[12:15]
    s_mov_b32 s35, 532480
    v_mfma_f32_16x16x32_bf16 v[16:19], a[200:203], v[160:163], v[16:19]
    ds_read_b128 a[240:243], v232 offset:53248
    v_mfma_f32_16x16x32_bf16 v[20:23], a[200:203], v[164:167], v[20:23]
    buffer_load_dwordx4 v229, s[8:11], s35 offen offset:0 sc1 lds
    v_mfma_f32_16x16x32_bf16 v[24:27], a[204:207], v[160:163], v[24:27]
    ds_read_b128 a[244:247], v232 offset:54272
    v_mfma_f32_16x16x32_bf16 v[28:31], a[204:207], v[164:167], v[28:31]
    buffer_load_dwordx4 v229, s[8:11], s35 offen offset:1024 sc1 lds
    s_waitcnt lgkmcnt(7)
    v_mfma_f32_16x16x32_bf16 v[32:35], a[208:211], v[160:163], v[32:35]
    ds_read_b128 a[248:251], v232 offset:55296
    v_mfma_f32_16x16x32_bf16 v[36:39], a[208:211], v[164:167], v[36:39]
    buffer_load_dwordx4 v229, s[8:11], s35 offen offset:2048 sc1 lds
    v_mfma_f32_16x16x32_bf16 v[40:43], a[212:215], v[160:163], v[40:43]
    ds_read_b128 a[252:255], v235 offset:51200
    v_mfma_f32_16x16x32_bf16 v[44:47], a[212:215], v[164:167], v[44:47]
    buffer_load_dwordx4 v229, s[8:11], s35 offen offset:3072 sc1 lds
    v_mfma_f32_16x16x32_bf16 v[48:51], a[216:219], v[160:163], v[48:51]
    ds_read_b128 v[96:99], v235 offset:52224
    s_add_u32 m0, s50, 24576
    v_mfma_f32_16x16x32_bf16 v[52:55], a[216:219], v[164:167], v[52:55]
    buffer_load_dwordx4 v230, s[8:11], s35 offen sc1 lds
    s_waitcnt lgkmcnt(7)
    v_mfma_f32_16x16x32_bf16 v[56:59], a[220:223], v[160:163], v[56:59]
    ds_read_b128 v[100:103], v235 offset:53248
    v_mfma_f32_16x16x32_bf16 v[60:63], a[220:223], v[164:167], v[60:63]
    v_mfma_f32_16x16x32_bf16 v[64:67], a[224:227], v[160:163], v[64:67]
    ds_read_b128 v[104:107], v235 offset:54272
    v_mfma_f32_16x16x32_bf16 v[68:71], a[224:227], v[164:167], v[68:71]
    v_mfma_f32_16x16x32_bf16 v[72:75], a[228:231], v[160:163], v[72:75]
    ds_read_b128 v[108:111], v235 offset:55296
    v_mfma_f32_16x16x32_bf16 v[76:79], a[228:231], v[164:167], v[76:79]
    s_waitcnt vmcnt(23) lgkmcnt(6)
    s_barrier
    v_mfma_f32_16x16x32_bf16 v[0:3], a[232:235], v[168:171], v[0:3]
    ds_read_b128 a[192:195], v233 offset:0
    s_mov_b32 s34, 425984
    v_mfma_f32_16x16x32_bf16 v[4:7], a[232:235], v[172:175], v[4:7]
    buffer_load_dwordx4 a[160:163], v228, s[4:7], s34 offen offset:0 sc1
    v_mfma_f32_16x16x32_bf16 v[8:11], a[236:239], v[168:171], v[8:11]
    ds_read_b128 a[196:199], v233 offset:1024
    v_mfma_f32_16x16x32_bf16 v[12:15], a[236:239], v[172:175], v[12:15]
    buffer_load_dwordx4 a[164:167], v228, s[4:7], s34 offen offset:1024 sc1
    v_mfma_f32_16x16x32_bf16 v[16:19], a[240:243], v[168:171], v[16:19]
    ds_read_b128 a[200:203], v233 offset:2048
    v_mfma_f32_16x16x32_bf16 v[20:23], a[240:243], v[172:175], v[20:23]
    buffer_load_dwordx4 a[168:171], v228, s[4:7], s34 offen offset:2048 sc1
    v_mfma_f32_16x16x32_bf16 v[24:27], a[244:247], v[168:171], v[24:27]
    ds_read_b128 a[204:207], v233 offset:3072
    v_mfma_f32_16x16x32_bf16 v[28:31], a[244:247], v[172:175], v[28:31]
    buffer_load_dwordx4 a[172:175], v228, s[4:7], s34 offen offset:3072 sc1
    s_waitcnt lgkmcnt(7)
    v_mfma_f32_16x16x32_bf16 v[32:35], a[248:251], v[168:171], v[32:35]
    ds_read_b128 a[208:211], v233 offset:4096
    s_add_u32 m0, s50, 81920
    v_mfma_f32_16x16x32_bf16 v[36:39], a[248:251], v[172:175], v[36:39]
    s_mov_b32 s35, 552960
    v_mfma_f32_16x16x32_bf16 v[40:43], a[252:255], v[168:171], v[40:43]
    ds_read_b128 a[212:215], v236 offset:0
    v_mfma_f32_16x16x32_bf16 v[44:47], a[252:255], v[172:175], v[44:47]
    buffer_load_dwordx4 v229, s[8:11], s35 offen offset:0 sc1 lds
    v_mfma_f32_16x16x32_bf16 v[48:51], v[96:99], v[168:171], v[48:51]
    ds_read_b128 a[216:219], v236 offset:1024
    v_mfma_f32_16x16x32_bf16 v[52:55], v[96:99], v[172:175], v[52:55]
    buffer_load_dwordx4 v229, s[8:11], s35 offen offset:1024 sc1 lds
    s_waitcnt lgkmcnt(7)
    v_mfma_f32_16x16x32_bf16 v[56:59], v[100:103], v[168:171], v[56:59]
    ds_read_b128 a[220:223], v236 offset:2048
    v_mfma_f32_16x16x32_bf16 v[60:63], v[100:103], v[172:175], v[60:63]
    v_mfma_f32_16x16x32_bf16 v[64:67], v[104:107], v[168:171], v[64:67]
    ds_read_b128 a[224:227], v236 offset:3072
    v_mfma_f32_16x16x32_bf16 v[68:71], v[104:107], v[172:175], v[68:71]
    v_mfma_f32_16x16x32_bf16 v[72:75], v[108:111], v[168:171], v[72:75]
    ds_read_b128 a[228:231], v236 offset:4096
    v_mfma_f32_16x16x32_bf16 v[76:79], v[108:111], v[172:175], v[76:79]
    s_waitcnt lgkmcnt(6)
    v_mfma_f32_16x16x32_bf16 v[0:3], a[192:195], v[176:179], v[0:3]
    ds_read_b128 a[232:235], v233 offset:10240
    v_mfma_f32_16x16x32_bf16 v[4:7], a[192:195], v[180:183], v[4:7]
    buffer_load_dwordx4 v229, s[8:11], s35 offen offset:2048 sc1 lds
    v_mfma_f32_16x16x32_bf16 v[8:11], a[196:199], v[176:179], v[8:11]
    ds_read_b128 a[236:239], v233 offset:11264
    v_mfma_f32_16x16x32_bf16 v[12:15], a[196:199], v[180:183], v[12:15]
    buffer_load_dwordx4 v229, s[8:11], s35 offen offset:3072 sc1 lds
    v_mfma_f32_16x16x32_bf16 v[16:19], a[200:203], v[176:179], v[16:19]
    ds_read_b128 a[240:243], v233 offset:12288
    s_add_u32 m0, s50, 86016
    v_mfma_f32_16x16x32_bf16 v[20:23], a[200:203], v[180:183], v[20:23]
    buffer_load_dwordx4 v230, s[8:11], s35 offen sc1 lds
    v_mfma_f32_16x16x32_bf16 v[24:27], a[204:207], v[176:179], v[24:27]
    ds_read_b128 a[244:247], v233 offset:13312
    s_mov_b32 s34, 442368
    v_mfma_f32_16x16x32_bf16 v[28:31], a[204:207], v[180:183], v[28:31]
    buffer_load_dwordx4 a[176:179], v228, s[4:7], s34 offen offset:0 sc1
    s_waitcnt lgkmcnt(7)
    v_mfma_f32_16x16x32_bf16 v[32:35], a[208:211], v[176:179], v[32:35]
    ds_read_b128 a[248:251], v233 offset:14336
    v_mfma_f32_16x16x32_bf16 v[36:39], a[208:211], v[180:183], v[36:39]
    buffer_load_dwordx4 a[180:183], v228, s[4:7], s34 offen offset:1024 sc1
    v_mfma_f32_16x16x32_bf16 v[40:43], a[212:215], v[176:179], v[40:43]
    ds_read_b128 a[252:255], v236 offset:10240
    v_mfma_f32_16x16x32_bf16 v[44:47], a[212:215], v[180:183], v[44:47]
    buffer_load_dwordx4 a[184:187], v228, s[4:7], s34 offen offset:2048 sc1
    v_mfma_f32_16x16x32_bf16 v[48:51], a[216:219], v[176:179], v[48:51]
    ds_read_b128 v[96:99], v236 offset:11264
    v_mfma_f32_16x16x32_bf16 v[52:55], a[216:219], v[180:183], v[52:55]
    s_waitcnt lgkmcnt(7)
    v_mfma_f32_16x16x32_bf16 v[56:59], a[220:223], v[176:179], v[56:59]
    ds_read_b128 v[100:103], v236 offset:12288
    v_mfma_f32_16x16x32_bf16 v[60:63], a[220:223], v[180:183], v[60:63]
    v_mfma_f32_16x16x32_bf16 v[64:67], a[224:227], v[176:179], v[64:67]
    ds_read_b128 v[104:107], v236 offset:13312
    v_mfma_f32_16x16x32_bf16 v[68:71], a[224:227], v[180:183], v[68:71]
    v_mfma_f32_16x16x32_bf16 v[72:75], a[228:231], v[176:179], v[72:75]
    ds_read_b128 v[108:111], v236 offset:14336
    v_mfma_f32_16x16x32_bf16 v[76:79], a[228:231], v[180:183], v[76:79]
    s_waitcnt vmcnt(26) lgkmcnt(6)
    s_barrier
    v_mfma_f32_16x16x32_bf16 v[0:3], a[232:235], v[184:187], v[0:3]
    ds_read_b128 a[192:195], v236 offset:20480
    v_mfma_f32_16x16x32_bf16 v[4:7], a[232:235], v[188:191], v[4:7]
    buffer_load_dwordx4 a[188:191], v228, s[4:7], s34 offen offset:3072 sc1
    v_mfma_f32_16x16x32_bf16 v[8:11], a[236:239], v[184:187], v[8:11]
    ds_read_b128 a[196:199], v236 offset:21504
    s_add_u32 m0, s50, 40960
    v_mfma_f32_16x16x32_bf16 v[12:15], a[236:239], v[188:191], v[12:15]
    s_mov_b32 s35, 573440
    v_mfma_f32_16x16x32_bf16 v[16:19], a[240:243], v[184:187], v[16:19]
    ds_read_b128 a[200:203], v236 offset:22528
    v_mfma_f32_16x16x32_bf16 v[20:23], a[240:243], v[188:191], v[20:23]
    buffer_load_dwordx4 v229, s[8:11], s35 offen offset:0 sc1 lds
    v_mfma_f32_16x16x32_bf16 v[24:27], a[244:247], v[184:187], v[24:27]
    ds_read_b128 a[204:207], v236 offset:23552
    v_mfma_f32_16x16x32_bf16 v[28:31], a[244:247], v[188:191], v[28:31]
    buffer_load_dwordx4 v229, s[8:11], s35 offen offset:1024 sc1 lds
    s_waitcnt lgkmcnt(7)
    v_mfma_f32_16x16x32_bf16 v[32:35], a[248:251], v[184:187], v[32:35]
    ds_read_b128 a[208:211], v236 offset:24576
    v_mfma_f32_16x16x32_bf16 v[36:39], a[248:251], v[188:191], v[36:39]
    buffer_load_dwordx4 v229, s[8:11], s35 offen offset:2048 sc1 lds
    v_mfma_f32_16x16x32_bf16 v[40:43], a[252:255], v[184:187], v[40:43]
    ds_read_b128 a[212:215], v236 offset:30720
    v_mfma_f32_16x16x32_bf16 v[44:47], a[252:255], v[188:191], v[44:47]
    buffer_load_dwordx4 v229, s[8:11], s35 offen offset:3072 sc1 lds
    v_mfma_f32_16x16x32_bf16 v[48:51], v[96:99], v[184:187], v[48:51]
    ds_read_b128 a[216:219], v236 offset:31744
    s_add_u32 m0, s50, 45056
    v_mfma_f32_16x16x32_bf16 v[52:55], v[96:99], v[188:191], v[52:55]
    buffer_load_dwordx4 v230, s[8:11], s35 offen sc1 lds
    s_waitcnt lgkmcnt(7)
    v_mfma_f32_16x16x32_bf16 v[56:59], v[100:103], v[184:187], v[56:59]
    ds_read_b128 a[220:223], v236 offset:32768
    v_mfma_f32_16x16x32_bf16 v[60:63], v[100:103], v[188:191], v[60:63]
    v_mfma_f32_16x16x32_bf16 v[64:67], v[104:107], v[184:187], v[64:67]
    ds_read_b128 a[224:227], v236 offset:33792
    v_mfma_f32_16x16x32_bf16 v[68:71], v[104:107], v[188:191], v[68:71]
    v_mfma_f32_16x16x32_bf16 v[72:75], v[108:111], v[184:187], v[72:75]
    ds_read_b128 a[228:231], v236 offset:34816
    v_mfma_f32_16x16x32_bf16 v[76:79], v[108:111], v[188:191], v[76:79]
    s_waitcnt vmcnt(23) lgkmcnt(6)
    s_barrier
    v_mfma_f32_16x16x32_bf16 v[40:43], a[192:195], a[128:131], v[40:43]
    ds_read_b128 a[232:235], v234 offset:0
    s_mov_b32 s34, 458752
    v_mfma_f32_16x16x32_bf16 v[44:47], a[192:195], a[132:135], v[44:47]
    buffer_load_dwordx4 v[128:131], v228, s[4:7], s34 offen offset:0 sc1
    v_mfma_f32_16x16x32_bf16 v[48:51], a[196:199], a[128:131], v[48:51]
    ds_read_b128 a[236:239], v234 offset:1024
    v_mfma_f32_16x16x32_bf16 v[52:55], a[196:199], a[132:135], v[52:55]
    buffer_load_dwordx4 v[132:135], v228, s[4:7], s34 offen offset:1024 sc1
    v_mfma_f32_16x16x32_bf16 v[56:59], a[200:203], a[128:131], v[56:59]
    ds_read_b128 a[240:243], v234 offset:2048
    v_mfma_f32_16x16x32_bf16 v[60:63], a[200:203], a[132:135], v[60:63]
    buffer_load_dwordx4 v[136:139], v228, s[4:7], s34 offen offset:2048 sc1
    v_mfma_f32_16x16x32_bf16 v[64:67], a[204:207], a[128:131], v[64:67]
    ds_read_b128 a[244:247], v234 offset:3072
    v_mfma_f32_16x16x32_bf16 v[68:71], a[204:207], a[132:135], v[68:71]
    buffer_load_dwordx4 v[140:143], v228, s[4:7], s34 offen offset:3072 sc1
    s_waitcnt lgkmcnt(7)
    v_mfma_f32_16x16x32_bf16 v[72:75], a[208:211], a[128:131], v[72:75]
    ds_read_b128 a[248:251], v234 offset:4096
    s_add_u32 m0, s50, 61440
    v_mfma_f32_16x16x32_bf16 v[76:79], a[208:211], a[132:135], v[76:79]
    s_mov_b32 s35, 593920
    v_mfma_f32_16x16x32_bf16 v[40:43], a[212:215], a[136:139], v[40:43]
    ds_read_b128 a[252:255], v234 offset:10240
    v_mfma_f32_16x16x32_bf16 v[44:47], a[212:215], a[140:143], v[44:47]
    buffer_load_dwordx4 v229, s[8:11], s35 offen offset:0 sc1 lds
    v_mfma_f32_16x16x32_bf16 v[48:51], a[216:219], a[136:139], v[48:51]
    ds_read_b128 v[96:99], v234 offset:11264
    v_mfma_f32_16x16x32_bf16 v[52:55], a[216:219], a[140:143], v[52:55]
    buffer_load_dwordx4 v229, s[8:11], s35 offen offset:1024 sc1 lds
    s_waitcnt lgkmcnt(7)
    v_mfma_f32_16x16x32_bf16 v[56:59], a[220:223], a[136:139], v[56:59]
    ds_read_b128 v[100:103], v234 offset:12288
    v_mfma_f32_16x16x32_bf16 v[60:63], a[220:223], a[140:143], v[60:63]
    v_mfma_f32_16x16x32_bf16 v[64:67], a[224:227], a[136:139], v[64:67]
    ds_read_b128 v[104:107], v234 offset:13312
    v_mfma_f32_16x16x32_bf16 v[68:71], a[224:227], a[140:143], v[68:71]
    v_mfma_f32_16x16x32_bf16 v[72:75], a[228:231], a[136:139], v[72:75]
    ds_read_b128 v[108:111], v234 offset:14336
    v_mfma_f32_16x16x32_bf16 v[76:79], a[228:231], a[140:143], v[76:79]
    s_waitcnt vmcnt(20) lgkmcnt(6)
    s_barrier
    v_mfma_f32_16x16x32_bf16 v[40:43], a[232:235], a[144:147], v[40:43]
    ds_read_b128 a[192:195], v234 offset:20480
    v_mfma_f32_16x16x32_bf16 v[44:47], a[232:235], a[148:151], v[44:47]
    buffer_load_dwordx4 v229, s[8:11], s35 offen offset:2048 sc1 lds
    v_mfma_f32_16x16x32_bf16 v[48:51], a[236:239], a[144:147], v[48:51]
    ds_read_b128 a[196:199], v234 offset:21504
    v_mfma_f32_16x16x32_bf16 v[52:55], a[236:239], a[148:151], v[52:55]
    buffer_load_dwordx4 v229, s[8:11], s35 offen offset:3072 sc1 lds
    v_mfma_f32_16x16x32_bf16 v[56:59], a[240:243], a[144:147], v[56:59]
    ds_read_b128 a[200:203], v234 offset:22528
    s_add_u32 m0, s50, 65536
    v_mfma_f32_16x16x32_bf16 v[60:63], a[240:243], a[148:151], v[60:63]
    buffer_load_dwordx4 v230, s[8:11], s35 offen sc1 lds
    v_mfma_f32_16x16x32_bf16 v[64:67], a[244:247], a[144:147], v[64:67]
    ds_read_b128 a[204:207], v234 offset:23552
    s_mov_b32 s34, 475136
    v_mfma_f32_16x16x32_bf16 v[68:71], a[244:247], a[148:151], v[68:71]
    buffer_load_dwordx4 v[144:147], v228, s[4:7], s34 offen offset:0 sc1
    s_waitcnt lgkmcnt(7)
    v_mfma_f32_16x16x32_bf16 v[72:75], a[248:251], a[144:147], v[72:75]
    ds_read_b128 a[208:211], v234 offset:24576
    v_mfma_f32_16x16x32_bf16 v[76:79], a[248:251], a[148:151], v[76:79]
    buffer_load_dwordx4 v[148:151], v228, s[4:7], s34 offen offset:1024 sc1
    v_mfma_f32_16x16x32_bf16 v[40:43], a[252:255], a[152:155], v[40:43]
    ds_read_b128 a[212:215], v234 offset:30720
    v_mfma_f32_16x16x32_bf16 v[44:47], a[252:255], a[156:159], v[44:47]
    buffer_load_dwordx4 v[152:155], v228, s[4:7], s34 offen offset:2048 sc1
    v_mfma_f32_16x16x32_bf16 v[48:51], v[96:99], a[152:155], v[48:51]
    ds_read_b128 a[216:219], v234 offset:31744
    v_mfma_f32_16x16x32_bf16 v[52:55], v[96:99], a[156:159], v[52:55]
    s_waitcnt lgkmcnt(7)
    v_mfma_f32_16x16x32_bf16 v[56:59], v[100:103], a[152:155], v[56:59]
    ds_read_b128 a[220:223], v234 offset:32768
    v_mfma_f32_16x16x32_bf16 v[60:63], v[100:103], a[156:159], v[60:63]
    v_mfma_f32_16x16x32_bf16 v[64:67], v[104:107], a[152:155], v[64:67]
    ds_read_b128 a[224:227], v234 offset:33792
    v_mfma_f32_16x16x32_bf16 v[68:71], v[104:107], a[156:159], v[68:71]
    v_mfma_f32_16x16x32_bf16 v[72:75], v[108:111], a[152:155], v[72:75]
    ds_read_b128 a[228:231], v234 offset:34816
    v_mfma_f32_16x16x32_bf16 v[76:79], v[108:111], a[156:159], v[76:79]
    s_waitcnt vmcnt(17) lgkmcnt(6)
    s_barrier
    v_mfma_f32_16x16x32_bf16 v[40:43], a[192:195], a[160:163], v[40:43]
    ds_read_b128 a[232:235], v235 offset:20480
    v_mfma_f32_16x16x32_bf16 v[44:47], a[192:195], a[164:167], v[44:47]
    buffer_load_dwordx4 v[156:159], v228, s[4:7], s34 offen offset:3072 sc1
    v_mfma_f32_16x16x32_bf16 v[48:51], a[196:199], a[160:163], v[48:51]
    ds_read_b128 a[236:239], v235 offset:21504
    s_add_u32 m0, s50, 102400
    v_mfma_f32_16x16x32_bf16 v[52:55], a[196:199], a[164:167], v[52:55]
    s_mov_b32 s35, 614400
    v_mfma_f32_16x16x32_bf16 v[56:59], a[200:203], a[160:163], v[56:59]
    ds_read_b128 a[240:243], v235 offset:22528
    v_mfma_f32_16x16x32_bf16 v[60:63], a[200:203], a[164:167], v[60:63]
    buffer_load_dwordx4 v229, s[8:11], s35 offen offset:0 sc1 lds
    v_mfma_f32_16x16x32_bf16 v[64:67], a[204:207], a[160:163], v[64:67]
    ds_read_b128 a[244:247], v235 offset:23552
    v_mfma_f32_16x16x32_bf16 v[68:71], a[204:207], a[164:167], v[68:71]
    buffer_load_dwordx4 v229, s[8:11], s35 offen offset:1024 sc1 lds
    s_waitcnt lgkmcnt(7)
    v_mfma_f32_16x16x32_bf16 v[72:75], a[208:211], a[160:163], v[72:75]
    ds_read_b128 a[248:251], v235 offset:24576
    v_mfma_f32_16x16x32_bf16 v[76:79], a[208:211], a[164:167], v[76:79]
    buffer_load_dwordx4 v229, s[8:11], s35 offen offset:2048 sc1 lds
    v_mfma_f32_16x16x32_bf16 v[40:43], a[212:215], a[168:171], v[40:43]
    ds_read_b128 a[252:255], v235 offset:30720
    v_mfma_f32_16x16x32_bf16 v[44:47], a[212:215], a[172:175], v[44:47]
    buffer_load_dwordx4 v229, s[8:11], s35 offen offset:3072 sc1 lds
    v_mfma_f32_16x16x32_bf16 v[48:51], a[216:219], a[168:171], v[48:51]
    ds_read_b128 v[96:99], v235 offset:31744
    s_add_u32 m0, s50, 106496
    v_mfma_f32_16x16x32_bf16 v[52:55], a[216:219], a[172:175], v[52:55]
    buffer_load_dwordx4 v230, s[8:11], s35 offen sc1 lds
    s_waitcnt lgkmcnt(7)
    v_mfma_f32_16x16x32_bf16 v[56:59], a[220:223], a[168:171], v[56:59]
    ds_read_b128 v[100:103], v235 offset:32768
    v_mfma_f32_16x16x32_bf16 v[60:63], a[220:223], a[172:175], v[60:63]
    v_mfma_f32_16x16x32_bf16 v[64:67], a[224:227], a[168:171], v[64:67]
    ds_read_b128 v[104:107], v235 offset:33792
    v_mfma_f32_16x16x32_bf16 v[68:71], a[224:227], a[172:175], v[68:71]
    v_mfma_f32_16x16x32_bf16 v[72:75], a[228:231], a[168:171], v[72:75]
    ds_read_b128 v[108:111], v235 offset:34816
    v_mfma_f32_16x16x32_bf16 v[76:79], a[228:231], a[172:175], v[76:79]
    s_waitcnt vmcnt(14) lgkmcnt(6)
    s_barrier
    v_mfma_f32_16x16x32_bf16 v[40:43], a[232:235], a[176:179], v[40:43]
    ds_read_b128 a[192:195], v234 offset:40960
    s_mov_b32 s34, 491520
    v_mfma_f32_16x16x32_bf16 v[44:47], a[232:235], a[180:183], v[44:47]
    buffer_load_dwordx4 v[160:163], v228, s[4:7], s34 offen offset:0 sc1
    v_mfma_f32_16x16x32_bf16 v[48:51], a[236:239], a[176:179], v[48:51]
    ds_read_b128 a[196:199], v234 offset:41984
    v_mfma_f32_16x16x32_bf16 v[52:55], a[236:239], a[180:183], v[52:55]
    buffer_load_dwordx4 v[164:167], v228, s[4:7], s34 offen offset:1024 sc1
    v_mfma_f32_16x16x32_bf16 v[56:59], a[240:243], a[176:179], v[56:59]
    ds_read_b128 a[200:203], v234 offset:43008
    v_mfma_f32_16x16x32_bf16 v[60:63], a[240:243], a[180:183], v[60:63]
    buffer_load_dwordx4 v[168:171], v228, s[4:7], s34 offen offset:2048 sc1
    v_mfma_f32_16x16x32_bf16 v[64:67], a[244:247], a[176:179], v[64:67]
    ds_read_b128 a[204:207], v234 offset:44032
    v_mfma_f32_16x16x32_bf16 v[68:71], a[244:247], a[180:183], v[68:71]
    buffer_load_dwordx4 v[172:175], v228, s[4:7], s34 offen offset:3072 sc1
    s_waitcnt lgkmcnt(7)
    v_mfma_f32_16x16x32_bf16 v[72:75], a[248:251], a[176:179], v[72:75]
    ds_read_b128 a[208:211], v234 offset:45056
    s_add_u32 m0, s50, 122880
    v_mfma_f32_16x16x32_bf16 v[76:79], a[248:251], a[180:183], v[76:79]
    s_mov_b32 s35, 634880
    v_mfma_f32_16x16x32_bf16 v[40:43], a[252:255], a[184:187], v[40:43]
    ds_read_b128 a[212:215], v234 offset:51200
    v_mfma_f32_16x16x32_bf16 v[44:47], a[252:255], a[188:191], v[44:47]
    buffer_load_dwordx4 v229, s[8:11], s35 offen offset:0 sc1 lds
    v_mfma_f32_16x16x32_bf16 v[48:51], v[96:99], a[184:187], v[48:51]
    ds_read_b128 a[216:219], v234 offset:52224
    v_mfma_f32_16x16x32_bf16 v[52:55], v[96:99], a[188:191], v[52:55]
    buffer_load_dwordx4 v229, s[8:11], s35 offen offset:1024 sc1 lds
    s_waitcnt lgkmcnt(7)
    v_mfma_f32_16x16x32_bf16 v[56:59], v[100:103], a[184:187], v[56:59]
    ds_read_b128 a[220:223], v234 offset:53248
    v_mfma_f32_16x16x32_bf16 v[60:63], v[100:103], a[188:191], v[60:63]
    v_mfma_f32_16x16x32_bf16 v[64:67], v[104:107], a[184:187], v[64:67]
    ds_read_b128 a[224:227], v234 offset:54272
    v_mfma_f32_16x16x32_bf16 v[68:71], v[104:107], a[188:191], v[68:71]
    v_mfma_f32_16x16x32_bf16 v[72:75], v[108:111], a[184:187], v[72:75]
    ds_read_b128 a[228:231], v234 offset:55296
    v_mfma_f32_16x16x32_bf16 v[76:79], v[108:111], a[188:191], v[76:79]
    s_waitcnt vmcnt(11) lgkmcnt(6)
    s_barrier
    v_mfma_f32_16x16x32_bf16 v[40:43], a[192:195], v[128:131], v[40:43]
    ds_read_b128 a[232:235], v235 offset:0
    v_mfma_f32_16x16x32_bf16 v[44:47], a[192:195], v[132:135], v[44:47]
    buffer_load_dwordx4 v229, s[8:11], s35 offen offset:2048 sc1 lds
    v_mfma_f32_16x16x32_bf16 v[48:51], a[196:199], v[128:131], v[48:51]
    ds_read_b128 a[236:239], v235 offset:1024
    v_mfma_f32_16x16x32_bf16 v[52:55], a[196:199], v[132:135], v[52:55]
    buffer_load_dwordx4 v229, s[8:11], s35 offen offset:3072 sc1 lds
    v_mfma_f32_16x16x32_bf16 v[56:59], a[200:203], v[128:131], v[56:59]
    ds_read_b128 a[240:243], v235 offset:2048
    s_add_u32 m0, s50, 126976
    v_mfma_f32_16x16x32_bf16 v[60:63], a[200:203], v[132:135], v[60:63]
    buffer_load_dwordx4 v230, s[8:11], s35 offen sc1 lds
    v_mfma_f32_16x16x32_bf16 v[64:67], a[204:207], v[128:131], v[64:67]
    ds_read_b128 a[244:247], v235 offset:3072
    s_mov_b32 s34, 507904
    v_mfma_f32_16x16x32_bf16 v[68:71], a[204:207], v[132:135], v[68:71]
    buffer_load_dwordx4 v[176:179], v228, s[4:7], s34 offen offset:0 sc1
    s_waitcnt lgkmcnt(7)
    v_mfma_f32_16x16x32_bf16 v[72:75], a[208:211], v[128:131], v[72:75]
    ds_read_b128 a[248:251], v235 offset:4096
    v_mfma_f32_16x16x32_bf16 v[76:79], a[208:211], v[132:135], v[76:79]
    buffer_load_dwordx4 v[180:183], v228, s[4:7], s34 offen offset:1024 sc1
    v_mfma_f32_16x16x32_bf16 v[40:43], a[212:215], v[136:139], v[40:43]
    ds_read_b128 a[252:255], v235 offset:10240
    v_mfma_f32_16x16x32_bf16 v[44:47], a[212:215], v[140:143], v[44:47]
    buffer_load_dwordx4 v[184:187], v228, s[4:7], s34 offen offset:2048 sc1
    v_mfma_f32_16x16x32_bf16 v[48:51], a[216:219], v[136:139], v[48:51]
    ds_read_b128 v[96:99], v235 offset:11264
    v_mfma_f32_16x16x32_bf16 v[52:55], a[216:219], v[140:143], v[52:55]
    s_waitcnt lgkmcnt(7)
    v_mfma_f32_16x16x32_bf16 v[56:59], a[220:223], v[136:139], v[56:59]
    ds_read_b128 v[100:103], v235 offset:12288
    v_mfma_f32_16x16x32_bf16 v[60:63], a[220:223], v[140:143], v[60:63]
    v_mfma_f32_16x16x32_bf16 v[64:67], a[224:227], v[136:139], v[64:67]
    ds_read_b128 v[104:107], v235 offset:13312
    v_mfma_f32_16x16x32_bf16 v[68:71], a[224:227], v[140:143], v[68:71]
    v_mfma_f32_16x16x32_bf16 v[72:75], a[228:231], v[136:139], v[72:75]
    ds_read_b128 v[108:111], v235 offset:14336
    v_mfma_f32_16x16x32_bf16 v[76:79], a[228:231], v[140:143], v[76:79]
    s_waitcnt vmcnt(8) lgkmcnt(6)
    s_barrier
    v_mfma_f32_16x16x32_bf16 v[40:43], a[232:235], v[144:147], v[40:43]
    ds_read_b128 a[192:195], v235 offset:40960
    v_mfma_f32_16x16x32_bf16 v[44:47], a[232:235], v[148:151], v[44:47]
    buffer_load_dwordx4 v[188:191], v228, s[4:7], s34 offen offset:3072 sc1
    v_mfma_f32_16x16x32_bf16 v[48:51], a[236:239], v[144:147], v[48:51]
    ds_read_b128 a[196:199], v235 offset:41984
    v_mfma_f32_16x16x32_bf16 v[52:55], a[236:239], v[148:151], v[52:55]
    v_mfma_f32_16x16x32_bf16 v[56:59], a[240:243], v[144:147], v[56:59]
    ds_read_b128 a[200:203], v235 offset:43008
    v_mfma_f32_16x16x32_bf16 v[60:63], a[240:243], v[148:151], v[60:63]
    v_mfma_f32_16x16x32_bf16 v[64:67], a[244:247], v[144:147], v[64:67]
    ds_read_b128 a[204:207], v235 offset:44032
    v_mfma_f32_16x16x32_bf16 v[68:71], a[244:247], v[148:151], v[68:71]
    s_waitcnt lgkmcnt(7)
    v_mfma_f32_16x16x32_bf16 v[72:75], a[248:251], v[144:147], v[72:75]
    ds_read_b128 a[208:211], v235 offset:45056
    v_mfma_f32_16x16x32_bf16 v[76:79], a[248:251], v[148:151], v[76:79]
    v_mfma_f32_16x16x32_bf16 v[40:43], a[252:255], v[152:155], v[40:43]
    ds_read_b128 a[212:215], v235 offset:51200
    v_mfma_f32_16x16x32_bf16 v[44:47], a[252:255], v[156:159], v[44:47]
    v_mfma_f32_16x16x32_bf16 v[48:51], v[96:99], v[152:155], v[48:51]
    ds_read_b128 a[216:219], v235 offset:52224
    v_mfma_f32_16x16x32_bf16 v[52:55], v[96:99], v[156:159], v[52:55]
    s_waitcnt lgkmcnt(7)
    v_mfma_f32_16x16x32_bf16 v[56:59], v[100:103], v[152:155], v[56:59]
    ds_read_b128 a[220:223], v235 offset:53248
    v_mfma_f32_16x16x32_bf16 v[60:63], v[100:103], v[156:159], v[60:63]
    v_mfma_f32_16x16x32_bf16 v[64:67], v[104:107], v[152:155], v[64:67]
    ds_read_b128 a[224:227], v235 offset:54272
    v_mfma_f32_16x16x32_bf16 v[68:71], v[104:107], v[156:159], v[68:71]
    v_mfma_f32_16x16x32_bf16 v[72:75], v[108:111], v[152:155], v[72:75]
    ds_read_b128 a[228:231], v235 offset:55296
    v_mfma_f32_16x16x32_bf16 v[76:79], v[108:111], v[156:159], v[76:79]
    s_waitcnt vmcnt(0) lgkmcnt(6)
    s_barrier
    v_mfma_f32_16x16x32_bf16 v[40:43], a[192:195], v[160:163], v[40:43]
    ds_read_b128 a[232:235], v236 offset:0
    v_mfma_f32_16x16x32_bf16 v[44:47], a[192:195], v[164:167], v[44:47]
    v_mfma_f32_16x16x32_bf16 v[48:51], a[196:199], v[160:163], v[48:51]
    ds_read_b128 a[236:239], v236 offset:1024
    v_mfma_f32_16x16x32_bf16 v[52:55], a[196:199], v[164:167], v[52:55]
    v_mfma_f32_16x16x32_bf16 v[56:59], a[200:203], v[160:163], v[56:59]
    ds_read_b128 a[240:243], v236 offset:2048
    v_mfma_f32_16x16x32_bf16 v[60:63], a[200:203], v[164:167], v[60:63]
    v_mfma_f32_16x16x32_bf16 v[64:67], a[204:207], v[160:163], v[64:67]
    ds_read_b128 a[244:247], v236 offset:3072
    v_mfma_f32_16x16x32_bf16 v[68:71], a[204:207], v[164:167], v[68:71]
    s_waitcnt lgkmcnt(7)
    v_mfma_f32_16x16x32_bf16 v[72:75], a[208:211], v[160:163], v[72:75]
    ds_read_b128 a[248:251], v236 offset:4096
    v_mfma_f32_16x16x32_bf16 v[76:79], a[208:211], v[164:167], v[76:79]
    v_mfma_f32_16x16x32_bf16 v[40:43], a[212:215], v[168:171], v[40:43]
    ds_read_b128 a[252:255], v236 offset:10240
    v_mfma_f32_16x16x32_bf16 v[44:47], a[212:215], v[172:175], v[44:47]
    v_mfma_f32_16x16x32_bf16 v[48:51], a[216:219], v[168:171], v[48:51]
    ds_read_b128 v[96:99], v236 offset:11264
    v_mfma_f32_16x16x32_bf16 v[52:55], a[216:219], v[172:175], v[52:55]
    s_waitcnt lgkmcnt(7)
    v_mfma_f32_16x16x32_bf16 v[56:59], a[220:223], v[168:171], v[56:59]
    ds_read_b128 v[100:103], v236 offset:12288
    v_mfma_f32_16x16x32_bf16 v[60:63], a[220:223], v[172:175], v[60:63]
    v_mfma_f32_16x16x32_bf16 v[64:67], a[224:227], v[168:171], v[64:67]
    ds_read_b128 v[104:107], v236 offset:13312
    v_mfma_f32_16x16x32_bf16 v[68:71], a[224:227], v[172:175], v[68:71]
    v_mfma_f32_16x16x32_bf16 v[72:75], a[228:231], v[168:171], v[72:75]
    ds_read_b128 v[108:111], v236 offset:14336
    v_mfma_f32_16x16x32_bf16 v[76:79], a[228:231], v[172:175], v[76:79]
    s_waitcnt lgkmcnt(6)
    v_mfma_f32_16x16x32_bf16 v[40:43], a[232:235], v[176:179], v[40:43]
    ds_read_b128 a[192:195], v233 offset:20480
    v_mfma_f32_16x16x32_bf16 v[44:47], a[232:235], v[180:183], v[44:47]
    v_mfma_f32_16x16x32_bf16 v[48:51], a[236:239], v[176:179], v[48:51]
    ds_read_b128 a[196:199], v233 offset:21504
    v_mfma_f32_16x16x32_bf16 v[52:55], a[236:239], v[180:183], v[52:55]
    v_mfma_f32_16x16x32_bf16 v[56:59], a[240:243], v[176:179], v[56:59]
    ds_read_b128 a[200:203], v233 offset:22528
    v_mfma_f32_16x16x32_bf16 v[60:63], a[240:243], v[180:183], v[60:63]
    v_mfma_f32_16x16x32_bf16 v[64:67], a[244:247], v[176:179], v[64:67]
    ds_read_b128 a[204:207], v233 offset:23552
    v_mfma_f32_16x16x32_bf16 v[68:71], a[244:247], v[180:183], v[68:71]
    s_waitcnt lgkmcnt(7)
    v_mfma_f32_16x16x32_bf16 v[72:75], a[248:251], v[176:179], v[72:75]
    ds_read_b128 a[208:211], v233 offset:24576
    v_mfma_f32_16x16x32_bf16 v[76:79], a[248:251], v[180:183], v[76:79]
    v_mfma_f32_16x16x32_bf16 v[40:43], a[252:255], v[184:187], v[40:43]
    ds_read_b128 a[212:215], v233 offset:30720
    v_mfma_f32_16x16x32_bf16 v[44:47], a[252:255], v[188:191], v[44:47]
    v_mfma_f32_16x16x32_bf16 v[48:51], v[96:99], v[184:187], v[48:51]
    ds_read_b128 a[216:219], v233 offset:31744
    v_mfma_f32_16x16x32_bf16 v[52:55], v[96:99], v[188:191], v[52:55]
    s_waitcnt lgkmcnt(7)
    v_mfma_f32_16x16x32_bf16 v[56:59], v[100:103], v[184:187], v[56:59]
    ds_read_b128 a[220:223], v233 offset:32768
    v_mfma_f32_16x16x32_bf16 v[60:63], v[100:103], v[188:191], v[60:63]
    v_mfma_f32_16x16x32_bf16 v[64:67], v[104:107], v[184:187], v[64:67]
    ds_read_b128 a[224:227], v233 offset:33792
    v_mfma_f32_16x16x32_bf16 v[68:71], v[104:107], v[188:191], v[68:71]
    v_mfma_f32_16x16x32_bf16 v[72:75], v[108:111], v[184:187], v[72:75]
    ds_read_b128 a[228:231], v233 offset:34816
    v_mfma_f32_16x16x32_bf16 v[76:79], v[108:111], v[188:191], v[76:79]
    s_waitcnt lgkmcnt(6)
    v_mfma_f32_16x16x32_bf16 v[0:3], a[192:195], a[128:131], v[0:3]
    ds_read_b128 a[232:235], v231 offset:0
    v_mfma_f32_16x16x32_bf16 v[4:7], a[192:195], a[132:135], v[4:7]
    v_mfma_f32_16x16x32_bf16 v[8:11], a[196:199], a[128:131], v[8:11]
    ds_read_b128 a[236:239], v231 offset:1024
    v_mfma_f32_16x16x32_bf16 v[12:15], a[196:199], a[132:135], v[12:15]
    v_mfma_f32_16x16x32_bf16 v[16:19], a[200:203], a[128:131], v[16:19]
    ds_read_b128 a[240:243], v231 offset:2048
    v_mfma_f32_16x16x32_bf16 v[20:23], a[200:203], a[132:135], v[20:23]
    global_store_dwordx4 v238, v[40:43], s[94:95] offset:-4096 sc1
    v_mfma_f32_16x16x32_bf16 v[24:27], a[204:207], a[128:131], v[24:27]
    ds_read_b128 a[244:247], v231 offset:3072
    v_mfma_f32_16x16x32_bf16 v[28:31], a[204:207], a[132:135], v[28:31]
    s_waitcnt lgkmcnt(7)
    v_mfma_f32_16x16x32_bf16 v[32:35], a[208:211], a[128:131], v[32:35]
    ds_read_b128 a[248:251], v231 offset:4096
    v_mfma_f32_16x16x32_bf16 v[36:39], a[208:211], a[132:135], v[36:39]
    v_mfma_f32_16x16x32_bf16 v[0:3], a[212:215], a[136:139], v[0:3]
    ds_read_b128 a[252:255], v231 offset:10240
    v_mfma_f32_16x16x32_bf16 v[4:7], a[212:215], a[140:143], v[4:7]
    v_mfma_f32_16x16x32_bf16 v[8:11], a[216:219], a[136:139], v[8:11]
    ds_read_b128 v[96:99], v231 offset:11264
    v_mfma_f32_16x16x32_bf16 v[12:15], a[216:219], a[140:143], v[12:15]
    s_waitcnt lgkmcnt(7)
    v_mfma_f32_16x16x32_bf16 v[16:19], a[220:223], a[136:139], v[16:19]
    ds_read_b128 v[100:103], v231 offset:12288
    v_mfma_f32_16x16x32_bf16 v[20:23], a[220:223], a[140:143], v[20:23]
    v_mfma_f32_16x16x32_bf16 v[24:27], a[224:227], a[136:139], v[24:27]
    ds_read_b128 v[104:107], v231 offset:13312
    v_mfma_f32_16x16x32_bf16 v[28:31], a[224:227], a[140:143], v[28:31]
    global_store_dwordx4 v238, v[44:47], s[94:95] offset:-3072 sc1
    v_mfma_f32_16x16x32_bf16 v[32:35], a[228:231], a[136:139], v[32:35]
    ds_read_b128 v[108:111], v231 offset:14336
    v_mfma_f32_16x16x32_bf16 v[36:39], a[228:231], a[140:143], v[36:39]
    s_waitcnt lgkmcnt(6)
    v_mfma_f32_16x16x32_bf16 v[0:3], a[232:235], a[144:147], v[0:3]
    ds_read_b128 a[192:195], v231 offset:20480
    v_mfma_f32_16x16x32_bf16 v[4:7], a[232:235], a[148:151], v[4:7]
    v_mfma_f32_16x16x32_bf16 v[8:11], a[236:239], a[144:147], v[8:11]
    ds_read_b128 a[196:199], v231 offset:21504
    v_mfma_f32_16x16x32_bf16 v[12:15], a[236:239], a[148:151], v[12:15]
    v_mfma_f32_16x16x32_bf16 v[16:19], a[240:243], a[144:147], v[16:19]
    ds_read_b128 a[200:203], v231 offset:22528
    v_mfma_f32_16x16x32_bf16 v[20:23], a[240:243], a[148:151], v[20:23]
    v_mfma_f32_16x16x32_bf16 v[24:27], a[244:247], a[144:147], v[24:27]
    ds_read_b128 a[204:207], v231 offset:23552
    v_mfma_f32_16x16x32_bf16 v[28:31], a[244:247], a[148:151], v[28:31]
    s_waitcnt lgkmcnt(7)
    v_mfma_f32_16x16x32_bf16 v[32:35], a[248:251], a[144:147], v[32:35]
    ds_read_b128 a[208:211], v231 offset:24576
    v_mfma_f32_16x16x32_bf16 v[36:39], a[248:251], a[148:151], v[36:39]
    global_store_dwordx4 v238, v[48:51], s[94:95] offset:-2048 sc1
    v_mfma_f32_16x16x32_bf16 v[0:3], a[252:255], a[152:155], v[0:3]
    ds_read_b128 a[212:215], v231 offset:30720
    v_mfma_f32_16x16x32_bf16 v[4:7], a[252:255], a[156:159], v[4:7]
    v_mfma_f32_16x16x32_bf16 v[8:11], v[96:99], a[152:155], v[8:11]
    ds_read_b128 a[216:219], v231 offset:31744
    v_mfma_f32_16x16x32_bf16 v[12:15], v[96:99], a[156:159], v[12:15]
    s_waitcnt lgkmcnt(7)
    v_mfma_f32_16x16x32_bf16 v[16:19], v[100:103], a[152:155], v[16:19]
    ds_read_b128 a[220:223], v231 offset:32768
    v_mfma_f32_16x16x32_bf16 v[20:23], v[100:103], a[156:159], v[20:23]
    v_mfma_f32_16x16x32_bf16 v[24:27], v[104:107], a[152:155], v[24:27]
    ds_read_b128 a[224:227], v231 offset:33792
    v_mfma_f32_16x16x32_bf16 v[28:31], v[104:107], a[156:159], v[28:31]
    v_mfma_f32_16x16x32_bf16 v[32:35], v[108:111], a[152:155], v[32:35]
    ds_read_b128 a[228:231], v231 offset:34816
    v_mfma_f32_16x16x32_bf16 v[36:39], v[108:111], a[156:159], v[36:39]
    s_waitcnt lgkmcnt(6)
    v_mfma_f32_16x16x32_bf16 v[0:3], a[192:195], a[160:163], v[0:3]
    ds_read_b128 a[232:235], v232 offset:20480
    v_mfma_f32_16x16x32_bf16 v[4:7], a[192:195], a[164:167], v[4:7]
    global_store_dwordx4 v238, v[52:55], s[94:95] offset:-1024 sc1
    v_mfma_f32_16x16x32_bf16 v[8:11], a[196:199], a[160:163], v[8:11]
    ds_read_b128 a[236:239], v232 offset:21504
    v_mfma_f32_16x16x32_bf16 v[12:15], a[196:199], a[164:167], v[12:15]
    v_mfma_f32_16x16x32_bf16 v[16:19], a[200:203], a[160:163], v[16:19]
    ds_read_b128 a[240:243], v232 offset:22528
    v_mfma_f32_16x16x32_bf16 v[20:23], a[200:203], a[164:167], v[20:23]
    v_mfma_f32_16x16x32_bf16 v[24:27], a[204:207], a[160:163], v[24:27]
    ds_read_b128 a[244:247], v232 offset:23552
    v_mfma_f32_16x16x32_bf16 v[28:31], a[204:207], a[164:167], v[28:31]
    s_waitcnt lgkmcnt(7)
    v_mfma_f32_16x16x32_bf16 v[32:35], a[208:211], a[160:163], v[32:35]
    ds_read_b128 a[248:251], v232 offset:24576
    v_mfma_f32_16x16x32_bf16 v[36:39], a[208:211], a[164:167], v[36:39]
    v_mfma_f32_16x16x32_bf16 v[0:3], a[212:215], a[168:171], v[0:3]
    ds_read_b128 a[252:255], v232 offset:30720
    v_mfma_f32_16x16x32_bf16 v[4:7], a[212:215], a[172:175], v[4:7]
    v_mfma_f32_16x16x32_bf16 v[8:11], a[216:219], a[168:171], v[8:11]
    ds_read_b128 v[96:99], v232 offset:31744
    v_mfma_f32_16x16x32_bf16 v[12:15], a[216:219], a[172:175], v[12:15]
    global_store_dwordx4 v238, v[56:59], s[94:95] offset:0 sc1
    s_waitcnt lgkmcnt(7)
    v_mfma_f32_16x16x32_bf16 v[16:19], a[220:223], a[168:171], v[16:19]
    ds_read_b128 v[100:103], v232 offset:32768
    v_mfma_f32_16x16x32_bf16 v[20:23], a[220:223], a[172:175], v[20:23]
    v_mfma_f32_16x16x32_bf16 v[24:27], a[224:227], a[168:171], v[24:27]
    ds_read_b128 v[104:107], v232 offset:33792
    v_mfma_f32_16x16x32_bf16 v[28:31], a[224:227], a[172:175], v[28:31]
    v_mfma_f32_16x16x32_bf16 v[32:35], a[228:231], a[168:171], v[32:35]
    ds_read_b128 v[108:111], v232 offset:34816
    v_mfma_f32_16x16x32_bf16 v[36:39], a[228:231], a[172:175], v[36:39]
    s_waitcnt lgkmcnt(6)
    v_mfma_f32_16x16x32_bf16 v[0:3], a[232:235], a[176:179], v[0:3]
    ds_read_b128 a[192:195], v231 offset:40960
    v_mfma_f32_16x16x32_bf16 v[4:7], a[232:235], a[180:183], v[4:7]
    v_mfma_f32_16x16x32_bf16 v[8:11], a[236:239], a[176:179], v[8:11]
    ds_read_b128 a[196:199], v231 offset:41984
    v_mfma_f32_16x16x32_bf16 v[12:15], a[236:239], a[180:183], v[12:15]
    v_mfma_f32_16x16x32_bf16 v[16:19], a[240:243], a[176:179], v[16:19]
    ds_read_b128 a[200:203], v231 offset:43008
    v_mfma_f32_16x16x32_bf16 v[20:23], a[240:243], a[180:183], v[20:23]
    global_store_dwordx4 v238, v[60:63], s[94:95] offset:1024 sc1
    v_mfma_f32_16x16x32_bf16 v[24:27], a[244:247], a[176:179], v[24:27]
    ds_read_b128 a[204:207], v231 offset:44032
    v_mfma_f32_16x16x32_bf16 v[28:31], a[244:247], a[180:183], v[28:31]
    s_waitcnt lgkmcnt(7)
    v_mfma_f32_16x16x32_bf16 v[32:35], a[248:251], a[176:179], v[32:35]
    ds_read_b128 a[208:211], v231 offset:45056
    v_mfma_f32_16x16x32_bf16 v[36:39], a[248:251], a[180:183], v[36:39]
    v_mfma_f32_16x16x32_bf16 v[0:3], a[252:255], a[184:187], v[0:3]
    ds_read_b128 a[212:215], v231 offset:51200
    v_mfma_f32_16x16x32_bf16 v[4:7], a[252:255], a[188:191], v[4:7]
    v_mfma_f32_16x16x32_bf16 v[8:11], v[96:99], a[184:187], v[8:11]
    ds_read_b128 a[216:219], v231 offset:52224
    v_mfma_f32_16x16x32_bf16 v[12:15], v[96:99], a[188:191], v[12:15]
    s_waitcnt lgkmcnt(7)
    v_mfma_f32_16x16x32_bf16 v[16:19], v[100:103], a[184:187], v[16:19]
    ds_read_b128 a[220:223], v231 offset:53248
    v_mfma_f32_16x16x32_bf16 v[20:23], v[100:103], a[188:191], v[20:23]
    v_mfma_f32_16x16x32_bf16 v[24:27], v[104:107], a[184:187], v[24:27]
    ds_read_b128 a[224:227], v231 offset:54272
    v_mfma_f32_16x16x32_bf16 v[28:31], v[104:107], a[188:191], v[28:31]
    global_store_dwordx4 v238, v[64:67], s[94:95] offset:2048 sc1
    v_mfma_f32_16x16x32_bf16 v[32:35], v[108:111], a[184:187], v[32:35]
    ds_read_b128 a[228:231], v231 offset:55296
    v_mfma_f32_16x16x32_bf16 v[36:39], v[108:111], a[188:191], v[36:39]
    s_waitcnt lgkmcnt(6)
    v_mfma_f32_16x16x32_bf16 v[0:3], a[192:195], v[128:131], v[0:3]
    ds_read_b128 a[232:235], v232 offset:0
    v_mfma_f32_16x16x32_bf16 v[4:7], a[192:195], v[132:135], v[4:7]
    v_mfma_f32_16x16x32_bf16 v[8:11], a[196:199], v[128:131], v[8:11]
    ds_read_b128 a[236:239], v232 offset:1024
    v_mfma_f32_16x16x32_bf16 v[12:15], a[196:199], v[132:135], v[12:15]
    v_mfma_f32_16x16x32_bf16 v[16:19], a[200:203], v[128:131], v[16:19]
    ds_read_b128 a[240:243], v232 offset:2048
    v_mfma_f32_16x16x32_bf16 v[20:23], a[200:203], v[132:135], v[20:23]
    v_mfma_f32_16x16x32_bf16 v[24:27], a[204:207], v[128:131], v[24:27]
    ds_read_b128 a[244:247], v232 offset:3072
    v_mfma_f32_16x16x32_bf16 v[28:31], a[204:207], v[132:135], v[28:31]
    s_waitcnt lgkmcnt(7)
    v_mfma_f32_16x16x32_bf16 v[32:35], a[208:211], v[128:131], v[32:35]
    ds_read_b128 a[248:251], v232 offset:4096
    v_mfma_f32_16x16x32_bf16 v[36:39], a[208:211], v[132:135], v[36:39]
    global_store_dwordx4 v238, v[68:71], s[94:95] offset:3072 sc1
    v_mfma_f32_16x16x32_bf16 v[0:3], a[212:215], v[136:139], v[0:3]
    ds_read_b128 a[252:255], v232 offset:10240
    v_mfma_f32_16x16x32_bf16 v[4:7], a[212:215], v[140:143], v[4:7]
    v_mfma_f32_16x16x32_bf16 v[8:11], a[216:219], v[136:139], v[8:11]
    ds_read_b128 v[96:99], v232 offset:11264
    v_mfma_f32_16x16x32_bf16 v[12:15], a[216:219], v[140:143], v[12:15]
    s_waitcnt lgkmcnt(7)
    v_mfma_f32_16x16x32_bf16 v[16:19], a[220:223], v[136:139], v[16:19]
    ds_read_b128 v[100:103], v232 offset:12288
    v_mfma_f32_16x16x32_bf16 v[20:23], a[220:223], v[140:143], v[20:23]
    v_mfma_f32_16x16x32_bf16 v[24:27], a[224:227], v[136:139], v[24:27]
    ds_read_b128 v[104:107], v232 offset:13312
    v_mfma_f32_16x16x32_bf16 v[28:31], a[224:227], v[140:143], v[28:31]
    v_mfma_f32_16x16x32_bf16 v[32:35], a[228:231], v[136:139], v[32:35]
    ds_read_b128 v[108:111], v232 offset:14336
    v_mfma_f32_16x16x32_bf16 v[36:39], a[228:231], v[140:143], v[36:39]
    s_waitcnt lgkmcnt(6)
    v_mfma_f32_16x16x32_bf16 v[0:3], a[232:235], v[144:147], v[0:3]
    ds_read_b128 a[192:195], v232 offset:40960
    v_mfma_f32_16x16x32_bf16 v[4:7], a[232:235], v[148:151], v[4:7]
    global_store_dwordx4 v239, v[72:75], s[94:95] offset:-4096 sc1
    v_mfma_f32_16x16x32_bf16 v[8:11], a[236:239], v[144:147], v[8:11]
    ds_read_b128 a[196:199], v232 offset:41984
    v_mfma_f32_16x16x32_bf16 v[12:15], a[236:239], v[148:151], v[12:15]
    v_mfma_f32_16x16x32_bf16 v[16:19], a[240:243], v[144:147], v[16:19]
    ds_read_b128 a[200:203], v232 offset:43008
    v_mfma_f32_16x16x32_bf16 v[20:23], a[240:243], v[148:151], v[20:23]
    v_mfma_f32_16x16x32_bf16 v[24:27], a[244:247], v[144:147], v[24:27]
    ds_read_b128 a[204:207], v232 offset:44032
    v_mfma_f32_16x16x32_bf16 v[28:31], a[244:247], v[148:151], v[28:31]
    s_waitcnt lgkmcnt(7)
    v_mfma_f32_16x16x32_bf16 v[32:35], a[248:251], v[144:147], v[32:35]
    ds_read_b128 a[208:211], v232 offset:45056
    v_mfma_f32_16x16x32_bf16 v[36:39], a[248:251], v[148:151], v[36:39]
    v_mfma_f32_16x16x32_bf16 v[0:3], a[252:255], v[152:155], v[0:3]
    ds_read_b128 a[212:215], v232 offset:51200
    v_mfma_f32_16x16x32_bf16 v[4:7], a[252:255], v[156:159], v[4:7]
    v_mfma_f32_16x16x32_bf16 v[8:11], v[96:99], v[152:155], v[8:11]
    ds_read_b128 a[216:219], v232 offset:52224
    v_mfma_f32_16x16x32_bf16 v[12:15], v[96:99], v[156:159], v[12:15]
    global_store_dwordx4 v239, v[76:79], s[94:95] offset:-3072 sc1
    s_waitcnt lgkmcnt(7)
    v_mfma_f32_16x16x32_bf16 v[16:19], v[100:103], v[152:155], v[16:19]
    ds_read_b128 a[220:223], v232 offset:53248
    v_mfma_f32_16x16x32_bf16 v[20:23], v[100:103], v[156:159], v[20:23]
    v_mfma_f32_16x16x32_bf16 v[24:27], v[104:107], v[152:155], v[24:27]
    ds_read_b128 a[224:227], v232 offset:54272
    v_mfma_f32_16x16x32_bf16 v[28:31], v[104:107], v[156:159], v[28:31]
    v_mfma_f32_16x16x32_bf16 v[32:35], v[108:111], v[152:155], v[32:35]
    ds_read_b128 a[228:231], v232 offset:55296
    v_mfma_f32_16x16x32_bf16 v[36:39], v[108:111], v[156:159], v[36:39]
    s_waitcnt lgkmcnt(6)
    v_mfma_f32_16x16x32_bf16 v[0:3], a[192:195], v[160:163], v[0:3]
    ds_read_b128 a[232:235], v233 offset:0
    v_mfma_f32_16x16x32_bf16 v[4:7], a[192:195], v[164:167], v[4:7]
    v_mfma_f32_16x16x32_bf16 v[8:11], a[196:199], v[160:163], v[8:11]
    ds_read_b128 a[236:239], v233 offset:1024
    v_mfma_f32_16x16x32_bf16 v[12:15], a[196:199], v[164:167], v[12:15]
    v_mfma_f32_16x16x32_bf16 v[16:19], a[200:203], v[160:163], v[16:19]
    ds_read_b128 a[240:243], v233 offset:2048
    v_mfma_f32_16x16x32_bf16 v[20:23], a[200:203], v[164:167], v[20:23]
    v_mfma_f32_16x16x32_bf16 v[24:27], a[204:207], v[160:163], v[24:27]
    ds_read_b128 a[244:247], v233 offset:3072
    v_mfma_f32_16x16x32_bf16 v[28:31], a[204:207], v[164:167], v[28:31]
    s_waitcnt lgkmcnt(7)
    v_mfma_f32_16x16x32_bf16 v[32:35], a[208:211], v[160:163], v[32:35]
    ds_read_b128 a[248:251], v233 offset:4096
    v_mfma_f32_16x16x32_bf16 v[36:39], a[208:211], v[164:167], v[36:39]
    v_mfma_f32_16x16x32_bf16 v[0:3], a[212:215], v[168:171], v[0:3]
    ds_read_b128 a[252:255], v233 offset:10240
    v_mfma_f32_16x16x32_bf16 v[4:7], a[212:215], v[172:175], v[4:7]
    v_mfma_f32_16x16x32_bf16 v[8:11], a[216:219], v[168:171], v[8:11]
    ds_read_b128 v[96:99], v233 offset:11264
    v_mfma_f32_16x16x32_bf16 v[12:15], a[216:219], v[172:175], v[12:15]
    s_waitcnt lgkmcnt(7)
    v_mfma_f32_16x16x32_bf16 v[16:19], a[220:223], v[168:171], v[16:19]
    ds_read_b128 v[100:103], v233 offset:12288
    v_mfma_f32_16x16x32_bf16 v[20:23], a[220:223], v[172:175], v[20:23]
    v_mfma_f32_16x16x32_bf16 v[24:27], a[224:227], v[168:171], v[24:27]
    ds_read_b128 v[104:107], v233 offset:13312
    v_mfma_f32_16x16x32_bf16 v[28:31], a[224:227], v[172:175], v[28:31]
    v_mfma_f32_16x16x32_bf16 v[32:35], a[228:231], v[168:171], v[32:35]
    ds_read_b128 v[108:111], v233 offset:14336
    v_mfma_f32_16x16x32_bf16 v[36:39], a[228:231], v[172:175], v[36:39]
    s_waitcnt lgkmcnt(6)
    v_mfma_f32_16x16x32_bf16 v[0:3], a[232:235], v[176:179], v[0:3]
    v_mfma_f32_16x16x32_bf16 v[4:7], a[232:235], v[180:183], v[4:7]
    global_load_dwordx4 v[80:83], v212, s[94:95] offset:-4096 sc1
    v_mfma_f32_16x16x32_bf16 v[8:11], a[236:239], v[176:179], v[8:11]
    v_mfma_f32_16x16x32_bf16 v[12:15], a[236:239], v[180:183], v[12:15]
    global_load_dwordx4 v[84:87], v212, s[94:95] offset:-3072 sc1
    v_mfma_f32_16x16x32_bf16 v[16:19], a[240:243], v[176:179], v[16:19]
    v_mfma_f32_16x16x32_bf16 v[20:23], a[240:243], v[180:183], v[20:23]
    global_load_dwordx4 v[88:91], v212, s[94:95] offset:-2048 sc1
    v_mfma_f32_16x16x32_bf16 v[24:27], a[244:247], v[176:179], v[24:27]
    v_mfma_f32_16x16x32_bf16 v[28:31], a[244:247], v[180:183], v[28:31]
    global_load_dwordx4 v[92:95], v212, s[94:95] offset:-1024 sc1
    s_waitcnt lgkmcnt(3)
    v_mfma_f32_16x16x32_bf16 v[32:35], a[248:251], v[176:179], v[32:35]
    v_mfma_f32_16x16x32_bf16 v[36:39], a[248:251], v[180:183], v[36:39]
    global_load_dwordx4 v[112:115], v212, s[94:95] offset:0 sc1
    v_mfma_f32_16x16x32_bf16 v[0:3], a[252:255], v[184:187], v[0:3]
    v_mfma_f32_16x16x32_bf16 v[4:7], a[252:255], v[188:191], v[4:7]
    global_load_dwordx4 v[116:119], v212, s[94:95] offset:1024 sc1
    v_mfma_f32_16x16x32_bf16 v[8:11], v[96:99], v[184:187], v[8:11]
    v_mfma_f32_16x16x32_bf16 v[12:15], v[96:99], v[188:191], v[12:15]
    global_load_dwordx4 v[120:123], v212, s[94:95] offset:2048 sc1
    s_waitcnt lgkmcnt(0)
    v_mfma_f32_16x16x32_bf16 v[16:19], v[100:103], v[184:187], v[16:19]
    v_mfma_f32_16x16x32_bf16 v[20:23], v[100:103], v[188:191], v[20:23]
    global_load_dwordx4 v[124:127], v212, s[94:95] offset:3072 sc1
    v_mfma_f32_16x16x32_bf16 v[24:27], v[104:107], v[184:187], v[24:27]
    v_mfma_f32_16x16x32_bf16 v[28:31], v[104:107], v[188:191], v[28:31]
    global_load_dwordx4 v[196:199], v213, s[94:95] offset:-4096 sc1
    v_mfma_f32_16x16x32_bf16 v[32:35], v[108:111], v[184:187], v[32:35]
    v_mfma_f32_16x16x32_bf16 v[36:39], v[108:111], v[188:191], v[36:39]
    global_load_dwordx4 v[200:203], v213, s[94:95] offset:-3072 sc1
    s_branch K1_EXW
K1_EXL:
    global_load_dwordx4 v[80:83], v212, s[94:95] offset:-4096 sc1
    global_load_dwordx4 v[84:87], v212, s[94:95] offset:-3072 sc1
    global_load_dwordx4 v[88:91], v212, s[94:95] offset:-2048 sc1
    global_load_dwordx4 v[92:95], v212, s[94:95] offset:-1024 sc1
    global_load_dwordx4 v[112:115], v212, s[94:95] offset:0 sc1
    global_load_dwordx4 v[116:119], v212, s[94:95] offset:1024 sc1
    global_load_dwordx4 v[120:123], v212, s[94:95] offset:2048 sc1
    global_load_dwordx4 v[124:127], v212, s[94:95] offset:3072 sc1
    global_load_dwordx4 v[196:199], v213, s[94:95] offset:-4096 sc1
    global_load_dwordx4 v[200:203], v213, s[94:95] offset:-3072 sc1
K1_EXW:
    s_waitcnt vmcnt(0)
    v_max3_u32 v214, v80, v81, v82
    v_max3_u32 v215, v83, v84, v85
    v_max3_u32 v215, v215, v86, v87
    v_max3_u32 v214, v214, v88, v89
    v_max3_u32 v215, v215, v90, v91
    v_max3_u32 v214, v214, v92, v93
    v_max3_u32 v215, v215, v94, v95
    v_max3_u32 v214, v214, v112, v113
    v_max3_u32 v215, v215, v114, v115
    v_max3_u32 v214, v214, v116, v117
    v_max3_u32 v215, v215, v118, v119
    v_max3_u32 v214, v214, v120, v121
    v_max3_u32 v215, v215, v122, v123
    v_max3_u32 v214, v214, v124, v125
    v_max3_u32 v215, v215, v126, v127
    v_max3_u32 v214, v214, v196, v197
    v_max3_u32 v215, v215, v198, v199
    v_max3_u32 v214, v214, v200, v201
    v_max3_u32 v215, v215, v202, v203
    v_max_u32 v214, v214, v215
    v_cmp_eq_u32 vcc, -1, v214
    s_sub_u32 s51, s51, 1
    s_cselect_b64 vcc, 0, vcc
    s_cmp_lg_u64 vcc, 0
    s_cbranch_scc1 K1_EXL
    v_lshrrev_b32 v216, 4, v204
    v_lshlrev_b32 v217, 3, v216
    v_sub_u32 v217, v237, v217
    v_lshrrev_b32 v218, 1, v216
    v_lshl_add_u32 v217, v218, 4, v217
    v_and_b32 v216, 1, v216
    v_lshl_add_u32 v218, v216, 5, v217
    v_mul_u32_u24 v216, 40960, v216
    v_add_u32 v219, v216, v217
    s_mov_b32 s101, 40960
    v_pk_add_f32 v[0:1], v[0:1], v[80:81]
    v_pk_add_f32 v[2:3], v[2:3], v[82:83]
    v_pk_add_f32 v[8:9], v[8:9], v[88:89]
    v_pk_add_f32 v[10:11], v[10:11], v[90:91]
    v_cvt_pk_bf16_f32 v0, v0, v1
    v_cvt_pk_bf16_f32 v1, v2, v3
    v_cvt_pk_bf16_f32 v2, v8, v9
    v_cvt_pk_bf16_f32 v3, v10, v11
    s_nop 1
    v_permlane16_swap_b32 v0, v2
    v_permlane16_swap_b32 v1, v3
    s_nop 1
    buffer_store_dwordx4 v[0:3], v218, s[24:27], 0 offen offset:0 sc1
    v_pk_add_f32 v[4:5], v[4:5], v[84:85]
    v_pk_add_f32 v[6:7], v[6:7], v[86:87]
    v_pk_add_f32 v[12:13], v[12:13], v[92:93]
    v_pk_add_f32 v[14:15], v[14:15], v[94:95]
    v_cvt_pk_bf16_f32 v4, v4, v5
    v_cvt_pk_bf16_f32 v5, v6, v7
    v_cvt_pk_bf16_f32 v6, v12, v13
    v_cvt_pk_bf16_f32 v7, v14, v15
    s_nop 1
    v_permlane16_swap_b32 v4, v6
    v_permlane16_swap_b32 v5, v7
    s_nop 1
    buffer_store_dwordx4 v[4:7], v218, s[24:27], s101 offen offset:0 sc1
    v_pk_add_f32 v[16:17], v[16:17], v[112:113]
    v_pk_add_f32 v[18:19], v[18:19], v[114:115]
    v_pk_add_f32 v[24:25], v[24:25], v[120:121]
    v_pk_add_f32 v[26:27], v[26:27], v[122:123]
    v_cvt_pk_bf16_f32 v16, v16, v17
    v_cvt_pk_bf16_f32 v17, v18, v19
    v_cvt_pk_bf16_f32 v18, v24, v25
    v_cvt_pk_bf16_f32 v19, v26, v27
    s_nop 1
    v_permlane16_swap_b32 v16, v18
    v_permlane16_swap_b32 v17, v19
    s_nop 1
    buffer_store_dwordx4 v[16:19], v218, s[24:27], 0 offen offset:64 sc1
    v_pk_add_f32 v[20:21], v[20:21], v[116:117]
    v_pk_add_f32 v[22:23], v[22:23], v[118:119]
    v_pk_add_f32 v[28:29], v[28:29], v[124:125]
    v_pk_add_f32 v[30:31], v[30:31], v[126:127]
    v_cvt_pk_bf16_f32 v20, v20, v21
    v_cvt_pk_bf16_f32 v21, v22, v23
    v_cvt_pk_bf16_f32 v22, v28, v29
    v_cvt_pk_bf16_f32 v23, v30, v31
    s_nop 1
    v_permlane16_swap_b32 v20, v22
    v_permlane16_swap_b32 v21, v23
    s_nop 1
    buffer_store_dwordx4 v[20:23], v218, s[24:27], s101 offen offset:64 sc1
    v_pk_add_f32 v[32:33], v[32:33], v[196:197]
    v_pk_add_f32 v[34:35], v[34:35], v[198:199]
    v_pk_add_f32 v[36:37], v[36:37], v[200:201]
    v_pk_add_f32 v[38:39], v[38:39], v[202:203]
    v_cvt_pk_bf16_f32 v32, v32, v33
    v_cvt_pk_bf16_f32 v33, v34, v35
    v_cvt_pk_bf16_f32 v34, v36, v37
    v_cvt_pk_bf16_f32 v35, v38, v39
    s_nop 1
    v_permlane16_swap_b32 v32, v34
    v_permlane16_swap_b32 v33, v35
    s_nop 1
    buffer_store_dwordx4 v[32:35], v219, s[24:27], 0 offen offset:128 sc1
K1_END:
    s_endpgm
.section .rodata,"a"
.p2align 6
.amdhsa_kernel attn_kernel
  .amdhsa_next_free_vgpr 512
  .amdhsa_next_free_sgpr 102
  .amdhsa_accum_offset 256
  .amdhsa_group_segment_fixed_size 0
  .amdhsa_kernarg_size 104
  .amdhsa_user_sgpr_count 2
  .amdhsa_user_sgpr_kernarg_segment_ptr 1
  .amdhsa_system_sgpr_workgroup_id_x 1
.end_amdhsa_kernel
```
